```python
import torch

def _softmax(x, axis=-1):
    return torch.softmax(x, dim=axis)
def _gelu(x):
    return torch.nn.functional.gelu(x, approximate="tanh")
def _silu(x):
    return torch.nn.functional.silu(x)
def _sigmoid(x):
    return torch.sigmoid(x)
def _layernorm(x, axis=-1, eps=1e-5):
    m = x.mean(dim=axis, keepdim=True)
    v = x.var(dim=axis, keepdim=True, unbiased=False)
    return (x - m) / torch.sqrt(v + eps)
def _scatter_add(tgt, idx, src, axis=0):
    return tgt.clone().index_add_(axis, idx, src)
def _segment_sum(src, seg, n):
    out = torch.zeros((n,) + src.shape[1:], dtype=src.dtype)
    return out.index_add_(0, seg, src)
def _pad(x, pw):
    flat = tuple(v for pair in reversed(pw) for v in pair)
    return torch.nn.functional.pad(x, flat)

kernel_name = 'recurrent_scan__linear_kernel_hedgehog__dense_activation_silu__prompt'

def setup_inputs():

    _w = (lambda a: (lambda t: t.to(torch.bfloat16) if t.is_floating_point() else t)(torch.as_tensor(a)))
    def _A_setup():
        B, S, D, H = 1, 2048, 576, 32
        Dh = D // H
        return {
            "x": _w((lambda *s: torch.randn(*s, dtype=torch.bfloat16) * 0.05)(B, S, D)),
            "wqkv": _w((lambda *s: torch.randn(*s, dtype=torch.bfloat16) * 0.4)(D, 3 * D)),
            "w_phi": _w((lambda *s: torch.randn(*s, dtype=torch.bfloat16) * 0.4)(H, Dh, Dh) * (Dh ** -0.5)),
            "wo": _w((lambda *s: torch.randn(*s, dtype=torch.bfloat16) * 0.2)(D, D)),
        }
    _A_in = _A_setup()

    def _B_setup():
        B, S, D, F = 1, 2048, 576, 4608
        return {
            "x": _w((lambda *s: torch.randn(*s, dtype=torch.bfloat16) * 0.05)(B, S, D)),
            "w1": _w((lambda *s: torch.randn(*s, dtype=torch.bfloat16) * 0.4)(D, F) * (D ** -0.5)),
            "w2": _w((lambda *s: torch.randn(*s, dtype=torch.bfloat16) * 0.1)(F, D) * (F ** -0.5)),
        }
    _B_in = _B_setup()

    return {
        "A_x": _A_in["x"],
        "A_wqkv": _A_in["wqkv"],
        "A_w_phi": _A_in["w_phi"],
        "A_wo": _A_in["wo"],
        "B_x": _B_in["x"],
        "B_w1": _B_in["w1"],
        "B_w2": _B_in["w2"],
    }

def reference(A_x, A_wqkv, A_w_phi, A_wo, B_x, B_w1, B_w2):
    def _A_ref(x, wqkv, w_phi, wo):
        B, S, D = x.shape
        H = 32; Dh = D // H
        qkv = (lambda x, *d: x.permute(*d))((x @ wqkv).reshape(B, S, 3, H, Dh), 2, 0, 3, 1, 4)
        q, k, v = qkv[0], qkv[1], qkv[2]
        pq = torch.einsum("bhsd,hdf->bhsf", q, w_phi)
        pk = torch.einsum("bhsd,hdf->bhsf", k, w_phi)
        phi_q = torch.concatenate([_softmax(pq, axis=-1), _softmax(-pq, axis=-1)], axis=-1)
        phi_k = torch.concatenate([_softmax(pk, axis=-1), _softmax(-pk, axis=-1)], axis=-1)
        kv = torch.einsum("bhsf,bhsd->bhfd", phi_k, v)
        z  = torch.einsum("bhsf->bhf", phi_k)
        num = torch.einsum("bhqf,bhfd->bhqd", phi_q, kv)
        den = torch.einsum("bhqf,bhf->bhq", phi_q, z)[..., None] + 1e-6
        o = num / den
        return (lambda x, *d: x.permute(*d))(o, 0, 2, 1, 3).reshape(B, S, D) @ wo

    def _B_ref(x, w1, w2):
        h = torch.einsum("bsd,df->bsf", x, w1)
        h = _silu(h)
        out = torch.einsum("bsf,fd->bsd", h, w2)
        return out

    x = A_x
    xn = _layernorm(x, axis=-1)
    s = _A_ref(xn, A_wqkv, A_w_phi, A_wo)
    g = _silu(_B_ref(xn, B_w1, B_w2))
    return x + s * g
```

```asm
; @launch grid=(256,1,1) block=(256,1,1) lds=163840
.amdgcn_target "amdgcn-amd-amdhsa--gfx950"
.text
.globl recurrent_scan__linear_kernel_hedgehog__dense_activation_silu__prompt_kernel
.p2align 8
.type recurrent_scan__linear_kernel_hedgehog__dense_activation_silu__prompt_kernel,@function
recurrent_scan__linear_kernel_hedgehog__dense_activation_silu__prompt_kernel:
    s_cmp_ge_u32 s2, 256
    s_cbranch_scc0 L_go
    s_endpgm
L_go:
    s_load_dwordx16 s[64:79], s[0:1], 0
    s_load_dwordx4 s[80:83], s[0:1], 64
    s_getpc_b64 s[60:61]
L_pc:
    v_lshrrev_b32 v224, 6, v0
    v_and_b32 v1, 63, v0
    v_readfirstlane_b32 s40, v224
    s_and_b32 s50, s2, 7
    s_lshr_b32 s51, s2, 3
    s_lshr_b32 s43, s50, 1
    s_and_b32 s50, s50, 1
    s_lshl_b32 s50, s50, 3
    s_and_b32 s52, s51, 7
    s_add_u32 s41, s50, s52
    s_lshr_b32 s42, s51, 3
    s_sub_u32 s42, 3, s42
    v_lshlrev_b32 v14, 4, v1
    v_lshlrev_b32 v229, 4, v0
    s_cmp_eq_u32 s42, 3
    s_cselect_b32 s50, L_tab1-L_tab0, 0
    s_add_u32 s50, s50, L_tab0-L_pc+4096
    s_add_u32 s96, s60, s50
    s_addc_u32 s97, s61, 0
    v_min_u32 v230, 7, v1
    v_lshl_add_u32 v230, v224, 3, v230
    s_lshl_b32 s51, s51, 5
    v_add_u32 v230, s51, v230
    v_lshlrev_b32 v230, 7, v230
    v_min_u32 v230, L_tabend-L_pc-4, v230
    global_load_dword v231, v230, s[60:61]
    s_mul_i32 s63, s43, 3
    s_add_u32 s63, s63, s42
    s_add_u32 s50, s43, 12
    s_cmp_eq_u32 s42, 3
    s_cselect_b32 s63, s50, s63
    s_lshl_b32 s50, s41, 2
    s_add_u32 s50, s50, s40
    s_mul_i32 s44, s50, 36864
    s_mul_i32 s55, s41, 10240
    s_add_u32 s55, s55, 33390592
    s_mov_b32 s45, 0x3f803f80
    s_mov_b32 s46, 0xffff0000
    s_and_b32 s50, s41, 7
    s_mul_i32 s51, s50, 86
    s_lshr_b32 s51, s51, 8
    s_mul_i32 s51, s51, 3
    s_sub_u32 s51, s50, s51
    s_mul_i32 s51, s51, 3
    s_cmp_eq_u32 s42, 3
    s_cselect_b32 s3, s50, s51
    s_lshl_b32 s50, s3, 3
    v_lshrrev_b32 v224, 5, v1
    v_and_b32 v225, 31, v1
    v_xor_b32 v225, v225, v224
    v_mul_u32_u24 v224, 1152, v224
    v_add_u32 v225, s50, v225
    v_subrev_u32 v226, 72, v225
    v_min_u32 v226, v225, v226
    v_lshl_add_u32 v248, v226, 4, v224
    v_add_u32 v225, 32, v225
    v_subrev_u32 v226, 72, v225
    v_min_u32 v226, v225, v226
    v_lshl_add_u32 v251, v226, 4, v224
    s_sub_u32 s50, s3, 1
    s_cselect_b32 s50, 8, s50
    s_lshl_b32 s50, s50, 7
    v_lshrrev_b32 v224, 3, v1
    v_mul_u32_u24 v224, 1152, v224
    v_add_u32 v224, s50, v224
    v_and_b32 v225, 7, v1
    v_lshrrev_b32 v226, 4, v1
    v_xor_b32 v225, v225, v226
    v_lshl_add_u32 v249, v225, 4, v224
    s_and_b32 s50, s42, 1
    s_lshl_b32 s50, s50, 6
    v_xor_b32 v249, s50, v249
    v_xor_b32 v250, 64, v249
    s_mul_i32 s47, s40, 16896
    s_lshl_b32 s53, s40, 12
    s_add_u32 s50, s42, 0
    s_and_b32 s50, s50, 3
    s_mul_i32 s51, s50, 9216
    s_add_u32 s84, s44, s51
    s_mul_i32 s51, s50, 4224
    s_add_u32 s88, s47, s51
    s_lshl_b32 s51, s50, 10
    s_add_u32 s92, s53, s51
    s_add_u32 s50, s42, 1
    s_and_b32 s50, s50, 3
    s_mul_i32 s51, s50, 9216
    s_add_u32 s85, s44, s51
    s_mul_i32 s51, s50, 4224
    s_add_u32 s89, s47, s51
    s_lshl_b32 s51, s50, 10
    s_add_u32 s93, s53, s51
    s_add_u32 s50, s42, 2
    s_and_b32 s50, s50, 3
    s_mul_i32 s51, s50, 9216
    s_add_u32 s86, s44, s51
    s_mul_i32 s51, s50, 4224
    s_add_u32 s90, s47, s51
    s_lshl_b32 s51, s50, 10
    s_add_u32 s94, s53, s51
    s_add_u32 s50, s42, 3
    s_and_b32 s50, s50, 3
    s_mul_i32 s51, s50, 9216
    s_add_u32 s87, s44, s51
    s_mul_i32 s51, s50, 4224
    s_add_u32 s91, s47, s51
    s_lshl_b32 s51, s50, 10
    s_add_u32 s95, s53, s51
    s_waitcnt lgkmcnt(0)
    s_mov_b32 s8, s64
    s_mov_b32 s9, s65
    s_mov_b32 s10, 2359296
    s_mov_b32 s11, 0x20000
    s_add_u32 m0, s88, 6144
    s_nop 0
    buffer_load_dwordx4 v248, s[8:11], s84 offen offset:0 lds
    s_add_u32 m0, s88, 4896
    s_nop 0
    buffer_load_dwordx4 v248, s[8:11], s84 offen offset:2304 lds
    s_add_u32 m0, s88, 8256
    s_add_u32 s54, s84, 4608
    buffer_load_dwordx4 v248, s[8:11], s54 offen offset:0 lds
    s_add_u32 m0, s88, 7008
    s_nop 0
    buffer_load_dwordx4 v248, s[8:11], s54 offen offset:2304 lds
    s_add_u32 m0, s88, 73728
    s_nop 0
    buffer_load_dwordx4 v251, s[8:11], s84 offen offset:0 lds
    s_add_u32 m0, s88, 72480
    s_nop 0
    buffer_load_dwordx4 v251, s[8:11], s84 offen offset:2304 lds
    s_add_u32 m0, s88, 75840
    s_add_u32 s54, s84, 4608
    buffer_load_dwordx4 v251, s[8:11], s54 offen offset:0 lds
    s_add_u32 m0, s88, 74592
    s_nop 0
    buffer_load_dwordx4 v251, s[8:11], s54 offen offset:2304 lds
    s_add_u32 m0, s92, 141312
    s_nop 0
    buffer_load_dwordx4 v249, s[8:11], s84 offen lds
    global_load_dwordx4 v[2:5], v14, s[96:97] offset:-4096
    global_load_dwordx4 v[6:9], v14, s[96:97] offset:-3072
    global_load_dwordx4 v[10:13], v14, s[96:97] offset:-2048
    s_mov_b32 s24, s66
    s_mov_b32 s25, s67
    s_mov_b32 s26, 1990656
    s_mov_b32 s27, 0x20000
    s_mov_b32 s28, s68
    s_mov_b32 s29, s69
    s_mov_b32 s30, 20736
    s_mov_b32 s31, 0x20000
    s_mov_b32 s32, s70
    s_mov_b32 s33, s71
    s_mov_b32 s34, 663552
    s_mov_b32 s35, 0x20000
    s_mov_b32 s12, s74
    s_mov_b32 s13, s75
    s_mov_b32 s14, 5308416
    s_mov_b32 s15, 0x20000
    s_mov_b32 s16, s76
    s_mov_b32 s17, s77
    s_mov_b32 s18, 5308416
    s_mov_b32 s19, 0x20000
    s_mov_b32 s4, s78
    s_mov_b32 s5, s79
    s_mov_b32 s6, 2359296
    s_mov_b32 s7, 0x20000
    s_mov_b32 s36, s80
    s_mov_b32 s37, s81
    s_mov_b32 s38, 256
    s_mov_b32 s39, 0x20000
    s_mov_b32 s20, s82
    s_mov_b32 s21, s83
    s_mov_b32 s22, 34603008
    s_mov_b32 s23, 0x20000
    s_and_b32 s50, s41, 3
    s_mul_i32 s50, s50, 3
    s_add_u32 s50, s50, s63
    s_cmp_ge_u32 s50, 12
    s_cselect_b32 s51, 12, 0
    s_sub_u32 s72, s50, s51
    s_cmp_eq_u32 s42, 3
    s_cselect_b32 s72, s63, s72
    v_mov_b32 v240, 0
    v_mov_b32 v241, 0
    v_mov_b32 v242, 0
    v_mov_b32 v243, 0
    s_mul_i32 s50, s40, 2560
    s_add_u32 s50, s50, s55
    s_lshl_b32 s99, s41, 4
    s_cmp_eq_u32 s72, 11
    s_cselect_b32 s50, s50, 1073741824
    s_cselect_b32 s99, s99, 1073741824
    buffer_store_dwordx4 v[240:243], v14, s[20:23], s50 offen offset:0 sc1
    buffer_store_dwordx4 v[240:243], v14, s[20:23], s50 offen offset:1024 sc1
    buffer_store_dwordx4 v[240:243], v14, s[20:23], s50 offen offset:1536 sc1
    s_cmp_eq_u32 s40, 0
    s_cselect_b32 s99, s99, 1073741824
    s_lshl_b32 s50, s40, 11
    s_add_u32 s55, s55, s50
    s_lshl_b32 s50, s72, 7
    s_add_u32 s62, s55, s50
    v_bfe_u32 v224, v1, 1, 4
    v_mul_u32_u24 v225, 1056, v224
    v_and_b32 v226, 1, v1
    v_lshl_add_u32 v225, v226, 9, v225
    v_lshrrev_b32 v227, 5, v1
    v_lshl_add_u32 v225, v227, 6, v225
    v_add_u32 v225, s47, v225
    v_lshlrev_b32 v226, 4, v226
    v_add_u32 v160, v225, v226
    v_sub_u32 v161, v225, v226
    v_add_u32 v166, 67584, v160
    v_add_u32 v167, 67584, v161
    v_and_b32 v224, 7, v224
    v_lshlrev_b32 v227, 2, v227
    v_xor_b32 v224, v224, v227
    v_and_b32 v225, 31, v1
    v_lshlrev_b32 v225, 7, v225
    v_lshl_add_u32 v225, v224, 4, v225
    v_add_u32 v225, 141312, v225
    v_add_u32 v162, s53, v225
    v_xor_b32 v163, 16, v162
    v_xor_b32 v164, 32, v162
    v_xor_b32 v165, 48, v162
    v_mov_b32 v168, 0
    v_mov_b32 v169, 0
    v_mov_b32 v170, 0
    v_mov_b32 v171, 0
    s_add_u32 m0, s89, 6144
    s_nop 0
    buffer_load_dwordx4 v248, s[8:11], s85 offen offset:0 lds
    s_add_u32 m0, s89, 4896
    s_nop 0
    buffer_load_dwordx4 v248, s[8:11], s85 offen offset:2304 lds
    s_add_u32 m0, s89, 8256
    s_add_u32 s54, s85, 4608
    buffer_load_dwordx4 v248, s[8:11], s54 offen offset:0 lds
    s_add_u32 m0, s89, 7008
    s_nop 0
    buffer_load_dwordx4 v248, s[8:11], s54 offen offset:2304 lds
    s_add_u32 m0, s90, 6144
    s_nop 0
    buffer_load_dwordx4 v248, s[8:11], s86 offen offset:0 lds
    s_add_u32 m0, s90, 4896
    s_nop 0
    buffer_load_dwordx4 v248, s[8:11], s86 offen offset:2304 lds
    s_add_u32 m0, s90, 8256
    s_add_u32 s54, s86, 4608
    buffer_load_dwordx4 v248, s[8:11], s54 offen offset:0 lds
    s_add_u32 m0, s90, 7008
    s_nop 0
    buffer_load_dwordx4 v248, s[8:11], s54 offen offset:2304 lds
    s_add_u32 m0, s91, 6144
    s_nop 0
    buffer_load_dwordx4 v248, s[8:11], s87 offen offset:0 lds
    s_add_u32 m0, s91, 4896
    s_nop 0
    buffer_load_dwordx4 v248, s[8:11], s87 offen offset:2304 lds
    s_add_u32 m0, s91, 8256
    s_add_u32 s54, s87, 4608
    buffer_load_dwordx4 v248, s[8:11], s54 offen offset:0 lds
    s_add_u32 m0, s91, 7008
    s_nop 0
    buffer_load_dwordx4 v248, s[8:11], s54 offen offset:2304 lds
    s_add_u32 m0, s89, 73728
    s_nop 0
    buffer_load_dwordx4 v251, s[8:11], s85 offen offset:0 lds
    s_add_u32 m0, s89, 72480
    s_nop 0
    buffer_load_dwordx4 v251, s[8:11], s85 offen offset:2304 lds
    s_add_u32 m0, s89, 75840
    s_add_u32 s54, s85, 4608
    buffer_load_dwordx4 v251, s[8:11], s54 offen offset:0 lds
    s_waitcnt vmcnt(3)
    ds_read_b128 v[16:19], v160 offset:6144
    ds_read_b128 v[20:23], v161 offset:6160
    ds_read_b128 v[24:27], v160 offset:6176
    ds_read_b128 v[28:31], v161 offset:6192
    s_add_u32 m0, s89, 74592
    s_nop 0
    buffer_load_dwordx4 v251, s[8:11], s54 offen offset:2304 lds
    ds_read_b128 v[32:35], v160 offset:6272
    ds_read_b128 v[36:39], v161 offset:6288
    ds_read_b128 v[40:43], v160 offset:6304
    ds_read_b128 v[44:47], v161 offset:6320
    s_add_u32 m0, s90, 73728
    s_nop 0
    buffer_load_dwordx4 v251, s[8:11], s86 offen offset:0 lds
    ds_read_b128 v[48:51], v160 offset:6400
    ds_read_b128 v[52:55], v161 offset:6416
    ds_read_b128 v[56:59], v160 offset:6432
    ds_read_b128 v[60:63], v161 offset:6448
    s_add_u32 m0, s90, 72480
    s_nop 0
    buffer_load_dwordx4 v251, s[8:11], s86 offen offset:2304 lds
    ds_read_b128 v[64:67], v160 offset:6528
    ds_read_b128 v[68:71], v161 offset:6544
    ds_read_b128 v[72:75], v160 offset:6560
    ds_read_b128 v[76:79], v161 offset:6576
    s_add_u32 m0, s90, 75840
    s_add_u32 s54, s86, 4608
    buffer_load_dwordx4 v251, s[8:11], s54 offen offset:0 lds
    s_add_u32 m0, s90, 74592
    s_nop 0
    buffer_load_dwordx4 v251, s[8:11], s54 offen offset:2304 lds
    s_waitcnt lgkmcnt(15)
    v_dot2c_f32_bf16 v168, s45, v16
    v_dot2c_f32_bf16 v170, v16, v16
    v_dot2c_f32_bf16 v169, s45, v17
    v_dot2c_f32_bf16 v171, v17, v17
    v_dot2c_f32_bf16 v168, s45, v18
    v_dot2c_f32_bf16 v170, v18, v18
    v_dot2c_f32_bf16 v169, s45, v19
    v_dot2c_f32_bf16 v171, v19, v19
    s_add_u32 m0, s91, 73728
    s_nop 0
    buffer_load_dwordx4 v251, s[8:11], s87 offen offset:0 lds
    s_waitcnt lgkmcnt(14)
    v_dot2c_f32_bf16 v168, s45, v20
    v_dot2c_f32_bf16 v170, v20, v20
    v_dot2c_f32_bf16 v169, s45, v21
    v_dot2c_f32_bf16 v171, v21, v21
    v_dot2c_f32_bf16 v168, s45, v22
    v_dot2c_f32_bf16 v170, v22, v22
    v_dot2c_f32_bf16 v169, s45, v23
    v_dot2c_f32_bf16 v171, v23, v23
    s_add_u32 m0, s91, 72480
    s_nop 0
    buffer_load_dwordx4 v251, s[8:11], s87 offen offset:2304 lds
    s_waitcnt lgkmcnt(13)
    v_dot2c_f32_bf16 v168, s45, v24
    v_dot2c_f32_bf16 v170, v24, v24
    v_dot2c_f32_bf16 v169, s45, v25
    v_dot2c_f32_bf16 v171, v25, v25
    v_dot2c_f32_bf16 v168, s45, v26
    v_dot2c_f32_bf16 v170, v26, v26
    v_dot2c_f32_bf16 v169, s45, v27
    v_dot2c_f32_bf16 v171, v27, v27
    s_add_u32 m0, s91, 75840
    s_add_u32 s54, s87, 4608
    buffer_load_dwordx4 v251, s[8:11], s54 offen offset:0 lds
    s_waitcnt lgkmcnt(12)
    v_dot2c_f32_bf16 v168, s45, v28
    v_dot2c_f32_bf16 v170, v28, v28
    v_dot2c_f32_bf16 v169, s45, v29
    v_dot2c_f32_bf16 v171, v29, v29
    v_dot2c_f32_bf16 v168, s45, v30
    v_dot2c_f32_bf16 v170, v30, v30
    v_dot2c_f32_bf16 v169, s45, v31
    v_dot2c_f32_bf16 v171, v31, v31
    s_add_u32 m0, s91, 74592
    s_nop 0
    buffer_load_dwordx4 v251, s[8:11], s54 offen offset:2304 lds
    s_waitcnt lgkmcnt(11)
    v_dot2c_f32_bf16 v168, s45, v32
    v_dot2c_f32_bf16 v170, v32, v32
    v_dot2c_f32_bf16 v169, s45, v33
    v_dot2c_f32_bf16 v171, v33, v33
    v_dot2c_f32_bf16 v168, s45, v34
    v_dot2c_f32_bf16 v170, v34, v34
    v_dot2c_f32_bf16 v169, s45, v35
    v_dot2c_f32_bf16 v171, v35, v35
    s_add_u32 m0, s93, 141312
    s_nop 0
    buffer_load_dwordx4 v250, s[8:11], s85 offen lds
    s_waitcnt lgkmcnt(10)
    v_dot2c_f32_bf16 v168, s45, v36
    v_dot2c_f32_bf16 v170, v36, v36
    v_dot2c_f32_bf16 v169, s45, v37
    v_dot2c_f32_bf16 v171, v37, v37
    v_dot2c_f32_bf16 v168, s45, v38
    v_dot2c_f32_bf16 v170, v38, v38
    v_dot2c_f32_bf16 v169, s45, v39
    v_dot2c_f32_bf16 v171, v39, v39
    s_add_u32 m0, s94, 141312
    s_nop 0
    buffer_load_dwordx4 v249, s[8:11], s86 offen lds
    s_waitcnt lgkmcnt(9)
    v_dot2c_f32_bf16 v168, s45, v40
    v_dot2c_f32_bf16 v170, v40, v40
    v_dot2c_f32_bf16 v169, s45, v41
    v_dot2c_f32_bf16 v171, v41, v41
    v_dot2c_f32_bf16 v168, s45, v42
    v_dot2c_f32_bf16 v170, v42, v42
    v_dot2c_f32_bf16 v169, s45, v43
    v_dot2c_f32_bf16 v171, v43, v43
    s_add_u32 m0, s95, 141312
    s_nop 0
    buffer_load_dwordx4 v250, s[8:11], s87 offen lds
    s_waitcnt lgkmcnt(8)
    v_dot2c_f32_bf16 v168, s45, v44
    v_dot2c_f32_bf16 v170, v44, v44
    v_dot2c_f32_bf16 v169, s45, v45
    v_dot2c_f32_bf16 v171, v45, v45
    v_dot2c_f32_bf16 v168, s45, v46
    v_dot2c_f32_bf16 v170, v46, v46
    v_dot2c_f32_bf16 v169, s45, v47
    v_dot2c_f32_bf16 v171, v47, v47
    s_waitcnt lgkmcnt(7)
    v_dot2c_f32_bf16 v168, s45, v48
    v_dot2c_f32_bf16 v170, v48, v48
    v_dot2c_f32_bf16 v169, s45, v49
    v_dot2c_f32_bf16 v171, v49, v49
    v_dot2c_f32_bf16 v168, s45, v50
    v_dot2c_f32_bf16 v170, v50, v50
    v_dot2c_f32_bf16 v169, s45, v51
    v_dot2c_f32_bf16 v171, v51, v51
    s_waitcnt lgkmcnt(6)
    v_dot2c_f32_bf16 v168, s45, v52
    v_dot2c_f32_bf16 v170, v52, v52
    v_dot2c_f32_bf16 v169, s45, v53
    v_dot2c_f32_bf16 v171, v53, v53
    v_dot2c_f32_bf16 v168, s45, v54
    v_dot2c_f32_bf16 v170, v54, v54
    v_dot2c_f32_bf16 v169, s45, v55
    v_dot2c_f32_bf16 v171, v55, v55
    s_waitcnt lgkmcnt(5)
    v_dot2c_f32_bf16 v168, s45, v56
    v_dot2c_f32_bf16 v170, v56, v56
    v_dot2c_f32_bf16 v169, s45, v57
    v_dot2c_f32_bf16 v171, v57, v57
    v_dot2c_f32_bf16 v168, s45, v58
    v_dot2c_f32_bf16 v170, v58, v58
    v_dot2c_f32_bf16 v169, s45, v59
    v_dot2c_f32_bf16 v171, v59, v59
    s_waitcnt lgkmcnt(4)
    v_dot2c_f32_bf16 v168, s45, v60
    v_dot2c_f32_bf16 v170, v60, v60
    v_dot2c_f32_bf16 v169, s45, v61
    v_dot2c_f32_bf16 v171, v61, v61
    v_dot2c_f32_bf16 v168, s45, v62
    v_dot2c_f32_bf16 v170, v62, v62
    v_dot2c_f32_bf16 v169, s45, v63
    v_dot2c_f32_bf16 v171, v63, v63
    s_waitcnt lgkmcnt(3)
    v_dot2c_f32_bf16 v168, s45, v64
    v_dot2c_f32_bf16 v170, v64, v64
    v_dot2c_f32_bf16 v169, s45, v65
    v_dot2c_f32_bf16 v171, v65, v65
    v_dot2c_f32_bf16 v168, s45, v66
    v_dot2c_f32_bf16 v170, v66, v66
    v_dot2c_f32_bf16 v169, s45, v67
    v_dot2c_f32_bf16 v171, v67, v67
    s_waitcnt lgkmcnt(2)
    v_dot2c_f32_bf16 v168, s45, v68
    v_dot2c_f32_bf16 v170, v68, v68
    v_dot2c_f32_bf16 v169, s45, v69
    v_dot2c_f32_bf16 v171, v69, v69
    v_dot2c_f32_bf16 v168, s45, v70
    v_dot2c_f32_bf16 v170, v70, v70
    v_dot2c_f32_bf16 v169, s45, v71
    v_dot2c_f32_bf16 v171, v71, v71
    s_waitcnt lgkmcnt(1)
    v_dot2c_f32_bf16 v168, s45, v72
    v_dot2c_f32_bf16 v170, v72, v72
    v_dot2c_f32_bf16 v169, s45, v73
    v_dot2c_f32_bf16 v171, v73, v73
    v_dot2c_f32_bf16 v168, s45, v74
    v_dot2c_f32_bf16 v170, v74, v74
    v_dot2c_f32_bf16 v169, s45, v75
    v_dot2c_f32_bf16 v171, v75, v75
    s_waitcnt lgkmcnt(0)
    v_dot2c_f32_bf16 v168, s45, v76
    v_dot2c_f32_bf16 v170, v76, v76
    v_dot2c_f32_bf16 v169, s45, v77
    v_dot2c_f32_bf16 v171, v77, v77
    v_dot2c_f32_bf16 v168, s45, v78
    v_dot2c_f32_bf16 v170, v78, v78
    v_dot2c_f32_bf16 v169, s45, v79
    v_dot2c_f32_bf16 v171, v79, v79
    global_load_dwordx4 a[132:135], v14, s[96:97] offset:-1024
    global_load_dwordx4 a[136:139], v14, s[96:97] offset:0
    global_load_dwordx4 a[232:235], v14, s[96:97] offset:1024
    global_load_dwordx4 a[236:239], v14, s[96:97] offset:2048
    global_load_dwordx4 a[140:143], v14, s[96:97] offset:3072
    s_add_u32 s96, s96, 6144
    s_addc_u32 s97, s97, 0
    global_load_dwordx4 a[156:159], v14, s[96:97] offset:-2048
    global_load_dwordx4 a[160:163], v14, s[96:97] offset:-1024
    global_load_dwordx4 a[144:147], v229, s[96:97]
    s_add_u32 s96, s96, 4096
    s_addc_u32 s97, s97, 0
    global_load_dwordx4 a[148:151], v229, s[96:97]
    s_add_u32 s96, s96, 4096
    s_addc_u32 s97, s97, 0
    global_load_dwordx4 a[152:155], v229, s[96:97]
    s_cmp_eq_u32 s42, 3
    s_cbranch_scc1 L_attn
    s_mul_i32 s48, s63, 768
    s_mul_i32 s51, s40, 442368
    s_add_u32 s48, s48, s51
    s_mul_i32 s47, s40, 6144
    s_mul_i32 s50, s3, 589824
    s_add_u32 s80, s48, s50
    s_add_u32 s50, s50, 1769472
    s_cmp_ge_u32 s50, 5308416
    s_cselect_b32 s50, 0, s50
    s_add_u32 s81, s48, s50
    s_add_u32 s50, s50, 1769472
    s_cmp_ge_u32 s50, 5308416
    s_cselect_b32 s50, 0, s50
    s_add_u32 s82, s48, s50
    s_min_u32 s77, s72, 8
    s_add_u32 s77, s77, 9
    s_sub_u32 s77, s77, s3
    s_cmp_ge_u32 s77, 9
    s_cselect_b32 s50, 9, 0
    s_sub_u32 s77, s77, s50
    s_and_b32 s50, s77, 3
    s_lshl_b32 s50, s50, 7
    v_add_u32 v244, s50, v160
    v_add_u32 v245, s50, v161
    ds_read_b128 a[224:227], v244 offset:6144
    ds_read_b128 a[228:231], v245 offset:6160
    ds_read_b128 a[244:247], v244 offset:6176
    ds_read_b128 a[248:251], v245 offset:6192
    s_waitcnt lgkmcnt(0)
    s_barrier
    s_add_u32 m0, s47, 0
    s_add_u32 s54, s80, 0
    buffer_load_dwordx4 v2, s[12:15], s54 offen offset:0 lds
    buffer_load_dwordx4 v3, s[12:15], s54 offen offset:1024 lds
    buffer_load_dwordx4 v4, s[12:15], s54 offen offset:2048 lds
    v_mov_b32 v241, 1
    buffer_store_dword v241, v240, s[36:39], s99 offen sc1
    s_waitcnt vmcnt(14)
    s_cmp_lt_u32 s77, 4
    s_cbranch_scc1 L_xd
    v_add_u32 v244, 67584, v244
    v_add_u32 v245, 67584, v245
    s_cmp_eq_u32 s77, 8
    s_cbranch_scc1 L_xc
    ds_read_b128 a[224:227], v244 offset:6144
    ds_read_b128 a[228:231], v245 offset:6160
    ds_read_b128 a[244:247], v244 offset:6176
    ds_read_b128 a[248:251], v245 offset:6192
    s_branch L_xd
L_xc:
    ds_read_b128 a[224:227], v162 offset:0
    ds_read_b128 a[228:231], v163 offset:0
    ds_read_b128 a[244:247], v164 offset:0
    ds_read_b128 a[248:251], v165 offset:0
L_xd:
    ds_read_b128 v[80:83], v166 offset:6144
    ds_read_b128 v[84:87], v167 offset:6160
    ds_read_b128 v[88:91], v166 offset:6176
    ds_read_b128 v[92:95], v167 offset:6192
    ds_read_b128 v[96:99], v166 offset:6272
    ds_read_b128 v[100:103], v167 offset:6288
    ds_read_b128 v[104:107], v166 offset:6304
    ds_read_b128 v[108:111], v167 offset:6320
    ds_read_b128 v[112:115], v166 offset:6400
    ds_read_b128 v[116:119], v167 offset:6416
    ds_read_b128 v[120:123], v166 offset:6432
    ds_read_b128 v[124:127], v167 offset:6448
    ds_read_b128 v[128:131], v166 offset:6528
    ds_read_b128 v[132:135], v167 offset:6544
    ds_read_b128 v[136:139], v166 offset:6560
    ds_read_b128 v[140:143], v167 offset:6576
    ds_read_b128 v[144:147], v162
    ds_read_b128 v[148:151], v163
    ds_read_b128 v[152:155], v164
    ds_read_b128 v[156:159], v165
    s_waitcnt lgkmcnt(15)
    v_dot2c_f32_bf16 v168, s45, v80
    v_dot2c_f32_bf16 v170, v80, v80
    v_dot2c_f32_bf16 v169, s45, v81
    v_dot2c_f32_bf16 v171, v81, v81
    v_dot2c_f32_bf16 v168, s45, v82
    v_dot2c_f32_bf16 v170, v82, v82
    v_dot2c_f32_bf16 v169, s45, v83
    v_dot2c_f32_bf16 v171, v83, v83
    s_add_u32 m0, s47, 3072
    s_add_u32 s54, s80, 221184
    v_dot2c_f32_bf16 v168, s45, v84
    v_dot2c_f32_bf16 v170, v84, v84
    v_dot2c_f32_bf16 v169, s45, v85
    v_dot2c_f32_bf16 v171, v85, v85
    v_dot2c_f32_bf16 v168, s45, v86
    v_dot2c_f32_bf16 v170, v86, v86
    v_dot2c_f32_bf16 v169, s45, v87
    v_dot2c_f32_bf16 v171, v87, v87
    v_dot2c_f32_bf16 v168, s45, v88
    v_dot2c_f32_bf16 v170, v88, v88
    v_dot2c_f32_bf16 v169, s45, v89
    v_dot2c_f32_bf16 v171, v89, v89
    v_dot2c_f32_bf16 v168, s45, v90
    v_dot2c_f32_bf16 v170, v90, v90
    v_dot2c_f32_bf16 v169, s45, v91
    v_dot2c_f32_bf16 v171, v91, v91
    buffer_load_dwordx4 v2, s[12:15], s54 offen offset:0 lds
    v_dot2c_f32_bf16 v168, s45, v92
    v_dot2c_f32_bf16 v170, v92, v92
    v_dot2c_f32_bf16 v169, s45, v93
    v_dot2c_f32_bf16 v171, v93, v93
    v_dot2c_f32_bf16 v168, s45, v94
    v_dot2c_f32_bf16 v170, v94, v94
    v_dot2c_f32_bf16 v169, s45, v95
    v_dot2c_f32_bf16 v171, v95, v95
    v_dot2c_f32_bf16 v168, s45, v96
    v_dot2c_f32_bf16 v170, v96, v96
    v_dot2c_f32_bf16 v169, s45, v97
    v_dot2c_f32_bf16 v171, v97, v97
    v_dot2c_f32_bf16 v168, s45, v98
    v_dot2c_f32_bf16 v170, v98, v98
    v_dot2c_f32_bf16 v169, s45, v99
    v_dot2c_f32_bf16 v171, v99, v99
    buffer_load_dwordx4 v3, s[12:15], s54 offen offset:1024 lds
    s_waitcnt lgkmcnt(14)
    v_dot2c_f32_bf16 v168, s45, v100
    v_dot2c_f32_bf16 v170, v100, v100
    v_dot2c_f32_bf16 v169, s45, v101
    v_dot2c_f32_bf16 v171, v101, v101
    v_dot2c_f32_bf16 v168, s45, v102
    v_dot2c_f32_bf16 v170, v102, v102
    v_dot2c_f32_bf16 v169, s45, v103
    v_dot2c_f32_bf16 v171, v103, v103
    s_waitcnt lgkmcnt(13)
    v_dot2c_f32_bf16 v168, s45, v104
    v_dot2c_f32_bf16 v170, v104, v104
    v_dot2c_f32_bf16 v169, s45, v105
    v_dot2c_f32_bf16 v171, v105, v105
    v_dot2c_f32_bf16 v168, s45, v106
    v_dot2c_f32_bf16 v170, v106, v106
    v_dot2c_f32_bf16 v169, s45, v107
    v_dot2c_f32_bf16 v171, v107, v107
    buffer_load_dwordx4 v4, s[12:15], s54 offen offset:2048 lds
    s_waitcnt lgkmcnt(12)
    v_dot2c_f32_bf16 v168, s45, v108
    v_dot2c_f32_bf16 v170, v108, v108
    v_dot2c_f32_bf16 v169, s45, v109
    v_dot2c_f32_bf16 v171, v109, v109
    v_dot2c_f32_bf16 v168, s45, v110
    v_dot2c_f32_bf16 v170, v110, v110
    v_dot2c_f32_bf16 v169, s45, v111
    v_dot2c_f32_bf16 v171, v111, v111
    s_waitcnt lgkmcnt(11)
    v_dot2c_f32_bf16 v168, s45, v112
    v_dot2c_f32_bf16 v170, v112, v112
    v_dot2c_f32_bf16 v169, s45, v113
    v_dot2c_f32_bf16 v171, v113, v113
    v_dot2c_f32_bf16 v168, s45, v114
    v_dot2c_f32_bf16 v170, v114, v114
    v_dot2c_f32_bf16 v169, s45, v115
    v_dot2c_f32_bf16 v171, v115, v115
    s_waitcnt lgkmcnt(10)
    v_dot2c_f32_bf16 v168, s45, v116
    v_dot2c_f32_bf16 v170, v116, v116
    v_dot2c_f32_bf16 v169, s45, v117
    v_dot2c_f32_bf16 v171, v117, v117
    v_dot2c_f32_bf16 v168, s45, v118
    v_dot2c_f32_bf16 v170, v118, v118
    v_dot2c_f32_bf16 v169, s45, v119
    v_dot2c_f32_bf16 v171, v119, v119
    s_waitcnt lgkmcnt(9)
    v_dot2c_f32_bf16 v168, s45, v120
    v_dot2c_f32_bf16 v170, v120, v120
    v_dot2c_f32_bf16 v169, s45, v121
    v_dot2c_f32_bf16 v171, v121, v121
    v_dot2c_f32_bf16 v168, s45, v122
    v_dot2c_f32_bf16 v170, v122, v122
    v_dot2c_f32_bf16 v169, s45, v123
    v_dot2c_f32_bf16 v171, v123, v123
    s_waitcnt lgkmcnt(8)
    v_dot2c_f32_bf16 v168, s45, v124
    v_dot2c_f32_bf16 v170, v124, v124
    v_dot2c_f32_bf16 v169, s45, v125
    v_dot2c_f32_bf16 v171, v125, v125
    v_dot2c_f32_bf16 v168, s45, v126
    v_dot2c_f32_bf16 v170, v126, v126
    v_dot2c_f32_bf16 v169, s45, v127
    v_dot2c_f32_bf16 v171, v127, v127
    s_waitcnt lgkmcnt(7)
    v_dot2c_f32_bf16 v168, s45, v128
    v_dot2c_f32_bf16 v170, v128, v128
    v_dot2c_f32_bf16 v169, s45, v129
    v_dot2c_f32_bf16 v171, v129, v129
    v_dot2c_f32_bf16 v168, s45, v130
    v_dot2c_f32_bf16 v170, v130, v130
    v_dot2c_f32_bf16 v169, s45, v131
    v_dot2c_f32_bf16 v171, v131, v131
    s_waitcnt lgkmcnt(6)
    v_dot2c_f32_bf16 v168, s45, v132
    v_dot2c_f32_bf16 v170, v132, v132
    v_dot2c_f32_bf16 v169, s45, v133
    v_dot2c_f32_bf16 v171, v133, v133
    v_dot2c_f32_bf16 v168, s45, v134
    v_dot2c_f32_bf16 v170, v134, v134
    v_dot2c_f32_bf16 v169, s45, v135
    v_dot2c_f32_bf16 v171, v135, v135
    s_waitcnt lgkmcnt(5)
    v_dot2c_f32_bf16 v168, s45, v136
    v_dot2c_f32_bf16 v170, v136, v136
    v_dot2c_f32_bf16 v169, s45, v137
    v_dot2c_f32_bf16 v171, v137, v137
    v_dot2c_f32_bf16 v168, s45, v138
    v_dot2c_f32_bf16 v170, v138, v138
    v_dot2c_f32_bf16 v169, s45, v139
    v_dot2c_f32_bf16 v171, v139, v139
    s_waitcnt lgkmcnt(4)
    v_dot2c_f32_bf16 v168, s45, v140
    v_dot2c_f32_bf16 v170, v140, v140
    v_dot2c_f32_bf16 v169, s45, v141
    v_dot2c_f32_bf16 v171, v141, v141
    v_dot2c_f32_bf16 v168, s45, v142
    v_dot2c_f32_bf16 v170, v142, v142
    v_dot2c_f32_bf16 v169, s45, v143
    v_dot2c_f32_bf16 v171, v143, v143
    s_waitcnt lgkmcnt(3)
    v_dot2c_f32_bf16 v168, s45, v144
    v_dot2c_f32_bf16 v170, v144, v144
    v_dot2c_f32_bf16 v169, s45, v145
    v_dot2c_f32_bf16 v171, v145, v145
    v_dot2c_f32_bf16 v168, s45, v146
    v_dot2c_f32_bf16 v170, v146, v146
    v_dot2c_f32_bf16 v169, s45, v147
    v_dot2c_f32_bf16 v171, v147, v147
    s_waitcnt lgkmcnt(2)
    v_dot2c_f32_bf16 v168, s45, v148
    v_dot2c_f32_bf16 v170, v148, v148
    v_dot2c_f32_bf16 v169, s45, v149
    v_dot2c_f32_bf16 v171, v149, v149
    v_dot2c_f32_bf16 v168, s45, v150
    v_dot2c_f32_bf16 v170, v150, v150
    v_dot2c_f32_bf16 v169, s45, v151
    v_dot2c_f32_bf16 v171, v151, v151
    s_waitcnt lgkmcnt(1)
    v_dot2c_f32_bf16 v168, s45, v152
    v_dot2c_f32_bf16 v170, v152, v152
    v_dot2c_f32_bf16 v169, s45, v153
    v_dot2c_f32_bf16 v171, v153, v153
    v_dot2c_f32_bf16 v168, s45, v154
    v_dot2c_f32_bf16 v170, v154, v154
    v_dot2c_f32_bf16 v169, s45, v155
    v_dot2c_f32_bf16 v171, v155, v155
    s_waitcnt lgkmcnt(0)
    v_dot2c_f32_bf16 v168, s45, v156
    v_dot2c_f32_bf16 v170, v156, v156
    v_dot2c_f32_bf16 v169, s45, v157
    v_dot2c_f32_bf16 v171, v157, v157
    v_dot2c_f32_bf16 v168, s45, v158
    v_dot2c_f32_bf16 v170, v158, v158
    v_dot2c_f32_bf16 v169, s45, v159
    v_dot2c_f32_bf16 v171, v159, v159
    s_nop 1
    v_add_f32 v172, v168, v169
    v_add_f32 v174, v170, v171
    v_mov_b32 v173, v172
    v_mov_b32 v175, v174
    s_nop 0
    v_permlane32_swap_b32 v172, v173
    v_add_f32 v172, v172, v173
    v_mul_f32 v172, 0xbae38e39, v172
    v_cvt_pk_bf16_f32 v173, v172, v172
    v_and_b32 v173, s46, v173
    v_mov_b32 v224, v173
    v_mov_b32 v225, v173
    v_mov_b32 v226, v173
    v_mov_b32 v227, v173
    v_mov_b32 v228, v173
    v_mov_b32 v229, v173
    v_mov_b32 v230, v173
    v_mov_b32 v231, v173
    v_mov_b32 v232, v173
    v_mov_b32 v233, v173
    v_mov_b32 v234, v173
    v_mov_b32 v235, v173
    v_mov_b32 v236, v173
    v_mov_b32 v237, v173
    v_mov_b32 v238, v173
    v_mov_b32 v239, v173
    s_waitcnt vmcnt(7)
    s_nop 0
    v_mfma_f32_32x32x16_bf16 v[192:207], a[232:235], v[16:19], v[224:239]
    v_permlane32_swap_b32 v174, v175
    v_add_f32 v174, v174, v175
    v_mul_f32 v174, 0x3ae38e39, v174
    v_fma_f32 v174, -v172, v172, v174
    v_mfma_f32_32x32x16_bf16 v[192:207], a[236:239], v[20:23], v[192:207]
    v_max_f32 v174, 0, v174
    v_cvt_pk_bf16_f32 v174, v174, v174
    v_and_b32 v174, s46, v174
    v_add_f32 v174, 0x3727c5ac, v174
    v_mfma_f32_32x32x16_bf16 v[208:223], a[232:235], v[24:27], v[224:239]
    s_nop 6
    v_cvt_pk_bf16_f32 v16, v192, v193
    v_cvt_pk_bf16_f32 v17, v194, v195
    v_cvt_pk_bf16_f32 v18, v196, v197
    v_cvt_pk_bf16_f32 v19, v198, v199
    v_mfma_f32_32x32x16_bf16 v[208:223], a[236:239], v[28:31], v[208:223]
    v_cvt_pk_bf16_f32 v20, v200, v201
    v_cvt_pk_bf16_f32 v21, v202, v203
    v_cvt_pk_bf16_f32 v22, v204, v205
    v_cvt_pk_bf16_f32 v23, v206, v207
    s_add_u32 m0, s47, 24576
    s_add_u32 s54, s81, 0
    v_mfma_f32_32x32x16_bf16 v[192:207], a[232:235], v[32:35], v[224:239]
    s_nop 4
    v_cvt_pk_bf16_f32 v24, v208, v209
    v_cvt_pk_bf16_f32 v25, v210, v211
    v_cvt_pk_bf16_f32 v26, v212, v213
    v_cvt_pk_bf16_f32 v27, v214, v215
    v_mfma_f32_32x32x16_bf16 v[192:207], a[236:239], v[36:39], v[192:207]
    v_cvt_pk_bf16_f32 v28, v216, v217
    v_cvt_pk_bf16_f32 v29, v218, v219
    v_cvt_pk_bf16_f32 v30, v220, v221
    v_cvt_pk_bf16_f32 v31, v222, v223
    v_cvt_pk_bf16_f32 v174, v174, v174
    v_and_b32 v174, s46, v174
    v_sqrt_f32 v174, v174
    s_nop 0
    v_cvt_pk_bf16_f32 v174, v174, v174
    v_and_b32 v255, s46, v174
    v_rcp_f32 v174, v255
    s_nop 0
    v_mul_f32 v254, 0x3fb8aa3b, v174
    v_accvgpr_write_b32 a241, v254
    v_sub_f32 v255, 0, v254
    v_cvt_pk_bf16_f32 v32, v192, v193
    v_cvt_pk_bf16_f32 v33, v194, v195
    v_cvt_pk_bf16_f32 v34, v196, v197
    v_cvt_pk_bf16_f32 v35, v198, v199
    v_cvt_pk_bf16_f32 v36, v200, v201
    v_cvt_pk_bf16_f32 v37, v202, v203
    v_cvt_pk_bf16_f32 v38, v204, v205
    v_cvt_pk_bf16_f32 v39, v206, v207
    s_waitcnt vmcnt(0)
    s_barrier
    ds_read_b64_tr_b16 a[168:169], v8 offset:0
    ds_read_b64_tr_b16 a[170:171], v8 offset:512
    ds_read_b64_tr_b16 a[172:173], v11 offset:0
    ds_read_b64_tr_b16 a[174:175], v11 offset:512
    ds_read_b64_tr_b16 a[176:177], v8 offset:1024
    ds_read_b64_tr_b16 a[178:179], v8 offset:1536
    ds_read_b64_tr_b16 a[180:181], v11 offset:1024
    ds_read_b64_tr_b16 a[182:183], v11 offset:1536
    s_waitcnt lgkmcnt(4)
    v_mfma_f32_32x32x16_bf16 v[208:223], a[232:235], v[40:43], v[224:239]
    ds_read_b64_tr_b16 a[192:193], v8 offset:2048
    ds_read_b64_tr_b16 a[194:195], v8 offset:2560
    buffer_load_dwordx4 v2, s[12:15], s54 offen offset:0 lds
    v_mfma_f32_32x32x16_bf16 v[208:223], a[236:239], v[44:47], v[208:223]
    ds_read_b64_tr_b16 a[196:197], v11 offset:2048
    ds_read_b64_tr_b16 a[198:199], v11 offset:2560
    buffer_load_dwordx4 v3, s[12:15], s54 offen offset:1024 lds
    v_mfma_f32_32x32x16_bf16 v[160:175], a[168:171], v[16:19], 0
    ds_read_b64_tr_b16 a[200:201], v8 offset:3072
    ds_read_b64_tr_b16 a[202:203], v8 offset:3584
    buffer_load_dwordx4 v4, s[12:15], s54 offen offset:2048 lds
    s_mul_i32 s49, s63, 442368
    v_mfma_f32_32x32x16_bf16 v[176:191], a[172:175], v[16:19], 0
    ds_read_b64_tr_b16 a[204:205], v11 offset:3072
    ds_read_b64_tr_b16 a[206:207], v11 offset:3584
    s_add_u32 m0, s47, 27648
    s_add_u32 s54, s81, 221184
    s_waitcnt lgkmcnt(8)
    v_mfma_f32_32x32x16_bf16 v[160:175], a[176:179], v[20:23], v[160:175]
    buffer_load_dwordx4 v2, s[12:15], s54 offen offset:0 lds
    s_mul_i32 s51, s40, 55296
    v_cvt_pk_bf16_f32 v40, v208, v209
    v_cvt_pk_bf16_f32 v41, v210, v211
    v_mfma_f32_32x32x16_bf16 v[176:191], a[180:183], v[20:23], v[176:191]
    s_add_u32 s49, s49, s51
    v_cvt_pk_bf16_f32 v42, v212, v213
    v_cvt_pk_bf16_f32 v43, v214, v215
    v_mfma_f32_32x32x16_bf16 v[192:207], a[232:235], v[48:51], v[224:239]
    ds_read_b64_tr_b16 a[168:169], v8 offset:8192
    ds_read_b64_tr_b16 a[170:171], v8 offset:8704
    buffer_load_dwordx4 v3, s[12:15], s54 offen offset:1024 lds
    v_cvt_pk_bf16_f32 v44, v216, v217
    v_cvt_pk_bf16_f32 v45, v218, v219
    v_mfma_f32_32x32x16_bf16 v[192:207], a[236:239], v[52:55], v[192:207]
    ds_read_b64_tr_b16 a[172:173], v11 offset:8192
    ds_read_b64_tr_b16 a[174:175], v11 offset:8704
    s_add_u32 s50, s72, 1
    v_cvt_pk_bf16_f32 v46, v220, v221
    v_cvt_pk_bf16_f32 v47, v222, v223
    s_waitcnt lgkmcnt(4)
    v_mfma_f32_32x32x16_bf16 v[160:175], a[192:195], v[24:27], v[160:175]
    ds_read_b64_tr_b16 a[176:177], v8 offset:9216
    ds_read_b64_tr_b16 a[178:179], v8 offset:9728
    buffer_load_dwordx4 v4, s[12:15], s54 offen offset:2048 lds
    v_mfma_f32_32x32x16_bf16 v[176:191], a[196:199], v[24:27], v[176:191]
    ds_read_b64_tr_b16 a[180:181], v11 offset:9216
    ds_read_b64_tr_b16 a[182:183], v11 offset:9728
    s_add_u32 m0, s47, 49152
    s_add_u32 s54, s82, 0
    s_sub_u32 s51, s72, 9
    v_mfma_f32_32x32x16_bf16 v[160:175], a[200:203], v[28:31], v[160:175]
    buffer_load_dwordx4 v2, s[12:15], s54 offen offset:0 lds
    s_mul_i32 s51, s51, 3
    v_cvt_pk_bf16_f32 v48, v192, v193
    v_cvt_pk_bf16_f32 v49, v194, v195
    v_mfma_f32_32x32x16_bf16 v[176:191], a[204:207], v[28:31], v[176:191]
    v_cvt_pk_bf16_f32 v50, v196, v197
    v_cvt_pk_bf16_f32 v51, v198, v199
    s_waitcnt lgkmcnt(4)
    v_mfma_f32_32x32x16_bf16 v[208:223], a[232:235], v[56:59], v[224:239]
    ds_read_b64_tr_b16 a[192:193], v8 offset:10240
    ds_read_b64_tr_b16 a[194:195], v8 offset:10752
    buffer_load_dwordx4 v3, s[12:15], s54 offen offset:1024 lds
    v_cvt_pk_bf16_f32 v52, v200, v201
    v_cvt_pk_bf16_f32 v53, v202, v203
    v_mfma_f32_32x32x16_bf16 v[208:223], a[236:239], v[60:63], v[208:223]
    ds_read_b64_tr_b16 a[196:197], v11 offset:10240
    ds_read_b64_tr_b16 a[198:199], v11 offset:10752
    s_cmp_lt_u32 s72, 9
    s_cselect_b32 s50, s50, s51
    v_cvt_pk_bf16_f32 v54, v204, v205
    v_cvt_pk_bf16_f32 v55, v206, v207
    v_mfma_f32_32x32x16_bf16 v[160:175], a[168:171], v[32:35], v[160:175]
    ds_read_b64_tr_b16 a[200:201], v8 offset:11264
    ds_read_b64_tr_b16 a[202:203], v8 offset:11776
    buffer_load_dwordx4 v4, s[12:15], s54 offen offset:2048 lds
    v_mfma_f32_32x32x16_bf16 v[176:191], a[172:175], v[32:35], v[176:191]
    ds_read_b64_tr_b16 a[204:205], v11 offset:11264
    ds_read_b64_tr_b16 a[206:207], v11 offset:11776
    s_add_u32 m0, s47, 52224
    s_add_u32 s54, s82, 221184
    s_lshl_b32 s50, s50, 7
    s_waitcnt lgkmcnt(8)
    v_mfma_f32_32x32x16_bf16 v[160:175], a[176:179], v[36:39], v[160:175]
    buffer_load_dwordx4 v2, s[12:15], s54 offen offset:0 lds
    v_cvt_pk_bf16_f32 v56, v208, v209
    v_cvt_pk_bf16_f32 v57, v210, v211
    v_mfma_f32_32x32x16_bf16 v[176:191], a[180:183], v[36:39], v[176:191]
    s_cmp_ge_u32 s50, 1152
    s_cselect_b32 s50, 0, s50
    v_cvt_pk_bf16_f32 v58, v212, v213
    v_cvt_pk_bf16_f32 v59, v214, v215
    v_mfma_f32_32x32x16_bf16 v[192:207], a[232:235], v[64:67], v[224:239]
    ds_read_b64_tr_b16 a[168:169], v8 offset:16384
    ds_read_b64_tr_b16 a[170:171], v8 offset:16896
    buffer_load_dwordx4 v3, s[12:15], s54 offen offset:1024 lds
    v_cvt_pk_bf16_f32 v60, v216, v217
    v_cvt_pk_bf16_f32 v61, v218, v219
    v_mfma_f32_32x32x16_bf16 v[192:207], a[236:239], v[68:71], v[192:207]
    ds_read_b64_tr_b16 a[172:173], v11 offset:16384
    ds_read_b64_tr_b16 a[174:175], v11 offset:16896
    v_cvt_pk_bf16_f32 v62, v220, v221
    v_cvt_pk_bf16_f32 v63, v222, v223
    s_waitcnt lgkmcnt(4)
    v_mfma_f32_32x32x16_bf16 v[160:175], a[192:195], v[40:43], v[160:175]
    ds_read_b64_tr_b16 a[176:177], v8 offset:17408
    ds_read_b64_tr_b16 a[178:179], v8 offset:17920
    buffer_load_dwordx4 v4, s[12:15], s54 offen offset:2048 lds
    s_add_u32 s84, s49, s50
    v_mfma_f32_32x32x16_bf16 v[176:191], a[196:199], v[40:43], v[176:191]
    ds_read_b64_tr_b16 a[180:181], v11 offset:17408
    ds_read_b64_tr_b16 a[182:183], v11 offset:17920
    s_add_u32 m0, s47, 73728
    s_add_u32 s54, s80, 128
    s_add_u32 s50, s50, 128
    v_mfma_f32_32x32x16_bf16 v[160:175], a[200:203], v[44:47], v[160:175]
    buffer_load_dwordx4 v2, s[12:15], s54 offen offset:0 lds
    v_cvt_pk_bf16_f32 v64, v192, v193
    v_cvt_pk_bf16_f32 v65, v194, v195
    v_mfma_f32_32x32x16_bf16 v[176:191], a[204:207], v[44:47], v[176:191]
    v_cvt_pk_bf16_f32 v66, v196, v197
    v_cvt_pk_bf16_f32 v67, v198, v199
    s_waitcnt lgkmcnt(4)
    v_mfma_f32_32x32x16_bf16 v[208:223], a[232:235], v[72:75], v[224:239]
    ds_read_b64_tr_b16 a[192:193], v8 offset:18432
    ds_read_b64_tr_b16 a[194:195], v8 offset:18944
    buffer_load_dwordx4 v3, s[12:15], s54 offen offset:1024 lds
    s_cmp_ge_u32 s50, 1152
    s_cselect_b32 s50, 0, s50
    v_cvt_pk_bf16_f32 v68, v200, v201
    v_cvt_pk_bf16_f32 v69, v202, v203
    v_mfma_f32_32x32x16_bf16 v[208:223], a[236:239], v[76:79], v[208:223]
    ds_read_b64_tr_b16 a[196:197], v11 offset:18432
    ds_read_b64_tr_b16 a[198:199], v11 offset:18944
    v_cvt_pk_bf16_f32 v70, v204, v205
    v_cvt_pk_bf16_f32 v71, v206, v207
    v_mfma_f32_32x32x16_bf16 v[160:175], a[168:171], v[48:51], v[160:175]
    ds_read_b64_tr_b16 a[200:201], v8 offset:19456
    ds_read_b64_tr_b16 a[202:203], v8 offset:19968
    buffer_load_dwordx4 v4, s[12:15], s54 offen offset:2048 lds
    s_add_u32 s85, s49, s50
    v_mfma_f32_32x32x16_bf16 v[176:191], a[172:175], v[48:51], v[176:191]
    ds_read_b64_tr_b16 a[204:205], v11 offset:19456
    ds_read_b64_tr_b16 a[206:207], v11 offset:19968
    s_add_u32 m0, s47, 76800
    s_add_u32 s54, s80, 221312
    s_add_u32 s50, s50, 128
    s_waitcnt lgkmcnt(8)
    v_mfma_f32_32x32x16_bf16 v[160:175], a[176:179], v[52:55], v[160:175]
    buffer_load_dwordx4 v2, s[12:15], s54 offen offset:0 lds
    v_cvt_pk_bf16_f32 v72, v208, v209
    v_cvt_pk_bf16_f32 v73, v210, v211
    v_mfma_f32_32x32x16_bf16 v[176:191], a[180:183], v[52:55], v[176:191]
    v_cvt_pk_bf16_f32 v74, v212, v213
    v_cvt_pk_bf16_f32 v75, v214, v215
    v_mfma_f32_32x32x16_bf16 v[192:207], a[232:235], v[80:83], v[224:239]
    s_waitcnt vmcnt(10)
    s_barrier
    ds_read_b64_tr_b16 a[168:169], v8 offset:24576
    ds_read_b64_tr_b16 a[170:171], v8 offset:25088
    buffer_load_dwordx4 v3, s[12:15], s54 offen offset:1024 lds
    s_cmp_ge_u32 s50, 1152
    s_cselect_b32 s50, 0, s50
    v_cvt_pk_bf16_f32 v76, v216, v217
    v_cvt_pk_bf16_f32 v77, v218, v219
    v_mfma_f32_32x32x16_bf16 v[192:207], a[236:239], v[84:87], v[192:207]
    ds_read_b64_tr_b16 a[172:173], v11 offset:24576
    ds_read_b64_tr_b16 a[174:175], v11 offset:25088
    v_cvt_pk_bf16_f32 v78, v220, v221
    v_cvt_pk_bf16_f32 v79, v222, v223
    s_waitcnt lgkmcnt(4)
    v_mfma_f32_32x32x16_bf16 v[160:175], a[192:195], v[56:59], v[160:175]
    ds_read_b64_tr_b16 a[176:177], v8 offset:25600
    ds_read_b64_tr_b16 a[178:179], v8 offset:26112
    buffer_load_dwordx4 v4, s[12:15], s54 offen offset:2048 lds
    s_add_u32 s86, s49, s50
    v_mfma_f32_32x32x16_bf16 v[176:191], a[196:199], v[56:59], v[176:191]
    ds_read_b64_tr_b16 a[180:181], v11 offset:25600
    ds_read_b64_tr_b16 a[182:183], v11 offset:26112
    s_add_u32 m0, s47, 98304
    s_add_u32 s54, s81, 128
    v_mfma_f32_32x32x16_bf16 v[160:175], a[200:203], v[60:63], v[160:175]
    buffer_load_dwordx4 v2, s[12:15], s54 offen offset:0 lds
    s_add_u32 s50, s50, 128
    v_cvt_pk_bf16_f32 v80, v192, v193
    v_cvt_pk_bf16_f32 v81, v194, v195
    v_mfma_f32_32x32x16_bf16 v[176:191], a[204:207], v[60:63], v[176:191]
    v_cvt_pk_bf16_f32 v82, v196, v197
    v_cvt_pk_bf16_f32 v83, v198, v199
    s_waitcnt lgkmcnt(4)
    v_mfma_f32_32x32x16_bf16 v[208:223], a[232:235], v[88:91], v[224:239]
    ds_read_b64_tr_b16 a[192:193], v8 offset:26624
    ds_read_b64_tr_b16 a[194:195], v8 offset:27136
    buffer_load_dwordx4 v3, s[12:15], s54 offen offset:1024 lds
    s_cmp_ge_u32 s50, 1152
    s_cselect_b32 s50, 0, s50
    v_cvt_pk_bf16_f32 v84, v200, v201
    v_cvt_pk_bf16_f32 v85, v202, v203
    v_mfma_f32_32x32x16_bf16 v[208:223], a[236:239], v[92:95], v[208:223]
    ds_read_b64_tr_b16 a[196:197], v11 offset:26624
    ds_read_b64_tr_b16 a[198:199], v11 offset:27136
    v_cvt_pk_bf16_f32 v86, v204, v205
    v_cvt_pk_bf16_f32 v87, v206, v207
    v_mfma_f32_32x32x16_bf16 v[160:175], a[168:171], v[64:67], v[160:175]
    ds_read_b64_tr_b16 a[200:201], v8 offset:27648
    ds_read_b64_tr_b16 a[202:203], v8 offset:28160
    buffer_load_dwordx4 v4, s[12:15], s54 offen offset:2048 lds
    s_add_u32 s87, s49, s50
    v_mfma_f32_32x32x16_bf16 v[176:191], a[172:175], v[64:67], v[176:191]
    ds_read_b64_tr_b16 a[204:205], v11 offset:27648
    ds_read_b64_tr_b16 a[206:207], v11 offset:28160
    s_add_u32 m0, s47, 101376
    s_add_u32 s54, s81, 221312
    s_waitcnt lgkmcnt(8)
    v_mfma_f32_32x32x16_bf16 v[160:175], a[176:179], v[68:71], v[160:175]
    buffer_load_dwordx4 v2, s[12:15], s54 offen offset:0 lds
    s_add_u32 s50, s50, 128
    v_cvt_pk_bf16_f32 v88, v208, v209
    v_cvt_pk_bf16_f32 v89, v210, v211
    v_mfma_f32_32x32x16_bf16 v[176:191], a[180:183], v[68:71], v[176:191]
    v_cvt_pk_bf16_f32 v90, v212, v213
    v_cvt_pk_bf16_f32 v91, v214, v215
    v_mfma_f32_32x32x16_bf16 v[192:207], a[232:235], v[96:99], v[224:239]
    ds_read_b64_tr_b16 a[168:169], v8 offset:32768
    ds_read_b64_tr_b16 a[170:171], v8 offset:33280
    buffer_load_dwordx4 v3, s[12:15], s54 offen offset:1024 lds
    s_cmp_ge_u32 s50, 1152
    s_cselect_b32 s50, 0, s50
    v_cvt_pk_bf16_f32 v92, v216, v217
    v_cvt_pk_bf16_f32 v93, v218, v219
    v_mfma_f32_32x32x16_bf16 v[192:207], a[236:239], v[100:103], v[192:207]
    ds_read_b64_tr_b16 a[172:173], v11 offset:32768
    ds_read_b64_tr_b16 a[174:175], v11 offset:33280
    v_cvt_pk_bf16_f32 v94, v220, v221
    v_cvt_pk_bf16_f32 v95, v222, v223
    s_waitcnt lgkmcnt(4)
    v_mfma_f32_32x32x16_bf16 v[160:175], a[192:195], v[72:75], v[160:175]
    ds_read_b64_tr_b16 a[176:177], v8 offset:33792
    ds_read_b64_tr_b16 a[178:179], v8 offset:34304
    buffer_load_dwordx4 v4, s[12:15], s54 offen offset:2048 lds
    v_mfma_f32_32x32x16_bf16 v[176:191], a[196:199], v[72:75], v[176:191]
    ds_read_b64_tr_b16 a[180:181], v11 offset:33792
    ds_read_b64_tr_b16 a[182:183], v11 offset:34304
    s_add_u32 m0, s47, 122880
    s_add_u32 s54, s82, 128
    s_add_u32 s88, s49, s50
    v_mfma_f32_32x32x16_bf16 v[160:175], a[200:203], v[76:79], v[160:175]
    buffer_load_dwordx4 v2, s[12:15], s54 offen offset:0 lds
    s_add_u32 s50, s50, 128
    v_cvt_pk_bf16_f32 v96, v192, v193
    v_cvt_pk_bf16_f32 v97, v194, v195
    v_mfma_f32_32x32x16_bf16 v[176:191], a[204:207], v[76:79], v[176:191]
    v_cvt_pk_bf16_f32 v98, v196, v197
    v_cvt_pk_bf16_f32 v99, v198, v199
    s_waitcnt lgkmcnt(4)
    v_mfma_f32_32x32x16_bf16 v[208:223], a[232:235], v[104:107], v[224:239]
    ds_read_b64_tr_b16 a[192:193], v8 offset:34816
    ds_read_b64_tr_b16 a[194:195], v8 offset:35328
    v_cvt_pk_bf16_f32 v100, v200, v201
    v_cvt_pk_bf16_f32 v101, v202, v203
    v_mfma_f32_32x32x16_bf16 v[208:223], a[236:239], v[108:111], v[208:223]
    ds_read_b64_tr_b16 a[196:197], v11 offset:34816
    ds_read_b64_tr_b16 a[198:199], v11 offset:35328
    buffer_load_dwordx4 v3, s[12:15], s54 offen offset:1024 lds
    s_cmp_ge_u32 s50, 1152
    s_cselect_b32 s50, 0, s50
    v_cvt_pk_bf16_f32 v102, v204, v205
    v_cvt_pk_bf16_f32 v103, v206, v207
    v_mfma_f32_32x32x16_bf16 v[160:175], a[168:171], v[80:83], v[160:175]
    ds_read_b64_tr_b16 a[200:201], v8 offset:35840
    ds_read_b64_tr_b16 a[202:203], v8 offset:36352
    v_mfma_f32_32x32x16_bf16 v[176:191], a[172:175], v[80:83], v[176:191]
    ds_read_b64_tr_b16 a[204:205], v11 offset:35840
    ds_read_b64_tr_b16 a[206:207], v11 offset:36352
    s_add_u32 s89, s49, s50
    s_waitcnt lgkmcnt(8)
    v_mfma_f32_32x32x16_bf16 v[160:175], a[176:179], v[84:87], v[160:175]
    buffer_load_dwordx4 v4, s[12:15], s54 offen offset:2048 lds
    v_cvt_pk_bf16_f32 v104, v208, v209
    v_cvt_pk_bf16_f32 v105, v210, v211
    v_mfma_f32_32x32x16_bf16 v[176:191], a[180:183], v[84:87], v[176:191]
    s_add_u32 m0, s47, 125952
    s_add_u32 s54, s82, 221312
    s_add_u32 s50, s50, 128
    v_cvt_pk_bf16_f32 v106, v212, v213
    v_cvt_pk_bf16_f32 v107, v214, v215
    v_mfma_f32_32x32x16_bf16 v[192:207], a[232:235], v[112:115], v[224:239]
    ds_read_b64_tr_b16 a[168:169], v8 offset:40960
    ds_read_b64_tr_b16 a[170:171], v8 offset:41472
    v_cvt_pk_bf16_f32 v108, v216, v217
    v_cvt_pk_bf16_f32 v109, v218, v219
    v_mfma_f32_32x32x16_bf16 v[192:207], a[236:239], v[116:119], v[192:207]
    ds_read_b64_tr_b16 a[172:173], v11 offset:40960
    ds_read_b64_tr_b16 a[174:175], v11 offset:41472
    buffer_load_dwordx4 v2, s[12:15], s54 offen offset:0 lds
    s_cmp_ge_u32 s50, 1152
    s_cselect_b32 s50, 0, s50
    v_cvt_pk_bf16_f32 v110, v220, v221
    v_cvt_pk_bf16_f32 v111, v222, v223
    s_waitcnt lgkmcnt(4)
    v_mfma_f32_32x32x16_bf16 v[160:175], a[192:195], v[88:91], v[160:175]
    ds_read_b64_tr_b16 a[176:177], v8 offset:41984
    ds_read_b64_tr_b16 a[178:179], v8 offset:42496
    v_mfma_f32_32x32x16_bf16 v[176:191], a[196:199], v[88:91], v[176:191]
    ds_read_b64_tr_b16 a[180:181], v11 offset:41984
    ds_read_b64_tr_b16 a[182:183], v11 offset:42496
    s_add_u32 s90, s49, s50
    v_mfma_f32_32x32x16_bf16 v[160:175], a[200:203], v[92:95], v[160:175]
    v_cvt_pk_bf16_f32 v112, v192, v193
    v_cvt_pk_bf16_f32 v113, v194, v195
    v_mfma_f32_32x32x16_bf16 v[176:191], a[204:207], v[92:95], v[176:191]
    buffer_load_dwordx4 v3, s[12:15], s54 offen offset:1024 lds
    s_add_u32 s50, s50, 128
    v_cvt_pk_bf16_f32 v114, v196, v197
    v_cvt_pk_bf16_f32 v115, v198, v199
    s_waitcnt lgkmcnt(4)
    v_mfma_f32_32x32x16_bf16 v[208:223], a[232:235], v[120:123], v[224:239]
    ds_read_b64_tr_b16 a[192:193], v8 offset:43008
    ds_read_b64_tr_b16 a[194:195], v8 offset:43520
    v_cvt_pk_bf16_f32 v116, v200, v201
    v_cvt_pk_bf16_f32 v117, v202, v203
    v_mfma_f32_32x32x16_bf16 v[208:223], a[236:239], v[124:127], v[208:223]
    ds_read_b64_tr_b16 a[196:197], v11 offset:43008
    ds_read_b64_tr_b16 a[198:199], v11 offset:43520
    s_cmp_ge_u32 s50, 1152
    s_cselect_b32 s50, 0, s50
    v_cvt_pk_bf16_f32 v118, v204, v205
    v_cvt_pk_bf16_f32 v119, v206, v207
    v_mfma_f32_32x32x16_bf16 v[160:175], a[168:171], v[96:99], v[160:175]
    ds_read_b64_tr_b16 a[200:201], v8 offset:44032
    ds_read_b64_tr_b16 a[202:203], v8 offset:44544
    v_mfma_f32_32x32x16_bf16 v[176:191], a[172:175], v[96:99], v[176:191]
    ds_read_b64_tr_b16 a[204:205], v11 offset:44032
    ds_read_b64_tr_b16 a[206:207], v11 offset:44544
    buffer_load_dwordx4 v4, s[12:15], s54 offen offset:2048 lds
    s_waitcnt lgkmcnt(8)
    v_mfma_f32_32x32x16_bf16 v[160:175], a[176:179], v[100:103], v[160:175]
    s_add_u32 s91, s49, s50
    v_cvt_pk_bf16_f32 v120, v208, v209
    v_cvt_pk_bf16_f32 v121, v210, v211
    v_mfma_f32_32x32x16_bf16 v[176:191], a[180:183], v[100:103], v[176:191]
    s_add_u32 s50, s50, 128
    v_cvt_pk_bf16_f32 v122, v212, v213
    v_cvt_pk_bf16_f32 v123, v214, v215
    v_mfma_f32_32x32x16_bf16 v[192:207], a[232:235], v[128:131], v[224:239]
    s_waitcnt vmcnt(18)
    s_barrier
    ds_read_b64_tr_b16 a[168:169], v8 offset:49152
    ds_read_b64_tr_b16 a[170:171], v8 offset:49664
    s_add_u32 m0, s47, 0
    s_add_u32 s54, s80, 256
    v_cvt_pk_bf16_f32 v124, v216, v217
    v_cvt_pk_bf16_f32 v125, v218, v219
    v_mfma_f32_32x32x16_bf16 v[192:207], a[236:239], v[132:135], v[192:207]
    ds_read_b64_tr_b16 a[172:173], v11 offset:49152
    ds_read_b64_tr_b16 a[174:175], v11 offset:49664
    v_cvt_pk_bf16_f32 v126, v220, v221
    v_cvt_pk_bf16_f32 v127, v222, v223
    s_waitcnt lgkmcnt(4)
    v_mfma_f32_32x32x16_bf16 v[160:175], a[192:195], v[104:107], v[160:175]
    ds_read_b64_tr_b16 a[176:177], v8 offset:50176
    ds_read_b64_tr_b16 a[178:179], v8 offset:50688
    buffer_load_dwordx4 v2, s[12:15], s54 offen offset:0 lds
    s_cmp_ge_u32 s50, 1152
    s_cselect_b32 s50, 0, s50
    v_mfma_f32_32x32x16_bf16 v[176:191], a[196:199], v[104:107], v[176:191]
    ds_read_b64_tr_b16 a[180:181], v11 offset:50176
    ds_read_b64_tr_b16 a[182:183], v11 offset:50688
    v_mfma_f32_32x32x16_bf16 v[160:175], a[200:203], v[108:111], v[160:175]
    s_add_u32 s92, s49, s50
    v_cvt_pk_bf16_f32 v128, v192, v193
    v_cvt_pk_bf16_f32 v129, v194, v195
    v_mfma_f32_32x32x16_bf16 v[176:191], a[204:207], v[108:111], v[176:191]
    buffer_load_dwordx4 v3, s[12:15], s54 offen offset:1024 lds
    s_add_u32 s50, s50, 128
    v_cvt_pk_bf16_f32 v130, v196, v197
    v_cvt_pk_bf16_f32 v131, v198, v199
    s_waitcnt lgkmcnt(4)
    v_mfma_f32_32x32x16_bf16 v[208:223], a[232:235], v[136:139], v[224:239]
    ds_read_b64_tr_b16 a[192:193], v8 offset:51200
    ds_read_b64_tr_b16 a[194:195], v8 offset:51712
    v_cvt_pk_bf16_f32 v132, v200, v201
    v_cvt_pk_bf16_f32 v133, v202, v203
    v_mfma_f32_32x32x16_bf16 v[208:223], a[236:239], v[140:143], v[208:223]
    ds_read_b64_tr_b16 a[196:197], v11 offset:51200
    ds_read_b64_tr_b16 a[198:199], v11 offset:51712
    s_mul_i32 s93, s41, 1769472
    v_cvt_pk_bf16_f32 v134, v204, v205
    v_cvt_pk_bf16_f32 v135, v206, v207
    v_mfma_f32_32x32x16_bf16 v[160:175], a[168:171], v[112:115], v[160:175]
    ds_read_b64_tr_b16 a[200:201], v8 offset:52224
    ds_read_b64_tr_b16 a[202:203], v8 offset:52736
    v_mfma_f32_32x32x16_bf16 v[176:191], a[172:175], v[112:115], v[176:191]
    ds_read_b64_tr_b16 a[204:205], v11 offset:52224
    ds_read_b64_tr_b16 a[206:207], v11 offset:52736
    buffer_load_dwordx4 v4, s[12:15], s54 offen offset:2048 lds
    s_lshl_b32 s51, s40, 12
    s_waitcnt lgkmcnt(8)
    v_mfma_f32_32x32x16_bf16 v[160:175], a[176:179], v[116:119], v[160:175]
    s_add_u32 m0, s47, 3072
    s_add_u32 s54, s80, 221440
    s_add_u32 s93, s93, s51
    v_cvt_pk_bf16_f32 v136, v208, v209
    v_cvt_pk_bf16_f32 v137, v210, v211
    v_mfma_f32_32x32x16_bf16 v[176:191], a[180:183], v[116:119], v[176:191]
    v_cvt_pk_bf16_f32 v138, v212, v213
    v_cvt_pk_bf16_f32 v139, v214, v215
    v_mfma_f32_32x32x16_bf16 v[192:207], a[232:235], v[144:147], v[224:239]
    ds_read_b64_tr_b16 a[168:169], v8 offset:57344
    ds_read_b64_tr_b16 a[170:171], v8 offset:57856
    s_mul_i32 s51, s72, 196608
    v_cvt_pk_bf16_f32 v140, v216, v217
    v_cvt_pk_bf16_f32 v141, v218, v219
    v_mfma_f32_32x32x16_bf16 v[192:207], a[236:239], v[148:151], v[192:207]
    ds_read_b64_tr_b16 a[172:173], v11 offset:57344
    ds_read_b64_tr_b16 a[174:175], v11 offset:57856
    buffer_load_dwordx4 v2, s[12:15], s54 offen offset:0 lds
    s_add_u32 s57, s93, s51
    v_cvt_pk_bf16_f32 v142, v220, v221
    v_cvt_pk_bf16_f32 v143, v222, v223
    s_waitcnt lgkmcnt(4)
    v_mfma_f32_32x32x16_bf16 v[160:175], a[192:195], v[120:123], v[160:175]
    ds_read_b64_tr_b16 a[176:177], v8 offset:58368
    ds_read_b64_tr_b16 a[178:179], v8 offset:58880
    v_mfma_f32_32x32x16_bf16 v[176:191], a[196:199], v[120:123], v[176:191]
    ds_read_b64_tr_b16 a[180:181], v11 offset:58368
    ds_read_b64_tr_b16 a[182:183], v11 offset:58880
    v_mfma_f32_32x32x16_bf16 v[160:175], a[200:203], v[124:127], v[160:175]
    ds_read_b64_tr_b16 a[184:185], v8 offset:59392
    ds_read_b64_tr_b16 a[186:187], v8 offset:59904
    s_cmp_lt_u32 s72, 9
    s_cselect_b32 s97, s55, 1073741824
    v_cvt_pk_bf16_f32 v144, v192, v193
    v_cvt_pk_bf16_f32 v145, v194, v195
    v_mfma_f32_32x32x16_bf16 v[176:191], a[204:207], v[124:127], v[176:191]
    ds_read_b64_tr_b16 a[188:189], v11 offset:59392
    ds_read_b64_tr_b16 a[190:191], v11 offset:59904
    buffer_load_dwordx4 v3, s[12:15], s54 offen offset:1024 lds
    v_cvt_pk_bf16_f32 v146, v196, v197
    v_cvt_pk_bf16_f32 v147, v198, v199
    s_waitcnt lgkmcnt(8)
    v_mfma_f32_32x32x16_bf16 v[208:223], a[232:235], v[152:155], v[224:239]
    ds_read_b64_tr_b16 a[192:193], v8 offset:60416
    ds_read_b64_tr_b16 a[194:195], v8 offset:60928
    s_lshl_b32 s51, s72, 14
    v_cvt_pk_bf16_f32 v148, v200, v201
    v_cvt_pk_bf16_f32 v149, v202, v203
    v_mfma_f32_32x32x16_bf16 v[208:223], a[236:239], v[156:159], v[208:223]
    ds_read_b64_tr_b16 a[196:197], v11 offset:60416
    ds_read_b64_tr_b16 a[198:199], v11 offset:60928
    v_cvt_pk_bf16_f32 v150, v204, v205
    v_cvt_pk_bf16_f32 v151, v206, v207
    v_mfma_f32_32x32x16_bf16 v[160:175], a[168:171], v[128:131], v[160:175]
    ds_read_b64_tr_b16 a[200:201], v9 offset:0
    ds_read_b64_tr_b16 a[202:203], v9 offset:512
    s_add_u32 s93, s93, s51
    v_mfma_f32_32x32x16_bf16 v[176:191], a[172:175], v[128:131], v[176:191]
    ds_read_b64_tr_b16 a[204:205], v12 offset:0
    ds_read_b64_tr_b16 a[206:207], v12 offset:512
    buffer_load_dwordx4 v4, s[12:15], s54 offen offset:2048 lds
    s_mul_i32 s51, s49, 1536
    s_waitcnt lgkmcnt(8)
    v_mfma_f32_32x32x16_bf16 v[160:175], a[176:179], v[132:135], v[160:175]
    ds_read_b64_tr_b16 a[160:161], v9 offset:1024
    ds_read_b64_tr_b16 a[162:163], v9 offset:1536
    v_cvt_pk_bf16_f32 v152, v208, v209
    v_cvt_pk_bf16_f32 v153, v210, v211
    v_mfma_f32_32x32x16_bf16 v[176:191], a[180:183], v[132:135], v[176:191]
    ds_read_b64_tr_b16 a[164:165], v12 offset:1024
    ds_read_b64_tr_b16 a[166:167], v12 offset:1536
    s_sub_u32 s93, s93, s51
    v_cvt_pk_bf16_f32 v154, v212, v213
    v_cvt_pk_bf16_f32 v155, v214, v215
    v_mfma_f32_32x32x16_bf16 v[160:175], a[184:187], v[136:139], v[160:175]
    ds_read_b64_tr_b16 a[168:169], v9 offset:2048
    ds_read_b64_tr_b16 a[170:171], v9 offset:2560
    v_cvt_pk_bf16_f32 v156, v216, v217
    v_cvt_pk_bf16_f32 v157, v218, v219
    v_mfma_f32_32x32x16_bf16 v[176:191], a[188:191], v[136:139], v[176:191]
    ds_read_b64_tr_b16 a[172:173], v12 offset:2048
    ds_read_b64_tr_b16 a[174:175], v12 offset:2560
    v_cvt_pk_bf16_f32 v158, v220, v221
    v_cvt_pk_bf16_f32 v159, v222, v223
    s_waitcnt lgkmcnt(8)
    v_mfma_f32_32x32x16_bf16 v[160:175], a[192:195], v[140:143], v[160:175]
    ds_read_b64_tr_b16 a[176:177], v9 offset:3072
    ds_read_b64_tr_b16 a[178:179], v9 offset:3584
    v_mfma_f32_32x32x16_bf16 v[176:191], a[196:199], v[140:143], v[176:191]
    ds_read_b64_tr_b16 a[180:181], v12 offset:3072
    ds_read_b64_tr_b16 a[182:183], v12 offset:3584
    v_mfma_f32_32x32x16_bf16 v[160:175], a[200:203], v[144:147], v[160:175]
    s_waitcnt vmcnt(18)
    s_barrier
    ds_read_b64_tr_b16 a[184:185], v9 offset:8192
    ds_read_b64_tr_b16 a[186:187], v9 offset:8704
    s_add_u32 m0, s47, 24576
    s_add_u32 s54, s81, 256
    v_mfma_f32_32x32x16_bf16 v[176:191], a[204:207], v[144:147], v[176:191]
    ds_read_b64_tr_b16 a[188:189], v12 offset:8192
    ds_read_b64_tr_b16 a[190:191], v12 offset:8704
    s_waitcnt lgkmcnt(8)
    v_mfma_f32_32x32x16_bf16 v[160:175], a[160:163], v[148:151], v[160:175]
    ds_read_b64_tr_b16 a[192:193], v9 offset:9216
    ds_read_b64_tr_b16 a[194:195], v9 offset:9728
    buffer_load_dwordx4 v2, s[12:15], s54 offen offset:0 lds
    v_mfma_f32_32x32x16_bf16 v[176:191], a[164:167], v[148:151], v[176:191]
    ds_read_b64_tr_b16 a[196:197], v12 offset:9216
    ds_read_b64_tr_b16 a[198:199], v12 offset:9728
    v_mfma_f32_32x32x16_bf16 v[160:175], a[168:171], v[152:155], v[160:175]
    ds_read_b64_tr_b16 a[200:201], v9 offset:10240
    ds_read_b64_tr_b16 a[202:203], v9 offset:10752
    v_mfma_f32_32x32x16_bf16 v[176:191], a[172:175], v[152:155], v[176:191]
    ds_read_b64_tr_b16 a[204:205], v12 offset:10240
    ds_read_b64_tr_b16 a[206:207], v12 offset:10752
    buffer_load_dwordx4 v3, s[12:15], s54 offen offset:1024 lds
    s_waitcnt lgkmcnt(8)
    v_mfma_f32_32x32x16_bf16 v[160:175], a[176:179], v[156:159], v[160:175]
    ds_read_b64_tr_b16 a[160:161], v9 offset:11264
    ds_read_b64_tr_b16 a[162:163], v9 offset:11776
    v_mfma_f32_32x32x16_bf16 v[176:191], a[180:183], v[156:159], v[176:191]
    ds_read_b64_tr_b16 a[164:165], v12 offset:11264
    ds_read_b64_tr_b16 a[166:167], v12 offset:11776
    v_mfma_f32_32x32x16_bf16 v[192:207], a[184:187], v[16:19], 0
    ds_read_b64_tr_b16 a[168:169], v9 offset:16384
    ds_read_b64_tr_b16 a[170:171], v9 offset:16896
    buffer_load_dwordx4 v4, s[12:15], s54 offen offset:2048 lds
    v_mfma_f32_32x32x16_bf16 v[208:223], a[188:191], v[16:19], 0
    ds_read_b64_tr_b16 a[172:173], v12 offset:16384
    ds_read_b64_tr_b16 a[174:175], v12 offset:16896
    s_add_u32 m0, s47, 27648
    s_add_u32 s54, s81, 221440
    v_mul_f32 v224, v255, v160
    v_mul_f32 v225, v255, v161
    v_mul_f32 v226, v255, v162
    v_mul_f32 v227, v255, v163
    s_waitcnt lgkmcnt(8)
    v_mfma_f32_32x32x16_bf16 v[192:207], a[192:195], v[20:23], v[192:207]
    ds_read_b64_tr_b16 a[176:177], v9 offset:17408
    ds_read_b64_tr_b16 a[178:179], v9 offset:17920
    v_exp_f32 v224, v224
    v_exp_f32 v225, v225
    v_mfma_f32_32x32x16_bf16 v[208:223], a[196:199], v[20:23], v[208:223]
    ds_read_b64_tr_b16 a[180:181], v12 offset:17408
    ds_read_b64_tr_b16 a[182:183], v12 offset:17920
    v_exp_f32 v226, v226
    v_exp_f32 v227, v227
    v_mfma_f32_32x32x16_bf16 v[192:207], a[200:203], v[24:27], v[192:207]
    ds_read_b64_tr_b16 a[184:185], v9 offset:18432
    ds_read_b64_tr_b16 a[186:187], v9 offset:18944
    buffer_load_dwordx4 v2, s[12:15], s54 offen offset:0 lds
    v_add_f32 v224, 1.0, v224
    v_add_f32 v225, 1.0, v225
    v_add_f32 v226, 1.0, v226
    s_and_b32 s51, s41, 7
    s_mul_i32 s51, s51, 55296
    s_mul_i32 s75, s63, 442368
    s_add_u32 s75, s75, s51
    v_accvgpr_read_b32 v251, a149
    s_lshr_b32 s76, s2, 3
    s_sub_u32 s76, s76, 8
    s_mul_i32 s76, s76, 27648
    v_mfma_f32_32x32x16_bf16 v[208:223], a[204:207], v[24:27], v[208:223]
    ds_read_b64_tr_b16 a[188:189], v12 offset:18432
    ds_read_b64_tr_b16 a[190:191], v12 offset:18944
    v_add_f32 v227, 1.0, v227
    v_rcp_f32 v224, v224
    v_rcp_f32 v225, v225
    s_waitcnt lgkmcnt(8)
    v_mfma_f32_32x32x16_bf16 v[192:207], a[160:163], v[28:31], v[192:207]
    ds_read_b64_tr_b16 a[192:193], v9 offset:19456
    ds_read_b64_tr_b16 a[194:195], v9 offset:19968
    v_rcp_f32 v226, v226
    buffer_load_dword v252, v251, s[16:19], s75 offen
    s_add_u32 s75, s75, 13824
    v_mfma_f32_32x32x16_bf16 v[208:223], a[164:167], v[28:31], v[208:223]
    ds_read_b64_tr_b16 a[196:197], v12 offset:19456
    ds_read_b64_tr_b16 a[198:199], v12 offset:19968
    v_rcp_f32 v227, v227
    v_mul_f32 v224, v160, v224
    v_mul_f32 v225, v161, v225
    v_mul_f32 v226, v162, v226
    v_mfma_f32_32x32x16_bf16 v[192:207], a[168:171], v[32:35], v[192:207]
    ds_read_b64_tr_b16 a[200:201], v9 offset:24576
    ds_read_b64_tr_b16 a[202:203], v9 offset:25088
    buffer_load_dwordx4 v3, s[12:15], s54 offen offset:1024 lds
    v_mul_f32 v227, v163, v227
    v_cvt_pk_bf16_f32 v232, v224, v225
    v_cvt_pk_bf16_f32 v233, v226, v227
    v_mfma_f32_32x32x16_bf16 v[208:223], a[172:175], v[32:35], v[208:223]
    ds_read_b64_tr_b16 a[204:205], v12 offset:24576
    ds_read_b64_tr_b16 a[206:207], v12 offset:25088
    v_accvgpr_write_b32 a0, v232
    v_accvgpr_write_b32 a1, v233
    v_mul_f32 v228, v255, v164
    s_waitcnt lgkmcnt(8)
    v_mfma_f32_32x32x16_bf16 v[192:207], a[176:179], v[36:39], v[192:207]
    ds_read_b64_tr_b16 a[160:161], v9 offset:25600
    ds_read_b64_tr_b16 a[162:163], v9 offset:26112
    v_mul_f32 v229, v255, v165
    v_mul_f32 v230, v255, v166
    v_mul_f32 v231, v255, v167
    v_exp_f32 v228, v228
    v_mfma_f32_32x32x16_bf16 v[208:223], a[180:183], v[36:39], v[208:223]
    ds_read_b64_tr_b16 a[164:165], v12 offset:25600
    ds_read_b64_tr_b16 a[166:167], v12 offset:26112
    v_exp_f32 v229, v229
    v_exp_f32 v230, v230
    v_mfma_f32_32x32x16_bf16 v[192:207], a[184:187], v[40:43], v[192:207]
    ds_read_b64_tr_b16 a[168:169], v9 offset:26624
    ds_read_b64_tr_b16 a[170:171], v9 offset:27136
    buffer_load_dwordx4 v4, s[12:15], s54 offen offset:2048 lds
    v_exp_f32 v231, v231
    v_add_f32 v228, 1.0, v228
    v_mfma_f32_32x32x16_bf16 v[208:223], a[188:191], v[40:43], v[208:223]
    ds_read_b64_tr_b16 a[172:173], v12 offset:26624
    ds_read_b64_tr_b16 a[174:175], v12 offset:27136
    v_add_f32 v229, 1.0, v229
    v_add_f32 v230, 1.0, v230
    v_add_f32 v231, 1.0, v231
    s_waitcnt lgkmcnt(8)
    v_mfma_f32_32x32x16_bf16 v[192:207], a[192:195], v[44:47], v[192:207]
    ds_read_b64_tr_b16 a[176:177], v9 offset:27648
    ds_read_b64_tr_b16 a[178:179], v9 offset:28160
    v_rcp_f32 v228, v228
    v_rcp_f32 v229, v229
    v_mfma_f32_32x32x16_bf16 v[208:223], a[196:199], v[44:47], v[208:223]
    ds_read_b64_tr_b16 a[180:181], v12 offset:27648
    ds_read_b64_tr_b16 a[182:183], v12 offset:28160
    v_rcp_f32 v230, v230
    v_rcp_f32 v231, v231
    v_mfma_f32_32x32x16_bf16 v[192:207], a[200:203], v[48:51], v[192:207]
    s_waitcnt vmcnt(19)
    s_barrier
    ds_read_b64_tr_b16 a[184:185], v9 offset:32768
    ds_read_b64_tr_b16 a[186:187], v9 offset:33280
    s_add_u32 m0, s47, 49152
    s_add_u32 s54, s82, 256
    v_mul_f32 v228, v164, v228
    v_mul_f32 v229, v165, v229
    v_mul_f32 v230, v166, v230
    v_mul_f32 v231, v167, v231
    v_mfma_f32_32x32x16_bf16 v[208:223], a[204:207], v[48:51], v[208:223]
    ds_read_b64_tr_b16 a[188:189], v12 offset:32768
    ds_read_b64_tr_b16 a[190:191], v12 offset:33280
    v_cvt_pk_bf16_f32 v234, v228, v229
    v_cvt_pk_bf16_f32 v235, v230, v231
    v_accvgpr_write_b32 a2, v234
    s_waitcnt lgkmcnt(8)
    v_mfma_f32_32x32x16_bf16 v[192:207], a[160:163], v[52:55], v[192:207]
    ds_read_b64_tr_b16 a[192:193], v9 offset:33792
    ds_read_b64_tr_b16 a[194:195], v9 offset:34304
    buffer_load_dwordx4 v2, s[12:15], s54 offen offset:0 lds
    v_accvgpr_write_b32 a3, v235
    v_mul_f32 v224, v255, v168
    v_mul_f32 v225, v255, v169
    v_mul_f32 v226, v255, v170
    v_mfma_f32_32x32x16_bf16 v[208:223], a[164:167], v[52:55], v[208:223]
    ds_read_b64_tr_b16 a[196:197], v12 offset:33792
    ds_read_b64_tr_b16 a[198:199], v12 offset:34304
    v_mul_f32 v227, v255, v171
    v_exp_f32 v224, v224
    v_mfma_f32_32x32x16_bf16 v[192:207], a[168:171], v[56:59], v[192:207]
    ds_read_b64_tr_b16 a[200:201], v9 offset:34816
    ds_read_b64_tr_b16 a[202:203], v9 offset:35328
    v_exp_f32 v225, v225
    v_exp_f32 v226, v226
    v_mfma_f32_32x32x16_bf16 v[208:223], a[172:175], v[56:59], v[208:223]
    ds_read_b64_tr_b16 a[204:205], v12 offset:34816
    ds_read_b64_tr_b16 a[206:207], v12 offset:35328
    buffer_load_dwordx4 v3, s[12:15], s54 offen offset:1024 lds
    v_exp_f32 v227, v227
    v_add_f32 v224, 1.0, v224
    v_add_f32 v225, 1.0, v225
    s_waitcnt lgkmcnt(8)
    v_mfma_f32_32x32x16_bf16 v[192:207], a[176:179], v[60:63], v[192:207]
    ds_read_b64_tr_b16 a[160:161], v9 offset:35840
    ds_read_b64_tr_b16 a[162:163], v9 offset:36352
    v_add_f32 v226, 1.0, v226
    v_add_f32 v227, 1.0, v227
    v_rcp_f32 v224, v224
    v_mfma_f32_32x32x16_bf16 v[208:223], a[180:183], v[60:63], v[208:223]
    ds_read_b64_tr_b16 a[164:165], v12 offset:35840
    ds_read_b64_tr_b16 a[166:167], v12 offset:36352
    v_rcp_f32 v225, v225
    v_rcp_f32 v226, v226
    v_mfma_f32_32x32x16_bf16 v[192:207], a[184:187], v[64:67], v[192:207]
    ds_read_b64_tr_b16 a[168:169], v9 offset:40960
    ds_read_b64_tr_b16 a[170:171], v9 offset:41472
    buffer_load_dwordx4 v4, s[12:15], s54 offen offset:2048 lds
    v_rcp_f32 v227, v227
    v_mul_f32 v224, v168, v224
    v_mul_f32 v225, v169, v225
    v_mfma_f32_32x32x16_bf16 v[208:223], a[188:191], v[64:67], v[208:223]
    ds_read_b64_tr_b16 a[172:173], v12 offset:40960
    ds_read_b64_tr_b16 a[174:175], v12 offset:41472
    s_add_u32 m0, s47, 52224
    s_add_u32 s54, s82, 221440
    v_mul_f32 v226, v170, v226
    v_mul_f32 v227, v171, v227
    v_cvt_pk_bf16_f32 v232, v224, v225
    s_waitcnt lgkmcnt(8)
    v_mfma_f32_32x32x16_bf16 v[192:207], a[192:195], v[68:71], v[192:207]
    ds_read_b64_tr_b16 a[176:177], v9 offset:41984
    ds_read_b64_tr_b16 a[178:179], v9 offset:42496
    v_cvt_pk_bf16_f32 v233, v226, v227
    v_accvgpr_write_b32 a4, v232
    v_accvgpr_write_b32 a5, v233
    v_mfma_f32_32x32x16_bf16 v[208:223], a[196:199], v[68:71], v[208:223]
    ds_read_b64_tr_b16 a[180:181], v12 offset:41984
    ds_read_b64_tr_b16 a[182:183], v12 offset:42496
    v_mul_f32 v228, v255, v172
    v_mul_f32 v229, v255, v173
    v_mul_f32 v230, v255, v174
    v_mul_f32 v231, v255, v175
    v_mfma_f32_32x32x16_bf16 v[192:207], a[200:203], v[72:75], v[192:207]
    ds_read_b64_tr_b16 a[184:185], v9 offset:43008
    ds_read_b64_tr_b16 a[186:187], v9 offset:43520
    buffer_load_dwordx4 v2, s[12:15], s54 offen offset:0 lds
    v_exp_f32 v228, v228
    v_exp_f32 v229, v229
    v_mfma_f32_32x32x16_bf16 v[208:223], a[204:207], v[72:75], v[208:223]
    ds_read_b64_tr_b16 a[188:189], v12 offset:43008
    ds_read_b64_tr_b16 a[190:191], v12 offset:43520
    v_exp_f32 v230, v230
    v_exp_f32 v231, v231
    s_waitcnt lgkmcnt(8)
    v_mfma_f32_32x32x16_bf16 v[192:207], a[160:163], v[76:79], v[192:207]
    ds_read_b64_tr_b16 a[192:193], v9 offset:44032
    ds_read_b64_tr_b16 a[194:195], v9 offset:44544
    v_add_f32 v228, 1.0, v228
    v_add_f32 v229, 1.0, v229
    v_add_f32 v230, 1.0, v230
    v_add_f32 v231, 1.0, v231
    v_mfma_f32_32x32x16_bf16 v[208:223], a[164:167], v[76:79], v[208:223]
    ds_read_b64_tr_b16 a[196:197], v12 offset:44032
    ds_read_b64_tr_b16 a[198:199], v12 offset:44544
    v_rcp_f32 v228, v228
    v_rcp_f32 v229, v229
    v_mfma_f32_32x32x16_bf16 v[192:207], a[168:171], v[80:83], v[192:207]
    ds_read_b64_tr_b16 a[200:201], v9 offset:49152
    ds_read_b64_tr_b16 a[202:203], v9 offset:49664
    buffer_load_dwordx4 v3, s[12:15], s54 offen offset:1024 lds
    v_rcp_f32 v230, v230
    v_rcp_f32 v231, v231
    v_mfma_f32_32x32x16_bf16 v[208:223], a[172:175], v[80:83], v[208:223]
    ds_read_b64_tr_b16 a[204:205], v12 offset:49152
    ds_read_b64_tr_b16 a[206:207], v12 offset:49664
    v_mul_f32 v228, v172, v228
    v_mul_f32 v229, v173, v229
    v_mul_f32 v230, v174, v230
    s_waitcnt lgkmcnt(8)
    v_mfma_f32_32x32x16_bf16 v[192:207], a[176:179], v[84:87], v[192:207]
    ds_read_b64_tr_b16 a[160:161], v9 offset:50176
    ds_read_b64_tr_b16 a[162:163], v9 offset:50688
    v_mul_f32 v231, v175, v231
    v_cvt_pk_bf16_f32 v234, v228, v229
    v_cvt_pk_bf16_f32 v235, v230, v231
    v_mfma_f32_32x32x16_bf16 v[208:223], a[180:183], v[84:87], v[208:223]
    ds_read_b64_tr_b16 a[164:165], v12 offset:50176
    ds_read_b64_tr_b16 a[166:167], v12 offset:50688
    v_accvgpr_write_b32 a6, v234
    v_accvgpr_write_b32 a7, v235
    v_mul_f32 v224, v255, v176
    v_mul_f32 v225, v255, v177
    v_mfma_f32_32x32x16_bf16 v[192:207], a[184:187], v[88:91], v[192:207]
    ds_read_b64_tr_b16 a[168:169], v9 offset:51200
    ds_read_b64_tr_b16 a[170:171], v9 offset:51712
    buffer_load_dwordx4 v4, s[12:15], s54 offen offset:2048 lds
    v_mul_f32 v226, v255, v178
    v_mul_f32 v227, v255, v179
    v_exp_f32 v224, v224
    v_mfma_f32_32x32x16_bf16 v[208:223], a[188:191], v[88:91], v[208:223]
    ds_read_b64_tr_b16 a[172:173], v12 offset:51200
    ds_read_b64_tr_b16 a[174:175], v12 offset:51712
    v_exp_f32 v225, v225
    v_exp_f32 v226, v226
    s_waitcnt lgkmcnt(8)
    v_mfma_f32_32x32x16_bf16 v[192:207], a[192:195], v[92:95], v[192:207]
    ds_read_b64_tr_b16 a[176:177], v9 offset:52224
    ds_read_b64_tr_b16 a[178:179], v9 offset:52736
    v_exp_f32 v227, v227
    v_add_f32 v224, 1.0, v224
    v_mfma_f32_32x32x16_bf16 v[208:223], a[196:199], v[92:95], v[208:223]
    ds_read_b64_tr_b16 a[180:181], v12 offset:52224
    ds_read_b64_tr_b16 a[182:183], v12 offset:52736
    v_add_f32 v225, 1.0, v225
    v_add_f32 v226, 1.0, v226
    v_add_f32 v227, 1.0, v227
    v_rcp_f32 v224, v224
    v_mfma_f32_32x32x16_bf16 v[192:207], a[200:203], v[96:99], v[192:207]
    s_waitcnt vmcnt(19)
    s_barrier
    ds_read_b64_tr_b16 a[184:185], v9 offset:57344
    ds_read_b64_tr_b16 a[186:187], v9 offset:57856
    s_add_u32 m0, s47, 73728
    s_add_u32 s54, s80, 384
    v_rcp_f32 v225, v225
    v_rcp_f32 v226, v226
    v_mfma_f32_32x32x16_bf16 v[208:223], a[204:207], v[96:99], v[208:223]
    ds_read_b64_tr_b16 a[188:189], v12 offset:57344
    ds_read_b64_tr_b16 a[190:191], v12 offset:57856
    v_rcp_f32 v227, v227
    v_mul_f32 v224, v176, v224
    s_waitcnt lgkmcnt(8)
    v_mfma_f32_32x32x16_bf16 v[192:207], a[160:163], v[100:103], v[192:207]
    ds_read_b64_tr_b16 a[192:193], v9 offset:58368
    ds_read_b64_tr_b16 a[194:195], v9 offset:58880
    buffer_load_dwordx4 v2, s[12:15], s54 offen offset:0 lds
    v_mul_f32 v225, v177, v225
    v_mul_f32 v226, v178, v226
    v_mul_f32 v227, v179, v227
    v_cvt_pk_bf16_f32 v232, v224, v225
    v_mfma_f32_32x32x16_bf16 v[208:223], a[164:167], v[100:103], v[208:223]
    ds_read_b64_tr_b16 a[196:197], v12 offset:58368
    ds_read_b64_tr_b16 a[198:199], v12 offset:58880
    v_cvt_pk_bf16_f32 v233, v226, v227
    v_accvgpr_write_b32 a8, v232
    v_accvgpr_write_b32 a9, v233
    v_mfma_f32_32x32x16_bf16 v[192:207], a[168:171], v[104:107], v[192:207]
    ds_read_b64_tr_b16 a[200:201], v9 offset:59392
    ds_read_b64_tr_b16 a[202:203], v9 offset:59904
    v_mul_f32 v228, v255, v180
    v_mul_f32 v229, v255, v181
    v_mul_f32 v230, v255, v182
    v_mfma_f32_32x32x16_bf16 v[208:223], a[172:175], v[104:107], v[208:223]
    ds_read_b64_tr_b16 a[204:205], v12 offset:59392
    ds_read_b64_tr_b16 a[206:207], v12 offset:59904
    buffer_load_dwordx4 v3, s[12:15], s54 offen offset:1024 lds
    v_mul_f32 v231, v255, v183
    v_exp_f32 v228, v228
    v_exp_f32 v229, v229
    s_waitcnt lgkmcnt(8)
    v_mfma_f32_32x32x16_bf16 v[192:207], a[176:179], v[108:111], v[192:207]
    ds_read_b64_tr_b16 a[160:161], v9 offset:60416
    ds_read_b64_tr_b16 a[162:163], v9 offset:60928
    v_exp_f32 v230, v230
    v_mfma_f32_32x32x16_bf16 v[208:223], a[180:183], v[108:111], v[208:223]
    ds_read_b64_tr_b16 a[164:165], v12 offset:60416
    ds_read_b64_tr_b16 a[166:167], v12 offset:60928
    v_exp_f32 v231, v231
    v_add_f32 v228, 1.0, v228
    v_add_f32 v229, 1.0, v229
    v_add_f32 v230, 1.0, v230
    v_mfma_f32_32x32x16_bf16 v[192:207], a[184:187], v[112:115], v[192:207]
    ds_read_b64_tr_b16 a[168:169], v10 offset:0
    ds_read_b64_tr_b16 a[170:171], v10 offset:512
    buffer_load_dwordx4 v4, s[12:15], s54 offen offset:2048 lds
    v_add_f32 v231, 1.0, v231
    v_rcp_f32 v228, v228
    v_mfma_f32_32x32x16_bf16 v[208:223], a[188:191], v[112:115], v[208:223]
    ds_read_b64_tr_b16 a[172:173], v13 offset:0
    ds_read_b64_tr_b16 a[174:175], v13 offset:512
    s_add_u32 m0, s47, 76800
    s_add_u32 s54, s80, 221568
    v_rcp_f32 v229, v229
    v_rcp_f32 v230, v230
    s_waitcnt lgkmcnt(8)
    v_mfma_f32_32x32x16_bf16 v[192:207], a[192:195], v[116:119], v[192:207]
    ds_read_b64_tr_b16 a[176:177], v10 offset:1024
    ds_read_b64_tr_b16 a[178:179], v10 offset:1536
    v_rcp_f32 v231, v231
    v_mul_f32 v228, v180, v228
    v_mul_f32 v229, v181, v229
    v_mfma_f32_32x32x16_bf16 v[208:223], a[196:199], v[116:119], v[208:223]
    ds_read_b64_tr_b16 a[180:181], v13 offset:1024
    ds_read_b64_tr_b16 a[182:183], v13 offset:1536
    v_mul_f32 v230, v182, v230
    v_mul_f32 v231, v183, v231
    v_cvt_pk_bf16_f32 v234, v228, v229
    v_cvt_pk_bf16_f32 v235, v230, v231
    buffer_load_dword v252, v251, s[16:19], s75 offen
    s_add_u32 s75, s75, 13824
    v_mfma_f32_32x32x16_bf16 v[192:207], a[200:203], v[120:123], v[192:207]
    ds_read_b64_tr_b16 a[184:185], v10 offset:2048
    ds_read_b64_tr_b16 a[186:187], v10 offset:2560
    buffer_load_dwordx4 v2, s[12:15], s54 offen offset:0 lds
    v_accvgpr_write_b32 a10, v234
    v_accvgpr_write_b32 a11, v235
    v_mul_f32 v224, v255, v184
    v_mfma_f32_32x32x16_bf16 v[208:223], a[204:207], v[120:123], v[208:223]
    ds_read_b64_tr_b16 a[188:189], v13 offset:2048
    ds_read_b64_tr_b16 a[190:191], v13 offset:2560
    v_mul_f32 v225, v255, v185
    v_mul_f32 v226, v255, v186
    v_mul_f32 v227, v255, v187
    s_waitcnt lgkmcnt(8)
    v_mfma_f32_32x32x16_bf16 v[192:207], a[160:163], v[124:127], v[192:207]
    ds_read_b64_tr_b16 a[192:193], v10 offset:3072
    ds_read_b64_tr_b16 a[194:195], v10 offset:3584
    v_exp_f32 v224, v224
    v_exp_f32 v225, v225
    v_mfma_f32_32x32x16_bf16 v[208:223], a[164:167], v[124:127], v[208:223]
    ds_read_b64_tr_b16 a[196:197], v13 offset:3072
    ds_read_b64_tr_b16 a[198:199], v13 offset:3584
    v_exp_f32 v226, v226
    v_exp_f32 v227, v227
    v_mfma_f32_32x32x16_bf16 v[192:207], a[168:171], v[128:131], v[192:207]
    ds_read_b64_tr_b16 a[200:201], v10 offset:8192
    ds_read_b64_tr_b16 a[202:203], v10 offset:8704
    buffer_load_dwordx4 v3, s[12:15], s54 offen offset:1024 lds
    v_add_f32 v224, 1.0, v224
    v_add_f32 v225, 1.0, v225
    v_add_f32 v226, 1.0, v226
    v_add_f32 v227, 1.0, v227
    v_mfma_f32_32x32x16_bf16 v[208:223], a[172:175], v[128:131], v[208:223]
    ds_read_b64_tr_b16 a[204:205], v13 offset:8192
    ds_read_b64_tr_b16 a[206:207], v13 offset:8704
    v_rcp_f32 v224, v224
    v_rcp_f32 v225, v225
    s_waitcnt lgkmcnt(8)
    v_mfma_f32_32x32x16_bf16 v[192:207], a[176:179], v[132:135], v[192:207]
    ds_read_b64_tr_b16 a[160:161], v10 offset:9216
    ds_read_b64_tr_b16 a[162:163], v10 offset:9728
    v_rcp_f32 v226, v226
    v_rcp_f32 v227, v227
    v_mfma_f32_32x32x16_bf16 v[208:223], a[180:183], v[132:135], v[208:223]
    ds_read_b64_tr_b16 a[164:165], v13 offset:9216
    ds_read_b64_tr_b16 a[166:167], v13 offset:9728
    v_mul_f32 v224, v184, v224
    v_mul_f32 v225, v185, v225
    v_mul_f32 v226, v186, v226
    v_mul_f32 v227, v187, v227
    v_mfma_f32_32x32x16_bf16 v[192:207], a[184:187], v[136:139], v[192:207]
    ds_read_b64_tr_b16 a[168:169], v10 offset:10240
    ds_read_b64_tr_b16 a[170:171], v10 offset:10752
    buffer_load_dwordx4 v4, s[12:15], s54 offen offset:2048 lds
    v_cvt_pk_bf16_f32 v232, v224, v225
    v_cvt_pk_bf16_f32 v233, v226, v227
    v_accvgpr_write_b32 a12, v232
    v_mfma_f32_32x32x16_bf16 v[208:223], a[188:191], v[136:139], v[208:223]
    ds_read_b64_tr_b16 a[172:173], v13 offset:10240
    ds_read_b64_tr_b16 a[174:175], v13 offset:10752
    v_accvgpr_write_b32 a13, v233
    v_mul_f32 v228, v255, v188
    v_mul_f32 v229, v255, v189
    s_waitcnt lgkmcnt(8)
    v_mfma_f32_32x32x16_bf16 v[192:207], a[192:195], v[140:143], v[192:207]
    ds_read_b64_tr_b16 a[176:177], v10 offset:11264
    ds_read_b64_tr_b16 a[178:179], v10 offset:11776
    v_mul_f32 v230, v255, v190
    v_mul_f32 v231, v255, v191
    v_exp_f32 v228, v228
    v_mfma_f32_32x32x16_bf16 v[208:223], a[196:199], v[140:143], v[208:223]
    ds_read_b64_tr_b16 a[180:181], v13 offset:11264
    ds_read_b64_tr_b16 a[182:183], v13 offset:11776
    v_exp_f32 v229, v229
    v_exp_f32 v230, v230
    v_mfma_f32_32x32x16_bf16 v[192:207], a[200:203], v[144:147], v[192:207]
    s_waitcnt vmcnt(20)
    s_barrier
    ds_read_b64_tr_b16 a[184:185], v8 offset:0
    ds_read_b64_tr_b16 a[186:187], v8 offset:512
    s_add_u32 m0, s47, 98304
    s_add_u32 s54, s81, 384
    v_exp_f32 v231, v231
    v_add_f32 v228, 1.0, v228
    v_add_f32 v229, 1.0, v229
    v_mfma_f32_32x32x16_bf16 v[208:223], a[204:207], v[144:147], v[208:223]
    ds_read_b64_tr_b16 a[188:189], v11 offset:0
    ds_read_b64_tr_b16 a[190:191], v11 offset:512
    v_add_f32 v230, 1.0, v230
    v_add_f32 v231, 1.0, v231
    v_rcp_f32 v228, v228
    s_waitcnt lgkmcnt(8)
    v_mfma_f32_32x32x16_bf16 v[192:207], a[160:163], v[148:151], v[192:207]
    ds_read_b64_tr_b16 a[192:193], v8 offset:1024
    ds_read_b64_tr_b16 a[194:195], v8 offset:1536
    buffer_load_dwordx4 v2, s[12:15], s54 offen offset:0 lds
    v_rcp_f32 v229, v229
    v_rcp_f32 v230, v230
    v_mfma_f32_32x32x16_bf16 v[208:223], a[164:167], v[148:151], v[208:223]
    ds_read_b64_tr_b16 a[196:197], v11 offset:1024
    ds_read_b64_tr_b16 a[198:199], v11 offset:1536
    v_rcp_f32 v231, v231
    v_mul_f32 v228, v188, v228
    v_mfma_f32_32x32x16_bf16 v[192:207], a[168:171], v[152:155], v[192:207]
    ds_read_b64_tr_b16 a[200:201], v8 offset:2048
    ds_read_b64_tr_b16 a[202:203], v8 offset:2560
    v_mul_f32 v229, v189, v229
    v_mul_f32 v230, v190, v230
    v_mul_f32 v231, v191, v231
    v_cvt_pk_bf16_f32 v234, v228, v229
    v_mfma_f32_32x32x16_bf16 v[208:223], a[172:175], v[152:155], v[208:223]
    ds_read_b64_tr_b16 a[204:205], v11 offset:2048
    ds_read_b64_tr_b16 a[206:207], v11 offset:2560
    buffer_load_dwordx4 v3, s[12:15], s54 offen offset:1024 lds
    v_cvt_pk_bf16_f32 v235, v230, v231
    v_accvgpr_write_b32 a14, v234
    v_accvgpr_write_b32 a15, v235
    s_waitcnt lgkmcnt(8)
    v_mfma_f32_32x32x16_bf16 v[192:207], a[176:179], v[156:159], v[192:207]
    ds_read_b64_tr_b16 a[160:161], v8 offset:3072
    ds_read_b64_tr_b16 a[162:163], v8 offset:3584
    v_mfma_f32_32x32x16_bf16 v[208:223], a[180:183], v[156:159], v[208:223]
    ds_read_b64_tr_b16 a[164:165], v11 offset:3072
    ds_read_b64_tr_b16 a[166:167], v11 offset:3584
    v_mfma_f32_32x32x16_bf16 v[160:175], a[184:187], v[16:19], 0
    ds_read_b64_tr_b16 a[168:169], v8 offset:8192
    ds_read_b64_tr_b16 a[170:171], v8 offset:8704
    buffer_load_dwordx4 v4, s[12:15], s54 offen offset:2048 lds
    v_mfma_f32_32x32x16_bf16 v[176:191], a[188:191], v[16:19], 0
    ds_read_b64_tr_b16 a[172:173], v11 offset:8192
    ds_read_b64_tr_b16 a[174:175], v11 offset:8704
    s_add_u32 m0, s47, 101376
    s_add_u32 s54, s81, 221568
    v_mul_f32 v224, v255, v192
    v_mul_f32 v225, v255, v193
    v_mul_f32 v226, v255, v194
    v_mul_f32 v227, v255, v195
    s_waitcnt lgkmcnt(8)
    v_mfma_f32_32x32x16_bf16 v[160:175], a[192:195], v[20:23], v[160:175]
    ds_read_b64_tr_b16 a[176:177], v8 offset:9216
    ds_read_b64_tr_b16 a[178:179], v8 offset:9728
    v_exp_f32 v224, v224
    v_exp_f32 v225, v225
    v_mfma_f32_32x32x16_bf16 v[176:191], a[196:199], v[20:23], v[176:191]
    ds_read_b64_tr_b16 a[180:181], v11 offset:9216
    ds_read_b64_tr_b16 a[182:183], v11 offset:9728
    v_exp_f32 v226, v226
    v_exp_f32 v227, v227
    v_mfma_f32_32x32x16_bf16 v[160:175], a[200:203], v[24:27], v[160:175]
    ds_read_b64_tr_b16 a[184:185], v8 offset:10240
    ds_read_b64_tr_b16 a[186:187], v8 offset:10752
    buffer_load_dwordx4 v2, s[12:15], s54 offen offset:0 lds
    v_add_f32 v224, 1.0, v224
    v_add_f32 v225, 1.0, v225
    v_add_f32 v226, 1.0, v226
    v_mfma_f32_32x32x16_bf16 v[176:191], a[204:207], v[24:27], v[176:191]
    ds_read_b64_tr_b16 a[188:189], v11 offset:10240
    ds_read_b64_tr_b16 a[190:191], v11 offset:10752
    v_add_f32 v227, 1.0, v227
    v_rcp_f32 v224, v224
    v_rcp_f32 v225, v225
    s_waitcnt lgkmcnt(8)
    v_mfma_f32_32x32x16_bf16 v[160:175], a[160:163], v[28:31], v[160:175]
    ds_read_b64_tr_b16 a[192:193], v8 offset:11264
    ds_read_b64_tr_b16 a[194:195], v8 offset:11776
    v_rcp_f32 v226, v226
    v_mfma_f32_32x32x16_bf16 v[176:191], a[164:167], v[28:31], v[176:191]
    ds_read_b64_tr_b16 a[196:197], v11 offset:11264
    ds_read_b64_tr_b16 a[198:199], v11 offset:11776
    v_rcp_f32 v227, v227
    v_mul_f32 v224, v192, v224
    v_mul_f32 v225, v193, v225
    v_mul_f32 v226, v194, v226
    v_mfma_f32_32x32x16_bf16 v[160:175], a[168:171], v[32:35], v[160:175]
    ds_read_b64_tr_b16 a[200:201], v8 offset:16384
    ds_read_b64_tr_b16 a[202:203], v8 offset:16896
    buffer_load_dwordx4 v3, s[12:15], s54 offen offset:1024 lds
    v_mul_f32 v227, v195, v227
    v_cvt_pk_bf16_f32 v232, v224, v225
    v_cvt_pk_bf16_f32 v233, v226, v227
    v_mfma_f32_32x32x16_bf16 v[176:191], a[172:175], v[32:35], v[176:191]
    ds_read_b64_tr_b16 a[204:205], v11 offset:16384
    ds_read_b64_tr_b16 a[206:207], v11 offset:16896
    v_accvgpr_write_b32 a16, v232
    v_accvgpr_write_b32 a17, v233
    v_mul_f32 v228, v255, v196
    s_waitcnt lgkmcnt(8)
    v_mfma_f32_32x32x16_bf16 v[160:175], a[176:179], v[36:39], v[160:175]
    ds_read_b64_tr_b16 a[160:161], v8 offset:17408
    ds_read_b64_tr_b16 a[162:163], v8 offset:17920
    v_mul_f32 v229, v255, v197
    v_mul_f32 v230, v255, v198
    v_mul_f32 v231, v255, v199
    v_exp_f32 v228, v228
    v_mfma_f32_32x32x16_bf16 v[176:191], a[180:183], v[36:39], v[176:191]
    ds_read_b64_tr_b16 a[164:165], v11 offset:17408
    ds_read_b64_tr_b16 a[166:167], v11 offset:17920
    v_exp_f32 v229, v229
    v_exp_f32 v230, v230
    v_mfma_f32_32x32x16_bf16 v[160:175], a[184:187], v[40:43], v[160:175]
    ds_read_b64_tr_b16 a[168:169], v8 offset:18432
    ds_read_b64_tr_b16 a[170:171], v8 offset:18944
    buffer_load_dwordx4 v4, s[12:15], s54 offen offset:2048 lds
    v_exp_f32 v231, v231
    v_add_f32 v228, 1.0, v228
    v_mfma_f32_32x32x16_bf16 v[176:191], a[188:191], v[40:43], v[176:191]
    ds_read_b64_tr_b16 a[172:173], v11 offset:18432
    ds_read_b64_tr_b16 a[174:175], v11 offset:18944
    v_add_f32 v229, 1.0, v229
    v_add_f32 v230, 1.0, v230
    v_add_f32 v231, 1.0, v231
    s_waitcnt lgkmcnt(8)
    v_mfma_f32_32x32x16_bf16 v[160:175], a[192:195], v[44:47], v[160:175]
    ds_read_b64_tr_b16 a[176:177], v8 offset:19456
    ds_read_b64_tr_b16 a[178:179], v8 offset:19968
    v_rcp_f32 v228, v228
    v_rcp_f32 v229, v229
    v_mfma_f32_32x32x16_bf16 v[176:191], a[196:199], v[44:47], v[176:191]
    ds_read_b64_tr_b16 a[180:181], v11 offset:19456
    ds_read_b64_tr_b16 a[182:183], v11 offset:19968
    v_rcp_f32 v230, v230
    v_rcp_f32 v231, v231
    v_mfma_f32_32x32x16_bf16 v[160:175], a[200:203], v[48:51], v[160:175]
    s_waitcnt vmcnt(19)
    s_barrier
    ds_read_b64_tr_b16 a[184:185], v8 offset:24576
    ds_read_b64_tr_b16 a[186:187], v8 offset:25088
    s_add_u32 m0, s47, 122880
    s_add_u32 s54, s82, 384
    v_mul_f32 v228, v196, v228
    v_mul_f32 v229, v197, v229
    v_mul_f32 v230, v198, v230
    v_mul_f32 v231, v199, v231
    v_mfma_f32_32x32x16_bf16 v[176:191], a[204:207], v[48:51], v[176:191]
    ds_read_b64_tr_b16 a[188:189], v11 offset:24576
    ds_read_b64_tr_b16 a[190:191], v11 offset:25088
    v_cvt_pk_bf16_f32 v234, v228, v229
    v_cvt_pk_bf16_f32 v235, v230, v231
    v_accvgpr_write_b32 a18, v234
    s_waitcnt lgkmcnt(8)
    v_mfma_f32_32x32x16_bf16 v[160:175], a[160:163], v[52:55], v[160:175]
    ds_read_b64_tr_b16 a[192:193], v8 offset:25600
    ds_read_b64_tr_b16 a[194:195], v8 offset:26112
    buffer_load_dwordx4 v2, s[12:15], s54 offen offset:0 lds
    v_accvgpr_write_b32 a19, v235
    v_mul_f32 v224, v255, v200
    v_mul_f32 v225, v255, v201
    v_mul_f32 v226, v255, v202
    v_mfma_f32_32x32x16_bf16 v[176:191], a[164:167], v[52:55], v[176:191]
    ds_read_b64_tr_b16 a[196:197], v11 offset:25600
    ds_read_b64_tr_b16 a[198:199], v11 offset:26112
    v_mul_f32 v227, v255, v203
    v_exp_f32 v224, v224
    v_mfma_f32_32x32x16_bf16 v[160:175], a[168:171], v[56:59], v[160:175]
    ds_read_b64_tr_b16 a[200:201], v8 offset:26624
    ds_read_b64_tr_b16 a[202:203], v8 offset:27136
    v_exp_f32 v225, v225
    v_exp_f32 v226, v226
    v_mfma_f32_32x32x16_bf16 v[176:191], a[172:175], v[56:59], v[176:191]
    ds_read_b64_tr_b16 a[204:205], v11 offset:26624
    ds_read_b64_tr_b16 a[206:207], v11 offset:27136
    buffer_load_dwordx4 v3, s[12:15], s54 offen offset:1024 lds
    v_exp_f32 v227, v227
    v_add_f32 v224, 1.0, v224
    v_add_f32 v225, 1.0, v225
    s_waitcnt lgkmcnt(8)
    v_mfma_f32_32x32x16_bf16 v[160:175], a[176:179], v[60:63], v[160:175]
    ds_read_b64_tr_b16 a[160:161], v8 offset:27648
    ds_read_b64_tr_b16 a[162:163], v8 offset:28160
    v_add_f32 v226, 1.0, v226
    v_add_f32 v227, 1.0, v227
    v_rcp_f32 v224, v224
    v_mfma_f32_32x32x16_bf16 v[176:191], a[180:183], v[60:63], v[176:191]
    ds_read_b64_tr_b16 a[164:165], v11 offset:27648
    ds_read_b64_tr_b16 a[166:167], v11 offset:28160
    v_rcp_f32 v225, v225
    v_rcp_f32 v226, v226
    v_mfma_f32_32x32x16_bf16 v[160:175], a[184:187], v[64:67], v[160:175]
    ds_read_b64_tr_b16 a[168:169], v8 offset:32768
    ds_read_b64_tr_b16 a[170:171], v8 offset:33280
    buffer_load_dwordx4 v4, s[12:15], s54 offen offset:2048 lds
    v_rcp_f32 v227, v227
    v_mul_f32 v224, v200, v224
    v_mul_f32 v225, v201, v225
    buffer_load_dword v252, v251, s[16:19], s75 offen
    s_add_u32 s75, s75, 13824
    v_mfma_f32_32x32x16_bf16 v[176:191], a[188:191], v[64:67], v[176:191]
    ds_read_b64_tr_b16 a[172:173], v11 offset:32768
    ds_read_b64_tr_b16 a[174:175], v11 offset:33280
    s_add_u32 m0, s47, 125952
    s_add_u32 s54, s82, 221568
    v_mul_f32 v226, v202, v226
    v_mul_f32 v227, v203, v227
    v_cvt_pk_bf16_f32 v232, v224, v225
    s_waitcnt lgkmcnt(8)
    v_mfma_f32_32x32x16_bf16 v[160:175], a[192:195], v[68:71], v[160:175]
    ds_read_b64_tr_b16 a[176:177], v8 offset:33792
    ds_read_b64_tr_b16 a[178:179], v8 offset:34304
    v_cvt_pk_bf16_f32 v233, v226, v227
    v_accvgpr_write_b32 a20, v232
    v_accvgpr_write_b32 a21, v233
    v_mfma_f32_32x32x16_bf16 v[176:191], a[196:199], v[68:71], v[176:191]
    ds_read_b64_tr_b16 a[180:181], v11 offset:33792
    ds_read_b64_tr_b16 a[182:183], v11 offset:34304
    v_mul_f32 v228, v255, v204
    v_mul_f32 v229, v255, v205
    v_mul_f32 v230, v255, v206
    v_mul_f32 v231, v255, v207
    v_mfma_f32_32x32x16_bf16 v[160:175], a[200:203], v[72:75], v[160:175]
    ds_read_b64_tr_b16 a[184:185], v8 offset:34816
    ds_read_b64_tr_b16 a[186:187], v8 offset:35328
    buffer_load_dwordx4 v2, s[12:15], s54 offen offset:0 lds
    v_exp_f32 v228, v228
    v_exp_f32 v229, v229
    v_mfma_f32_32x32x16_bf16 v[176:191], a[204:207], v[72:75], v[176:191]
    ds_read_b64_tr_b16 a[188:189], v11 offset:34816
    ds_read_b64_tr_b16 a[190:191], v11 offset:35328
    v_exp_f32 v230, v230
    v_exp_f32 v231, v231
    s_waitcnt lgkmcnt(8)
    v_mfma_f32_32x32x16_bf16 v[160:175], a[160:163], v[76:79], v[160:175]
    ds_read_b64_tr_b16 a[192:193], v8 offset:35840
    ds_read_b64_tr_b16 a[194:195], v8 offset:36352
    v_add_f32 v228, 1.0, v228
    v_add_f32 v229, 1.0, v229
    v_add_f32 v230, 1.0, v230
    v_add_f32 v231, 1.0, v231
    v_mfma_f32_32x32x16_bf16 v[176:191], a[164:167], v[76:79], v[176:191]
    ds_read_b64_tr_b16 a[196:197], v11 offset:35840
    ds_read_b64_tr_b16 a[198:199], v11 offset:36352
    v_rcp_f32 v228, v228
    v_rcp_f32 v229, v229
    v_mfma_f32_32x32x16_bf16 v[160:175], a[168:171], v[80:83], v[160:175]
    ds_read_b64_tr_b16 a[200:201], v8 offset:40960
    ds_read_b64_tr_b16 a[202:203], v8 offset:41472
    buffer_load_dwordx4 v3, s[12:15], s54 offen offset:1024 lds
    v_rcp_f32 v230, v230
    v_rcp_f32 v231, v231
    v_mfma_f32_32x32x16_bf16 v[176:191], a[172:175], v[80:83], v[176:191]
    ds_read_b64_tr_b16 a[204:205], v11 offset:40960
    ds_read_b64_tr_b16 a[206:207], v11 offset:41472
    v_mul_f32 v228, v204, v228
    v_mul_f32 v229, v205, v229
    v_mul_f32 v230, v206, v230
    s_waitcnt lgkmcnt(8)
    v_mfma_f32_32x32x16_bf16 v[160:175], a[176:179], v[84:87], v[160:175]
    ds_read_b64_tr_b16 a[160:161], v8 offset:41984
    ds_read_b64_tr_b16 a[162:163], v8 offset:42496
    v_mul_f32 v231, v207, v231
    v_cvt_pk_bf16_f32 v234, v228, v229
    v_cvt_pk_bf16_f32 v235, v230, v231
    v_mfma_f32_32x32x16_bf16 v[176:191], a[180:183], v[84:87], v[176:191]
    ds_read_b64_tr_b16 a[164:165], v11 offset:41984
    ds_read_b64_tr_b16 a[166:167], v11 offset:42496
    v_accvgpr_write_b32 a22, v234
    v_accvgpr_write_b32 a23, v235
    v_mul_f32 v224, v255, v208
    v_mul_f32 v225, v255, v209
    v_mfma_f32_32x32x16_bf16 v[160:175], a[184:187], v[88:91], v[160:175]
    ds_read_b64_tr_b16 a[168:169], v8 offset:43008
    ds_read_b64_tr_b16 a[170:171], v8 offset:43520
    buffer_load_dwordx4 v4, s[12:15], s54 offen offset:2048 lds
    v_mul_f32 v226, v255, v210
    v_mul_f32 v227, v255, v211
    v_exp_f32 v224, v224
    v_mfma_f32_32x32x16_bf16 v[176:191], a[188:191], v[88:91], v[176:191]
    ds_read_b64_tr_b16 a[172:173], v11 offset:43008
    ds_read_b64_tr_b16 a[174:175], v11 offset:43520
    v_exp_f32 v225, v225
    v_exp_f32 v226, v226
    s_waitcnt lgkmcnt(8)
    v_mfma_f32_32x32x16_bf16 v[160:175], a[192:195], v[92:95], v[160:175]
    ds_read_b64_tr_b16 a[176:177], v8 offset:44032
    ds_read_b64_tr_b16 a[178:179], v8 offset:44544
    v_exp_f32 v227, v227
    v_add_f32 v224, 1.0, v224
    v_mfma_f32_32x32x16_bf16 v[176:191], a[196:199], v[92:95], v[176:191]
    ds_read_b64_tr_b16 a[180:181], v11 offset:44032
    ds_read_b64_tr_b16 a[182:183], v11 offset:44544
    v_add_f32 v225, 1.0, v225
    v_add_f32 v226, 1.0, v226
    v_add_f32 v227, 1.0, v227
    v_rcp_f32 v224, v224
    v_mfma_f32_32x32x16_bf16 v[160:175], a[200:203], v[96:99], v[160:175]
    s_waitcnt vmcnt(20)
    s_barrier
    ds_read_b64_tr_b16 a[184:185], v8 offset:49152
    ds_read_b64_tr_b16 a[186:187], v8 offset:49664
    s_add_u32 m0, s47, 0
    s_add_u32 s54, s80, 512
    v_rcp_f32 v225, v225
    v_rcp_f32 v226, v226
    v_mfma_f32_32x32x16_bf16 v[176:191], a[204:207], v[96:99], v[176:191]
    ds_read_b64_tr_b16 a[188:189], v11 offset:49152
    ds_read_b64_tr_b16 a[190:191], v11 offset:49664
    v_rcp_f32 v227, v227
    v_mul_f32 v224, v208, v224
    s_waitcnt lgkmcnt(8)
    v_mfma_f32_32x32x16_bf16 v[160:175], a[160:163], v[100:103], v[160:175]
    ds_read_b64_tr_b16 a[192:193], v8 offset:50176
    ds_read_b64_tr_b16 a[194:195], v8 offset:50688
    buffer_load_dwordx4 v2, s[12:15], s54 offen offset:0 lds
    v_mul_f32 v225, v209, v225
    v_mul_f32 v226, v210, v226
    v_mul_f32 v227, v211, v227
    v_cvt_pk_bf16_f32 v232, v224, v225
    v_mfma_f32_32x32x16_bf16 v[176:191], a[164:167], v[100:103], v[176:191]
    ds_read_b64_tr_b16 a[196:197], v11 offset:50176
    ds_read_b64_tr_b16 a[198:199], v11 offset:50688
    v_cvt_pk_bf16_f32 v233, v226, v227
    v_accvgpr_write_b32 a24, v232
    v_accvgpr_write_b32 a25, v233
    v_mfma_f32_32x32x16_bf16 v[160:175], a[168:171], v[104:107], v[160:175]
    ds_read_b64_tr_b16 a[200:201], v8 offset:51200
    ds_read_b64_tr_b16 a[202:203], v8 offset:51712
    v_mul_f32 v228, v255, v212
    v_mul_f32 v229, v255, v213
    v_mul_f32 v230, v255, v214
    v_mfma_f32_32x32x16_bf16 v[176:191], a[172:175], v[104:107], v[176:191]
    ds_read_b64_tr_b16 a[204:205], v11 offset:51200
    ds_read_b64_tr_b16 a[206:207], v11 offset:51712
    buffer_load_dwordx4 v3, s[12:15], s54 offen offset:1024 lds
    v_mul_f32 v231, v255, v215
    v_exp_f32 v228, v228
    v_exp_f32 v229, v229
    s_waitcnt lgkmcnt(8)
    v_mfma_f32_32x32x16_bf16 v[160:175], a[176:179], v[108:111], v[160:175]
    ds_read_b64_tr_b16 a[160:161], v8 offset:52224
    ds_read_b64_tr_b16 a[162:163], v8 offset:52736
    v_exp_f32 v230, v230
    v_mfma_f32_32x32x16_bf16 v[176:191], a[180:183], v[108:111], v[176:191]
    ds_read_b64_tr_b16 a[164:165], v11 offset:52224
    ds_read_b64_tr_b16 a[166:167], v11 offset:52736
    v_exp_f32 v231, v231
    v_add_f32 v228, 1.0, v228
    v_add_f32 v229, 1.0, v229
    v_add_f32 v230, 1.0, v230
    v_mfma_f32_32x32x16_bf16 v[160:175], a[184:187], v[112:115], v[160:175]
    ds_read_b64_tr_b16 a[168:169], v8 offset:57344
    ds_read_b64_tr_b16 a[170:171], v8 offset:57856
    buffer_load_dwordx4 v4, s[12:15], s54 offen offset:2048 lds
    v_add_f32 v231, 1.0, v231
    v_rcp_f32 v228, v228
    v_mfma_f32_32x32x16_bf16 v[176:191], a[188:191], v[112:115], v[176:191]
    ds_read_b64_tr_b16 a[172:173], v11 offset:57344
    ds_read_b64_tr_b16 a[174:175], v11 offset:57856
    s_add_u32 m0, s47, 3072
    s_add_u32 s54, s80, 221696
    v_rcp_f32 v229, v229
    v_rcp_f32 v230, v230
    s_waitcnt lgkmcnt(8)
    v_mfma_f32_32x32x16_bf16 v[160:175], a[192:195], v[116:119], v[160:175]
    ds_read_b64_tr_b16 a[176:177], v8 offset:58368
    ds_read_b64_tr_b16 a[178:179], v8 offset:58880
    v_rcp_f32 v231, v231
    v_mul_f32 v228, v212, v228
    v_mul_f32 v229, v213, v229
    v_mfma_f32_32x32x16_bf16 v[176:191], a[196:199], v[116:119], v[176:191]
    ds_read_b64_tr_b16 a[180:181], v11 offset:58368
    ds_read_b64_tr_b16 a[182:183], v11 offset:58880
    v_mul_f32 v230, v214, v230
    v_mul_f32 v231, v215, v231
    v_cvt_pk_bf16_f32 v234, v228, v229
    v_cvt_pk_bf16_f32 v235, v230, v231
    v_mfma_f32_32x32x16_bf16 v[160:175], a[200:203], v[120:123], v[160:175]
    ds_read_b64_tr_b16 a[184:185], v8 offset:59392
    ds_read_b64_tr_b16 a[186:187], v8 offset:59904
    buffer_load_dwordx4 v2, s[12:15], s54 offen offset:0 lds
    v_accvgpr_write_b32 a26, v234
    v_accvgpr_write_b32 a27, v235
    v_mul_f32 v224, v255, v216
    v_mfma_f32_32x32x16_bf16 v[176:191], a[204:207], v[120:123], v[176:191]
    ds_read_b64_tr_b16 a[188:189], v11 offset:59392
    ds_read_b64_tr_b16 a[190:191], v11 offset:59904
    v_mul_f32 v225, v255, v217
    v_mul_f32 v226, v255, v218
    v_mul_f32 v227, v255, v219
    s_waitcnt lgkmcnt(8)
    v_mfma_f32_32x32x16_bf16 v[160:175], a[160:163], v[124:127], v[160:175]
    ds_read_b64_tr_b16 a[192:193], v8 offset:60416
    ds_read_b64_tr_b16 a[194:195], v8 offset:60928
    v_exp_f32 v224, v224
    v_exp_f32 v225, v225
    v_mfma_f32_32x32x16_bf16 v[176:191], a[164:167], v[124:127], v[176:191]
    ds_read_b64_tr_b16 a[196:197], v11 offset:60416
    ds_read_b64_tr_b16 a[198:199], v11 offset:60928
    v_exp_f32 v226, v226
    v_exp_f32 v227, v227
    v_mfma_f32_32x32x16_bf16 v[160:175], a[168:171], v[128:131], v[160:175]
    ds_read_b64_tr_b16 a[200:201], v9 offset:0
    ds_read_b64_tr_b16 a[202:203], v9 offset:512
    buffer_load_dwordx4 v3, s[12:15], s54 offen offset:1024 lds
    v_add_f32 v224, 1.0, v224
    v_add_f32 v225, 1.0, v225
    v_add_f32 v226, 1.0, v226
    v_add_f32 v227, 1.0, v227
    v_mfma_f32_32x32x16_bf16 v[176:191], a[172:175], v[128:131], v[176:191]
    ds_read_b64_tr_b16 a[204:205], v12 offset:0
    ds_read_b64_tr_b16 a[206:207], v12 offset:512
    v_rcp_f32 v224, v224
    v_rcp_f32 v225, v225
    s_waitcnt lgkmcnt(8)
    v_mfma_f32_32x32x16_bf16 v[160:175], a[176:179], v[132:135], v[160:175]
    ds_read_b64_tr_b16 a[160:161], v9 offset:1024
    ds_read_b64_tr_b16 a[162:163], v9 offset:1536
    v_rcp_f32 v226, v226
    v_rcp_f32 v227, v227
    v_mfma_f32_32x32x16_bf16 v[176:191], a[180:183], v[132:135], v[176:191]
    ds_read_b64_tr_b16 a[164:165], v12 offset:1024
    ds_read_b64_tr_b16 a[166:167], v12 offset:1536
    v_mul_f32 v224, v216, v224
    v_mul_f32 v225, v217, v225
    v_mul_f32 v226, v218, v226
    v_mul_f32 v227, v219, v227
    v_mfma_f32_32x32x16_bf16 v[160:175], a[184:187], v[136:139], v[160:175]
    ds_read_b64_tr_b16 a[168:169], v9 offset:2048
    ds_read_b64_tr_b16 a[170:171], v9 offset:2560
    buffer_load_dwordx4 v4, s[12:15], s54 offen offset:2048 lds
    v_cvt_pk_bf16_f32 v232, v224, v225
    v_cvt_pk_bf16_f32 v233, v226, v227
    v_accvgpr_write_b32 a28, v232
    v_mfma_f32_32x32x16_bf16 v[176:191], a[188:191], v[136:139], v[176:191]
    ds_read_b64_tr_b16 a[172:173], v12 offset:2048
    ds_read_b64_tr_b16 a[174:175], v12 offset:2560
    v_accvgpr_write_b32 a29, v233
    v_mul_f32 v228, v255, v220
    v_mul_f32 v229, v255, v221
    s_waitcnt lgkmcnt(8)
    v_mfma_f32_32x32x16_bf16 v[160:175], a[192:195], v[140:143], v[160:175]
    ds_read_b64_tr_b16 a[176:177], v9 offset:3072
    ds_read_b64_tr_b16 a[178:179], v9 offset:3584
    v_mul_f32 v230, v255, v222
    v_mul_f32 v231, v255, v223
    v_exp_f32 v228, v228
    v_mfma_f32_32x32x16_bf16 v[176:191], a[196:199], v[140:143], v[176:191]
    ds_read_b64_tr_b16 a[180:181], v12 offset:3072
    ds_read_b64_tr_b16 a[182:183], v12 offset:3584
    v_exp_f32 v229, v229
    v_exp_f32 v230, v230
    v_mfma_f32_32x32x16_bf16 v[160:175], a[200:203], v[144:147], v[160:175]
    s_waitcnt vmcnt(19)
    s_barrier
    ds_read_b64_tr_b16 a[184:185], v9 offset:8192
    ds_read_b64_tr_b16 a[186:187], v9 offset:8704
    s_add_u32 m0, s47, 24576
    s_add_u32 s54, s81, 512
    v_exp_f32 v231, v231
    v_add_f32 v228, 1.0, v228
    v_add_f32 v229, 1.0, v229
    v_mfma_f32_32x32x16_bf16 v[176:191], a[204:207], v[144:147], v[176:191]
    ds_read_b64_tr_b16 a[188:189], v12 offset:8192
    ds_read_b64_tr_b16 a[190:191], v12 offset:8704
    v_add_f32 v230, 1.0, v230
    v_add_f32 v231, 1.0, v231
    v_rcp_f32 v228, v228
    s_waitcnt lgkmcnt(8)
    v_mfma_f32_32x32x16_bf16 v[160:175], a[160:163], v[148:151], v[160:175]
    ds_read_b64_tr_b16 a[192:193], v9 offset:9216
    ds_read_b64_tr_b16 a[194:195], v9 offset:9728
    buffer_load_dwordx4 v2, s[12:15], s54 offen offset:0 lds
    v_rcp_f32 v229, v229
    v_rcp_f32 v230, v230
    v_mfma_f32_32x32x16_bf16 v[176:191], a[164:167], v[148:151], v[176:191]
    ds_read_b64_tr_b16 a[196:197], v12 offset:9216
    ds_read_b64_tr_b16 a[198:199], v12 offset:9728
    v_rcp_f32 v231, v231
    v_mul_f32 v228, v220, v228
    v_mfma_f32_32x32x16_bf16 v[160:175], a[168:171], v[152:155], v[160:175]
    ds_read_b64_tr_b16 a[200:201], v9 offset:10240
    ds_read_b64_tr_b16 a[202:203], v9 offset:10752
    v_mul_f32 v229, v221, v229
    v_mul_f32 v230, v222, v230
    v_mul_f32 v231, v223, v231
    v_cvt_pk_bf16_f32 v234, v228, v229
    v_mfma_f32_32x32x16_bf16 v[176:191], a[172:175], v[152:155], v[176:191]
    ds_read_b64_tr_b16 a[204:205], v12 offset:10240
    ds_read_b64_tr_b16 a[206:207], v12 offset:10752
    buffer_load_dwordx4 v3, s[12:15], s54 offen offset:1024 lds
    v_cvt_pk_bf16_f32 v235, v230, v231
    v_accvgpr_write_b32 a30, v234
    v_accvgpr_write_b32 a31, v235
    buffer_load_dword v252, v251, s[16:19], s75 offen
    s_add_u32 s75, s75, 13824
    s_waitcnt lgkmcnt(8)
    v_mfma_f32_32x32x16_bf16 v[160:175], a[176:179], v[156:159], v[160:175]
    ds_read_b64_tr_b16 a[160:161], v9 offset:11264
    ds_read_b64_tr_b16 a[162:163], v9 offset:11776
    v_mfma_f32_32x32x16_bf16 v[176:191], a[180:183], v[156:159], v[176:191]
    ds_read_b64_tr_b16 a[164:165], v12 offset:11264
    ds_read_b64_tr_b16 a[166:167], v12 offset:11776
    v_mfma_f32_32x32x16_bf16 v[192:207], a[184:187], v[16:19], 0
    ds_read_b64_tr_b16 a[168:169], v9 offset:16384
    ds_read_b64_tr_b16 a[170:171], v9 offset:16896
    buffer_load_dwordx4 v4, s[12:15], s54 offen offset:2048 lds
    v_mfma_f32_32x32x16_bf16 v[208:223], a[188:191], v[16:19], 0
    ds_read_b64_tr_b16 a[172:173], v12 offset:16384
    ds_read_b64_tr_b16 a[174:175], v12 offset:16896
    s_add_u32 m0, s47, 27648
    s_add_u32 s54, s81, 221696
    v_mul_f32 v224, v255, v160
    v_mul_f32 v225, v255, v161
    v_mul_f32 v226, v255, v162
    v_mul_f32 v227, v255, v163
    s_waitcnt lgkmcnt(8)
    v_mfma_f32_32x32x16_bf16 v[192:207], a[192:195], v[20:23], v[192:207]
    ds_read_b64_tr_b16 a[176:177], v9 offset:17408
    ds_read_b64_tr_b16 a[178:179], v9 offset:17920
    v_exp_f32 v224, v224
    v_exp_f32 v225, v225
    v_mfma_f32_32x32x16_bf16 v[208:223], a[196:199], v[20:23], v[208:223]
    ds_read_b64_tr_b16 a[180:181], v12 offset:17408
    ds_read_b64_tr_b16 a[182:183], v12 offset:17920
    v_exp_f32 v226, v226
    v_exp_f32 v227, v227
    v_mfma_f32_32x32x16_bf16 v[192:207], a[200:203], v[24:27], v[192:207]
    ds_read_b64_tr_b16 a[184:185], v9 offset:18432
    ds_read_b64_tr_b16 a[186:187], v9 offset:18944
    buffer_load_dwordx4 v2, s[12:15], s54 offen offset:0 lds
    v_add_f32 v224, 1.0, v224
    v_add_f32 v225, 1.0, v225
    v_add_f32 v226, 1.0, v226
    v_mfma_f32_32x32x16_bf16 v[208:223], a[204:207], v[24:27], v[208:223]
    ds_read_b64_tr_b16 a[188:189], v12 offset:18432
    ds_read_b64_tr_b16 a[190:191], v12 offset:18944
    v_add_f32 v227, 1.0, v227
    v_rcp_f32 v224, v224
    v_rcp_f32 v225, v225
    s_waitcnt lgkmcnt(8)
    v_mfma_f32_32x32x16_bf16 v[192:207], a[160:163], v[28:31], v[192:207]
    ds_read_b64_tr_b16 a[192:193], v9 offset:19456
    ds_read_b64_tr_b16 a[194:195], v9 offset:19968
    v_rcp_f32 v226, v226
    v_mfma_f32_32x32x16_bf16 v[208:223], a[164:167], v[28:31], v[208:223]
    ds_read_b64_tr_b16 a[196:197], v12 offset:19456
    ds_read_b64_tr_b16 a[198:199], v12 offset:19968
    v_rcp_f32 v227, v227
    v_mul_f32 v224, v160, v224
    v_mul_f32 v225, v161, v225
    v_mul_f32 v226, v162, v226
    v_mfma_f32_32x32x16_bf16 v[192:207], a[168:171], v[32:35], v[192:207]
    ds_read_b64_tr_b16 a[200:201], v9 offset:24576
    ds_read_b64_tr_b16 a[202:203], v9 offset:25088
    buffer_load_dwordx4 v3, s[12:15], s54 offen offset:1024 lds
    v_mul_f32 v227, v163, v227
    v_cvt_pk_bf16_f32 v232, v224, v225
    v_cvt_pk_bf16_f32 v233, v226, v227
    v_mfma_f32_32x32x16_bf16 v[208:223], a[172:175], v[32:35], v[208:223]
    ds_read_b64_tr_b16 a[204:205], v12 offset:24576
    ds_read_b64_tr_b16 a[206:207], v12 offset:25088
    v_accvgpr_write_b32 a32, v232
    v_accvgpr_write_b32 a33, v233
    v_mul_f32 v228, v255, v164
    s_waitcnt lgkmcnt(8)
    v_mfma_f32_32x32x16_bf16 v[192:207], a[176:179], v[36:39], v[192:207]
    ds_read_b64_tr_b16 a[160:161], v9 offset:25600
    ds_read_b64_tr_b16 a[162:163], v9 offset:26112
    v_mul_f32 v229, v255, v165
    v_mul_f32 v230, v255, v166
    v_mul_f32 v231, v255, v167
    v_exp_f32 v228, v228
    v_mfma_f32_32x32x16_bf16 v[208:223], a[180:183], v[36:39], v[208:223]
    ds_read_b64_tr_b16 a[164:165], v12 offset:25600
    ds_read_b64_tr_b16 a[166:167], v12 offset:26112
    v_exp_f32 v229, v229
    v_exp_f32 v230, v230
    v_mfma_f32_32x32x16_bf16 v[192:207], a[184:187], v[40:43], v[192:207]
    ds_read_b64_tr_b16 a[168:169], v9 offset:26624
    ds_read_b64_tr_b16 a[170:171], v9 offset:27136
    buffer_load_dwordx4 v4, s[12:15], s54 offen offset:2048 lds
    v_exp_f32 v231, v231
    v_add_f32 v228, 1.0, v228
    v_mfma_f32_32x32x16_bf16 v[208:223], a[188:191], v[40:43], v[208:223]
    ds_read_b64_tr_b16 a[172:173], v12 offset:26624
    ds_read_b64_tr_b16 a[174:175], v12 offset:27136
    v_add_f32 v229, 1.0, v229
    v_add_f32 v230, 1.0, v230
    v_add_f32 v231, 1.0, v231
    s_waitcnt lgkmcnt(8)
    v_mfma_f32_32x32x16_bf16 v[192:207], a[192:195], v[44:47], v[192:207]
    ds_read_b64_tr_b16 a[176:177], v9 offset:27648
    ds_read_b64_tr_b16 a[178:179], v9 offset:28160
    v_rcp_f32 v228, v228
    v_rcp_f32 v229, v229
    v_mfma_f32_32x32x16_bf16 v[208:223], a[196:199], v[44:47], v[208:223]
    ds_read_b64_tr_b16 a[180:181], v12 offset:27648
    ds_read_b64_tr_b16 a[182:183], v12 offset:28160
    v_rcp_f32 v230, v230
    v_rcp_f32 v231, v231
    v_mfma_f32_32x32x16_bf16 v[192:207], a[200:203], v[48:51], v[192:207]
    s_waitcnt vmcnt(20)
    s_barrier
    ds_read_b64_tr_b16 a[184:185], v9 offset:32768
    ds_read_b64_tr_b16 a[186:187], v9 offset:33280
    s_add_u32 m0, s47, 49152
    s_add_u32 s54, s82, 512
    v_mul_f32 v228, v164, v228
    v_mul_f32 v229, v165, v229
    v_mul_f32 v230, v166, v230
    v_mul_f32 v231, v167, v231
    v_mfma_f32_32x32x16_bf16 v[208:223], a[204:207], v[48:51], v[208:223]
    ds_read_b64_tr_b16 a[188:189], v12 offset:32768
    ds_read_b64_tr_b16 a[190:191], v12 offset:33280
    v_cvt_pk_bf16_f32 v234, v228, v229
    v_cvt_pk_bf16_f32 v235, v230, v231
    v_accvgpr_write_b32 a34, v234
    s_waitcnt lgkmcnt(8)
    v_mfma_f32_32x32x16_bf16 v[192:207], a[160:163], v[52:55], v[192:207]
    ds_read_b64_tr_b16 a[192:193], v9 offset:33792
    ds_read_b64_tr_b16 a[194:195], v9 offset:34304
    buffer_load_dwordx4 v2, s[12:15], s54 offen offset:0 lds
    v_accvgpr_write_b32 a35, v235
    v_mul_f32 v224, v255, v168
    v_mul_f32 v225, v255, v169
    v_mul_f32 v226, v255, v170
    v_mfma_f32_32x32x16_bf16 v[208:223], a[164:167], v[52:55], v[208:223]
    ds_read_b64_tr_b16 a[196:197], v12 offset:33792
    ds_read_b64_tr_b16 a[198:199], v12 offset:34304
    v_mul_f32 v227, v255, v171
    v_exp_f32 v224, v224
    v_mfma_f32_32x32x16_bf16 v[192:207], a[168:171], v[56:59], v[192:207]
    ds_read_b64_tr_b16 a[200:201], v9 offset:34816
    ds_read_b64_tr_b16 a[202:203], v9 offset:35328
    v_exp_f32 v225, v225
    v_exp_f32 v226, v226
    v_mfma_f32_32x32x16_bf16 v[208:223], a[172:175], v[56:59], v[208:223]
    ds_read_b64_tr_b16 a[204:205], v12 offset:34816
    ds_read_b64_tr_b16 a[206:207], v12 offset:35328
    buffer_load_dwordx4 v3, s[12:15], s54 offen offset:1024 lds
    v_exp_f32 v227, v227
    v_add_f32 v224, 1.0, v224
    v_add_f32 v225, 1.0, v225
    s_waitcnt lgkmcnt(8)
    v_mfma_f32_32x32x16_bf16 v[192:207], a[176:179], v[60:63], v[192:207]
    ds_read_b64_tr_b16 a[160:161], v9 offset:35840
    ds_read_b64_tr_b16 a[162:163], v9 offset:36352
    v_add_f32 v226, 1.0, v226
    v_add_f32 v227, 1.0, v227
    v_rcp_f32 v224, v224
    v_mfma_f32_32x32x16_bf16 v[208:223], a[180:183], v[60:63], v[208:223]
    ds_read_b64_tr_b16 a[164:165], v12 offset:35840
    ds_read_b64_tr_b16 a[166:167], v12 offset:36352
    v_rcp_f32 v225, v225
    v_rcp_f32 v226, v226
    v_mfma_f32_32x32x16_bf16 v[192:207], a[184:187], v[64:67], v[192:207]
    ds_read_b64_tr_b16 a[168:169], v9 offset:40960
    ds_read_b64_tr_b16 a[170:171], v9 offset:41472
    buffer_load_dwordx4 v4, s[12:15], s54 offen offset:2048 lds
    v_rcp_f32 v227, v227
    v_mul_f32 v224, v168, v224
    v_mul_f32 v225, v169, v225
    v_mfma_f32_32x32x16_bf16 v[208:223], a[188:191], v[64:67], v[208:223]
    ds_read_b64_tr_b16 a[172:173], v12 offset:40960
    ds_read_b64_tr_b16 a[174:175], v12 offset:41472
    s_add_u32 m0, s47, 52224
    s_add_u32 s54, s82, 221696
    v_mul_f32 v226, v170, v226
    v_mul_f32 v227, v171, v227
    v_cvt_pk_bf16_f32 v232, v224, v225
    s_waitcnt lgkmcnt(8)
    v_mfma_f32_32x32x16_bf16 v[192:207], a[192:195], v[68:71], v[192:207]
    ds_read_b64_tr_b16 a[176:177], v9 offset:41984
    ds_read_b64_tr_b16 a[178:179], v9 offset:42496
    v_cvt_pk_bf16_f32 v233, v226, v227
    v_accvgpr_write_b32 a36, v232
    v_accvgpr_write_b32 a37, v233
    v_mfma_f32_32x32x16_bf16 v[208:223], a[196:199], v[68:71], v[208:223]
    ds_read_b64_tr_b16 a[180:181], v12 offset:41984
    ds_read_b64_tr_b16 a[182:183], v12 offset:42496
    v_mul_f32 v228, v255, v172
    v_mul_f32 v229, v255, v173
    v_mul_f32 v230, v255, v174
    v_mul_f32 v231, v255, v175
    v_mfma_f32_32x32x16_bf16 v[192:207], a[200:203], v[72:75], v[192:207]
    ds_read_b64_tr_b16 a[184:185], v9 offset:43008
    ds_read_b64_tr_b16 a[186:187], v9 offset:43520
    buffer_load_dwordx4 v2, s[12:15], s54 offen offset:0 lds
    v_exp_f32 v228, v228
    v_exp_f32 v229, v229
    v_mfma_f32_32x32x16_bf16 v[208:223], a[204:207], v[72:75], v[208:223]
    ds_read_b64_tr_b16 a[188:189], v12 offset:43008
    ds_read_b64_tr_b16 a[190:191], v12 offset:43520
    v_exp_f32 v230, v230
    v_exp_f32 v231, v231
    s_waitcnt lgkmcnt(8)
    v_mfma_f32_32x32x16_bf16 v[192:207], a[160:163], v[76:79], v[192:207]
    ds_read_b64_tr_b16 a[192:193], v9 offset:44032
    ds_read_b64_tr_b16 a[194:195], v9 offset:44544
    v_add_f32 v228, 1.0, v228
    v_add_f32 v229, 1.0, v229
    v_add_f32 v230, 1.0, v230
    v_add_f32 v231, 1.0, v231
    v_mfma_f32_32x32x16_bf16 v[208:223], a[164:167], v[76:79], v[208:223]
    ds_read_b64_tr_b16 a[196:197], v12 offset:44032
    ds_read_b64_tr_b16 a[198:199], v12 offset:44544
    v_rcp_f32 v228, v228
    v_rcp_f32 v229, v229
    v_mfma_f32_32x32x16_bf16 v[192:207], a[168:171], v[80:83], v[192:207]
    ds_read_b64_tr_b16 a[200:201], v9 offset:49152
    ds_read_b64_tr_b16 a[202:203], v9 offset:49664
    buffer_load_dwordx4 v3, s[12:15], s54 offen offset:1024 lds
    v_rcp_f32 v230, v230
    v_rcp_f32 v231, v231
    v_mfma_f32_32x32x16_bf16 v[208:223], a[172:175], v[80:83], v[208:223]
    ds_read_b64_tr_b16 a[204:205], v12 offset:49152
    ds_read_b64_tr_b16 a[206:207], v12 offset:49664
    v_mul_f32 v228, v172, v228
    v_mul_f32 v229, v173, v229
    v_mul_f32 v230, v174, v230
    s_waitcnt lgkmcnt(8)
    v_mfma_f32_32x32x16_bf16 v[192:207], a[176:179], v[84:87], v[192:207]
    ds_read_b64_tr_b16 a[160:161], v9 offset:50176
    ds_read_b64_tr_b16 a[162:163], v9 offset:50688
    v_mul_f32 v231, v175, v231
    v_cvt_pk_bf16_f32 v234, v228, v229
    v_cvt_pk_bf16_f32 v235, v230, v231
    v_mfma_f32_32x32x16_bf16 v[208:223], a[180:183], v[84:87], v[208:223]
    ds_read_b64_tr_b16 a[164:165], v12 offset:50176
    ds_read_b64_tr_b16 a[166:167], v12 offset:50688
    v_accvgpr_write_b32 a38, v234
    v_accvgpr_write_b32 a39, v235
    v_mul_f32 v224, v255, v176
    v_mul_f32 v225, v255, v177
    v_mfma_f32_32x32x16_bf16 v[192:207], a[184:187], v[88:91], v[192:207]
    ds_read_b64_tr_b16 a[168:169], v9 offset:51200
    ds_read_b64_tr_b16 a[170:171], v9 offset:51712
    buffer_load_dwordx4 v4, s[12:15], s54 offen offset:2048 lds
    v_mul_f32 v226, v255, v178
    v_mul_f32 v227, v255, v179
    v_exp_f32 v224, v224
    v_mfma_f32_32x32x16_bf16 v[208:223], a[188:191], v[88:91], v[208:223]
    ds_read_b64_tr_b16 a[172:173], v12 offset:51200
    ds_read_b64_tr_b16 a[174:175], v12 offset:51712
    v_exp_f32 v225, v225
    v_exp_f32 v226, v226
    s_waitcnt lgkmcnt(8)
    v_mfma_f32_32x32x16_bf16 v[192:207], a[192:195], v[92:95], v[192:207]
    ds_read_b64_tr_b16 a[176:177], v9 offset:52224
    ds_read_b64_tr_b16 a[178:179], v9 offset:52736
    v_exp_f32 v227, v227
    v_add_f32 v224, 1.0, v224
    v_mfma_f32_32x32x16_bf16 v[208:223], a[196:199], v[92:95], v[208:223]
    ds_read_b64_tr_b16 a[180:181], v12 offset:52224
    ds_read_b64_tr_b16 a[182:183], v12 offset:52736
    v_add_f32 v225, 1.0, v225
    v_add_f32 v226, 1.0, v226
    v_add_f32 v227, 1.0, v227
    v_rcp_f32 v224, v224
    v_mfma_f32_32x32x16_bf16 v[192:207], a[200:203], v[96:99], v[192:207]
    s_waitcnt vmcnt(19)
    s_barrier
    ds_read_b64_tr_b16 a[184:185], v9 offset:57344
    ds_read_b64_tr_b16 a[186:187], v9 offset:57856
    s_add_u32 m0, s47, 73728
    s_add_u32 s54, s80, 640
    v_rcp_f32 v225, v225
    v_rcp_f32 v226, v226
    v_mfma_f32_32x32x16_bf16 v[208:223], a[204:207], v[96:99], v[208:223]
    ds_read_b64_tr_b16 a[188:189], v12 offset:57344
    ds_read_b64_tr_b16 a[190:191], v12 offset:57856
    v_rcp_f32 v227, v227
    v_mul_f32 v224, v176, v224
    s_waitcnt lgkmcnt(8)
    v_mfma_f32_32x32x16_bf16 v[192:207], a[160:163], v[100:103], v[192:207]
    ds_read_b64_tr_b16 a[192:193], v9 offset:58368
    ds_read_b64_tr_b16 a[194:195], v9 offset:58880
    buffer_load_dwordx4 v2, s[12:15], s54 offen offset:0 lds
    buffer_load_dword v252, v251, s[32:35], s76 offen
    s_add_u32 s76, s76, 13824
    v_mul_f32 v225, v177, v225
    v_mul_f32 v226, v178, v226
    v_mul_f32 v227, v179, v227
    v_cvt_pk_bf16_f32 v232, v224, v225
    v_mfma_f32_32x32x16_bf16 v[208:223], a[164:167], v[100:103], v[208:223]
    ds_read_b64_tr_b16 a[196:197], v12 offset:58368
    ds_read_b64_tr_b16 a[198:199], v12 offset:58880
    v_cvt_pk_bf16_f32 v233, v226, v227
    v_accvgpr_write_b32 a40, v232
    v_accvgpr_write_b32 a41, v233
    v_mfma_f32_32x32x16_bf16 v[192:207], a[168:171], v[104:107], v[192:207]
    ds_read_b64_tr_b16 a[200:201], v9 offset:59392
    ds_read_b64_tr_b16 a[202:203], v9 offset:59904
    v_mul_f32 v228, v255, v180
    v_mul_f32 v229, v255, v181
    v_mul_f32 v230, v255, v182
    v_mfma_f32_32x32x16_bf16 v[208:223], a[172:175], v[104:107], v[208:223]
    ds_read_b64_tr_b16 a[204:205], v12 offset:59392
    ds_read_b64_tr_b16 a[206:207], v12 offset:59904
    buffer_load_dwordx4 v3, s[12:15], s54 offen offset:1024 lds
    v_mul_f32 v231, v255, v183
    v_exp_f32 v228, v228
    v_exp_f32 v229, v229
    s_waitcnt lgkmcnt(8)
    v_mfma_f32_32x32x16_bf16 v[192:207], a[176:179], v[108:111], v[192:207]
    ds_read_b64_tr_b16 a[160:161], v9 offset:60416
    ds_read_b64_tr_b16 a[162:163], v9 offset:60928
    v_exp_f32 v230, v230
    v_mfma_f32_32x32x16_bf16 v[208:223], a[180:183], v[108:111], v[208:223]
    ds_read_b64_tr_b16 a[164:165], v12 offset:60416
    ds_read_b64_tr_b16 a[166:167], v12 offset:60928
    v_exp_f32 v231, v231
    v_add_f32 v228, 1.0, v228
    v_add_f32 v229, 1.0, v229
    v_add_f32 v230, 1.0, v230
    v_mfma_f32_32x32x16_bf16 v[192:207], a[184:187], v[112:115], v[192:207]
    ds_read_b64_tr_b16 a[168:169], v10 offset:0
    ds_read_b64_tr_b16 a[170:171], v10 offset:512
    buffer_load_dwordx4 v4, s[12:15], s54 offen offset:2048 lds
    v_add_f32 v231, 1.0, v231
    v_rcp_f32 v228, v228
    v_mfma_f32_32x32x16_bf16 v[208:223], a[188:191], v[112:115], v[208:223]
    ds_read_b64_tr_b16 a[172:173], v13 offset:0
    ds_read_b64_tr_b16 a[174:175], v13 offset:512
    s_add_u32 m0, s47, 76800
    s_add_u32 s54, s80, 221824
    v_rcp_f32 v229, v229
    v_rcp_f32 v230, v230
    s_waitcnt lgkmcnt(8)
    v_mfma_f32_32x32x16_bf16 v[192:207], a[192:195], v[116:119], v[192:207]
    ds_read_b64_tr_b16 a[176:177], v10 offset:1024
    ds_read_b64_tr_b16 a[178:179], v10 offset:1536
    v_rcp_f32 v231, v231
    v_mul_f32 v228, v180, v228
    v_mul_f32 v229, v181, v229
    v_mfma_f32_32x32x16_bf16 v[208:223], a[196:199], v[116:119], v[208:223]
    ds_read_b64_tr_b16 a[180:181], v13 offset:1024
    ds_read_b64_tr_b16 a[182:183], v13 offset:1536
    v_mul_f32 v230, v182, v230
    v_mul_f32 v231, v183, v231
    v_cvt_pk_bf16_f32 v234, v228, v229
    v_cvt_pk_bf16_f32 v235, v230, v231
    v_mfma_f32_32x32x16_bf16 v[192:207], a[200:203], v[120:123], v[192:207]
    ds_read_b64_tr_b16 a[184:185], v10 offset:2048
    ds_read_b64_tr_b16 a[186:187], v10 offset:2560
    buffer_load_dwordx4 v2, s[12:15], s54 offen offset:0 lds
    v_accvgpr_write_b32 a42, v234
    v_accvgpr_write_b32 a43, v235
    v_mul_f32 v224, v255, v184
    v_mfma_f32_32x32x16_bf16 v[208:223], a[204:207], v[120:123], v[208:223]
    ds_read_b64_tr_b16 a[188:189], v13 offset:2048
    ds_read_b64_tr_b16 a[190:191], v13 offset:2560
    v_mul_f32 v225, v255, v185
    v_mul_f32 v226, v255, v186
    v_mul_f32 v227, v255, v187
    s_waitcnt lgkmcnt(8)
    v_mfma_f32_32x32x16_bf16 v[192:207], a[160:163], v[124:127], v[192:207]
    ds_read_b64_tr_b16 a[192:193], v10 offset:3072
    ds_read_b64_tr_b16 a[194:195], v10 offset:3584
    v_exp_f32 v224, v224
    v_exp_f32 v225, v225
    v_mfma_f32_32x32x16_bf16 v[208:223], a[164:167], v[124:127], v[208:223]
    ds_read_b64_tr_b16 a[196:197], v13 offset:3072
    ds_read_b64_tr_b16 a[198:199], v13 offset:3584
    v_exp_f32 v226, v226
    v_exp_f32 v227, v227
    v_mfma_f32_32x32x16_bf16 v[192:207], a[168:171], v[128:131], v[192:207]
    ds_read_b64_tr_b16 a[200:201], v10 offset:8192
    ds_read_b64_tr_b16 a[202:203], v10 offset:8704
    buffer_load_dwordx4 v3, s[12:15], s54 offen offset:1024 lds
    v_add_f32 v224, 1.0, v224
    v_add_f32 v225, 1.0, v225
    v_add_f32 v226, 1.0, v226
    v_add_f32 v227, 1.0, v227
    v_mfma_f32_32x32x16_bf16 v[208:223], a[172:175], v[128:131], v[208:223]
    ds_read_b64_tr_b16 a[204:205], v13 offset:8192
    ds_read_b64_tr_b16 a[206:207], v13 offset:8704
    v_rcp_f32 v224, v224
    v_rcp_f32 v225, v225
    s_waitcnt lgkmcnt(8)
    v_mfma_f32_32x32x16_bf16 v[192:207], a[176:179], v[132:135], v[192:207]
    ds_read_b64_tr_b16 a[160:161], v10 offset:9216
    ds_read_b64_tr_b16 a[162:163], v10 offset:9728
    v_rcp_f32 v226, v226
    v_rcp_f32 v227, v227
    v_mfma_f32_32x32x16_bf16 v[208:223], a[180:183], v[132:135], v[208:223]
    ds_read_b64_tr_b16 a[164:165], v13 offset:9216
    ds_read_b64_tr_b16 a[166:167], v13 offset:9728
    v_mul_f32 v224, v184, v224
    v_mul_f32 v225, v185, v225
    v_mul_f32 v226, v186, v226
    v_mul_f32 v227, v187, v227
    v_mfma_f32_32x32x16_bf16 v[192:207], a[184:187], v[136:139], v[192:207]
    ds_read_b64_tr_b16 a[168:169], v10 offset:10240
    ds_read_b64_tr_b16 a[170:171], v10 offset:10752
    buffer_load_dwordx4 v4, s[12:15], s54 offen offset:2048 lds
    v_cvt_pk_bf16_f32 v232, v224, v225
    v_cvt_pk_bf16_f32 v233, v226, v227
    v_accvgpr_write_b32 a44, v232
    v_mfma_f32_32x32x16_bf16 v[208:223], a[188:191], v[136:139], v[208:223]
    ds_read_b64_tr_b16 a[172:173], v13 offset:10240
    ds_read_b64_tr_b16 a[174:175], v13 offset:10752
    v_accvgpr_write_b32 a45, v233
    v_mul_f32 v228, v255, v188
    v_mul_f32 v229, v255, v189
    s_waitcnt lgkmcnt(8)
    v_mfma_f32_32x32x16_bf16 v[192:207], a[192:195], v[140:143], v[192:207]
    ds_read_b64_tr_b16 a[176:177], v10 offset:11264
    ds_read_b64_tr_b16 a[178:179], v10 offset:11776
    v_mul_f32 v230, v255, v190
    v_mul_f32 v231, v255, v191
    v_exp_f32 v228, v228
    v_mfma_f32_32x32x16_bf16 v[208:223], a[196:199], v[140:143], v[208:223]
    ds_read_b64_tr_b16 a[180:181], v13 offset:11264
    ds_read_b64_tr_b16 a[182:183], v13 offset:11776
    v_exp_f32 v229, v229
    v_exp_f32 v230, v230
    v_mfma_f32_32x32x16_bf16 v[192:207], a[200:203], v[144:147], v[192:207]
    s_waitcnt vmcnt(20)
    s_barrier
    ds_read_b64_tr_b16 a[184:185], v8 offset:0
    ds_read_b64_tr_b16 a[186:187], v8 offset:512
    s_add_u32 m0, s47, 98304
    s_add_u32 s54, s81, 640
    v_exp_f32 v231, v231
    v_add_f32 v228, 1.0, v228
    v_add_f32 v229, 1.0, v229
    v_mfma_f32_32x32x16_bf16 v[208:223], a[204:207], v[144:147], v[208:223]
    ds_read_b64_tr_b16 a[188:189], v11 offset:0
    ds_read_b64_tr_b16 a[190:191], v11 offset:512
    v_add_f32 v230, 1.0, v230
    v_add_f32 v231, 1.0, v231
    v_rcp_f32 v228, v228
    s_waitcnt lgkmcnt(8)
    v_mfma_f32_32x32x16_bf16 v[192:207], a[160:163], v[148:151], v[192:207]
    ds_read_b64_tr_b16 a[192:193], v8 offset:1024
    ds_read_b64_tr_b16 a[194:195], v8 offset:1536
    buffer_load_dwordx4 v2, s[12:15], s54 offen offset:0 lds
    v_rcp_f32 v229, v229
    v_rcp_f32 v230, v230
    v_mfma_f32_32x32x16_bf16 v[208:223], a[164:167], v[148:151], v[208:223]
    ds_read_b64_tr_b16 a[196:197], v11 offset:1024
    ds_read_b64_tr_b16 a[198:199], v11 offset:1536
    v_rcp_f32 v231, v231
    v_mul_f32 v228, v188, v228
    v_mfma_f32_32x32x16_bf16 v[192:207], a[168:171], v[152:155], v[192:207]
    ds_read_b64_tr_b16 a[200:201], v8 offset:2048
    ds_read_b64_tr_b16 a[202:203], v8 offset:2560
    v_mul_f32 v229, v189, v229
    v_mul_f32 v230, v190, v230
    v_mul_f32 v231, v191, v231
    v_cvt_pk_bf16_f32 v234, v228, v229
    v_mfma_f32_32x32x16_bf16 v[208:223], a[172:175], v[152:155], v[208:223]
    ds_read_b64_tr_b16 a[204:205], v11 offset:2048
    ds_read_b64_tr_b16 a[206:207], v11 offset:2560
    buffer_load_dwordx4 v3, s[12:15], s54 offen offset:1024 lds
    v_cvt_pk_bf16_f32 v235, v230, v231
    v_accvgpr_write_b32 a46, v234
    v_accvgpr_write_b32 a47, v235
    s_waitcnt lgkmcnt(8)
    v_mfma_f32_32x32x16_bf16 v[192:207], a[176:179], v[156:159], v[192:207]
    ds_read_b64_tr_b16 a[160:161], v8 offset:3072
    ds_read_b64_tr_b16 a[162:163], v8 offset:3584
    v_mfma_f32_32x32x16_bf16 v[208:223], a[180:183], v[156:159], v[208:223]
    ds_read_b64_tr_b16 a[164:165], v11 offset:3072
    ds_read_b64_tr_b16 a[166:167], v11 offset:3584
    v_mfma_f32_32x32x16_bf16 v[160:175], a[184:187], v[16:19], 0
    ds_read_b64_tr_b16 a[168:169], v8 offset:8192
    ds_read_b64_tr_b16 a[170:171], v8 offset:8704
    buffer_load_dwordx4 v4, s[12:15], s54 offen offset:2048 lds
    v_mfma_f32_32x32x16_bf16 v[176:191], a[188:191], v[16:19], 0
    ds_read_b64_tr_b16 a[172:173], v11 offset:8192
    ds_read_b64_tr_b16 a[174:175], v11 offset:8704
    s_add_u32 m0, s47, 101376
    s_add_u32 s54, s81, 221824
    v_mul_f32 v224, v255, v192
    v_mul_f32 v225, v255, v193
    v_mul_f32 v226, v255, v194
    v_mul_f32 v227, v255, v195
    s_waitcnt lgkmcnt(8)
    v_mfma_f32_32x32x16_bf16 v[160:175], a[192:195], v[20:23], v[160:175]
    ds_read_b64_tr_b16 a[176:177], v8 offset:9216
    ds_read_b64_tr_b16 a[178:179], v8 offset:9728
    v_exp_f32 v224, v224
    v_exp_f32 v225, v225
    v_mfma_f32_32x32x16_bf16 v[176:191], a[196:199], v[20:23], v[176:191]
    ds_read_b64_tr_b16 a[180:181], v11 offset:9216
    ds_read_b64_tr_b16 a[182:183], v11 offset:9728
    v_exp_f32 v226, v226
    v_exp_f32 v227, v227
    v_mfma_f32_32x32x16_bf16 v[160:175], a[200:203], v[24:27], v[160:175]
    ds_read_b64_tr_b16 a[184:185], v8 offset:10240
    ds_read_b64_tr_b16 a[186:187], v8 offset:10752
    buffer_load_dwordx4 v2, s[12:15], s54 offen offset:0 lds
    v_add_f32 v224, 1.0, v224
    v_add_f32 v225, 1.0, v225
    v_add_f32 v226, 1.0, v226
    v_mfma_f32_32x32x16_bf16 v[176:191], a[204:207], v[24:27], v[176:191]
    ds_read_b64_tr_b16 a[188:189], v11 offset:10240
    ds_read_b64_tr_b16 a[190:191], v11 offset:10752
    v_add_f32 v227, 1.0, v227
    v_rcp_f32 v224, v224
    v_rcp_f32 v225, v225
    s_waitcnt lgkmcnt(8)
    v_mfma_f32_32x32x16_bf16 v[160:175], a[160:163], v[28:31], v[160:175]
    ds_read_b64_tr_b16 a[192:193], v8 offset:11264
    ds_read_b64_tr_b16 a[194:195], v8 offset:11776
    v_rcp_f32 v226, v226
    v_mfma_f32_32x32x16_bf16 v[176:191], a[164:167], v[28:31], v[176:191]
    ds_read_b64_tr_b16 a[196:197], v11 offset:11264
    ds_read_b64_tr_b16 a[198:199], v11 offset:11776
    v_rcp_f32 v227, v227
    v_mul_f32 v224, v192, v224
    v_mul_f32 v225, v193, v225
    v_mul_f32 v226, v194, v226
    v_mfma_f32_32x32x16_bf16 v[160:175], a[168:171], v[32:35], v[160:175]
    ds_read_b64_tr_b16 a[200:201], v8 offset:16384
    ds_read_b64_tr_b16 a[202:203], v8 offset:16896
    buffer_load_dwordx4 v3, s[12:15], s54 offen offset:1024 lds
    v_mul_f32 v227, v195, v227
    v_cvt_pk_bf16_f32 v232, v224, v225
    v_cvt_pk_bf16_f32 v233, v226, v227
    v_mfma_f32_32x32x16_bf16 v[176:191], a[172:175], v[32:35], v[176:191]
    ds_read_b64_tr_b16 a[204:205], v11 offset:16384
    ds_read_b64_tr_b16 a[206:207], v11 offset:16896
    v_accvgpr_write_b32 a48, v232
    v_accvgpr_write_b32 a49, v233
    v_mul_f32 v228, v255, v196
    s_waitcnt lgkmcnt(8)
    v_mfma_f32_32x32x16_bf16 v[160:175], a[176:179], v[36:39], v[160:175]
    ds_read_b64_tr_b16 a[160:161], v8 offset:17408
    ds_read_b64_tr_b16 a[162:163], v8 offset:17920
    v_mul_f32 v229, v255, v197
    v_mul_f32 v230, v255, v198
    v_mul_f32 v231, v255, v199
    v_exp_f32 v228, v228
    v_mfma_f32_32x32x16_bf16 v[176:191], a[180:183], v[36:39], v[176:191]
    ds_read_b64_tr_b16 a[164:165], v11 offset:17408
    ds_read_b64_tr_b16 a[166:167], v11 offset:17920
    v_exp_f32 v229, v229
    v_exp_f32 v230, v230
    v_mfma_f32_32x32x16_bf16 v[160:175], a[184:187], v[40:43], v[160:175]
    ds_read_b64_tr_b16 a[168:169], v8 offset:18432
    ds_read_b64_tr_b16 a[170:171], v8 offset:18944
    buffer_load_dwordx4 v4, s[12:15], s54 offen offset:2048 lds
    v_exp_f32 v231, v231
    v_add_f32 v228, 1.0, v228
    v_mfma_f32_32x32x16_bf16 v[176:191], a[188:191], v[40:43], v[176:191]
    ds_read_b64_tr_b16 a[172:173], v11 offset:18432
    ds_read_b64_tr_b16 a[174:175], v11 offset:18944
    v_add_f32 v229, 1.0, v229
    v_add_f32 v230, 1.0, v230
    v_add_f32 v231, 1.0, v231
    s_waitcnt lgkmcnt(8)
    v_mfma_f32_32x32x16_bf16 v[160:175], a[192:195], v[44:47], v[160:175]
    ds_read_b64_tr_b16 a[176:177], v8 offset:19456
    ds_read_b64_tr_b16 a[178:179], v8 offset:19968
    v_rcp_f32 v228, v228
    v_rcp_f32 v229, v229
    v_mfma_f32_32x32x16_bf16 v[176:191], a[196:199], v[44:47], v[176:191]
    ds_read_b64_tr_b16 a[180:181], v11 offset:19456
    ds_read_b64_tr_b16 a[182:183], v11 offset:19968
    buffer_load_dword v252, v251, s[32:35], s76 offen
    s_add_u32 s76, s76, 13824
    v_rcp_f32 v230, v230
    v_rcp_f32 v231, v231
    v_mfma_f32_32x32x16_bf16 v[160:175], a[200:203], v[48:51], v[160:175]
    s_waitcnt vmcnt(20)
    s_barrier
    ds_read_b64_tr_b16 a[184:185], v8 offset:24576
    ds_read_b64_tr_b16 a[186:187], v8 offset:25088
    s_add_u32 m0, s47, 122880
    s_add_u32 s54, s82, 640
    v_mul_f32 v228, v196, v228
    v_mul_f32 v229, v197, v229
    v_mul_f32 v230, v198, v230
    v_mul_f32 v231, v199, v231
    v_mfma_f32_32x32x16_bf16 v[176:191], a[204:207], v[48:51], v[176:191]
    ds_read_b64_tr_b16 a[188:189], v11 offset:24576
    ds_read_b64_tr_b16 a[190:191], v11 offset:25088
    v_cvt_pk_bf16_f32 v234, v228, v229
    v_cvt_pk_bf16_f32 v235, v230, v231
    v_accvgpr_write_b32 a50, v234
    s_waitcnt lgkmcnt(8)
    v_mfma_f32_32x32x16_bf16 v[160:175], a[160:163], v[52:55], v[160:175]
    ds_read_b64_tr_b16 a[192:193], v8 offset:25600
    ds_read_b64_tr_b16 a[194:195], v8 offset:26112
    buffer_load_dwordx4 v2, s[12:15], s54 offen offset:0 lds
    v_accvgpr_write_b32 a51, v235
    v_mul_f32 v224, v255, v200
    v_mul_f32 v225, v255, v201
    v_mul_f32 v226, v255, v202
    v_mfma_f32_32x32x16_bf16 v[176:191], a[164:167], v[52:55], v[176:191]
    ds_read_b64_tr_b16 a[196:197], v11 offset:25600
    ds_read_b64_tr_b16 a[198:199], v11 offset:26112
    v_mul_f32 v227, v255, v203
    v_exp_f32 v224, v224
    v_mfma_f32_32x32x16_bf16 v[160:175], a[168:171], v[56:59], v[160:175]
    ds_read_b64_tr_b16 a[200:201], v8 offset:26624
    ds_read_b64_tr_b16 a[202:203], v8 offset:27136
    v_exp_f32 v225, v225
    v_exp_f32 v226, v226
    v_mfma_f32_32x32x16_bf16 v[176:191], a[172:175], v[56:59], v[176:191]
    ds_read_b64_tr_b16 a[204:205], v11 offset:26624
    ds_read_b64_tr_b16 a[206:207], v11 offset:27136
    buffer_load_dwordx4 v3, s[12:15], s54 offen offset:1024 lds
    v_exp_f32 v227, v227
    v_add_f32 v224, 1.0, v224
    v_add_f32 v225, 1.0, v225
    s_waitcnt lgkmcnt(8)
    v_mfma_f32_32x32x16_bf16 v[160:175], a[176:179], v[60:63], v[160:175]
    ds_read_b64_tr_b16 a[160:161], v8 offset:27648
    ds_read_b64_tr_b16 a[162:163], v8 offset:28160
    v_add_f32 v226, 1.0, v226
    v_add_f32 v227, 1.0, v227
    v_rcp_f32 v224, v224
    v_mfma_f32_32x32x16_bf16 v[176:191], a[180:183], v[60:63], v[176:191]
    ds_read_b64_tr_b16 a[164:165], v11 offset:27648
    ds_read_b64_tr_b16 a[166:167], v11 offset:28160
    v_rcp_f32 v225, v225
    v_rcp_f32 v226, v226
    v_mfma_f32_32x32x16_bf16 v[160:175], a[184:187], v[64:67], v[160:175]
    ds_read_b64_tr_b16 a[168:169], v8 offset:32768
    ds_read_b64_tr_b16 a[170:171], v8 offset:33280
    buffer_load_dwordx4 v4, s[12:15], s54 offen offset:2048 lds
    v_rcp_f32 v227, v227
    v_mul_f32 v224, v200, v224
    v_mul_f32 v225, v201, v225
    v_mfma_f32_32x32x16_bf16 v[176:191], a[188:191], v[64:67], v[176:191]
    ds_read_b64_tr_b16 a[172:173], v11 offset:32768
    ds_read_b64_tr_b16 a[174:175], v11 offset:33280
    s_add_u32 m0, s47, 125952
    s_add_u32 s54, s82, 221824
    v_mul_f32 v226, v202, v226
    v_mul_f32 v227, v203, v227
    v_cvt_pk_bf16_f32 v232, v224, v225
    s_waitcnt lgkmcnt(8)
    v_mfma_f32_32x32x16_bf16 v[160:175], a[192:195], v[68:71], v[160:175]
    ds_read_b64_tr_b16 a[176:177], v8 offset:33792
    ds_read_b64_tr_b16 a[178:179], v8 offset:34304
    v_cvt_pk_bf16_f32 v233, v226, v227
    v_accvgpr_write_b32 a52, v232
    v_accvgpr_write_b32 a53, v233
    v_mfma_f32_32x32x16_bf16 v[176:191], a[196:199], v[68:71], v[176:191]
    ds_read_b64_tr_b16 a[180:181], v11 offset:33792
    ds_read_b64_tr_b16 a[182:183], v11 offset:34304
    v_mul_f32 v228, v255, v204
    v_mul_f32 v229, v255, v205
    v_mul_f32 v230, v255, v206
    v_mul_f32 v231, v255, v207
    v_mfma_f32_32x32x16_bf16 v[160:175], a[200:203], v[72:75], v[160:175]
    ds_read_b64_tr_b16 a[184:185], v8 offset:34816
    ds_read_b64_tr_b16 a[186:187], v8 offset:35328
    buffer_load_dwordx4 v2, s[12:15], s54 offen offset:0 lds
    v_exp_f32 v228, v228
    v_exp_f32 v229, v229
    v_mfma_f32_32x32x16_bf16 v[176:191], a[204:207], v[72:75], v[176:191]
    ds_read_b64_tr_b16 a[188:189], v11 offset:34816
    ds_read_b64_tr_b16 a[190:191], v11 offset:35328
    v_exp_f32 v230, v230
    v_exp_f32 v231, v231
    s_waitcnt lgkmcnt(8)
    v_mfma_f32_32x32x16_bf16 v[160:175], a[160:163], v[76:79], v[160:175]
    ds_read_b64_tr_b16 a[192:193], v8 offset:35840
    ds_read_b64_tr_b16 a[194:195], v8 offset:36352
    v_add_f32 v228, 1.0, v228
    v_add_f32 v229, 1.0, v229
    v_add_f32 v230, 1.0, v230
    v_add_f32 v231, 1.0, v231
    v_mfma_f32_32x32x16_bf16 v[176:191], a[164:167], v[76:79], v[176:191]
    ds_read_b64_tr_b16 a[196:197], v11 offset:35840
    ds_read_b64_tr_b16 a[198:199], v11 offset:36352
    v_rcp_f32 v228, v228
    v_rcp_f32 v229, v229
    v_mfma_f32_32x32x16_bf16 v[160:175], a[168:171], v[80:83], v[160:175]
    ds_read_b64_tr_b16 a[200:201], v8 offset:40960
    ds_read_b64_tr_b16 a[202:203], v8 offset:41472
    buffer_load_dwordx4 v3, s[12:15], s54 offen offset:1024 lds
    v_rcp_f32 v230, v230
    v_rcp_f32 v231, v231
    v_mfma_f32_32x32x16_bf16 v[176:191], a[172:175], v[80:83], v[176:191]
    ds_read_b64_tr_b16 a[204:205], v11 offset:40960
    ds_read_b64_tr_b16 a[206:207], v11 offset:41472
    v_mul_f32 v228, v204, v228
    v_mul_f32 v229, v205, v229
    v_mul_f32 v230, v206, v230
    s_waitcnt lgkmcnt(8)
    v_mfma_f32_32x32x16_bf16 v[160:175], a[176:179], v[84:87], v[160:175]
    ds_read_b64_tr_b16 a[160:161], v8 offset:41984
    ds_read_b64_tr_b16 a[162:163], v8 offset:42496
    v_mul_f32 v231, v207, v231
    v_cvt_pk_bf16_f32 v234, v228, v229
    v_cvt_pk_bf16_f32 v235, v230, v231
    v_mfma_f32_32x32x16_bf16 v[176:191], a[180:183], v[84:87], v[176:191]
    ds_read_b64_tr_b16 a[164:165], v11 offset:41984
    ds_read_b64_tr_b16 a[166:167], v11 offset:42496
    v_accvgpr_write_b32 a54, v234
    v_accvgpr_write_b32 a55, v235
    v_mul_f32 v224, v255, v208
    v_mul_f32 v225, v255, v209
    v_mfma_f32_32x32x16_bf16 v[160:175], a[184:187], v[88:91], v[160:175]
    ds_read_b64_tr_b16 a[168:169], v8 offset:43008
    ds_read_b64_tr_b16 a[170:171], v8 offset:43520
    buffer_load_dwordx4 v4, s[12:15], s54 offen offset:2048 lds
    v_mul_f32 v226, v255, v210
    v_mul_f32 v227, v255, v211
    v_exp_f32 v224, v224
    v_mfma_f32_32x32x16_bf16 v[176:191], a[188:191], v[88:91], v[176:191]
    ds_read_b64_tr_b16 a[172:173], v11 offset:43008
    ds_read_b64_tr_b16 a[174:175], v11 offset:43520
    v_exp_f32 v225, v225
    v_exp_f32 v226, v226
    s_waitcnt lgkmcnt(8)
    v_mfma_f32_32x32x16_bf16 v[160:175], a[192:195], v[92:95], v[160:175]
    ds_read_b64_tr_b16 a[176:177], v8 offset:44032
    ds_read_b64_tr_b16 a[178:179], v8 offset:44544
    v_exp_f32 v227, v227
    v_add_f32 v224, 1.0, v224
    v_mfma_f32_32x32x16_bf16 v[176:191], a[196:199], v[92:95], v[176:191]
    ds_read_b64_tr_b16 a[180:181], v11 offset:44032
    ds_read_b64_tr_b16 a[182:183], v11 offset:44544
    v_add_f32 v225, 1.0, v225
    v_add_f32 v226, 1.0, v226
    v_add_f32 v227, 1.0, v227
    v_rcp_f32 v224, v224
    v_mfma_f32_32x32x16_bf16 v[160:175], a[200:203], v[96:99], v[160:175]
    s_waitcnt vmcnt(20)
    s_barrier
    ds_read_b64_tr_b16 a[184:185], v8 offset:49152
    ds_read_b64_tr_b16 a[186:187], v8 offset:49664
    s_add_u32 m0, s47, 0
    s_add_u32 s54, s84, 0
    v_rcp_f32 v225, v225
    v_rcp_f32 v226, v226
    v_mfma_f32_32x32x16_bf16 v[176:191], a[204:207], v[96:99], v[176:191]
    ds_read_b64_tr_b16 a[188:189], v11 offset:49152
    ds_read_b64_tr_b16 a[190:191], v11 offset:49664
    v_rcp_f32 v227, v227
    v_mul_f32 v224, v208, v224
    s_waitcnt lgkmcnt(8)
    v_mfma_f32_32x32x16_bf16 v[160:175], a[160:163], v[100:103], v[160:175]
    ds_read_b64_tr_b16 a[192:193], v8 offset:50176
    ds_read_b64_tr_b16 a[194:195], v8 offset:50688
    buffer_load_dwordx4 v5, s[16:19], s54 offen offset:0 lds
    v_mul_f32 v225, v209, v225
    v_mul_f32 v226, v210, v226
    v_mul_f32 v227, v211, v227
    v_cvt_pk_bf16_f32 v232, v224, v225
    v_mfma_f32_32x32x16_bf16 v[176:191], a[164:167], v[100:103], v[176:191]
    ds_read_b64_tr_b16 a[196:197], v11 offset:50176
    ds_read_b64_tr_b16 a[198:199], v11 offset:50688
    v_cvt_pk_bf16_f32 v233, v226, v227
    v_accvgpr_write_b32 a56, v232
    v_accvgpr_write_b32 a57, v233
    v_mfma_f32_32x32x16_bf16 v[160:175], a[168:171], v[104:107], v[160:175]
    ds_read_b64_tr_b16 a[200:201], v8 offset:51200
    ds_read_b64_tr_b16 a[202:203], v8 offset:51712
    v_mul_f32 v228, v255, v212
    v_mul_f32 v229, v255, v213
    v_mul_f32 v230, v255, v214
    v_mov_b32 v241, 0
    s_lshl_b32 s99, s41, 4
    buffer_load_dword v239, v241, s[36:39], s99 offen sc1
    v_mfma_f32_32x32x16_bf16 v[176:191], a[172:175], v[104:107], v[176:191]
    ds_read_b64_tr_b16 a[204:205], v11 offset:51200
    ds_read_b64_tr_b16 a[206:207], v11 offset:51712
    buffer_load_dwordx4 v6, s[16:19], s54 offen offset:1024 lds
    v_mul_f32 v231, v255, v215
    v_exp_f32 v228, v228
    v_exp_f32 v229, v229
    s_waitcnt lgkmcnt(8)
    v_mfma_f32_32x32x16_bf16 v[160:175], a[176:179], v[108:111], v[160:175]
    ds_read_b64_tr_b16 a[160:161], v8 offset:52224
    ds_read_b64_tr_b16 a[162:163], v8 offset:52736
    v_exp_f32 v230, v230
    v_mfma_f32_32x32x16_bf16 v[176:191], a[180:183], v[108:111], v[176:191]
    ds_read_b64_tr_b16 a[164:165], v11 offset:52224
    ds_read_b64_tr_b16 a[166:167], v11 offset:52736
    v_exp_f32 v231, v231
    v_add_f32 v228, 1.0, v228
    v_add_f32 v229, 1.0, v229
    v_add_f32 v230, 1.0, v230
    v_mfma_f32_32x32x16_bf16 v[160:175], a[184:187], v[112:115], v[160:175]
    ds_read_b64_tr_b16 a[168:169], v8 offset:57344
    ds_read_b64_tr_b16 a[170:171], v8 offset:57856
    buffer_load_dwordx4 v7, s[16:19], s54 offen offset:2048 lds
    v_add_f32 v231, 1.0, v231
    v_rcp_f32 v228, v228
    v_mfma_f32_32x32x16_bf16 v[176:191], a[188:191], v[112:115], v[176:191]
    ds_read_b64_tr_b16 a[172:173], v11 offset:57344
    ds_read_b64_tr_b16 a[174:175], v11 offset:57856
    s_add_u32 m0, s47, 3072
    s_add_u32 s54, s84, 27648
    v_rcp_f32 v229, v229
    v_rcp_f32 v230, v230
    s_waitcnt lgkmcnt(8)
    v_mfma_f32_32x32x16_bf16 v[160:175], a[192:195], v[116:119], v[160:175]
    ds_read_b64_tr_b16 a[176:177], v8 offset:58368
    ds_read_b64_tr_b16 a[178:179], v8 offset:58880
    v_rcp_f32 v231, v231
    v_mul_f32 v228, v212, v228
    v_mul_f32 v229, v213, v229
    v_mfma_f32_32x32x16_bf16 v[176:191], a[196:199], v[116:119], v[176:191]
    ds_read_b64_tr_b16 a[180:181], v11 offset:58368
    ds_read_b64_tr_b16 a[182:183], v11 offset:58880
    v_mul_f32 v230, v214, v230
    v_mul_f32 v231, v215, v231
    v_cvt_pk_bf16_f32 v234, v228, v229
    v_cvt_pk_bf16_f32 v235, v230, v231
    v_mfma_f32_32x32x16_bf16 v[160:175], a[200:203], v[120:123], v[160:175]
    ds_read_b64_tr_b16 a[184:185], v8 offset:59392
    ds_read_b64_tr_b16 a[186:187], v8 offset:59904
    buffer_load_dwordx4 v5, s[16:19], s54 offen offset:0 lds
    v_accvgpr_write_b32 a58, v234
    v_accvgpr_write_b32 a59, v235
    v_mul_f32 v224, v255, v216
    v_mfma_f32_32x32x16_bf16 v[176:191], a[204:207], v[120:123], v[176:191]
    ds_read_b64_tr_b16 a[188:189], v11 offset:59392
    ds_read_b64_tr_b16 a[190:191], v11 offset:59904
    v_mul_f32 v225, v255, v217
    v_mul_f32 v226, v255, v218
    v_mul_f32 v227, v255, v219
    s_waitcnt lgkmcnt(8)
    v_mfma_f32_32x32x16_bf16 v[160:175], a[160:163], v[124:127], v[160:175]
    ds_read_b64_tr_b16 a[192:193], v8 offset:60416
    ds_read_b64_tr_b16 a[194:195], v8 offset:60928
    v_exp_f32 v224, v224
    v_exp_f32 v225, v225
    v_mfma_f32_32x32x16_bf16 v[176:191], a[164:167], v[124:127], v[176:191]
    ds_read_b64_tr_b16 a[196:197], v11 offset:60416
    ds_read_b64_tr_b16 a[198:199], v11 offset:60928
    v_exp_f32 v226, v226
    v_exp_f32 v227, v227
    v_mfma_f32_32x32x16_bf16 v[160:175], a[168:171], v[128:131], v[160:175]
    ds_read_b64_tr_b16 a[200:201], v9 offset:0
    ds_read_b64_tr_b16 a[202:203], v9 offset:512
    buffer_load_dwordx4 v6, s[16:19], s54 offen offset:1024 lds
    v_add_f32 v224, 1.0, v224
    v_add_f32 v225, 1.0, v225
    v_add_f32 v226, 1.0, v226
    v_add_f32 v227, 1.0, v227
    v_mfma_f32_32x32x16_bf16 v[176:191], a[172:175], v[128:131], v[176:191]
    ds_read_b64_tr_b16 a[204:205], v12 offset:0
    ds_read_b64_tr_b16 a[206:207], v12 offset:512
    v_rcp_f32 v224, v224
    v_rcp_f32 v225, v225
    s_waitcnt lgkmcnt(8)
    v_mfma_f32_32x32x16_bf16 v[160:175], a[176:179], v[132:135], v[160:175]
    ds_read_b64_tr_b16 a[160:161], v9 offset:1024
    ds_read_b64_tr_b16 a[162:163], v9 offset:1536
    v_rcp_f32 v226, v226
    v_rcp_f32 v227, v227
    v_mfma_f32_32x32x16_bf16 v[176:191], a[180:183], v[132:135], v[176:191]
    ds_read_b64_tr_b16 a[164:165], v12 offset:1024
    ds_read_b64_tr_b16 a[166:167], v12 offset:1536
    v_mul_f32 v224, v216, v224
    v_mul_f32 v225, v217, v225
    v_mul_f32 v226, v218, v226
    v_mul_f32 v227, v219, v227
    v_mfma_f32_32x32x16_bf16 v[160:175], a[184:187], v[136:139], v[160:175]
    ds_read_b64_tr_b16 a[168:169], v9 offset:2048
    ds_read_b64_tr_b16 a[170:171], v9 offset:2560
    buffer_load_dwordx4 v7, s[16:19], s54 offen offset:2048 lds
    v_cvt_pk_bf16_f32 v232, v224, v225
    v_cvt_pk_bf16_f32 v233, v226, v227
    v_accvgpr_write_b32 a60, v232
    v_mfma_f32_32x32x16_bf16 v[176:191], a[188:191], v[136:139], v[176:191]
    ds_read_b64_tr_b16 a[172:173], v12 offset:2048
    ds_read_b64_tr_b16 a[174:175], v12 offset:2560
    v_accvgpr_write_b32 a61, v233
    v_mul_f32 v228, v255, v220
    v_mul_f32 v229, v255, v221
    s_waitcnt lgkmcnt(8)
    v_mfma_f32_32x32x16_bf16 v[160:175], a[192:195], v[140:143], v[160:175]
    ds_read_b64_tr_b16 a[176:177], v9 offset:3072
    ds_read_b64_tr_b16 a[178:179], v9 offset:3584
    v_mul_f32 v230, v255, v222
    v_mul_f32 v231, v255, v223
    v_exp_f32 v228, v228
    v_mfma_f32_32x32x16_bf16 v[176:191], a[196:199], v[140:143], v[176:191]
    ds_read_b64_tr_b16 a[180:181], v12 offset:3072
    ds_read_b64_tr_b16 a[182:183], v12 offset:3584
    v_exp_f32 v229, v229
    v_exp_f32 v230, v230
    v_mfma_f32_32x32x16_bf16 v[160:175], a[200:203], v[144:147], v[160:175]
    s_waitcnt vmcnt(20)
    s_barrier
    ds_read_b64_tr_b16 a[184:185], v9 offset:8192
    ds_read_b64_tr_b16 a[186:187], v9 offset:8704
    s_add_u32 m0, s47, 24576
    s_add_u32 s54, s85, 0
    v_exp_f32 v231, v231
    v_add_f32 v228, 1.0, v228
    v_add_f32 v229, 1.0, v229
    v_mfma_f32_32x32x16_bf16 v[176:191], a[204:207], v[144:147], v[176:191]
    ds_read_b64_tr_b16 a[188:189], v12 offset:8192
    ds_read_b64_tr_b16 a[190:191], v12 offset:8704
    v_add_f32 v230, 1.0, v230
    v_add_f32 v231, 1.0, v231
    v_rcp_f32 v228, v228
    s_waitcnt lgkmcnt(8)
    v_mfma_f32_32x32x16_bf16 v[160:175], a[160:163], v[148:151], v[160:175]
    ds_read_b64_tr_b16 a[192:193], v9 offset:9216
    ds_read_b64_tr_b16 a[194:195], v9 offset:9728
    buffer_load_dwordx4 v5, s[16:19], s54 offen offset:0 lds
    v_rcp_f32 v229, v229
    v_rcp_f32 v230, v230
    v_mfma_f32_32x32x16_bf16 v[176:191], a[164:167], v[148:151], v[176:191]
    ds_read_b64_tr_b16 a[196:197], v12 offset:9216
    ds_read_b64_tr_b16 a[198:199], v12 offset:9728
    v_rcp_f32 v231, v231
    v_mul_f32 v228, v220, v228
    v_mfma_f32_32x32x16_bf16 v[160:175], a[168:171], v[152:155], v[160:175]
    ds_read_b64_tr_b16 a[200:201], v9 offset:10240
    ds_read_b64_tr_b16 a[202:203], v9 offset:10752
    v_mul_f32 v229, v221, v229
    v_mul_f32 v230, v222, v230
    v_mul_f32 v231, v223, v231
    v_cvt_pk_bf16_f32 v234, v228, v229
    v_mfma_f32_32x32x16_bf16 v[176:191], a[172:175], v[152:155], v[176:191]
    ds_read_b64_tr_b16 a[204:205], v12 offset:10240
    ds_read_b64_tr_b16 a[206:207], v12 offset:10752
    buffer_load_dwordx4 v6, s[16:19], s54 offen offset:1024 lds
    v_cvt_pk_bf16_f32 v235, v230, v231
    v_accvgpr_write_b32 a62, v234
    v_accvgpr_write_b32 a63, v235
    s_waitcnt lgkmcnt(8)
    v_mfma_f32_32x32x16_bf16 v[160:175], a[176:179], v[156:159], v[160:175]
    ds_read_b64_tr_b16 a[160:161], v9 offset:11264
    ds_read_b64_tr_b16 a[162:163], v9 offset:11776
    v_mfma_f32_32x32x16_bf16 v[176:191], a[180:183], v[156:159], v[176:191]
    ds_read_b64_tr_b16 a[164:165], v12 offset:11264
    ds_read_b64_tr_b16 a[166:167], v12 offset:11776
    v_mfma_f32_32x32x16_bf16 v[192:207], a[184:187], v[16:19], 0
    ds_read_b64_tr_b16 a[168:169], v9 offset:16384
    ds_read_b64_tr_b16 a[170:171], v9 offset:16896
    buffer_load_dwordx4 v7, s[16:19], s54 offen offset:2048 lds
    v_mfma_f32_32x32x16_bf16 v[208:223], a[188:191], v[16:19], 0
    ds_read_b64_tr_b16 a[172:173], v12 offset:16384
    ds_read_b64_tr_b16 a[174:175], v12 offset:16896
    s_add_u32 m0, s47, 27648
    s_add_u32 s54, s85, 27648
    v_mul_f32 v224, v255, v160
    v_mul_f32 v225, v255, v161
    v_mul_f32 v226, v255, v162
    v_mul_f32 v227, v255, v163
    s_waitcnt lgkmcnt(8)
    v_mfma_f32_32x32x16_bf16 v[192:207], a[192:195], v[20:23], v[192:207]
    ds_read_b64_tr_b16 a[176:177], v9 offset:17408
    ds_read_b64_tr_b16 a[178:179], v9 offset:17920
    v_exp_f32 v224, v224
    v_exp_f32 v225, v225
    v_mfma_f32_32x32x16_bf16 v[208:223], a[196:199], v[20:23], v[208:223]
    ds_read_b64_tr_b16 a[180:181], v12 offset:17408
    ds_read_b64_tr_b16 a[182:183], v12 offset:17920
    v_exp_f32 v226, v226
    v_exp_f32 v227, v227
    v_mfma_f32_32x32x16_bf16 v[192:207], a[200:203], v[24:27], v[192:207]
    ds_read_b64_tr_b16 a[184:185], v9 offset:18432
    ds_read_b64_tr_b16 a[186:187], v9 offset:18944
    buffer_load_dwordx4 v5, s[16:19], s54 offen offset:0 lds
    v_add_f32 v224, 1.0, v224
    v_add_f32 v225, 1.0, v225
    v_add_f32 v226, 1.0, v226
    v_mfma_f32_32x32x16_bf16 v[208:223], a[204:207], v[24:27], v[208:223]
    ds_read_b64_tr_b16 a[188:189], v12 offset:18432
    ds_read_b64_tr_b16 a[190:191], v12 offset:18944
    v_add_f32 v227, 1.0, v227
    v_rcp_f32 v224, v224
    v_rcp_f32 v225, v225
    s_waitcnt lgkmcnt(8)
    v_mfma_f32_32x32x16_bf16 v[192:207], a[160:163], v[28:31], v[192:207]
    ds_read_b64_tr_b16 a[192:193], v9 offset:19456
    ds_read_b64_tr_b16 a[194:195], v9 offset:19968
    v_rcp_f32 v226, v226
    v_mfma_f32_32x32x16_bf16 v[208:223], a[164:167], v[28:31], v[208:223]
    ds_read_b64_tr_b16 a[196:197], v12 offset:19456
    ds_read_b64_tr_b16 a[198:199], v12 offset:19968
    v_rcp_f32 v227, v227
    v_mul_f32 v224, v160, v224
    v_mul_f32 v225, v161, v225
    v_mul_f32 v226, v162, v226
    v_mfma_f32_32x32x16_bf16 v[192:207], a[168:171], v[32:35], v[192:207]
    ds_read_b64_tr_b16 a[200:201], v9 offset:24576
    ds_read_b64_tr_b16 a[202:203], v9 offset:25088
    buffer_load_dwordx4 v6, s[16:19], s54 offen offset:1024 lds
    v_mul_f32 v227, v163, v227
    v_cvt_pk_bf16_f32 v232, v224, v225
    v_cvt_pk_bf16_f32 v233, v226, v227
    v_mfma_f32_32x32x16_bf16 v[208:223], a[172:175], v[32:35], v[208:223]
    ds_read_b64_tr_b16 a[204:205], v12 offset:24576
    ds_read_b64_tr_b16 a[206:207], v12 offset:25088
    v_accvgpr_write_b32 a64, v232
    v_accvgpr_write_b32 a65, v233
    v_mul_f32 v228, v255, v164
    s_waitcnt lgkmcnt(8)
    v_mfma_f32_32x32x16_bf16 v[192:207], a[176:179], v[36:39], v[192:207]
    ds_read_b64_tr_b16 a[160:161], v9 offset:25600
    ds_read_b64_tr_b16 a[162:163], v9 offset:26112
    v_mul_f32 v229, v255, v165
    v_mul_f32 v230, v255, v166
    v_mul_f32 v231, v255, v167
    v_exp_f32 v228, v228
    v_mfma_f32_32x32x16_bf16 v[208:223], a[180:183], v[36:39], v[208:223]
    ds_read_b64_tr_b16 a[164:165], v12 offset:25600
    ds_read_b64_tr_b16 a[166:167], v12 offset:26112
    v_exp_f32 v229, v229
    v_exp_f32 v230, v230
    v_mfma_f32_32x32x16_bf16 v[192:207], a[184:187], v[40:43], v[192:207]
    ds_read_b64_tr_b16 a[168:169], v9 offset:26624
    ds_read_b64_tr_b16 a[170:171], v9 offset:27136
    buffer_load_dwordx4 v7, s[16:19], s54 offen offset:2048 lds
    v_exp_f32 v231, v231
    v_add_f32 v228, 1.0, v228
    v_mfma_f32_32x32x16_bf16 v[208:223], a[188:191], v[40:43], v[208:223]
    ds_read_b64_tr_b16 a[172:173], v12 offset:26624
    ds_read_b64_tr_b16 a[174:175], v12 offset:27136
    v_add_f32 v229, 1.0, v229
    v_add_f32 v230, 1.0, v230
    v_add_f32 v231, 1.0, v231
    s_waitcnt lgkmcnt(8)
    v_mfma_f32_32x32x16_bf16 v[192:207], a[192:195], v[44:47], v[192:207]
    ds_read_b64_tr_b16 a[176:177], v9 offset:27648
    ds_read_b64_tr_b16 a[178:179], v9 offset:28160
    v_rcp_f32 v228, v228
    v_rcp_f32 v229, v229
    v_mfma_f32_32x32x16_bf16 v[208:223], a[196:199], v[44:47], v[208:223]
    ds_read_b64_tr_b16 a[180:181], v12 offset:27648
    ds_read_b64_tr_b16 a[182:183], v12 offset:28160
    v_rcp_f32 v230, v230
    v_rcp_f32 v231, v231
    v_mfma_f32_32x32x16_bf16 v[192:207], a[200:203], v[48:51], v[192:207]
    s_waitcnt vmcnt(20)
    s_barrier
    ds_read_b64_tr_b16 a[184:185], v9 offset:32768
    ds_read_b64_tr_b16 a[186:187], v9 offset:33280
    s_add_u32 m0, s47, 49152
    s_add_u32 s54, s84, 221184
    v_mul_f32 v228, v164, v228
    v_mul_f32 v229, v165, v229
    v_mul_f32 v230, v166, v230
    v_mul_f32 v231, v167, v231
    v_mfma_f32_32x32x16_bf16 v[208:223], a[204:207], v[48:51], v[208:223]
    ds_read_b64_tr_b16 a[188:189], v12 offset:32768
    ds_read_b64_tr_b16 a[190:191], v12 offset:33280
    v_cvt_pk_bf16_f32 v234, v228, v229
    v_cvt_pk_bf16_f32 v235, v230, v231
    v_accvgpr_write_b32 a66, v234
    s_waitcnt lgkmcnt(8)
    v_mfma_f32_32x32x16_bf16 v[192:207], a[160:163], v[52:55], v[192:207]
    ds_read_b64_tr_b16 a[192:193], v9 offset:33792
    ds_read_b64_tr_b16 a[194:195], v9 offset:34304
    buffer_load_dwordx4 v5, s[16:19], s54 offen offset:0 lds
    v_accvgpr_write_b32 a67, v235
    v_mul_f32 v224, v255, v168
    v_mul_f32 v225, v255, v169
    v_mul_f32 v226, v255, v170
    v_mfma_f32_32x32x16_bf16 v[208:223], a[164:167], v[52:55], v[208:223]
    ds_read_b64_tr_b16 a[196:197], v12 offset:33792
    ds_read_b64_tr_b16 a[198:199], v12 offset:34304
    v_mul_f32 v227, v255, v171
    v_exp_f32 v224, v224
    v_mfma_f32_32x32x16_bf16 v[192:207], a[168:171], v[56:59], v[192:207]
    ds_read_b64_tr_b16 a[200:201], v9 offset:34816
    ds_read_b64_tr_b16 a[202:203], v9 offset:35328
    v_exp_f32 v225, v225
    v_exp_f32 v226, v226
    v_mfma_f32_32x32x16_bf16 v[208:223], a[172:175], v[56:59], v[208:223]
    ds_read_b64_tr_b16 a[204:205], v12 offset:34816
    ds_read_b64_tr_b16 a[206:207], v12 offset:35328
    buffer_load_dwordx4 v6, s[16:19], s54 offen offset:1024 lds
    v_exp_f32 v227, v227
    v_add_f32 v224, 1.0, v224
    v_add_f32 v225, 1.0, v225
    s_waitcnt lgkmcnt(8)
    v_mfma_f32_32x32x16_bf16 v[192:207], a[176:179], v[60:63], v[192:207]
    ds_read_b64_tr_b16 a[160:161], v9 offset:35840
    ds_read_b64_tr_b16 a[162:163], v9 offset:36352
    v_add_f32 v226, 1.0, v226
    v_add_f32 v227, 1.0, v227
    v_rcp_f32 v224, v224
    v_mfma_f32_32x32x16_bf16 v[208:223], a[180:183], v[60:63], v[208:223]
    ds_read_b64_tr_b16 a[164:165], v12 offset:35840
    ds_read_b64_tr_b16 a[166:167], v12 offset:36352
    v_rcp_f32 v225, v225
    v_rcp_f32 v226, v226
    v_mfma_f32_32x32x16_bf16 v[192:207], a[184:187], v[64:67], v[192:207]
    ds_read_b64_tr_b16 a[168:169], v9 offset:40960
    ds_read_b64_tr_b16 a[170:171], v9 offset:41472
    buffer_load_dwordx4 v7, s[16:19], s54 offen offset:2048 lds
    v_rcp_f32 v227, v227
    v_mul_f32 v224, v168, v224
    v_mul_f32 v225, v169, v225
    v_mfma_f32_32x32x16_bf16 v[208:223], a[188:191], v[64:67], v[208:223]
    ds_read_b64_tr_b16 a[172:173], v12 offset:40960
    ds_read_b64_tr_b16 a[174:175], v12 offset:41472
    s_add_u32 m0, s47, 52224
    s_add_u32 s54, s84, 248832
    v_mul_f32 v226, v170, v226
    v_mul_f32 v227, v171, v227
    v_cvt_pk_bf16_f32 v232, v224, v225
    s_waitcnt lgkmcnt(8)
    v_mfma_f32_32x32x16_bf16 v[192:207], a[192:195], v[68:71], v[192:207]
    ds_read_b64_tr_b16 a[176:177], v9 offset:41984
    ds_read_b64_tr_b16 a[178:179], v9 offset:42496
    v_cvt_pk_bf16_f32 v233, v226, v227
    v_accvgpr_write_b32 a68, v232
    v_accvgpr_write_b32 a69, v233
    v_mfma_f32_32x32x16_bf16 v[208:223], a[196:199], v[68:71], v[208:223]
    ds_read_b64_tr_b16 a[180:181], v12 offset:41984
    ds_read_b64_tr_b16 a[182:183], v12 offset:42496
    v_mul_f32 v228, v255, v172
    v_mul_f32 v229, v255, v173
    v_mul_f32 v230, v255, v174
    v_mul_f32 v231, v255, v175
    v_mfma_f32_32x32x16_bf16 v[192:207], a[200:203], v[72:75], v[192:207]
    ds_read_b64_tr_b16 a[184:185], v9 offset:43008
    ds_read_b64_tr_b16 a[186:187], v9 offset:43520
    buffer_load_dwordx4 v5, s[16:19], s54 offen offset:0 lds
    v_exp_f32 v228, v228
    v_exp_f32 v229, v229
    v_mfma_f32_32x32x16_bf16 v[208:223], a[204:207], v[72:75], v[208:223]
    ds_read_b64_tr_b16 a[188:189], v12 offset:43008
    ds_read_b64_tr_b16 a[190:191], v12 offset:43520
    v_exp_f32 v230, v230
    v_exp_f32 v231, v231
    s_waitcnt lgkmcnt(8)
    v_mfma_f32_32x32x16_bf16 v[192:207], a[160:163], v[76:79], v[192:207]
    ds_read_b64_tr_b16 a[192:193], v9 offset:44032
    ds_read_b64_tr_b16 a[194:195], v9 offset:44544
    v_add_f32 v228, 1.0, v228
    v_add_f32 v229, 1.0, v229
    v_add_f32 v230, 1.0, v230
    v_add_f32 v231, 1.0, v231
    v_mfma_f32_32x32x16_bf16 v[208:223], a[164:167], v[76:79], v[208:223]
    ds_read_b64_tr_b16 a[196:197], v12 offset:44032
    ds_read_b64_tr_b16 a[198:199], v12 offset:44544
    v_rcp_f32 v228, v228
    v_rcp_f32 v229, v229
    v_mfma_f32_32x32x16_bf16 v[192:207], a[168:171], v[80:83], v[192:207]
    ds_read_b64_tr_b16 a[200:201], v9 offset:49152
    ds_read_b64_tr_b16 a[202:203], v9 offset:49664
    buffer_load_dwordx4 v6, s[16:19], s54 offen offset:1024 lds
    v_rcp_f32 v230, v230
    v_rcp_f32 v231, v231
    v_mfma_f32_32x32x16_bf16 v[208:223], a[172:175], v[80:83], v[208:223]
    ds_read_b64_tr_b16 a[204:205], v12 offset:49152
    ds_read_b64_tr_b16 a[206:207], v12 offset:49664
    v_mul_f32 v228, v172, v228
    v_mul_f32 v229, v173, v229
    v_mul_f32 v230, v174, v230
    s_waitcnt lgkmcnt(8)
    v_mfma_f32_32x32x16_bf16 v[192:207], a[176:179], v[84:87], v[192:207]
    ds_read_b64_tr_b16 a[160:161], v9 offset:50176
    ds_read_b64_tr_b16 a[162:163], v9 offset:50688
    v_mul_f32 v231, v175, v231
    v_cvt_pk_bf16_f32 v234, v228, v229
    v_cvt_pk_bf16_f32 v235, v230, v231
    v_mfma_f32_32x32x16_bf16 v[208:223], a[180:183], v[84:87], v[208:223]
    ds_read_b64_tr_b16 a[164:165], v12 offset:50176
    ds_read_b64_tr_b16 a[166:167], v12 offset:50688
    v_accvgpr_write_b32 a70, v234
    v_accvgpr_write_b32 a71, v235
    v_mul_f32 v224, v255, v176
    v_mul_f32 v225, v255, v177
    v_mfma_f32_32x32x16_bf16 v[192:207], a[184:187], v[88:91], v[192:207]
    ds_read_b64_tr_b16 a[168:169], v9 offset:51200
    ds_read_b64_tr_b16 a[170:171], v9 offset:51712
    buffer_load_dwordx4 v7, s[16:19], s54 offen offset:2048 lds
    v_mul_f32 v226, v255, v178
    v_mul_f32 v227, v255, v179
    v_exp_f32 v224, v224
    v_mfma_f32_32x32x16_bf16 v[208:223], a[188:191], v[88:91], v[208:223]
    ds_read_b64_tr_b16 a[172:173], v12 offset:51200
    ds_read_b64_tr_b16 a[174:175], v12 offset:51712
    v_exp_f32 v225, v225
    v_exp_f32 v226, v226
    s_waitcnt lgkmcnt(8)
    v_mfma_f32_32x32x16_bf16 v[192:207], a[192:195], v[92:95], v[192:207]
    ds_read_b64_tr_b16 a[176:177], v9 offset:52224
    ds_read_b64_tr_b16 a[178:179], v9 offset:52736
    v_exp_f32 v227, v227
    v_add_f32 v224, 1.0, v224
    v_mfma_f32_32x32x16_bf16 v[208:223], a[196:199], v[92:95], v[208:223]
    ds_read_b64_tr_b16 a[180:181], v12 offset:52224
    ds_read_b64_tr_b16 a[182:183], v12 offset:52736
    v_add_f32 v225, 1.0, v225
    v_add_f32 v226, 1.0, v226
    v_add_f32 v227, 1.0, v227
    v_rcp_f32 v224, v224
    v_mfma_f32_32x32x16_bf16 v[192:207], a[200:203], v[96:99], v[192:207]
    s_waitcnt vmcnt(19)
    s_barrier
    ds_read_b64_tr_b16 a[184:185], v9 offset:57344
    ds_read_b64_tr_b16 a[186:187], v9 offset:57856
    s_add_u32 m0, s47, 73728
    s_add_u32 s54, s85, 221184
    v_rcp_f32 v225, v225
    v_rcp_f32 v226, v226
    v_mfma_f32_32x32x16_bf16 v[208:223], a[204:207], v[96:99], v[208:223]
    ds_read_b64_tr_b16 a[188:189], v12 offset:57344
    ds_read_b64_tr_b16 a[190:191], v12 offset:57856
    v_rcp_f32 v227, v227
    v_mul_f32 v224, v176, v224
    s_waitcnt lgkmcnt(8)
    v_mfma_f32_32x32x16_bf16 v[192:207], a[160:163], v[100:103], v[192:207]
    ds_read_b64_tr_b16 a[192:193], v9 offset:58368
    ds_read_b64_tr_b16 a[194:195], v9 offset:58880
    buffer_load_dwordx4 v5, s[16:19], s54 offen offset:0 lds
    v_mul_f32 v225, v177, v225
    v_mul_f32 v226, v178, v226
    v_mul_f32 v227, v179, v227
    v_cvt_pk_bf16_f32 v232, v224, v225
    s_waitcnt vmcnt(18)
    v_readfirstlane_b32 s51, v239
    s_nop 1
    s_cmp_ge_u32 s51, 1
    s_cbranch_scc0 L_sp0
L_ok0:
    v_mfma_f32_32x32x16_bf16 v[208:223], a[164:167], v[100:103], v[208:223]
    ds_read_b64_tr_b16 a[196:197], v12 offset:58368
    ds_read_b64_tr_b16 a[198:199], v12 offset:58880
    v_cvt_pk_bf16_f32 v233, v226, v227
    v_accvgpr_write_b32 a72, v232
    v_accvgpr_write_b32 a73, v233
    v_mfma_f32_32x32x16_bf16 v[192:207], a[168:171], v[104:107], v[192:207]
    ds_read_b64_tr_b16 a[200:201], v9 offset:59392
    ds_read_b64_tr_b16 a[202:203], v9 offset:59904
    v_mul_f32 v228, v255, v180
    v_mul_f32 v229, v255, v181
    v_mul_f32 v230, v255, v182
    v_mfma_f32_32x32x16_bf16 v[208:223], a[172:175], v[104:107], v[208:223]
    ds_read_b64_tr_b16 a[204:205], v12 offset:59392
    ds_read_b64_tr_b16 a[206:207], v12 offset:59904
    buffer_load_dwordx4 v6, s[16:19], s54 offen offset:1024 lds
    v_mul_f32 v231, v255, v183
    v_exp_f32 v228, v228
    v_exp_f32 v229, v229
    s_waitcnt lgkmcnt(8)
    v_mfma_f32_32x32x16_bf16 v[192:207], a[176:179], v[108:111], v[192:207]
    ds_read_b64_tr_b16 a[160:161], v9 offset:60416
    ds_read_b64_tr_b16 a[162:163], v9 offset:60928
    v_exp_f32 v230, v230
    v_mfma_f32_32x32x16_bf16 v[208:223], a[180:183], v[108:111], v[208:223]
    ds_read_b64_tr_b16 a[164:165], v12 offset:60416
    ds_read_b64_tr_b16 a[166:167], v12 offset:60928
    v_exp_f32 v231, v231
    v_add_f32 v228, 1.0, v228
    v_add_f32 v229, 1.0, v229
    v_add_f32 v230, 1.0, v230
    v_mfma_f32_32x32x16_bf16 v[192:207], a[184:187], v[112:115], v[192:207]
    ds_read_b64_tr_b16 a[168:169], v10 offset:0
    ds_read_b64_tr_b16 a[170:171], v10 offset:512
    buffer_load_dwordx4 v7, s[16:19], s54 offen offset:2048 lds
    v_add_f32 v231, 1.0, v231
    v_rcp_f32 v228, v228
    v_mfma_f32_32x32x16_bf16 v[208:223], a[188:191], v[112:115], v[208:223]
    ds_read_b64_tr_b16 a[172:173], v13 offset:0
    ds_read_b64_tr_b16 a[174:175], v13 offset:512
    s_add_u32 m0, s47, 76800
    s_add_u32 s54, s85, 248832
    v_rcp_f32 v229, v229
    v_rcp_f32 v230, v230
    s_waitcnt lgkmcnt(8)
    v_mfma_f32_32x32x16_bf16 v[192:207], a[192:195], v[116:119], v[192:207]
    ds_read_b64_tr_b16 a[176:177], v10 offset:1024
    ds_read_b64_tr_b16 a[178:179], v10 offset:1536
    v_rcp_f32 v231, v231
    v_mul_f32 v228, v180, v228
    v_mul_f32 v229, v181, v229
    v_mfma_f32_32x32x16_bf16 v[208:223], a[196:199], v[116:119], v[208:223]
    ds_read_b64_tr_b16 a[180:181], v13 offset:1024
    ds_read_b64_tr_b16 a[182:183], v13 offset:1536
    v_mul_f32 v230, v182, v230
    v_mul_f32 v231, v183, v231
    v_cvt_pk_bf16_f32 v234, v228, v229
    v_cvt_pk_bf16_f32 v235, v230, v231
    v_mfma_f32_32x32x16_bf16 v[192:207], a[200:203], v[120:123], v[192:207]
    ds_read_b64_tr_b16 a[184:185], v10 offset:2048
    ds_read_b64_tr_b16 a[186:187], v10 offset:2560
    buffer_load_dwordx4 v5, s[16:19], s54 offen offset:0 lds
    v_accvgpr_write_b32 a74, v234
    v_accvgpr_write_b32 a75, v235
    v_mul_f32 v224, v255, v184
    v_mfma_f32_32x32x16_bf16 v[208:223], a[204:207], v[120:123], v[208:223]
    ds_read_b64_tr_b16 a[188:189], v13 offset:2048
    ds_read_b64_tr_b16 a[190:191], v13 offset:2560
    v_mul_f32 v225, v255, v185
    v_mul_f32 v226, v255, v186
    v_mul_f32 v227, v255, v187
    s_waitcnt lgkmcnt(8)
    v_mfma_f32_32x32x16_bf16 v[192:207], a[160:163], v[124:127], v[192:207]
    ds_read_b64_tr_b16 a[192:193], v10 offset:3072
    ds_read_b64_tr_b16 a[194:195], v10 offset:3584
    v_exp_f32 v224, v224
    v_exp_f32 v225, v225
    v_mfma_f32_32x32x16_bf16 v[208:223], a[164:167], v[124:127], v[208:223]
    ds_read_b64_tr_b16 a[196:197], v13 offset:3072
    ds_read_b64_tr_b16 a[198:199], v13 offset:3584
    v_exp_f32 v226, v226
    v_exp_f32 v227, v227
    v_mfma_f32_32x32x16_bf16 v[192:207], a[168:171], v[128:131], v[192:207]
    ds_read_b64_tr_b16 a[200:201], v10 offset:8192
    ds_read_b64_tr_b16 a[202:203], v10 offset:8704
    buffer_load_dwordx4 v6, s[16:19], s54 offen offset:1024 lds
    v_add_f32 v224, 1.0, v224
    v_add_f32 v225, 1.0, v225
    v_add_f32 v226, 1.0, v226
    v_add_f32 v227, 1.0, v227
    v_mfma_f32_32x32x16_bf16 v[208:223], a[172:175], v[128:131], v[208:223]
    ds_read_b64_tr_b16 a[204:205], v13 offset:8192
    ds_read_b64_tr_b16 a[206:207], v13 offset:8704
    v_rcp_f32 v224, v224
    v_rcp_f32 v225, v225
    s_waitcnt lgkmcnt(8)
    v_mfma_f32_32x32x16_bf16 v[192:207], a[176:179], v[132:135], v[192:207]
    ds_read_b64_tr_b16 a[160:161], v10 offset:9216
    ds_read_b64_tr_b16 a[162:163], v10 offset:9728
    v_rcp_f32 v226, v226
    v_rcp_f32 v227, v227
    v_mfma_f32_32x32x16_bf16 v[208:223], a[180:183], v[132:135], v[208:223]
    ds_read_b64_tr_b16 a[164:165], v13 offset:9216
    ds_read_b64_tr_b16 a[166:167], v13 offset:9728
    v_mul_f32 v224, v184, v224
    v_mul_f32 v225, v185, v225
    v_mul_f32 v226, v186, v226
    v_mul_f32 v227, v187, v227
    v_mfma_f32_32x32x16_bf16 v[192:207], a[184:187], v[136:139], v[192:207]
    ds_read_b64_tr_b16 a[168:169], v10 offset:10240
    ds_read_b64_tr_b16 a[170:171], v10 offset:10752
    buffer_load_dwordx4 v7, s[16:19], s54 offen offset:2048 lds
    v_cvt_pk_bf16_f32 v232, v224, v225
    v_cvt_pk_bf16_f32 v233, v226, v227
    v_accvgpr_write_b32 a76, v232
    v_mfma_f32_32x32x16_bf16 v[208:223], a[188:191], v[136:139], v[208:223]
    ds_read_b64_tr_b16 a[172:173], v13 offset:10240
    ds_read_b64_tr_b16 a[174:175], v13 offset:10752
    v_accvgpr_write_b32 a77, v233
    v_mul_f32 v228, v255, v188
    v_mul_f32 v229, v255, v189
    s_waitcnt lgkmcnt(8)
    v_mfma_f32_32x32x16_bf16 v[192:207], a[192:195], v[140:143], v[192:207]
    ds_read_b64_tr_b16 a[176:177], v10 offset:11264
    ds_read_b64_tr_b16 a[178:179], v10 offset:11776
    v_mul_f32 v230, v255, v190
    v_mul_f32 v231, v255, v191
    v_exp_f32 v228, v228
    v_mfma_f32_32x32x16_bf16 v[208:223], a[196:199], v[140:143], v[208:223]
    ds_read_b64_tr_b16 a[180:181], v13 offset:11264
    ds_read_b64_tr_b16 a[182:183], v13 offset:11776
    v_exp_f32 v229, v229
    v_exp_f32 v230, v230
    v_mfma_f32_32x32x16_bf16 v[192:207], a[200:203], v[144:147], v[192:207]
    s_waitcnt vmcnt(18)
    s_barrier
    ds_read_b64_tr_b16 a[184:185], v8 offset:0
    ds_read_b64_tr_b16 a[186:187], v8 offset:512
    s_add_u32 m0, s47, 98304
    s_add_u32 s54, s86, 0
    v_exp_f32 v231, v231
    v_add_f32 v228, 1.0, v228
    v_add_f32 v229, 1.0, v229
    v_mfma_f32_32x32x16_bf16 v[208:223], a[204:207], v[144:147], v[208:223]
    ds_read_b64_tr_b16 a[188:189], v11 offset:0
    ds_read_b64_tr_b16 a[190:191], v11 offset:512
    v_add_f32 v230, 1.0, v230
    v_add_f32 v231, 1.0, v231
    v_rcp_f32 v228, v228
    s_waitcnt lgkmcnt(8)
    v_mfma_f32_32x32x16_bf16 v[192:207], a[160:163], v[148:151], v[192:207]
    ds_read_b64_tr_b16 a[192:193], v8 offset:1024
    ds_read_b64_tr_b16 a[194:195], v8 offset:1536
    buffer_load_dwordx4 v5, s[16:19], s54 offen offset:0 lds
    v_rcp_f32 v229, v229
    v_rcp_f32 v230, v230
    v_mfma_f32_32x32x16_bf16 v[208:223], a[164:167], v[148:151], v[208:223]
    ds_read_b64_tr_b16 a[196:197], v11 offset:1024
    ds_read_b64_tr_b16 a[198:199], v11 offset:1536
    v_rcp_f32 v231, v231
    v_mul_f32 v228, v188, v228
    v_mfma_f32_32x32x16_bf16 v[192:207], a[168:171], v[152:155], v[192:207]
    ds_read_b64_tr_b16 a[200:201], v8 offset:2048
    ds_read_b64_tr_b16 a[202:203], v8 offset:2560
    v_mul_f32 v229, v189, v229
    v_mul_f32 v230, v190, v230
    v_mul_f32 v231, v191, v231
    v_cvt_pk_bf16_f32 v234, v228, v229
    v_mfma_f32_32x32x16_bf16 v[208:223], a[172:175], v[152:155], v[208:223]
    ds_read_b64_tr_b16 a[204:205], v11 offset:2048
    ds_read_b64_tr_b16 a[206:207], v11 offset:2560
    buffer_load_dwordx4 v6, s[16:19], s54 offen offset:1024 lds
    v_cvt_pk_bf16_f32 v235, v230, v231
    v_accvgpr_write_b32 a78, v234
    v_accvgpr_write_b32 a79, v235
    s_waitcnt lgkmcnt(8)
    v_mfma_f32_32x32x16_bf16 v[192:207], a[176:179], v[156:159], v[192:207]
    ds_read_b64_tr_b16 a[160:161], v8 offset:3072
    ds_read_b64_tr_b16 a[162:163], v8 offset:3584
    v_mfma_f32_32x32x16_bf16 v[208:223], a[180:183], v[156:159], v[208:223]
    ds_read_b64_tr_b16 a[164:165], v11 offset:3072
    ds_read_b64_tr_b16 a[166:167], v11 offset:3584
    v_mfma_f32_32x32x16_bf16 v[16:31], a[184:187], a[0:3], 0
    ds_read_b64_tr_b16 a[168:169], v8 offset:8192
    ds_read_b64_tr_b16 a[170:171], v8 offset:8704
    buffer_load_dwordx4 v7, s[16:19], s54 offen offset:2048 lds
    v_mfma_f32_32x32x16_bf16 v[32:47], a[188:191], a[0:3], 0
    ds_read_b64_tr_b16 a[172:173], v11 offset:8192
    ds_read_b64_tr_b16 a[174:175], v11 offset:8704
    s_add_u32 m0, s47, 101376
    s_add_u32 s54, s86, 27648
    v_mul_f32 v224, v255, v192
    v_mul_f32 v225, v255, v193
    v_mul_f32 v226, v255, v194
    v_mul_f32 v227, v255, v195
    s_waitcnt lgkmcnt(8)
    v_mfma_f32_32x32x16_bf16 v[16:31], a[192:195], a[4:7], v[16:31]
    ds_read_b64_tr_b16 a[176:177], v8 offset:9216
    ds_read_b64_tr_b16 a[178:179], v8 offset:9728
    v_exp_f32 v224, v224
    v_exp_f32 v225, v225
    v_mfma_f32_32x32x16_bf16 v[32:47], a[196:199], a[4:7], v[32:47]
    ds_read_b64_tr_b16 a[180:181], v11 offset:9216
    ds_read_b64_tr_b16 a[182:183], v11 offset:9728
    v_exp_f32 v226, v226
    v_exp_f32 v227, v227
    v_add_f32 v224, 1.0, v224
    v_mfma_f32_32x32x16_bf16 v[16:31], a[200:203], a[8:11], v[16:31]
    ds_read_b64_tr_b16 a[184:185], v8 offset:10240
    ds_read_b64_tr_b16 a[186:187], v8 offset:10752
    buffer_load_dwordx4 v5, s[16:19], s54 offen offset:0 lds
    v_add_f32 v225, 1.0, v225
    v_add_f32 v226, 1.0, v226
    v_add_f32 v227, 1.0, v227
    v_rcp_f32 v224, v224
    v_mfma_f32_32x32x16_bf16 v[32:47], a[204:207], a[8:11], v[32:47]
    ds_read_b64_tr_b16 a[188:189], v11 offset:10240
    ds_read_b64_tr_b16 a[190:191], v11 offset:10752
    v_rcp_f32 v225, v225
    v_rcp_f32 v226, v226
    s_waitcnt lgkmcnt(8)
    v_mfma_f32_32x32x16_bf16 v[16:31], a[160:163], a[12:15], v[16:31]
    ds_read_b64_tr_b16 a[192:193], v8 offset:11264
    ds_read_b64_tr_b16 a[194:195], v8 offset:11776
    v_rcp_f32 v227, v227
    v_mul_f32 v224, v192, v224
    v_mul_f32 v225, v193, v225
    v_mfma_f32_32x32x16_bf16 v[32:47], a[164:167], a[12:15], v[32:47]
    ds_read_b64_tr_b16 a[196:197], v11 offset:11264
    ds_read_b64_tr_b16 a[198:199], v11 offset:11776
    v_mul_f32 v226, v194, v226
    v_mul_f32 v227, v195, v227
    v_cvt_pk_bf16_f32 v232, v224, v225
    v_cvt_pk_bf16_f32 v233, v226, v227
    v_mfma_f32_32x32x16_bf16 v[16:31], a[168:171], a[16:19], v[16:31]
    ds_read_b64_tr_b16 a[200:201], v8 offset:16384
    ds_read_b64_tr_b16 a[202:203], v8 offset:16896
    buffer_load_dwordx4 v6, s[16:19], s54 offen offset:1024 lds
    v_accvgpr_write_b32 a80, v232
    v_accvgpr_write_b32 a81, v233
    v_mul_f32 v228, v255, v196
    v_mul_f32 v229, v255, v197
    v_mfma_f32_32x32x16_bf16 v[32:47], a[172:175], a[16:19], v[32:47]
    ds_read_b64_tr_b16 a[204:205], v11 offset:16384
    ds_read_b64_tr_b16 a[206:207], v11 offset:16896
    v_mul_f32 v230, v255, v198
    v_mul_f32 v231, v255, v199
    v_exp_f32 v228, v228
    s_waitcnt lgkmcnt(8)
    v_mfma_f32_32x32x16_bf16 v[16:31], a[176:179], a[20:23], v[16:31]
    ds_read_b64_tr_b16 a[160:161], v8 offset:17408
    ds_read_b64_tr_b16 a[162:163], v8 offset:17920
    v_exp_f32 v229, v229
    v_exp_f32 v230, v230
    v_mfma_f32_32x32x16_bf16 v[32:47], a[180:183], a[20:23], v[32:47]
    ds_read_b64_tr_b16 a[164:165], v11 offset:17408
    ds_read_b64_tr_b16 a[166:167], v11 offset:17920
    v_exp_f32 v231, v231
    v_add_f32 v228, 1.0, v228
    v_add_f32 v229, 1.0, v229
    v_add_f32 v230, 1.0, v230
    v_mfma_f32_32x32x16_bf16 v[16:31], a[184:187], a[24:27], v[16:31]
    ds_read_b64_tr_b16 a[168:169], v8 offset:18432
    ds_read_b64_tr_b16 a[170:171], v8 offset:18944
    buffer_load_dwordx4 v7, s[16:19], s54 offen offset:2048 lds
    v_add_f32 v231, 1.0, v231
    v_rcp_f32 v228, v228
    v_mfma_f32_32x32x16_bf16 v[32:47], a[188:191], a[24:27], v[32:47]
    ds_read_b64_tr_b16 a[172:173], v11 offset:18432
    ds_read_b64_tr_b16 a[174:175], v11 offset:18944
    v_rcp_f32 v229, v229
    v_rcp_f32 v230, v230
    v_rcp_f32 v231, v231
    s_waitcnt lgkmcnt(8)
    v_mfma_f32_32x32x16_bf16 v[16:31], a[192:195], a[28:31], v[16:31]
    ds_read_b64_tr_b16 a[176:177], v8 offset:19456
    ds_read_b64_tr_b16 a[178:179], v8 offset:19968
    v_mul_f32 v228, v196, v228
    v_mul_f32 v229, v197, v229
    v_mul_f32 v230, v198, v230
    v_mul_f32 v231, v199, v231
    v_mfma_f32_32x32x16_bf16 v[32:47], a[196:199], a[28:31], v[32:47]
    ds_read_b64_tr_b16 a[180:181], v11 offset:19456
    ds_read_b64_tr_b16 a[182:183], v11 offset:19968
    v_cvt_pk_bf16_f32 v234, v228, v229
    v_cvt_pk_bf16_f32 v235, v230, v231
    v_accvgpr_write_b32 a82, v234
    v_mfma_f32_32x32x16_bf16 v[16:31], a[200:203], a[32:35], v[16:31]
    s_waitcnt vmcnt(18)
    s_barrier
    ds_read_b64_tr_b16 a[184:185], v8 offset:24576
    ds_read_b64_tr_b16 a[186:187], v8 offset:25088
    s_add_u32 m0, s47, 122880
    s_add_u32 s54, s86, 221184
    v_accvgpr_write_b32 a83, v235
    v_mul_f32 v224, v255, v200
    v_mul_f32 v225, v255, v201
    v_mul_f32 v226, v255, v202
    v_mfma_f32_32x32x16_bf16 v[32:47], a[204:207], a[32:35], v[32:47]
    ds_read_b64_tr_b16 a[188:189], v11 offset:24576
    ds_read_b64_tr_b16 a[190:191], v11 offset:25088
    v_mul_f32 v227, v255, v203
    v_exp_f32 v224, v224
    v_exp_f32 v225, v225
    s_waitcnt lgkmcnt(8)
    v_mfma_f32_32x32x16_bf16 v[16:31], a[160:163], a[36:39], v[16:31]
    ds_read_b64_tr_b16 a[192:193], v8 offset:25600
    ds_read_b64_tr_b16 a[194:195], v8 offset:26112
    buffer_load_dwordx4 v5, s[16:19], s54 offen offset:0 lds
    v_exp_f32 v226, v226
    v_exp_f32 v227, v227
    v_mfma_f32_32x32x16_bf16 v[32:47], a[164:167], a[36:39], v[32:47]
    ds_read_b64_tr_b16 a[196:197], v11 offset:25600
    ds_read_b64_tr_b16 a[198:199], v11 offset:26112
    v_add_f32 v224, 1.0, v224
    v_add_f32 v225, 1.0, v225
    v_add_f32 v226, 1.0, v226
    v_add_f32 v227, 1.0, v227
    v_mfma_f32_32x32x16_bf16 v[16:31], a[168:171], a[40:43], v[16:31]
    ds_read_b64_tr_b16 a[200:201], v8 offset:26624
    ds_read_b64_tr_b16 a[202:203], v8 offset:27136
    v_rcp_f32 v224, v224
    v_rcp_f32 v225, v225
    v_mfma_f32_32x32x16_bf16 v[32:47], a[172:175], a[40:43], v[32:47]
    ds_read_b64_tr_b16 a[204:205], v11 offset:26624
    ds_read_b64_tr_b16 a[206:207], v11 offset:27136
    buffer_load_dwordx4 v6, s[16:19], s54 offen offset:1024 lds
    v_rcp_f32 v226, v226
    v_rcp_f32 v227, v227
    v_mul_f32 v224, v200, v224
    s_waitcnt lgkmcnt(8)
    v_mfma_f32_32x32x16_bf16 v[16:31], a[176:179], a[44:47], v[16:31]
    ds_read_b64_tr_b16 a[160:161], v8 offset:27648
    ds_read_b64_tr_b16 a[162:163], v8 offset:28160
    v_mul_f32 v225, v201, v225
    v_mul_f32 v226, v202, v226
    v_mul_f32 v227, v203, v227
    v_cvt_pk_bf16_f32 v232, v224, v225
    v_mfma_f32_32x32x16_bf16 v[32:47], a[180:183], a[44:47], v[32:47]
    ds_read_b64_tr_b16 a[164:165], v11 offset:27648
    ds_read_b64_tr_b16 a[166:167], v11 offset:28160
    v_cvt_pk_bf16_f32 v233, v226, v227
    v_accvgpr_write_b32 a84, v232
    v_accvgpr_write_b32 a85, v233
    v_mul_f32 v228, v255, v204
    v_mfma_f32_32x32x16_bf16 v[48:63], a[184:187], a[0:3], 0
    ds_read_b64_tr_b16 a[168:169], v8 offset:32768
    ds_read_b64_tr_b16 a[170:171], v8 offset:33280
    buffer_load_dwordx4 v7, s[16:19], s54 offen offset:2048 lds
    v_mul_f32 v229, v255, v205
    v_mul_f32 v230, v255, v206
    v_mul_f32 v231, v255, v207
    v_mfma_f32_32x32x16_bf16 v[64:79], a[188:191], a[0:3], 0
    ds_read_b64_tr_b16 a[172:173], v11 offset:32768
    ds_read_b64_tr_b16 a[174:175], v11 offset:33280
    s_add_u32 m0, s47, 125952
    s_add_u32 s54, s86, 248832
    v_exp_f32 v228, v228
    v_exp_f32 v229, v229
    v_exp_f32 v230, v230
    s_waitcnt lgkmcnt(8)
    v_mfma_f32_32x32x16_bf16 v[48:63], a[192:195], a[4:7], v[48:63]
    ds_read_b64_tr_b16 a[176:177], v8 offset:33792
    ds_read_b64_tr_b16 a[178:179], v8 offset:34304
    v_exp_f32 v231, v231
    v_add_f32 v228, 1.0, v228
    v_add_f32 v229, 1.0, v229
    v_mfma_f32_32x32x16_bf16 v[64:79], a[196:199], a[4:7], v[64:79]
    ds_read_b64_tr_b16 a[180:181], v11 offset:33792
    ds_read_b64_tr_b16 a[182:183], v11 offset:34304
    v_add_f32 v230, 1.0, v230
    v_add_f32 v231, 1.0, v231
    v_rcp_f32 v228, v228
    v_mfma_f32_32x32x16_bf16 v[48:63], a[200:203], a[8:11], v[48:63]
    ds_read_b64_tr_b16 a[184:185], v8 offset:34816
    ds_read_b64_tr_b16 a[186:187], v8 offset:35328
    buffer_load_dwordx4 v5, s[16:19], s54 offen offset:0 lds
    v_rcp_f32 v229, v229
    v_rcp_f32 v230, v230
    v_mfma_f32_32x32x16_bf16 v[64:79], a[204:207], a[8:11], v[64:79]
    ds_read_b64_tr_b16 a[188:189], v11 offset:34816
    ds_read_b64_tr_b16 a[190:191], v11 offset:35328
    v_rcp_f32 v231, v231
    v_mul_f32 v228, v204, v228
    v_mul_f32 v229, v205, v229
    v_mul_f32 v230, v206, v230
    s_waitcnt lgkmcnt(8)
    v_mfma_f32_32x32x16_bf16 v[48:63], a[160:163], a[12:15], v[48:63]
    ds_read_b64_tr_b16 a[192:193], v8 offset:35840
    ds_read_b64_tr_b16 a[194:195], v8 offset:36352
    v_mul_f32 v231, v207, v231
    v_cvt_pk_bf16_f32 v234, v228, v229
    v_cvt_pk_bf16_f32 v235, v230, v231
    v_mfma_f32_32x32x16_bf16 v[64:79], a[164:167], a[12:15], v[64:79]
    ds_read_b64_tr_b16 a[196:197], v11 offset:35840
    ds_read_b64_tr_b16 a[198:199], v11 offset:36352
    v_accvgpr_write_b32 a86, v234
    v_accvgpr_write_b32 a87, v235
    v_mul_f32 v224, v255, v208
    v_mul_f32 v225, v255, v209
    v_mfma_f32_32x32x16_bf16 v[48:63], a[168:171], a[16:19], v[48:63]
    ds_read_b64_tr_b16 a[200:201], v8 offset:40960
    ds_read_b64_tr_b16 a[202:203], v8 offset:41472
    buffer_load_dwordx4 v6, s[16:19], s54 offen offset:1024 lds
    v_mul_f32 v226, v255, v210
    v_mul_f32 v227, v255, v211
    v_exp_f32 v224, v224
    v_mfma_f32_32x32x16_bf16 v[64:79], a[172:175], a[16:19], v[64:79]
    ds_read_b64_tr_b16 a[204:205], v11 offset:40960
    ds_read_b64_tr_b16 a[206:207], v11 offset:41472
    v_exp_f32 v225, v225
    v_exp_f32 v226, v226
    s_waitcnt lgkmcnt(8)
    v_mfma_f32_32x32x16_bf16 v[48:63], a[176:179], a[20:23], v[48:63]
    ds_read_b64_tr_b16 a[160:161], v8 offset:41984
    ds_read_b64_tr_b16 a[162:163], v8 offset:42496
    v_exp_f32 v227, v227
    v_add_f32 v224, 1.0, v224
    v_add_f32 v225, 1.0, v225
    v_add_f32 v226, 1.0, v226
    v_mfma_f32_32x32x16_bf16 v[64:79], a[180:183], a[20:23], v[64:79]
    ds_read_b64_tr_b16 a[164:165], v11 offset:41984
    ds_read_b64_tr_b16 a[166:167], v11 offset:42496
    v_add_f32 v227, 1.0, v227
    v_rcp_f32 v224, v224
    v_rcp_f32 v225, v225
    v_mfma_f32_32x32x16_bf16 v[48:63], a[184:187], a[24:27], v[48:63]
    ds_read_b64_tr_b16 a[168:169], v8 offset:43008
    ds_read_b64_tr_b16 a[170:171], v8 offset:43520
    buffer_load_dwordx4 v7, s[16:19], s54 offen offset:2048 lds
    v_rcp_f32 v226, v226
    v_rcp_f32 v227, v227
    v_mfma_f32_32x32x16_bf16 v[64:79], a[188:191], a[24:27], v[64:79]
    ds_read_b64_tr_b16 a[172:173], v11 offset:43008
    ds_read_b64_tr_b16 a[174:175], v11 offset:43520
    v_mul_f32 v224, v208, v224
    v_mul_f32 v225, v209, v225
    v_mul_f32 v226, v210, v226
    v_mul_f32 v227, v211, v227
    s_waitcnt lgkmcnt(8)
    v_mfma_f32_32x32x16_bf16 v[48:63], a[192:195], a[28:31], v[48:63]
    ds_read_b64_tr_b16 a[176:177], v8 offset:44032
    ds_read_b64_tr_b16 a[178:179], v8 offset:44544
    v_cvt_pk_bf16_f32 v232, v224, v225
    v_cvt_pk_bf16_f32 v233, v226, v227
    v_accvgpr_write_b32 a88, v232
    v_accvgpr_write_b32 a89, v233
    v_mfma_f32_32x32x16_bf16 v[64:79], a[196:199], a[28:31], v[64:79]
    ds_read_b64_tr_b16 a[180:181], v11 offset:44032
    ds_read_b64_tr_b16 a[182:183], v11 offset:44544
    v_mul_f32 v228, v255, v212
    v_mul_f32 v229, v255, v213
    v_mul_f32 v230, v255, v214
    v_mul_f32 v231, v255, v215
    v_mfma_f32_32x32x16_bf16 v[48:63], a[200:203], a[32:35], v[48:63]
    s_waitcnt vmcnt(18)
    s_barrier
    ds_read_b64_tr_b16 a[184:185], v8 offset:49152
    ds_read_b64_tr_b16 a[186:187], v8 offset:49664
    s_add_u32 m0, s47, 0
    s_add_u32 s54, s87, 0
    v_exp_f32 v228, v228
    v_exp_f32 v229, v229
    v_mfma_f32_32x32x16_bf16 v[64:79], a[204:207], a[32:35], v[64:79]
    ds_read_b64_tr_b16 a[188:189], v11 offset:49152
    ds_read_b64_tr_b16 a[190:191], v11 offset:49664
    v_exp_f32 v230, v230
    v_exp_f32 v231, v231
    s_waitcnt lgkmcnt(8)
    v_mfma_f32_32x32x16_bf16 v[48:63], a[160:163], a[36:39], v[48:63]
    ds_read_b64_tr_b16 a[192:193], v8 offset:50176
    ds_read_b64_tr_b16 a[194:195], v8 offset:50688
    buffer_load_dwordx4 v5, s[16:19], s54 offen offset:0 lds
    v_add_f32 v228, 1.0, v228
    v_add_f32 v229, 1.0, v229
    v_add_f32 v230, 1.0, v230
    v_add_f32 v231, 1.0, v231
    v_mfma_f32_32x32x16_bf16 v[64:79], a[164:167], a[36:39], v[64:79]
    ds_read_b64_tr_b16 a[196:197], v11 offset:50176
    ds_read_b64_tr_b16 a[198:199], v11 offset:50688
    v_rcp_f32 v228, v228
    v_rcp_f32 v229, v229
    v_rcp_f32 v230, v230
    v_mfma_f32_32x32x16_bf16 v[48:63], a[168:171], a[40:43], v[48:63]
    ds_read_b64_tr_b16 a[200:201], v8 offset:51200
    ds_read_b64_tr_b16 a[202:203], v8 offset:51712
    v_rcp_f32 v231, v231
    v_mul_f32 v228, v212, v228
    v_mfma_f32_32x32x16_bf16 v[64:79], a[172:175], a[40:43], v[64:79]
    ds_read_b64_tr_b16 a[204:205], v11 offset:51200
    ds_read_b64_tr_b16 a[206:207], v11 offset:51712
    buffer_load_dwordx4 v6, s[16:19], s54 offen offset:1024 lds
    v_mul_f32 v229, v213, v229
    v_mul_f32 v230, v214, v230
    v_mul_f32 v231, v215, v231
    v_cvt_pk_bf16_f32 v234, v228, v229
    s_waitcnt lgkmcnt(8)
    v_mfma_f32_32x32x16_bf16 v[48:63], a[176:179], a[44:47], v[48:63]
    ds_read_b64_tr_b16 a[160:161], v8 offset:52224
    ds_read_b64_tr_b16 a[162:163], v8 offset:52736
    v_cvt_pk_bf16_f32 v235, v230, v231
    v_accvgpr_write_b32 a90, v234
    v_accvgpr_write_b32 a91, v235
    v_mul_f32 v224, v255, v216
    v_mfma_f32_32x32x16_bf16 v[64:79], a[180:183], a[44:47], v[64:79]
    ds_read_b64_tr_b16 a[164:165], v11 offset:52224
    ds_read_b64_tr_b16 a[166:167], v11 offset:52736
    v_mul_f32 v225, v255, v217
    v_mul_f32 v226, v255, v218
    v_mul_f32 v227, v255, v219
    v_exp_f32 v224, v224
    v_mfma_f32_32x32x16_bf16 v[16:31], a[184:187], a[48:51], v[16:31]
    ds_read_b64_tr_b16 a[168:169], v8 offset:57344
    ds_read_b64_tr_b16 a[170:171], v8 offset:57856
    buffer_load_dwordx4 v7, s[16:19], s54 offen offset:2048 lds
    v_exp_f32 v225, v225
    v_exp_f32 v226, v226
    v_mfma_f32_32x32x16_bf16 v[32:47], a[188:191], a[48:51], v[32:47]
    ds_read_b64_tr_b16 a[172:173], v11 offset:57344
    ds_read_b64_tr_b16 a[174:175], v11 offset:57856
    s_add_u32 m0, s47, 3072
    s_add_u32 s54, s87, 27648
    v_exp_f32 v227, v227
    v_add_f32 v224, 1.0, v224
    v_add_f32 v225, 1.0, v225
    s_waitcnt lgkmcnt(8)
    v_mfma_f32_32x32x16_bf16 v[16:31], a[192:195], a[52:55], v[16:31]
    ds_read_b64_tr_b16 a[176:177], v8 offset:58368
    ds_read_b64_tr_b16 a[178:179], v8 offset:58880
    v_add_f32 v226, 1.0, v226
    v_add_f32 v227, 1.0, v227
    v_rcp_f32 v224, v224
    v_mfma_f32_32x32x16_bf16 v[32:47], a[196:199], a[52:55], v[32:47]
    ds_read_b64_tr_b16 a[180:181], v11 offset:58368
    ds_read_b64_tr_b16 a[182:183], v11 offset:58880
    v_rcp_f32 v225, v225
    v_rcp_f32 v226, v226
    v_mfma_f32_32x32x16_bf16 v[16:31], a[200:203], a[56:59], v[16:31]
    ds_read_b64_tr_b16 a[184:185], v8 offset:59392
    ds_read_b64_tr_b16 a[186:187], v8 offset:59904
    buffer_load_dwordx4 v5, s[16:19], s54 offen offset:0 lds
    v_rcp_f32 v227, v227
    v_mul_f32 v224, v216, v224
    v_mul_f32 v225, v217, v225
    v_mul_f32 v226, v218, v226
    v_mfma_f32_32x32x16_bf16 v[32:47], a[204:207], a[56:59], v[32:47]
    ds_read_b64_tr_b16 a[188:189], v11 offset:59392
    ds_read_b64_tr_b16 a[190:191], v11 offset:59904
    v_mul_f32 v227, v219, v227
    v_cvt_pk_bf16_f32 v232, v224, v225
    v_cvt_pk_bf16_f32 v233, v226, v227
    v_accvgpr_write_b32 a92, v232
    s_waitcnt lgkmcnt(8)
    v_mfma_f32_32x32x16_bf16 v[16:31], a[160:163], a[60:63], v[16:31]
    ds_read_b64_tr_b16 a[192:193], v8 offset:60416
    ds_read_b64_tr_b16 a[194:195], v8 offset:60928
    v_accvgpr_write_b32 a93, v233
    v_mul_f32 v228, v255, v220
    v_mul_f32 v229, v255, v221
    v_mul_f32 v230, v255, v222
    v_mfma_f32_32x32x16_bf16 v[32:47], a[164:167], a[60:63], v[32:47]
    ds_read_b64_tr_b16 a[196:197], v11 offset:60416
    ds_read_b64_tr_b16 a[198:199], v11 offset:60928
    v_mul_f32 v231, v255, v223
    v_exp_f32 v228, v228
    v_exp_f32 v229, v229
    v_mfma_f32_32x32x16_bf16 v[16:31], a[168:171], a[64:67], v[16:31]
    ds_read_b64_tr_b16 a[200:201], v9 offset:0
    ds_read_b64_tr_b16 a[202:203], v9 offset:512
    buffer_load_dwordx4 v6, s[16:19], s54 offen offset:1024 lds
    v_exp_f32 v230, v230
    v_exp_f32 v231, v231
    v_mfma_f32_32x32x16_bf16 v[32:47], a[172:175], a[64:67], v[32:47]
    ds_read_b64_tr_b16 a[204:205], v12 offset:0
    ds_read_b64_tr_b16 a[206:207], v12 offset:512
    v_add_f32 v228, 1.0, v228
    v_add_f32 v229, 1.0, v229
    v_add_f32 v230, 1.0, v230
    v_add_f32 v231, 1.0, v231
    s_waitcnt lgkmcnt(8)
    v_mfma_f32_32x32x16_bf16 v[16:31], a[176:179], a[68:71], v[16:31]
    ds_read_b64_tr_b16 a[160:161], v9 offset:1024
    ds_read_b64_tr_b16 a[162:163], v9 offset:1536
    v_rcp_f32 v228, v228
    v_rcp_f32 v229, v229
    v_mfma_f32_32x32x16_bf16 v[32:47], a[180:183], a[68:71], v[32:47]
    ds_read_b64_tr_b16 a[164:165], v12 offset:1024
    ds_read_b64_tr_b16 a[166:167], v12 offset:1536
    v_rcp_f32 v230, v230
    v_rcp_f32 v231, v231
    v_mfma_f32_32x32x16_bf16 v[16:31], a[184:187], a[72:75], v[16:31]
    ds_read_b64_tr_b16 a[168:169], v9 offset:2048
    ds_read_b64_tr_b16 a[170:171], v9 offset:2560
    buffer_load_dwordx4 v7, s[16:19], s54 offen offset:2048 lds
    v_mul_f32 v228, v220, v228
    v_mul_f32 v229, v221, v229
    v_mul_f32 v230, v222, v230
    v_mul_f32 v231, v223, v231
    v_cvt_pk_bf16_f32 v234, v228, v229
    v_mfma_f32_32x32x16_bf16 v[32:47], a[188:191], a[72:75], v[32:47]
    ds_read_b64_tr_b16 a[172:173], v12 offset:2048
    ds_read_b64_tr_b16 a[174:175], v12 offset:2560
    v_cvt_pk_bf16_f32 v235, v230, v231
    v_accvgpr_write_b32 a94, v234
    v_accvgpr_write_b32 a95, v235
    s_waitcnt lgkmcnt(8)
    v_mfma_f32_32x32x16_bf16 v[16:31], a[192:195], a[76:79], v[16:31]
    ds_read_b64_tr_b16 a[176:177], v9 offset:3072
    ds_read_b64_tr_b16 a[178:179], v9 offset:3584
    v_mfma_f32_32x32x16_bf16 v[32:47], a[196:199], a[76:79], v[32:47]
    ds_read_b64_tr_b16 a[180:181], v12 offset:3072
    ds_read_b64_tr_b16 a[182:183], v12 offset:3584
    v_mfma_f32_32x32x16_bf16 v[16:31], a[200:203], a[80:83], v[16:31]
    s_waitcnt vmcnt(18)
    s_barrier
    ds_read_b64_tr_b16 a[184:185], v9 offset:8192
    ds_read_b64_tr_b16 a[186:187], v9 offset:8704
    s_add_u32 m0, s47, 24576
    s_add_u32 s54, s87, 221184
    v_mfma_f32_32x32x16_bf16 v[32:47], a[204:207], a[80:83], v[32:47]
    ds_read_b64_tr_b16 a[188:189], v12 offset:8192
    ds_read_b64_tr_b16 a[190:191], v12 offset:8704
    v_accvgpr_read_b32 v224, a144
    s_waitcnt lgkmcnt(8)
    v_mfma_f32_32x32x16_bf16 v[16:31], a[160:163], a[84:87], v[16:31]
    ds_read_b64_tr_b16 a[192:193], v9 offset:9216
    ds_read_b64_tr_b16 a[194:195], v9 offset:9728
    buffer_load_dwordx4 v5, s[16:19], s54 offen offset:0 lds
    v_mfma_f32_32x32x16_bf16 v[32:47], a[164:167], a[84:87], v[32:47]
    ds_read_b64_tr_b16 a[196:197], v12 offset:9216
    ds_read_b64_tr_b16 a[198:199], v12 offset:9728
    v_accvgpr_read_b32 v225, a145
    v_mfma_f32_32x32x16_bf16 v[16:31], a[168:171], a[88:91], v[16:31]
    ds_read_b64_tr_b16 a[200:201], v9 offset:10240
    ds_read_b64_tr_b16 a[202:203], v9 offset:10752
    v_mfma_f32_32x32x16_bf16 v[32:47], a[172:175], a[88:91], v[32:47]
    ds_read_b64_tr_b16 a[204:205], v12 offset:10240
    ds_read_b64_tr_b16 a[206:207], v12 offset:10752
    buffer_load_dwordx4 v6, s[16:19], s54 offen offset:1024 lds
    v_accvgpr_read_b32 v226, a146
    s_waitcnt lgkmcnt(8)
    v_mfma_f32_32x32x16_bf16 v[16:31], a[176:179], a[92:95], v[16:31]
    ds_read_b64_tr_b16 a[160:161], v9 offset:11264
    ds_read_b64_tr_b16 a[162:163], v9 offset:11776
    v_mfma_f32_32x32x16_bf16 v[32:47], a[180:183], a[92:95], v[32:47]
    ds_read_b64_tr_b16 a[164:165], v12 offset:11264
    ds_read_b64_tr_b16 a[166:167], v12 offset:11776
    v_accvgpr_read_b32 v227, a147
    v_mfma_f32_32x32x16_bf16 v[48:63], a[184:187], a[48:51], v[48:63]
    ds_read_b64_tr_b16 a[168:169], v9 offset:16384
    ds_read_b64_tr_b16 a[170:171], v9 offset:16896
    buffer_load_dwordx4 v7, s[16:19], s54 offen offset:2048 lds
    v_mfma_f32_32x32x16_bf16 v[64:79], a[188:191], a[48:51], v[64:79]
    ds_read_b64_tr_b16 a[172:173], v12 offset:16384
    ds_read_b64_tr_b16 a[174:175], v12 offset:16896
    s_add_u32 m0, s47, 27648
    s_add_u32 s54, s87, 248832
    s_mul_i32 s56, s84, 1536
    s_add_u32 s56, s56, s93
    v_cvt_pk_bf16_f32 v80, v16, v17
    v_accvgpr_read_b32 v228, a148
    s_waitcnt lgkmcnt(8)
    v_mfma_f32_32x32x16_bf16 v[48:63], a[192:195], a[52:55], v[48:63]
    ds_read_b64_tr_b16 a[176:177], v9 offset:17408
    ds_read_b64_tr_b16 a[178:179], v9 offset:17920
    ds_read_b64_tr_b16 a[180:181], v12 offset:17408
    v_cvt_pk_bf16_f32 v81, v18, v19
    v_cvt_pk_bf16_f32 v82, v20, v21
    v_mfma_f32_32x32x16_bf16 v[64:79], a[196:199], a[52:55], v[64:79]
    ds_read_b64_tr_b16 a[182:183], v12 offset:17920
    ds_read_b64_tr_b16 a[184:185], v9 offset:18432
    v_cvt_pk_bf16_f32 v83, v22, v23
    v_accvgpr_read_b32 v229, a132
    v_mfma_f32_32x32x16_bf16 v[48:63], a[200:203], a[56:59], v[48:63]
    ds_read_b64_tr_b16 a[186:187], v9 offset:18944
    buffer_store_dwordx4 v[80:83], v14, s[20:23], s56 offen offset:0 sc1
    v_mfma_f32_32x32x16_bf16 v[64:79], a[204:207], a[56:59], v[64:79]
    ds_read_b64_tr_b16 a[188:189], v12 offset:18432
    ds_read_b64_tr_b16 a[190:191], v12 offset:18944
    buffer_load_dwordx4 v5, s[16:19], s54 offen offset:0 lds
    s_waitcnt lgkmcnt(8)
    v_mfma_f32_32x32x16_bf16 v[48:63], a[160:163], a[60:63], v[48:63]
    ds_read_b64_tr_b16 a[192:193], v9 offset:19456
    ds_read_b64_tr_b16 a[194:195], v9 offset:19968
    v_cvt_pk_bf16_f32 v84, v24, v25
    v_cvt_pk_bf16_f32 v85, v26, v27
    v_accvgpr_read_b32 v230, a133
    v_mfma_f32_32x32x16_bf16 v[64:79], a[164:167], a[60:63], v[64:79]
    ds_read_b64_tr_b16 a[196:197], v12 offset:19456
    ds_read_b64_tr_b16 a[198:199], v12 offset:19968
    ds_read_b64_tr_b16 a[200:201], v9 offset:24576
    v_cvt_pk_bf16_f32 v86, v28, v29
    v_cvt_pk_bf16_f32 v87, v30, v31
    v_mfma_f32_32x32x16_bf16 v[48:63], a[168:171], a[64:67], v[48:63]
    ds_read_b64_tr_b16 a[202:203], v9 offset:25088
    ds_read_b64_tr_b16 a[204:205], v12 offset:24576
    v_accvgpr_read_b32 v231, a134
    v_mfma_f32_32x32x16_bf16 v[64:79], a[172:175], a[64:67], v[64:79]
    ds_read_b64_tr_b16 a[206:207], v12 offset:25088
    buffer_store_dwordx4 v[84:87], v14, s[20:23], s56 offen offset:1024 sc1
    s_waitcnt lgkmcnt(8)
    v_mfma_f32_32x32x16_bf16 v[48:63], a[176:179], a[68:71], v[48:63]
    ds_read_b64_tr_b16 a[160:161], v9 offset:25600
    ds_read_b64_tr_b16 a[162:163], v9 offset:26112
    buffer_load_dwordx4 v6, s[16:19], s54 offen offset:1024 lds
    v_accvgpr_read_b32 v232, a135
    v_mfma_f32_32x32x16_bf16 v[64:79], a[180:183], a[68:71], v[64:79]
    ds_read_b64_tr_b16 a[164:165], v12 offset:25600
    ds_read_b64_tr_b16 a[166:167], v12 offset:26112
    v_cvt_pk_bf16_f32 v88, v32, v33
    v_cvt_pk_bf16_f32 v89, v34, v35
    v_mfma_f32_32x32x16_bf16 v[48:63], a[184:187], a[72:75], v[48:63]
    ds_read_b64_tr_b16 a[168:169], v9 offset:26624
    ds_read_b64_tr_b16 a[170:171], v9 offset:27136
    ds_read_b64_tr_b16 a[172:173], v12 offset:26624
    v_cvt_pk_bf16_f32 v90, v36, v37
    v_cvt_pk_bf16_f32 v91, v38, v39
    v_accvgpr_read_b32 v233, a136
    v_mfma_f32_32x32x16_bf16 v[64:79], a[188:191], a[72:75], v[64:79]
    ds_read_b64_tr_b16 a[174:175], v12 offset:27136
    ds_read_b64_tr_b16 a[176:177], v9 offset:27648
    s_waitcnt lgkmcnt(9)
    v_mfma_f32_32x32x16_bf16 v[48:63], a[192:195], a[76:79], v[48:63]
    ds_read_b64_tr_b16 a[178:179], v9 offset:28160
    buffer_store_dwordx4 v[88:91], v14, s[20:23], s56 offen offset:2048 sc1
    v_accvgpr_read_b32 v234, a137
    v_mfma_f32_32x32x16_bf16 v[64:79], a[196:199], a[76:79], v[64:79]
    ds_read_b64_tr_b16 a[180:181], v12 offset:27648
    ds_read_b64_tr_b16 a[182:183], v12 offset:28160
    buffer_load_dwordx4 v7, s[16:19], s54 offen offset:2048 lds
    v_cvt_pk_bf16_f32 v92, v40, v41
    v_mfma_f32_32x32x16_bf16 v[48:63], a[200:203], a[80:83], v[48:63]
    s_waitcnt vmcnt(21)
    s_barrier
    ds_read_b64_tr_b16 a[184:185], v9 offset:32768
    ds_read_b64_tr_b16 a[186:187], v9 offset:33280
    ds_read_b64_tr_b16 a[188:189], v12 offset:32768
    v_cvt_pk_bf16_f32 v93, v42, v43
    v_cvt_pk_bf16_f32 v94, v44, v45
    v_accvgpr_read_b32 v235, a138
    v_mfma_f32_32x32x16_bf16 v[64:79], a[204:207], a[80:83], v[64:79]
    ds_read_b64_tr_b16 a[190:191], v12 offset:33280
    ds_read_b64_tr_b16 a[192:193], v9 offset:33792
    v_cvt_pk_bf16_f32 v95, v46, v47
    s_waitcnt lgkmcnt(9)
    v_mfma_f32_32x32x16_bf16 v[48:63], a[160:163], a[84:87], v[48:63]
    ds_read_b64_tr_b16 a[194:195], v9 offset:34304
    buffer_store_dwordx4 v[92:95], v14, s[20:23], s56 offen offset:3072 sc1
    v_accvgpr_read_b32 v236, a139
    v_mfma_f32_32x32x16_bf16 v[64:79], a[164:167], a[84:87], v[64:79]
    ds_read_b64_tr_b16 a[196:197], v12 offset:33792
    ds_read_b64_tr_b16 a[198:199], v12 offset:34304
    s_add_u32 m0, s47, 49152
    s_add_u32 s54, s88, 0
    v_mfma_f32_32x32x16_bf16 v[48:63], a[168:171], a[88:91], v[48:63]
    ds_read_b64_tr_b16 a[200:201], v9 offset:34816
    ds_read_b64_tr_b16 a[202:203], v9 offset:35328
    buffer_load_dwordx4 v5, s[16:19], s54 offen offset:0 lds
    v_mfma_f32_32x32x16_bf16 v[64:79], a[172:175], a[88:91], v[64:79]
    ds_read_b64_tr_b16 a[204:205], v12 offset:34816
    ds_read_b64_tr_b16 a[206:207], v12 offset:35328
    v_accvgpr_read_b32 v243, a140
    s_waitcnt lgkmcnt(8)
    v_mfma_f32_32x32x16_bf16 v[48:63], a[176:179], a[92:95], v[48:63]
    ds_read_b64_tr_b16 a[160:161], v9 offset:35840
    ds_read_b64_tr_b16 a[162:163], v9 offset:36352
    v_mfma_f32_32x32x16_bf16 v[64:79], a[180:183], a[92:95], v[64:79]
    ds_read_b64_tr_b16 a[164:165], v12 offset:35840
    ds_read_b64_tr_b16 a[166:167], v12 offset:36352
    buffer_load_dwordx4 v6, s[16:19], s54 offen offset:1024 lds
    v_accvgpr_read_b32 v245, a141
    v_mfma_f32_32x32x16_bf16 v[16:31], a[184:187], a[0:3], 0
    ds_read_b64_tr_b16 a[168:169], v9 offset:40960
    ds_read_b64_tr_b16 a[170:171], v9 offset:41472
    v_mfma_f32_32x32x16_bf16 v[32:47], a[188:191], a[0:3], 0
    ds_read_b64_tr_b16 a[172:173], v12 offset:40960
    ds_read_b64_tr_b16 a[174:175], v12 offset:41472
    s_mul_i32 s56, s85, 1536
    s_add_u32 s56, s56, s93
    v_add_u32 v243, s72, v243
    s_waitcnt lgkmcnt(8)
    v_mfma_f32_32x32x16_bf16 v[16:31], a[192:195], a[4:7], v[16:31]
    ds_read_b64_tr_b16 a[176:177], v9 offset:41984
    ds_read_b64_tr_b16 a[178:179], v9 offset:42496
    buffer_load_dwordx4 v7, s[16:19], s54 offen offset:2048 lds
    v_cvt_pk_bf16_f32 v96, v48, v49
    v_subrev_u32 v244, 9, v243
    v_mfma_f32_32x32x16_bf16 v[32:47], a[196:199], a[4:7], v[32:47]
    ds_read_b64_tr_b16 a[180:181], v12 offset:41984
    ds_read_b64_tr_b16 a[182:183], v12 offset:42496
    s_add_u32 m0, s47, 52224
    s_add_u32 s54, s88, 27648
    v_cvt_pk_bf16_f32 v97, v50, v51
    v_mfma_f32_32x32x16_bf16 v[16:31], a[200:203], a[8:11], v[16:31]
    ds_read_b64_tr_b16 a[184:185], v9 offset:43008
    ds_read_b64_tr_b16 a[186:187], v9 offset:43520
    v_cvt_pk_bf16_f32 v98, v52, v53
    v_min_u32 v243, v243, v244
    v_mfma_f32_32x32x16_bf16 v[32:47], a[204:207], a[8:11], v[32:47]
    ds_read_b64_tr_b16 a[188:189], v12 offset:43008
    ds_read_b64_tr_b16 a[190:191], v12 offset:43520
    buffer_load_dwordx4 v5, s[16:19], s54 offen offset:0 lds
    v_cvt_pk_bf16_f32 v99, v54, v55
    s_waitcnt lgkmcnt(8)
    v_mfma_f32_32x32x16_bf16 v[16:31], a[160:163], a[12:15], v[16:31]
    ds_read_b64_tr_b16 a[192:193], v9 offset:44032
    ds_read_b64_tr_b16 a[194:195], v9 offset:44544
    ds_read_b64_tr_b16 a[196:197], v12 offset:44032
    v_and_b32 v243, v243, v245
    v_mfma_f32_32x32x16_bf16 v[32:47], a[164:167], a[12:15], v[32:47]
    ds_read_b64_tr_b16 a[198:199], v12 offset:44544
    ds_read_b64_tr_b16 a[200:201], v9 offset:49152
    v_mfma_f32_32x32x16_bf16 v[16:31], a[168:171], a[16:19], v[16:31]
    ds_read_b64_tr_b16 a[202:203], v9 offset:49664
    buffer_store_dwordx4 v[96:99], v14, s[20:23], s56 offen offset:0 sc1
    v_add_u32 v237, 1, v243
    v_mfma_f32_32x32x16_bf16 v[32:47], a[172:175], a[16:19], v[32:47]
    ds_read_b64_tr_b16 a[204:205], v12 offset:49152
    ds_read_b64_tr_b16 a[206:207], v12 offset:49664
    buffer_load_dwordx4 v6, s[16:19], s54 offen offset:1024 lds
    v_cvt_pk_bf16_f32 v100, v56, v57
    s_mul_i32 s98, s40, 5120
    s_waitcnt lgkmcnt(8)
    v_mfma_f32_32x32x16_bf16 v[16:31], a[176:179], a[20:23], v[16:31]
    ds_read_b64_tr_b16 a[160:161], v9 offset:50176
    ds_read_b64_tr_b16 a[162:163], v9 offset:50688
    v_cvt_pk_bf16_f32 v101, v58, v59
    v_mfma_f32_32x32x16_bf16 v[32:47], a[180:183], a[20:23], v[32:47]
    ds_read_b64_tr_b16 a[164:165], v12 offset:50176
    ds_read_b64_tr_b16 a[166:167], v12 offset:50688
    v_cvt_pk_bf16_f32 v102, v60, v61
    s_min_u32 s48, s72, 8
    v_mfma_f32_32x32x16_bf16 v[16:31], a[184:187], a[24:27], v[16:31]
    ds_read_b64_tr_b16 a[168:169], v9 offset:51200
    ds_read_b64_tr_b16 a[170:171], v9 offset:51712
    v_cvt_pk_bf16_f32 v103, v62, v63
    v_mfma_f32_32x32x16_bf16 v[32:47], a[188:191], a[24:27], v[32:47]
    ds_read_b64_tr_b16 a[172:173], v12 offset:51200
    ds_read_b64_tr_b16 a[174:175], v12 offset:51712
    ds_read_b64_tr_b16 a[176:177], v9 offset:52224
    s_lshl_b32 s48, s48, 7
    s_waitcnt lgkmcnt(9)
    v_mfma_f32_32x32x16_bf16 v[16:31], a[192:195], a[28:31], v[16:31]
    ds_read_b64_tr_b16 a[178:179], v9 offset:52736
    ds_read_b64_tr_b16 a[180:181], v12 offset:52224
    v_mfma_f32_32x32x16_bf16 v[32:47], a[196:199], a[28:31], v[32:47]
    ds_read_b64_tr_b16 a[182:183], v12 offset:52736
    buffer_store_dwordx4 v[100:103], v14, s[20:23], s56 offen offset:1024 sc1
    s_add_u32 s74, s48, s44
    v_mfma_f32_32x32x16_bf16 v[16:31], a[200:203], a[32:35], v[16:31]
    s_waitcnt vmcnt(23)
    s_barrier
    ds_read_b64_tr_b16 a[184:185], v9 offset:57344
    ds_read_b64_tr_b16 a[186:187], v9 offset:57856
    buffer_load_dwordx4 v7, s[16:19], s54 offen offset:2048 lds
    v_cvt_pk_bf16_f32 v104, v64, v65
    s_add_u32 s73, s44, 28311552
    v_mfma_f32_32x32x16_bf16 v[32:47], a[204:207], a[32:35], v[32:47]
    ds_read_b64_tr_b16 a[188:189], v12 offset:57344
    ds_read_b64_tr_b16 a[190:191], v12 offset:57856
    s_add_u32 m0, s47, 73728
    s_add_u32 s54, s88, 221184
    v_cvt_pk_bf16_f32 v105, v66, v67
    s_waitcnt lgkmcnt(8)
    v_mfma_f32_32x32x16_bf16 v[16:31], a[160:163], a[36:39], v[16:31]
    ds_read_b64_tr_b16 a[192:193], v9 offset:58368
    ds_read_b64_tr_b16 a[194:195], v9 offset:58880
    v_cvt_pk_bf16_f32 v106, v68, v69
    v_and_b32 v246, 31, v1
    v_mfma_f32_32x32x16_bf16 v[32:47], a[164:167], a[36:39], v[32:47]
    ds_read_b64_tr_b16 a[196:197], v12 offset:58368
    ds_read_b64_tr_b16 a[198:199], v12 offset:58880
    buffer_load_dwordx4 v5, s[16:19], s54 offen offset:0 lds
    v_cvt_pk_bf16_f32 v107, v70, v71
    v_mfma_f32_32x32x16_bf16 v[16:31], a[168:171], a[40:43], v[16:31]
    ds_read_b64_tr_b16 a[200:201], v9 offset:59392
    ds_read_b64_tr_b16 a[202:203], v9 offset:59904
    ds_read_b64_tr_b16 a[204:205], v12 offset:59392
    v_lshlrev_b32 v246, 7, v246
    v_mfma_f32_32x32x16_bf16 v[32:47], a[172:175], a[40:43], v[32:47]
    ds_read_b64_tr_b16 a[206:207], v12 offset:59904
    ds_read_b64_tr_b16 a[160:161], v9 offset:60416
    s_mov_b32 s78, 0
    s_waitcnt lgkmcnt(9)
    v_mfma_f32_32x32x16_bf16 v[16:31], a[176:179], a[44:47], v[16:31]
    ds_read_b64_tr_b16 a[162:163], v9 offset:60928
    buffer_store_dwordx4 v[104:107], v14, s[20:23], s56 offen offset:2048 sc1
    v_mfma_f32_32x32x16_bf16 v[32:47], a[180:183], a[44:47], v[32:47]
    ds_read_b64_tr_b16 a[164:165], v12 offset:60416
    ds_read_b64_tr_b16 a[166:167], v12 offset:60928
    buffer_load_dwordx4 v6, s[16:19], s54 offen offset:1024 lds
    v_cvt_pk_bf16_f32 v108, v72, v73
    s_mov_b32 s79, 0
    v_mfma_f32_32x32x16_bf16 v[16:31], a[184:187], a[48:51], v[16:31]
    ds_read_b64_tr_b16 a[168:169], v10 offset:0
    ds_read_b64_tr_b16 a[170:171], v10 offset:512
    v_cvt_pk_bf16_f32 v109, v74, v75
    v_mfma_f32_32x32x16_bf16 v[32:47], a[188:191], a[48:51], v[32:47]
    ds_read_b64_tr_b16 a[172:173], v13 offset:0
    ds_read_b64_tr_b16 a[174:175], v13 offset:512
    v_cvt_pk_bf16_f32 v110, v76, v77
    s_mov_b32 s83, 0
    s_waitcnt lgkmcnt(8)
    v_mfma_f32_32x32x16_bf16 v[16:31], a[192:195], a[52:55], v[16:31]
    ds_read_b64_tr_b16 a[176:177], v10 offset:1024
    ds_read_b64_tr_b16 a[178:179], v10 offset:1536
    buffer_load_dwordx4 v7, s[16:19], s54 offen offset:2048 lds
    v_cvt_pk_bf16_f32 v111, v78, v79
    v_mfma_f32_32x32x16_bf16 v[32:47], a[196:199], a[52:55], v[32:47]
    ds_read_b64_tr_b16 a[180:181], v13 offset:1024
    ds_read_b64_tr_b16 a[182:183], v13 offset:1536
    ds_read_b64_tr_b16 a[184:185], v10 offset:2048
    s_mov_b32 s94, 0
    v_mfma_f32_32x32x16_bf16 v[16:31], a[200:203], a[56:59], v[16:31]
    ds_read_b64_tr_b16 a[186:187], v10 offset:2560
    ds_read_b64_tr_b16 a[188:189], v13 offset:2048
    s_mov_b32 s95, 0
    v_mfma_f32_32x32x16_bf16 v[32:47], a[204:207], a[56:59], v[32:47]
    ds_read_b64_tr_b16 a[190:191], v13 offset:2560
    buffer_store_dwordx4 v[108:111], v14, s[20:23], s56 offen offset:3072 sc1
    s_waitcnt lgkmcnt(8)
    v_mfma_f32_32x32x16_bf16 v[16:31], a[160:163], a[60:63], v[16:31]
    ds_read_b64_tr_b16 a[192:193], v10 offset:3072
    ds_read_b64_tr_b16 a[194:195], v10 offset:3584
    s_add_u32 m0, s47, 76800
    s_add_u32 s54, s88, 248832
    v_mfma_f32_32x32x16_bf16 v[32:47], a[164:167], a[60:63], v[32:47]
    ds_read_b64_tr_b16 a[196:197], v13 offset:3072
    ds_read_b64_tr_b16 a[198:199], v13 offset:3584
    buffer_load_dwordx4 v5, s[16:19], s54 offen offset:0 lds
    v_mfma_f32_32x32x16_bf16 v[16:31], a[168:171], a[64:67], v[16:31]
    ds_read_b64_tr_b16 a[200:201], v10 offset:8192
    ds_read_b64_tr_b16 a[202:203], v10 offset:8704
    v_mfma_f32_32x32x16_bf16 v[32:47], a[172:175], a[64:67], v[32:47]
    ds_read_b64_tr_b16 a[204:205], v13 offset:8192
    ds_read_b64_tr_b16 a[206:207], v13 offset:8704
    s_cmp_lt_u32 s72, 9
    s_cselect_b32 s57, s57, 1073741824
    s_cselect_b32 s50, -1, 0
    v_and_b32 v237, s50, v237
    s_waitcnt lgkmcnt(8)
    v_mfma_f32_32x32x16_bf16 v[16:31], a[176:179], a[68:71], v[16:31]
    ds_read_b64_tr_b16 a[160:161], v10 offset:9216
    ds_read_b64_tr_b16 a[162:163], v10 offset:9728
    buffer_load_dwordx4 v6, s[16:19], s54 offen offset:1024 lds
    v_mfma_f32_32x32x16_bf16 v[32:47], a[180:183], a[68:71], v[32:47]
    ds_read_b64_tr_b16 a[164:165], v13 offset:9216
    ds_read_b64_tr_b16 a[166:167], v13 offset:9728
    v_mfma_f32_32x32x16_bf16 v[16:31], a[184:187], a[72:75], v[16:31]
    ds_read_b64_tr_b16 a[168:169], v10 offset:10240
    ds_read_b64_tr_b16 a[170:171], v10 offset:10752
    v_mfma_f32_32x32x16_bf16 v[32:47], a[188:191], a[72:75], v[32:47]
    ds_read_b64_tr_b16 a[172:173], v13 offset:10240
    ds_read_b64_tr_b16 a[174:175], v13 offset:10752
    buffer_load_dwordx4 v7, s[16:19], s54 offen offset:2048 lds
    s_add_u32 s64, s72, 8
    s_waitcnt lgkmcnt(8)
    v_mfma_f32_32x32x16_bf16 v[16:31], a[192:195], a[76:79], v[16:31]
    ds_read_b64_tr_b16 a[176:177], v10 offset:11264
    ds_read_b64_tr_b16 a[178:179], v10 offset:11776
    v_mfma_f32_32x32x16_bf16 v[32:47], a[196:199], a[76:79], v[32:47]
    ds_read_b64_tr_b16 a[180:181], v13 offset:11264
    ds_read_b64_tr_b16 a[182:183], v13 offset:11776
    v_mfma_f32_32x32x16_bf16 v[16:31], a[200:203], a[80:83], v[16:31]
    s_waitcnt vmcnt(26)
    s_barrier
    ds_read_b64_tr_b16 a[184:185], v8 offset:0
    ds_read_b64_tr_b16 a[186:187], v8 offset:512
    s_add_u32 m0, s47, 98304
    s_add_u32 s54, s89, 0
    s_cmp_ge_u32 s64, 9
    s_cselect_b32 s50, 9, 0
    s_sub_u32 s64, s64, s50
    v_mfma_f32_32x32x16_bf16 v[32:47], a[204:207], a[80:83], v[32:47]
    ds_read_b64_tr_b16 a[188:189], v11 offset:0
    ds_read_b64_tr_b16 a[190:191], v11 offset:512
    s_waitcnt lgkmcnt(8)
    v_mfma_f32_32x32x16_bf16 v[16:31], a[160:163], a[84:87], v[16:31]
    ds_read_b64_tr_b16 a[192:193], v8 offset:1024
    ds_read_b64_tr_b16 a[194:195], v8 offset:1536
    buffer_load_dwordx4 v5, s[16:19], s54 offen offset:0 lds
    v_mfma_f32_32x32x16_bf16 v[32:47], a[164:167], a[84:87], v[32:47]
    ds_read_b64_tr_b16 a[196:197], v11 offset:1024
    ds_read_b64_tr_b16 a[198:199], v11 offset:1536
    v_mfma_f32_32x32x16_bf16 v[16:31], a[168:171], a[88:91], v[16:31]
    ds_read_b64_tr_b16 a[200:201], v8 offset:2048
    ds_read_b64_tr_b16 a[202:203], v8 offset:2560
    s_bitset1_b32 s83, s64
    v_mfma_f32_32x32x16_bf16 v[32:47], a[172:175], a[88:91], v[32:47]
    ds_read_b64_tr_b16 a[204:205], v11 offset:2048
    ds_read_b64_tr_b16 a[206:207], v11 offset:2560
    buffer_load_dwordx4 v6, s[16:19], s54 offen offset:1024 lds
    s_waitcnt lgkmcnt(8)
    v_mfma_f32_32x32x16_bf16 v[16:31], a[176:179], a[92:95], v[16:31]
    ds_read_b64_tr_b16 a[160:161], v8 offset:3072
    ds_read_b64_tr_b16 a[162:163], v8 offset:3584
    s_lshl_b32 s64, s64, 14
    v_mfma_f32_32x32x16_bf16 v[32:47], a[180:183], a[92:95], v[32:47]
    ds_read_b64_tr_b16 a[164:165], v11 offset:3072
    ds_read_b64_tr_b16 a[166:167], v11 offset:3584
    s_add_u32 s64, s64, s57
    v_mfma_f32_32x32x16_bf16 v[48:63], a[184:187], a[0:3], 0
    ds_read_b64_tr_b16 a[168:169], v8 offset:8192
    ds_read_b64_tr_b16 a[170:171], v8 offset:8704
    buffer_load_dwordx4 v7, s[16:19], s54 offen offset:2048 lds
    v_mfma_f32_32x32x16_bf16 v[64:79], a[188:191], a[0:3], 0
    ds_read_b64_tr_b16 a[172:173], v11 offset:8192
    ds_read_b64_tr_b16 a[174:175], v11 offset:8704
    s_add_u32 m0, s47, 101376
    s_add_u32 s54, s89, 27648
    s_mul_i32 s56, s86, 1536
    s_add_u32 s56, s56, s93
    s_add_u32 s65, s72, 7
    s_waitcnt lgkmcnt(8)
    v_mfma_f32_32x32x16_bf16 v[48:63], a[192:195], a[4:7], v[48:63]
    ds_read_b64_tr_b16 a[176:177], v8 offset:9216
    ds_read_b64_tr_b16 a[178:179], v8 offset:9728
    v_cvt_pk_bf16_f32 v80, v16, v17
    v_mfma_f32_32x32x16_bf16 v[64:79], a[196:199], a[4:7], v[64:79]
    ds_read_b64_tr_b16 a[180:181], v11 offset:9216
    ds_read_b64_tr_b16 a[182:183], v11 offset:9728
    v_cvt_pk_bf16_f32 v81, v18, v19
    v_mfma_f32_32x32x16_bf16 v[48:63], a[200:203], a[8:11], v[48:63]
    ds_read_b64_tr_b16 a[184:185], v8 offset:10240
    ds_read_b64_tr_b16 a[186:187], v8 offset:10752
    buffer_load_dwordx4 v5, s[16:19], s54 offen offset:0 lds
    v_cvt_pk_bf16_f32 v82, v20, v21
    v_mfma_f32_32x32x16_bf16 v[64:79], a[204:207], a[8:11], v[64:79]
    ds_read_b64_tr_b16 a[188:189], v11 offset:10240
    ds_read_b64_tr_b16 a[190:191], v11 offset:10752
    v_cvt_pk_bf16_f32 v83, v22, v23
    s_cmp_ge_u32 s65, 9
    s_cselect_b32 s50, 9, 0
    s_sub_u32 s65, s65, s50
    s_waitcnt lgkmcnt(8)
    v_mfma_f32_32x32x16_bf16 v[48:63], a[160:163], a[12:15], v[48:63]
    ds_read_b64_tr_b16 a[192:193], v8 offset:11264
    ds_read_b64_tr_b16 a[194:195], v8 offset:11776
    ds_read_b64_tr_b16 a[196:197], v11 offset:11264
    v_mfma_f32_32x32x16_bf16 v[64:79], a[164:167], a[12:15], v[64:79]
    ds_read_b64_tr_b16 a[198:199], v11 offset:11776
    ds_read_b64_tr_b16 a[200:201], v8 offset:16384
    v_mfma_f32_32x32x16_bf16 v[48:63], a[168:171], a[16:19], v[48:63]
    ds_read_b64_tr_b16 a[202:203], v8 offset:16896
    buffer_store_dwordx4 v[80:83], v14, s[20:23], s56 offen offset:0 sc1
    s_bitset1_b32 s83, s65
    v_mfma_f32_32x32x16_bf16 v[64:79], a[172:175], a[16:19], v[64:79]
    ds_read_b64_tr_b16 a[204:205], v11 offset:16384
    ds_read_b64_tr_b16 a[206:207], v11 offset:16896
    buffer_load_dwordx4 v6, s[16:19], s54 offen offset:1024 lds
    v_cvt_pk_bf16_f32 v84, v24, v25
    s_waitcnt lgkmcnt(8)
    v_mfma_f32_32x32x16_bf16 v[48:63], a[176:179], a[20:23], v[48:63]
    ds_read_b64_tr_b16 a[160:161], v8 offset:17408
    ds_read_b64_tr_b16 a[162:163], v8 offset:17920
    v_cvt_pk_bf16_f32 v85, v26, v27
    s_lshl_b32 s65, s65, 14
    v_mfma_f32_32x32x16_bf16 v[64:79], a[180:183], a[20:23], v[64:79]
    ds_read_b64_tr_b16 a[164:165], v11 offset:17408
    ds_read_b64_tr_b16 a[166:167], v11 offset:17920
    v_cvt_pk_bf16_f32 v86, v28, v29
    s_add_u32 s65, s65, s57
    v_mfma_f32_32x32x16_bf16 v[48:63], a[184:187], a[24:27], v[48:63]
    ds_read_b64_tr_b16 a[168:169], v8 offset:18432
    ds_read_b64_tr_b16 a[170:171], v8 offset:18944
    v_cvt_pk_bf16_f32 v87, v30, v31
    v_mfma_f32_32x32x16_bf16 v[64:79], a[188:191], a[24:27], v[64:79]
    ds_read_b64_tr_b16 a[172:173], v11 offset:18432
    ds_read_b64_tr_b16 a[174:175], v11 offset:18944
    ds_read_b64_tr_b16 a[176:177], v8 offset:19456
    s_add_u32 s66, s72, 6
    s_waitcnt lgkmcnt(9)
    v_mfma_f32_32x32x16_bf16 v[48:63], a[192:195], a[28:31], v[48:63]
    ds_read_b64_tr_b16 a[178:179], v8 offset:19968
    ds_read_b64_tr_b16 a[180:181], v11 offset:19456
    v_mfma_f32_32x32x16_bf16 v[64:79], a[196:199], a[28:31], v[64:79]
    ds_read_b64_tr_b16 a[182:183], v11 offset:19968
    buffer_store_dwordx4 v[84:87], v14, s[20:23], s56 offen offset:1024 sc1
    v_mfma_f32_32x32x16_bf16 v[48:63], a[200:203], a[32:35], v[48:63]
    s_waitcnt vmcnt(24)
    s_barrier
    ds_read_b64_tr_b16 a[184:185], v8 offset:24576
    ds_read_b64_tr_b16 a[186:187], v8 offset:25088
    buffer_load_dwordx4 v7, s[16:19], s54 offen offset:2048 lds
    v_cvt_pk_bf16_f32 v88, v32, v33
    v_mfma_f32_32x32x16_bf16 v[64:79], a[204:207], a[32:35], v[64:79]
    ds_read_b64_tr_b16 a[188:189], v11 offset:24576
    ds_read_b64_tr_b16 a[190:191], v11 offset:25088
    s_add_u32 m0, s47, 122880
    s_add_u32 s54, s89, 221184
    v_cvt_pk_bf16_f32 v89, v34, v35
    s_cmp_ge_u32 s66, 9
    s_cselect_b32 s50, 9, 0
    s_sub_u32 s66, s66, s50
    s_waitcnt lgkmcnt(8)
    v_mfma_f32_32x32x16_bf16 v[48:63], a[160:163], a[36:39], v[48:63]
    ds_read_b64_tr_b16 a[192:193], v8 offset:25600
    ds_read_b64_tr_b16 a[194:195], v8 offset:26112
    v_cvt_pk_bf16_f32 v90, v36, v37
    v_mfma_f32_32x32x16_bf16 v[64:79], a[164:167], a[36:39], v[64:79]
    ds_read_b64_tr_b16 a[196:197], v11 offset:25600
    ds_read_b64_tr_b16 a[198:199], v11 offset:26112
    buffer_load_dwordx4 v5, s[16:19], s54 offen offset:0 lds
    v_cvt_pk_bf16_f32 v91, v38, v39
    v_mfma_f32_32x32x16_bf16 v[48:63], a[168:171], a[40:43], v[48:63]
    ds_read_b64_tr_b16 a[200:201], v8 offset:26624
    ds_read_b64_tr_b16 a[202:203], v8 offset:27136
    ds_read_b64_tr_b16 a[204:205], v11 offset:26624
    s_bitset1_b32 s83, s66
    v_mfma_f32_32x32x16_bf16 v[64:79], a[172:175], a[40:43], v[64:79]
    ds_read_b64_tr_b16 a[206:207], v11 offset:27136
    ds_read_b64_tr_b16 a[160:161], v8 offset:27648
    s_waitcnt lgkmcnt(9)
    v_mfma_f32_32x32x16_bf16 v[48:63], a[176:179], a[44:47], v[48:63]
    ds_read_b64_tr_b16 a[162:163], v8 offset:28160
    buffer_store_dwordx4 v[88:91], v14, s[20:23], s56 offen offset:2048 sc1
    s_lshl_b32 s66, s66, 14
    v_mfma_f32_32x32x16_bf16 v[64:79], a[180:183], a[44:47], v[64:79]
    ds_read_b64_tr_b16 a[164:165], v11 offset:27648
    ds_read_b64_tr_b16 a[166:167], v11 offset:28160
    buffer_load_dwordx4 v6, s[16:19], s54 offen offset:1024 lds
    v_cvt_pk_bf16_f32 v92, v40, v41
    v_mfma_f32_32x32x16_bf16 v[48:63], a[184:187], a[48:51], v[48:63]
    ds_read_b64_tr_b16 a[168:169], v8 offset:32768
    ds_read_b64_tr_b16 a[170:171], v8 offset:33280
    v_cvt_pk_bf16_f32 v93, v42, v43
    s_add_u32 s66, s66, s57
    v_mfma_f32_32x32x16_bf16 v[64:79], a[188:191], a[48:51], v[64:79]
    ds_read_b64_tr_b16 a[172:173], v11 offset:32768
    ds_read_b64_tr_b16 a[174:175], v11 offset:33280
    v_cvt_pk_bf16_f32 v94, v44, v45
    s_mul_i32 s67, s72, 86
    s_waitcnt lgkmcnt(8)
    v_mfma_f32_32x32x16_bf16 v[48:63], a[192:195], a[52:55], v[48:63]
    ds_read_b64_tr_b16 a[176:177], v8 offset:33792
    ds_read_b64_tr_b16 a[178:179], v8 offset:34304
    buffer_load_dwordx4 v7, s[16:19], s54 offen offset:2048 lds
    v_cvt_pk_bf16_f32 v95, v46, v47
    v_mfma_f32_32x32x16_bf16 v[64:79], a[196:199], a[52:55], v[64:79]
    ds_read_b64_tr_b16 a[180:181], v11 offset:33792
    ds_read_b64_tr_b16 a[182:183], v11 offset:34304
    ds_read_b64_tr_b16 a[184:185], v8 offset:34816
    s_lshr_b32 s67, s67, 8
    v_mfma_f32_32x32x16_bf16 v[48:63], a[200:203], a[56:59], v[48:63]
    ds_read_b64_tr_b16 a[186:187], v8 offset:35328
    ds_read_b64_tr_b16 a[188:189], v11 offset:34816
    v_mfma_f32_32x32x16_bf16 v[64:79], a[204:207], a[56:59], v[64:79]
    ds_read_b64_tr_b16 a[190:191], v11 offset:35328
    buffer_store_dwordx4 v[92:95], v14, s[20:23], s56 offen offset:3072 sc1
    s_add_u32 s67, s67, 3
    s_waitcnt lgkmcnt(8)
    v_mfma_f32_32x32x16_bf16 v[48:63], a[160:163], a[60:63], v[48:63]
    ds_read_b64_tr_b16 a[192:193], v8 offset:35840
    ds_read_b64_tr_b16 a[194:195], v8 offset:36352
    s_add_u32 m0, s47, 125952
    s_add_u32 s54, s89, 248832
    v_mfma_f32_32x32x16_bf16 v[64:79], a[164:167], a[60:63], v[64:79]
    ds_read_b64_tr_b16 a[196:197], v11 offset:35840
    ds_read_b64_tr_b16 a[198:199], v11 offset:36352
    buffer_load_dwordx4 v5, s[16:19], s54 offen offset:0 lds
    v_mfma_f32_32x32x16_bf16 v[48:63], a[168:171], a[64:67], v[48:63]
    ds_read_b64_tr_b16 a[200:201], v8 offset:40960
    ds_read_b64_tr_b16 a[202:203], v8 offset:41472
    s_cmp_ge_u32 s67, 3
    s_cselect_b32 s50, -6, -9
    s_sub_u32 s67, s67, s50
    v_mfma_f32_32x32x16_bf16 v[64:79], a[172:175], a[64:67], v[64:79]
    ds_read_b64_tr_b16 a[204:205], v11 offset:40960
    ds_read_b64_tr_b16 a[206:207], v11 offset:41472
    s_waitcnt lgkmcnt(8)
    v_mfma_f32_32x32x16_bf16 v[48:63], a[176:179], a[68:71], v[48:63]
    ds_read_b64_tr_b16 a[160:161], v8 offset:41984
    ds_read_b64_tr_b16 a[162:163], v8 offset:42496
    buffer_load_dwordx4 v6, s[16:19], s54 offen offset:1024 lds
    v_mfma_f32_32x32x16_bf16 v[64:79], a[180:183], a[68:71], v[64:79]
    ds_read_b64_tr_b16 a[164:165], v11 offset:41984
    ds_read_b64_tr_b16 a[166:167], v11 offset:42496
    v_mfma_f32_32x32x16_bf16 v[48:63], a[184:187], a[72:75], v[48:63]
    ds_read_b64_tr_b16 a[168:169], v8 offset:43008
    ds_read_b64_tr_b16 a[170:171], v8 offset:43520
    s_bitset1_b32 s83, s67
    v_mfma_f32_32x32x16_bf16 v[64:79], a[188:191], a[72:75], v[64:79]
    ds_read_b64_tr_b16 a[172:173], v11 offset:43008
    ds_read_b64_tr_b16 a[174:175], v11 offset:43520
    buffer_load_dwordx4 v7, s[16:19], s54 offen offset:2048 lds
    s_lshl_b32 s67, s67, 14
    s_waitcnt lgkmcnt(8)
    v_mfma_f32_32x32x16_bf16 v[48:63], a[192:195], a[76:79], v[48:63]
    ds_read_b64_tr_b16 a[176:177], v8 offset:44032
    ds_read_b64_tr_b16 a[178:179], v8 offset:44544
    v_mfma_f32_32x32x16_bf16 v[64:79], a[196:199], a[76:79], v[64:79]
    ds_read_b64_tr_b16 a[180:181], v11 offset:44032
    ds_read_b64_tr_b16 a[182:183], v11 offset:44544
    s_add_u32 s67, s67, s57
    v_mfma_f32_32x32x16_bf16 v[48:63], a[200:203], a[80:83], v[48:63]
    s_waitcnt vmcnt(24)
    s_barrier
    ds_read_b64_tr_b16 a[184:185], v8 offset:49152
    ds_read_b64_tr_b16 a[186:187], v8 offset:49664
    s_add_u32 m0, s47, 0
    s_add_u32 s54, s90, 0
    v_mfma_f32_32x32x16_bf16 v[64:79], a[204:207], a[80:83], v[64:79]
    ds_read_b64_tr_b16 a[188:189], v11 offset:49152
    ds_read_b64_tr_b16 a[190:191], v11 offset:49664
    s_add_u32 s68, s72, 5
    s_waitcnt lgkmcnt(8)
    v_mfma_f32_32x32x16_bf16 v[48:63], a[160:163], a[84:87], v[48:63]
    ds_read_b64_tr_b16 a[192:193], v8 offset:50176
    ds_read_b64_tr_b16 a[194:195], v8 offset:50688
    buffer_load_dwordx4 v5, s[16:19], s54 offen offset:0 lds
    v_mfma_f32_32x32x16_bf16 v[64:79], a[164:167], a[84:87], v[64:79]
    ds_read_b64_tr_b16 a[196:197], v11 offset:50176
    ds_read_b64_tr_b16 a[198:199], v11 offset:50688
    v_mfma_f32_32x32x16_bf16 v[48:63], a[168:171], a[88:91], v[48:63]
    ds_read_b64_tr_b16 a[200:201], v8 offset:51200
    ds_read_b64_tr_b16 a[202:203], v8 offset:51712
    s_cmp_ge_u32 s68, 9
    s_cselect_b32 s50, 9, 0
    s_sub_u32 s68, s68, s50
    v_mfma_f32_32x32x16_bf16 v[64:79], a[172:175], a[88:91], v[64:79]
    ds_read_b64_tr_b16 a[204:205], v11 offset:51200
    ds_read_b64_tr_b16 a[206:207], v11 offset:51712
    buffer_load_dwordx4 v6, s[16:19], s54 offen offset:1024 lds
    s_waitcnt lgkmcnt(8)
    v_mfma_f32_32x32x16_bf16 v[48:63], a[176:179], a[92:95], v[48:63]
    ds_read_b64_tr_b16 a[160:161], v8 offset:52224
    ds_read_b64_tr_b16 a[162:163], v8 offset:52736
    v_mfma_f32_32x32x16_bf16 v[64:79], a[180:183], a[92:95], v[64:79]
    ds_read_b64_tr_b16 a[164:165], v11 offset:52224
    ds_read_b64_tr_b16 a[166:167], v11 offset:52736
    v_mfma_f32_32x32x16_bf16 v[16:31], a[184:187], a[0:3], 0
    ds_read_b64_tr_b16 a[168:169], v8 offset:57344
    ds_read_b64_tr_b16 a[170:171], v8 offset:57856
    buffer_load_dwordx4 v7, s[16:19], s54 offen offset:2048 lds
    s_bitset1_b32 s78, s68
    v_mfma_f32_32x32x16_bf16 v[32:47], a[188:191], a[0:3], 0
    ds_read_b64_tr_b16 a[172:173], v11 offset:57344
    ds_read_b64_tr_b16 a[174:175], v11 offset:57856
    s_add_u32 m0, s47, 3072
    s_add_u32 s54, s90, 27648
    s_mul_i32 s56, s87, 1536
    s_add_u32 s56, s56, s93
    s_lshl_b32 s68, s68, 14
    s_waitcnt lgkmcnt(8)
    v_mfma_f32_32x32x16_bf16 v[16:31], a[192:195], a[4:7], v[16:31]
    ds_read_b64_tr_b16 a[176:177], v8 offset:58368
    ds_read_b64_tr_b16 a[178:179], v8 offset:58880
    v_cvt_pk_bf16_f32 v96, v48, v49
    v_mfma_f32_32x32x16_bf16 v[32:47], a[196:199], a[4:7], v[32:47]
    ds_read_b64_tr_b16 a[180:181], v11 offset:58368
    ds_read_b64_tr_b16 a[182:183], v11 offset:58880
    v_cvt_pk_bf16_f32 v97, v50, v51
    s_add_u32 s68, s68, s57
    v_mfma_f32_32x32x16_bf16 v[16:31], a[200:203], a[8:11], v[16:31]
    ds_read_b64_tr_b16 a[184:185], v8 offset:59392
    ds_read_b64_tr_b16 a[186:187], v8 offset:59904
    buffer_load_dwordx4 v5, s[16:19], s54 offen offset:0 lds
    v_cvt_pk_bf16_f32 v98, v52, v53
    v_mfma_f32_32x32x16_bf16 v[32:47], a[204:207], a[8:11], v[32:47]
    ds_read_b64_tr_b16 a[188:189], v11 offset:59392
    ds_read_b64_tr_b16 a[190:191], v11 offset:59904
    v_cvt_pk_bf16_f32 v99, v54, v55
    s_add_u32 s69, s72, 4
    s_waitcnt lgkmcnt(8)
    v_mfma_f32_32x32x16_bf16 v[16:31], a[160:163], a[12:15], v[16:31]
    ds_read_b64_tr_b16 a[192:193], v8 offset:60416
    ds_read_b64_tr_b16 a[194:195], v8 offset:60928
    ds_read_b64_tr_b16 a[196:197], v11 offset:60416
    s_waitcnt vmcnt(7)
    v_mov_b32 v240, 3
    buffer_store_dword v240, v241, s[20:23], s62 offen sc1
    v_mfma_f32_32x32x16_bf16 v[32:47], a[164:167], a[12:15], v[32:47]
    ds_read_b64_tr_b16 a[198:199], v11 offset:60928
    ds_read_b64_tr_b16 a[200:201], v9 offset:0
    v_mfma_f32_32x32x16_bf16 v[16:31], a[168:171], a[16:19], v[16:31]
    ds_read_b64_tr_b16 a[202:203], v9 offset:512
    buffer_store_dwordx4 v[96:99], v14, s[20:23], s56 offen offset:0 sc1
    s_cmp_ge_u32 s69, 9
    s_cselect_b32 s50, 9, 0
    s_sub_u32 s69, s69, s50
    v_mfma_f32_32x32x16_bf16 v[32:47], a[172:175], a[16:19], v[32:47]
    ds_read_b64_tr_b16 a[204:205], v12 offset:0
    ds_read_b64_tr_b16 a[206:207], v12 offset:512
    buffer_load_dwordx4 v6, s[16:19], s54 offen offset:1024 lds
    v_cvt_pk_bf16_f32 v100, v56, v57
    s_waitcnt lgkmcnt(8)
    v_mfma_f32_32x32x16_bf16 v[16:31], a[176:179], a[20:23], v[16:31]
    ds_read_b64_tr_b16 a[160:161], v9 offset:1024
    ds_read_b64_tr_b16 a[162:163], v9 offset:1536
    v_cvt_pk_bf16_f32 v101, v58, v59
    v_mfma_f32_32x32x16_bf16 v[32:47], a[180:183], a[20:23], v[32:47]
    ds_read_b64_tr_b16 a[164:165], v12 offset:1024
    ds_read_b64_tr_b16 a[166:167], v12 offset:1536
    v_cvt_pk_bf16_f32 v102, v60, v61
    v_mfma_f32_32x32x16_bf16 v[16:31], a[184:187], a[24:27], v[16:31]
    ds_read_b64_tr_b16 a[168:169], v9 offset:2048
    ds_read_b64_tr_b16 a[170:171], v9 offset:2560
    v_cvt_pk_bf16_f32 v103, v62, v63
    s_bitset1_b32 s78, s69
    v_mfma_f32_32x32x16_bf16 v[32:47], a[188:191], a[24:27], v[32:47]
    ds_read_b64_tr_b16 a[172:173], v12 offset:2048
    ds_read_b64_tr_b16 a[174:175], v12 offset:2560
    ds_read_b64_tr_b16 a[176:177], v9 offset:3072
    s_waitcnt lgkmcnt(9)
    v_mfma_f32_32x32x16_bf16 v[16:31], a[192:195], a[28:31], v[16:31]
    ds_read_b64_tr_b16 a[178:179], v9 offset:3584
    ds_read_b64_tr_b16 a[180:181], v12 offset:3072
    s_lshl_b32 s69, s69, 14
    v_mfma_f32_32x32x16_bf16 v[32:47], a[196:199], a[28:31], v[32:47]
    ds_read_b64_tr_b16 a[182:183], v12 offset:3584
    buffer_store_dwordx4 v[100:103], v14, s[20:23], s56 offen offset:1024 sc1
    s_add_u32 s69, s69, s57
    v_mfma_f32_32x32x16_bf16 v[16:31], a[200:203], a[32:35], v[16:31]
    s_barrier
    ds_read_b64_tr_b16 a[184:185], v9 offset:8192
    ds_read_b64_tr_b16 a[186:187], v9 offset:8704
    buffer_load_dwordx4 v7, s[16:19], s54 offen offset:2048 lds
    v_cvt_pk_bf16_f32 v104, v64, v65
    v_mfma_f32_32x32x16_bf16 v[32:47], a[204:207], a[32:35], v[32:47]
    ds_read_b64_tr_b16 a[188:189], v12 offset:8192
    ds_read_b64_tr_b16 a[190:191], v12 offset:8704
    s_add_u32 m0, s47, 24576
    s_add_u32 s54, s90, 221184
    v_cvt_pk_bf16_f32 v105, v66, v67
    s_add_u32 s70, s72, 3
    s_waitcnt lgkmcnt(8)
    v_mfma_f32_32x32x16_bf16 v[16:31], a[160:163], a[36:39], v[16:31]
    ds_read_b64_tr_b16 a[192:193], v9 offset:9216
    ds_read_b64_tr_b16 a[194:195], v9 offset:9728
    v_cvt_pk_bf16_f32 v106, v68, v69
    v_mfma_f32_32x32x16_bf16 v[32:47], a[164:167], a[36:39], v[32:47]
    ds_read_b64_tr_b16 a[196:197], v12 offset:9216
    ds_read_b64_tr_b16 a[198:199], v12 offset:9728
    buffer_load_dwordx4 v5, s[16:19], s54 offen offset:0 lds
    v_cvt_pk_bf16_f32 v107, v70, v71
    v_mfma_f32_32x32x16_bf16 v[16:31], a[168:171], a[40:43], v[16:31]
    ds_read_b64_tr_b16 a[200:201], v9 offset:10240
    ds_read_b64_tr_b16 a[202:203], v9 offset:10752
    ds_read_b64_tr_b16 a[204:205], v12 offset:10240
    s_cmp_ge_u32 s70, 9
    s_cselect_b32 s50, 9, 0
    s_sub_u32 s70, s70, s50
    v_mfma_f32_32x32x16_bf16 v[32:47], a[172:175], a[40:43], v[32:47]
    ds_read_b64_tr_b16 a[206:207], v12 offset:10752
    ds_read_b64_tr_b16 a[160:161], v9 offset:11264
    s_waitcnt lgkmcnt(9)
    v_mfma_f32_32x32x16_bf16 v[16:31], a[176:179], a[44:47], v[16:31]
    ds_read_b64_tr_b16 a[162:163], v9 offset:11776
    buffer_store_dwordx4 v[104:107], v14, s[20:23], s56 offen offset:2048 sc1
    v_mfma_f32_32x32x16_bf16 v[32:47], a[180:183], a[44:47], v[32:47]
    ds_read_b64_tr_b16 a[164:165], v12 offset:11264
    ds_read_b64_tr_b16 a[166:167], v12 offset:11776
    buffer_load_dwordx4 v6, s[16:19], s54 offen offset:1024 lds
    v_cvt_pk_bf16_f32 v108, v72, v73
    v_mfma_f32_32x32x16_bf16 v[16:31], a[184:187], a[48:51], v[16:31]
    ds_read_b64_tr_b16 a[168:169], v9 offset:16384
    ds_read_b64_tr_b16 a[170:171], v9 offset:16896
    v_cvt_pk_bf16_f32 v109, v74, v75
    s_bitset1_b32 s78, s70
    v_mfma_f32_32x32x16_bf16 v[32:47], a[188:191], a[48:51], v[32:47]
    ds_read_b64_tr_b16 a[172:173], v12 offset:16384
    ds_read_b64_tr_b16 a[174:175], v12 offset:16896
    v_cvt_pk_bf16_f32 v110, v76, v77
    s_waitcnt lgkmcnt(8)
    v_mfma_f32_32x32x16_bf16 v[16:31], a[192:195], a[52:55], v[16:31]
    ds_read_b64_tr_b16 a[176:177], v9 offset:17408
    ds_read_b64_tr_b16 a[178:179], v9 offset:17920
    buffer_load_dwordx4 v7, s[16:19], s54 offen offset:2048 lds
    v_cvt_pk_bf16_f32 v111, v78, v79
    s_lshl_b32 s70, s70, 14
    v_mfma_f32_32x32x16_bf16 v[32:47], a[196:199], a[52:55], v[32:47]
    ds_read_b64_tr_b16 a[180:181], v12 offset:17408
    ds_read_b64_tr_b16 a[182:183], v12 offset:17920
    ds_read_b64_tr_b16 a[184:185], v9 offset:18432
    s_add_u32 s70, s70, s57
    v_mfma_f32_32x32x16_bf16 v[16:31], a[200:203], a[56:59], v[16:31]
    ds_read_b64_tr_b16 a[186:187], v9 offset:18944
    ds_read_b64_tr_b16 a[188:189], v12 offset:18432
    v_mfma_f32_32x32x16_bf16 v[32:47], a[204:207], a[56:59], v[32:47]
    ds_read_b64_tr_b16 a[190:191], v12 offset:18944
    buffer_store_dwordx4 v[108:111], v14, s[20:23], s56 offen offset:3072 sc1
    s_mul_i32 s71, s72, 86
    s_waitcnt lgkmcnt(8)
    v_mfma_f32_32x32x16_bf16 v[16:31], a[160:163], a[60:63], v[16:31]
    ds_read_b64_tr_b16 a[192:193], v9 offset:19456
    ds_read_b64_tr_b16 a[194:195], v9 offset:19968
    s_add_u32 m0, s47, 27648
    s_add_u32 s54, s90, 248832
    v_mfma_f32_32x32x16_bf16 v[32:47], a[164:167], a[60:63], v[32:47]
    ds_read_b64_tr_b16 a[196:197], v12 offset:19456
    ds_read_b64_tr_b16 a[198:199], v12 offset:19968
    buffer_load_dwordx4 v5, s[16:19], s54 offen offset:0 lds
    s_lshr_b32 s71, s71, 8
    v_mfma_f32_32x32x16_bf16 v[16:31], a[168:171], a[64:67], v[16:31]
    ds_read_b64_tr_b16 a[200:201], v9 offset:24576
    ds_read_b64_tr_b16 a[202:203], v9 offset:25088
    v_mfma_f32_32x32x16_bf16 v[32:47], a[172:175], a[64:67], v[32:47]
    ds_read_b64_tr_b16 a[204:205], v12 offset:24576
    ds_read_b64_tr_b16 a[206:207], v12 offset:25088
    s_add_u32 s71, s71, 2
    s_waitcnt lgkmcnt(8)
    v_mfma_f32_32x32x16_bf16 v[16:31], a[176:179], a[68:71], v[16:31]
    ds_read_b64_tr_b16 a[160:161], v9 offset:25600
    ds_read_b64_tr_b16 a[162:163], v9 offset:26112
    buffer_load_dwordx4 v6, s[16:19], s54 offen offset:1024 lds
    v_mfma_f32_32x32x16_bf16 v[32:47], a[180:183], a[68:71], v[32:47]
    ds_read_b64_tr_b16 a[164:165], v12 offset:25600
    ds_read_b64_tr_b16 a[166:167], v12 offset:26112
    v_mfma_f32_32x32x16_bf16 v[16:31], a[184:187], a[72:75], v[16:31]
    ds_read_b64_tr_b16 a[168:169], v9 offset:26624
    ds_read_b64_tr_b16 a[170:171], v9 offset:27136
    s_cmp_ge_u32 s71, 3
    s_cselect_b32 s50, -6, -9
    s_sub_u32 s71, s71, s50
    v_mfma_f32_32x32x16_bf16 v[32:47], a[188:191], a[72:75], v[32:47]
    ds_read_b64_tr_b16 a[172:173], v12 offset:26624
    ds_read_b64_tr_b16 a[174:175], v12 offset:27136
    buffer_load_dwordx4 v7, s[16:19], s54 offen offset:2048 lds
    s_waitcnt lgkmcnt(8)
    v_mfma_f32_32x32x16_bf16 v[16:31], a[192:195], a[76:79], v[16:31]
    ds_read_b64_tr_b16 a[176:177], v9 offset:27648
    ds_read_b64_tr_b16 a[178:179], v9 offset:28160
    v_mfma_f32_32x32x16_bf16 v[32:47], a[196:199], a[76:79], v[32:47]
    ds_read_b64_tr_b16 a[180:181], v12 offset:27648
    ds_read_b64_tr_b16 a[182:183], v12 offset:28160
    s_bitset1_b32 s78, s71
    v_mfma_f32_32x32x16_bf16 v[16:31], a[200:203], a[80:83], v[16:31]
    s_barrier
    ds_read_b64_tr_b16 a[184:185], v9 offset:32768
    ds_read_b64_tr_b16 a[186:187], v9 offset:33280
    s_add_u32 m0, s47, 49152
    s_add_u32 s54, s91, 0
    v_mfma_f32_32x32x16_bf16 v[32:47], a[204:207], a[80:83], v[32:47]
    ds_read_b64_tr_b16 a[188:189], v12 offset:32768
    ds_read_b64_tr_b16 a[190:191], v12 offset:33280
    s_lshl_b32 s71, s71, 14
    s_waitcnt lgkmcnt(8)
    v_mfma_f32_32x32x16_bf16 v[16:31], a[160:163], a[84:87], v[16:31]
    ds_read_b64_tr_b16 a[192:193], v9 offset:33792
    ds_read_b64_tr_b16 a[194:195], v9 offset:34304
    buffer_load_dwordx4 v5, s[16:19], s54 offen offset:0 lds
    v_mfma_f32_32x32x16_bf16 v[32:47], a[164:167], a[84:87], v[32:47]
    ds_read_b64_tr_b16 a[196:197], v12 offset:33792
    ds_read_b64_tr_b16 a[198:199], v12 offset:34304
    s_add_u32 s71, s71, s57
    v_mfma_f32_32x32x16_bf16 v[16:31], a[168:171], a[88:91], v[16:31]
    ds_read_b64_tr_b16 a[200:201], v9 offset:34816
    ds_read_b64_tr_b16 a[202:203], v9 offset:35328
    v_mfma_f32_32x32x16_bf16 v[32:47], a[172:175], a[88:91], v[32:47]
    ds_read_b64_tr_b16 a[204:205], v12 offset:34816
    ds_read_b64_tr_b16 a[206:207], v12 offset:35328
    buffer_load_dwordx4 v6, s[16:19], s54 offen offset:1024 lds
    s_add_u32 s75, s72, 2
    s_waitcnt lgkmcnt(8)
    v_mfma_f32_32x32x16_bf16 v[16:31], a[176:179], a[92:95], v[16:31]
    ds_read_b64_tr_b16 a[160:161], v9 offset:35840
    ds_read_b64_tr_b16 a[162:163], v9 offset:36352
    v_mfma_f32_32x32x16_bf16 v[32:47], a[180:183], a[92:95], v[32:47]
    ds_read_b64_tr_b16 a[164:165], v12 offset:35840
    ds_read_b64_tr_b16 a[166:167], v12 offset:36352
    v_mfma_f32_32x32x16_bf16 v[48:63], a[184:187], a[0:3], 0
    ds_read_b64_tr_b16 a[168:169], v9 offset:40960
    ds_read_b64_tr_b16 a[170:171], v9 offset:41472
    buffer_load_dwordx4 v7, s[16:19], s54 offen offset:2048 lds
    s_cmp_ge_u32 s75, 9
    s_cselect_b32 s50, 9, 0
    s_sub_u32 s75, s75, s50
    v_mfma_f32_32x32x16_bf16 v[64:79], a[188:191], a[0:3], 0
    ds_read_b64_tr_b16 a[172:173], v12 offset:40960
    ds_read_b64_tr_b16 a[174:175], v12 offset:41472
    s_add_u32 m0, s47, 52224
    s_add_u32 s54, s91, 27648
    s_mul_i32 s56, s88, 1536
    s_add_u32 s56, s56, s93
    s_waitcnt lgkmcnt(8)
    v_mfma_f32_32x32x16_bf16 v[48:63], a[192:195], a[4:7], v[48:63]
    ds_read_b64_tr_b16 a[176:177], v9 offset:41984
    ds_read_b64_tr_b16 a[178:179], v9 offset:42496
    v_cvt_pk_bf16_f32 v80, v16, v17
    v_mfma_f32_32x32x16_bf16 v[64:79], a[196:199], a[4:7], v[64:79]
    ds_read_b64_tr_b16 a[180:181], v12 offset:41984
    ds_read_b64_tr_b16 a[182:183], v12 offset:42496
    v_cvt_pk_bf16_f32 v81, v18, v19
    v_mfma_f32_32x32x16_bf16 v[48:63], a[200:203], a[8:11], v[48:63]
    ds_read_b64_tr_b16 a[184:185], v9 offset:43008
    ds_read_b64_tr_b16 a[186:187], v9 offset:43520
    buffer_load_dwordx4 v5, s[16:19], s54 offen offset:0 lds
    v_cvt_pk_bf16_f32 v82, v20, v21
    s_bitset1_b32 s78, s75
    v_mfma_f32_32x32x16_bf16 v[64:79], a[204:207], a[8:11], v[64:79]
    ds_read_b64_tr_b16 a[188:189], v12 offset:43008
    ds_read_b64_tr_b16 a[190:191], v12 offset:43520
    v_cvt_pk_bf16_f32 v83, v22, v23
    s_lshl_b32 s75, s75, 14
    s_waitcnt lgkmcnt(8)
    v_mfma_f32_32x32x16_bf16 v[48:63], a[160:163], a[12:15], v[48:63]
    ds_read_b64_tr_b16 a[192:193], v9 offset:44032
    ds_read_b64_tr_b16 a[194:195], v9 offset:44544
    ds_read_b64_tr_b16 a[196:197], v12 offset:44032
    s_waitcnt vmcnt(7)
    v_mov_b32 v240, 4
    buffer_store_dword v240, v241, s[20:23], s62 offen sc1
    v_mfma_f32_32x32x16_bf16 v[64:79], a[164:167], a[12:15], v[64:79]
    ds_read_b64_tr_b16 a[198:199], v12 offset:44544
    ds_read_b64_tr_b16 a[200:201], v9 offset:49152
    s_add_u32 s75, s75, s57
    v_mfma_f32_32x32x16_bf16 v[48:63], a[168:171], a[16:19], v[48:63]
    ds_read_b64_tr_b16 a[202:203], v9 offset:49664
    buffer_store_dwordx4 v[80:83], v14, s[20:23], s56 offen offset:0 sc1
    v_mfma_f32_32x32x16_bf16 v[64:79], a[172:175], a[16:19], v[64:79]
    ds_read_b64_tr_b16 a[204:205], v12 offset:49152
    ds_read_b64_tr_b16 a[206:207], v12 offset:49664
    buffer_load_dwordx4 v6, s[16:19], s54 offen offset:1024 lds
    v_cvt_pk_bf16_f32 v84, v24, v25
    s_add_u32 s76, s72, 1
    s_waitcnt lgkmcnt(8)
    v_mfma_f32_32x32x16_bf16 v[48:63], a[176:179], a[20:23], v[48:63]
    ds_read_b64_tr_b16 a[160:161], v9 offset:50176
    ds_read_b64_tr_b16 a[162:163], v9 offset:50688
    v_cvt_pk_bf16_f32 v85, v26, v27
    v_mfma_f32_32x32x16_bf16 v[64:79], a[180:183], a[20:23], v[64:79]
    ds_read_b64_tr_b16 a[164:165], v12 offset:50176
    ds_read_b64_tr_b16 a[166:167], v12 offset:50688
    v_cvt_pk_bf16_f32 v86, v28, v29
    v_mfma_f32_32x32x16_bf16 v[48:63], a[184:187], a[24:27], v[48:63]
    ds_read_b64_tr_b16 a[168:169], v9 offset:51200
    ds_read_b64_tr_b16 a[170:171], v9 offset:51712
    v_cvt_pk_bf16_f32 v87, v30, v31
    s_cmp_ge_u32 s76, 9
    s_cselect_b32 s50, 9, 0
    s_sub_u32 s76, s76, s50
    v_mfma_f32_32x32x16_bf16 v[64:79], a[188:191], a[24:27], v[64:79]
    ds_read_b64_tr_b16 a[172:173], v12 offset:51200
    ds_read_b64_tr_b16 a[174:175], v12 offset:51712
    ds_read_b64_tr_b16 a[176:177], v9 offset:52224
    s_waitcnt lgkmcnt(9)
    v_mfma_f32_32x32x16_bf16 v[48:63], a[192:195], a[28:31], v[48:63]
    ds_read_b64_tr_b16 a[178:179], v9 offset:52736
    ds_read_b64_tr_b16 a[180:181], v12 offset:52224
    v_mfma_f32_32x32x16_bf16 v[64:79], a[196:199], a[28:31], v[64:79]
    ds_read_b64_tr_b16 a[182:183], v12 offset:52736
    buffer_store_dwordx4 v[84:87], v14, s[20:23], s56 offen offset:1024 sc1
    v_mfma_f32_32x32x16_bf16 v[48:63], a[200:203], a[32:35], v[48:63]
    s_barrier
    ds_read_b64_tr_b16 a[184:185], v9 offset:57344
    ds_read_b64_tr_b16 a[186:187], v9 offset:57856
    buffer_load_dwordx4 v7, s[16:19], s54 offen offset:2048 lds
    v_cvt_pk_bf16_f32 v88, v32, v33
    s_bitset1_b32 s79, s76
    v_mfma_f32_32x32x16_bf16 v[64:79], a[204:207], a[32:35], v[64:79]
    ds_read_b64_tr_b16 a[188:189], v12 offset:57344
    ds_read_b64_tr_b16 a[190:191], v12 offset:57856
    s_add_u32 m0, s47, 73728
    s_add_u32 s54, s91, 221184
    v_cvt_pk_bf16_f32 v89, v34, v35
    s_lshl_b32 s76, s76, 14
    s_waitcnt lgkmcnt(8)
    v_mfma_f32_32x32x16_bf16 v[48:63], a[160:163], a[36:39], v[48:63]
    ds_read_b64_tr_b16 a[192:193], v9 offset:58368
    ds_read_b64_tr_b16 a[194:195], v9 offset:58880
    v_cvt_pk_bf16_f32 v90, v36, v37
    v_mfma_f32_32x32x16_bf16 v[64:79], a[164:167], a[36:39], v[64:79]
    ds_read_b64_tr_b16 a[196:197], v12 offset:58368
    ds_read_b64_tr_b16 a[198:199], v12 offset:58880
    buffer_load_dwordx4 v5, s[16:19], s54 offen offset:0 lds
    v_cvt_pk_bf16_f32 v91, v38, v39
    s_add_u32 s76, s76, s57
    v_mfma_f32_32x32x16_bf16 v[48:63], a[168:171], a[40:43], v[48:63]
    ds_read_b64_tr_b16 a[200:201], v9 offset:59392
    ds_read_b64_tr_b16 a[202:203], v9 offset:59904
    ds_read_b64_tr_b16 a[204:205], v12 offset:59392
    v_mfma_f32_32x32x16_bf16 v[64:79], a[172:175], a[40:43], v[64:79]
    ds_read_b64_tr_b16 a[206:207], v12 offset:59904
    ds_read_b64_tr_b16 a[160:161], v9 offset:60416
    s_mul_i32 s77, s72, 86
    s_waitcnt lgkmcnt(9)
    v_mfma_f32_32x32x16_bf16 v[48:63], a[176:179], a[44:47], v[48:63]
    ds_read_b64_tr_b16 a[162:163], v9 offset:60928
    buffer_store_dwordx4 v[88:91], v14, s[20:23], s56 offen offset:2048 sc1
    v_mfma_f32_32x32x16_bf16 v[64:79], a[180:183], a[44:47], v[64:79]
    ds_read_b64_tr_b16 a[164:165], v12 offset:60416
    ds_read_b64_tr_b16 a[166:167], v12 offset:60928
    buffer_load_dwordx4 v6, s[16:19], s54 offen offset:1024 lds
    v_cvt_pk_bf16_f32 v92, v40, v41
    s_lshr_b32 s77, s77, 8
    v_mfma_f32_32x32x16_bf16 v[48:63], a[184:187], a[48:51], v[48:63]
    ds_read_b64_tr_b16 a[168:169], v10 offset:0
    ds_read_b64_tr_b16 a[170:171], v10 offset:512
    v_cvt_pk_bf16_f32 v93, v42, v43
    s_add_u32 s77, s77, 1
    v_mfma_f32_32x32x16_bf16 v[64:79], a[188:191], a[48:51], v[64:79]
    ds_read_b64_tr_b16 a[172:173], v13 offset:0
    ds_read_b64_tr_b16 a[174:175], v13 offset:512
    v_cvt_pk_bf16_f32 v94, v44, v45
    s_waitcnt lgkmcnt(8)
    v_mfma_f32_32x32x16_bf16 v[48:63], a[192:195], a[52:55], v[48:63]
    ds_read_b64_tr_b16 a[176:177], v10 offset:1024
    ds_read_b64_tr_b16 a[178:179], v10 offset:1536
    buffer_load_dwordx4 v7, s[16:19], s54 offen offset:2048 lds
    v_cvt_pk_bf16_f32 v95, v46, v47
    v_mfma_f32_32x32x16_bf16 v[64:79], a[196:199], a[52:55], v[64:79]
    ds_read_b64_tr_b16 a[180:181], v13 offset:1024
    ds_read_b64_tr_b16 a[182:183], v13 offset:1536
    ds_read_b64_tr_b16 a[184:185], v10 offset:2048
    v_mfma_f32_32x32x16_bf16 v[48:63], a[200:203], a[56:59], v[48:63]
    ds_read_b64_tr_b16 a[186:187], v10 offset:2560
    ds_read_b64_tr_b16 a[188:189], v13 offset:2048
    s_cmp_ge_u32 s77, 3
    s_cselect_b32 s50, -6, -9
    s_sub_u32 s77, s77, s50
    v_mfma_f32_32x32x16_bf16 v[64:79], a[204:207], a[56:59], v[64:79]
    ds_read_b64_tr_b16 a[190:191], v13 offset:2560
    buffer_store_dwordx4 v[92:95], v14, s[20:23], s56 offen offset:3072 sc1
    s_waitcnt lgkmcnt(8)
    v_mfma_f32_32x32x16_bf16 v[48:63], a[160:163], a[60:63], v[48:63]
    ds_read_b64_tr_b16 a[192:193], v10 offset:3072
    ds_read_b64_tr_b16 a[194:195], v10 offset:3584
    s_add_u32 m0, s47, 76800
    s_add_u32 s54, s91, 248832
    v_mfma_f32_32x32x16_bf16 v[64:79], a[164:167], a[60:63], v[64:79]
    ds_read_b64_tr_b16 a[196:197], v13 offset:3072
    ds_read_b64_tr_b16 a[198:199], v13 offset:3584
    buffer_load_dwordx4 v5, s[16:19], s54 offen offset:0 lds
    s_bitset1_b32 s79, s77
    v_mfma_f32_32x32x16_bf16 v[48:63], a[168:171], a[64:67], v[48:63]
    ds_read_b64_tr_b16 a[200:201], v10 offset:8192
    ds_read_b64_tr_b16 a[202:203], v10 offset:8704
    v_mfma_f32_32x32x16_bf16 v[64:79], a[172:175], a[64:67], v[64:79]
    ds_read_b64_tr_b16 a[204:205], v13 offset:8192
    ds_read_b64_tr_b16 a[206:207], v13 offset:8704
    s_lshl_b32 s77, s77, 14
    s_waitcnt lgkmcnt(8)
    v_mfma_f32_32x32x16_bf16 v[48:63], a[176:179], a[68:71], v[48:63]
    ds_read_b64_tr_b16 a[160:161], v10 offset:9216
    ds_read_b64_tr_b16 a[162:163], v10 offset:9728
    buffer_load_dwordx4 v6, s[16:19], s54 offen offset:1024 lds
    v_mfma_f32_32x32x16_bf16 v[64:79], a[180:183], a[68:71], v[64:79]
    ds_read_b64_tr_b16 a[164:165], v13 offset:9216
    ds_read_b64_tr_b16 a[166:167], v13 offset:9728
    s_add_u32 s77, s77, s57
    v_mfma_f32_32x32x16_bf16 v[48:63], a[184:187], a[72:75], v[48:63]
    ds_read_b64_tr_b16 a[168:169], v10 offset:10240
    ds_read_b64_tr_b16 a[170:171], v10 offset:10752
    v_mfma_f32_32x32x16_bf16 v[64:79], a[188:191], a[72:75], v[64:79]
    ds_read_b64_tr_b16 a[172:173], v13 offset:10240
    ds_read_b64_tr_b16 a[174:175], v13 offset:10752
    buffer_load_dwordx4 v7, s[16:19], s54 offen offset:2048 lds
    s_waitcnt lgkmcnt(8)
    v_mfma_f32_32x32x16_bf16 v[48:63], a[192:195], a[76:79], v[48:63]
    ds_read_b64_tr_b16 a[176:177], v10 offset:11264
    ds_read_b64_tr_b16 a[178:179], v10 offset:11776
    v_mfma_f32_32x32x16_bf16 v[64:79], a[196:199], a[76:79], v[64:79]
    ds_read_b64_tr_b16 a[180:181], v13 offset:11264
    ds_read_b64_tr_b16 a[182:183], v13 offset:11776
    v_mfma_f32_32x32x16_bf16 v[48:63], a[200:203], a[80:83], v[48:63]
    s_barrier
    ds_read_b64_tr_b16 a[184:185], v8 offset:0
    ds_read_b64_tr_b16 a[186:187], v8 offset:512
    s_add_u32 m0, s47, 98304
    s_add_u32 s54, s92, 0
    v_mfma_f32_32x32x16_bf16 v[64:79], a[204:207], a[80:83], v[64:79]
    ds_read_b64_tr_b16 a[188:189], v11 offset:0
    ds_read_b64_tr_b16 a[190:191], v11 offset:512
    s_waitcnt lgkmcnt(8)
    v_mfma_f32_32x32x16_bf16 v[48:63], a[160:163], a[84:87], v[48:63]
    ds_read_b64_tr_b16 a[192:193], v8 offset:1024
    ds_read_b64_tr_b16 a[194:195], v8 offset:1536
    buffer_load_dwordx4 v5, s[16:19], s54 offen offset:0 lds
    v_mfma_f32_32x32x16_bf16 v[64:79], a[164:167], a[84:87], v[64:79]
    ds_read_b64_tr_b16 a[196:197], v11 offset:1024
    ds_read_b64_tr_b16 a[198:199], v11 offset:1536
    v_mfma_f32_32x32x16_bf16 v[48:63], a[168:171], a[88:91], v[48:63]
    ds_read_b64_tr_b16 a[200:201], v8 offset:2048
    ds_read_b64_tr_b16 a[202:203], v8 offset:2560
    v_mfma_f32_32x32x16_bf16 v[64:79], a[172:175], a[88:91], v[64:79]
    ds_read_b64_tr_b16 a[204:205], v11 offset:2048
    ds_read_b64_tr_b16 a[206:207], v11 offset:2560
    buffer_load_dwordx4 v6, s[16:19], s54 offen offset:1024 lds
    s_waitcnt lgkmcnt(8)
    v_mfma_f32_32x32x16_bf16 v[48:63], a[176:179], a[92:95], v[48:63]
    ds_read_b64_tr_b16 a[160:161], v8 offset:3072
    ds_read_b64_tr_b16 a[162:163], v8 offset:3584
    v_mfma_f32_32x32x16_bf16 v[64:79], a[180:183], a[92:95], v[64:79]
    ds_read_b64_tr_b16 a[164:165], v11 offset:3072
    ds_read_b64_tr_b16 a[166:167], v11 offset:3584
    v_mfma_f32_32x32x16_bf16 v[16:31], a[184:187], a[0:3], 0
    ds_read_b64_tr_b16 a[168:169], v8 offset:8192
    ds_read_b64_tr_b16 a[170:171], v8 offset:8704
    buffer_load_dwordx4 v7, s[16:19], s54 offen offset:2048 lds
    v_mfma_f32_32x32x16_bf16 v[32:47], a[188:191], a[0:3], 0
    ds_read_b64_tr_b16 a[172:173], v11 offset:8192
    ds_read_b64_tr_b16 a[174:175], v11 offset:8704
    s_add_u32 m0, s47, 101376
    s_add_u32 s54, s92, 27648
    s_mul_i32 s56, s89, 1536
    s_add_u32 s56, s56, s93
    s_waitcnt lgkmcnt(8)
    v_mfma_f32_32x32x16_bf16 v[16:31], a[192:195], a[4:7], v[16:31]
    ds_read_b64_tr_b16 a[176:177], v8 offset:9216
    ds_read_b64_tr_b16 a[178:179], v8 offset:9728
    v_cvt_pk_bf16_f32 v96, v48, v49
    v_mfma_f32_32x32x16_bf16 v[32:47], a[196:199], a[4:7], v[32:47]
    ds_read_b64_tr_b16 a[180:181], v11 offset:9216
    ds_read_b64_tr_b16 a[182:183], v11 offset:9728
    v_cvt_pk_bf16_f32 v97, v50, v51
    v_mfma_f32_32x32x16_bf16 v[16:31], a[200:203], a[8:11], v[16:31]
    ds_read_b64_tr_b16 a[184:185], v8 offset:10240
    ds_read_b64_tr_b16 a[186:187], v8 offset:10752
    buffer_load_dwordx4 v5, s[16:19], s54 offen offset:0 lds
    v_cvt_pk_bf16_f32 v98, v52, v53
    v_mfma_f32_32x32x16_bf16 v[32:47], a[204:207], a[8:11], v[32:47]
    ds_read_b64_tr_b16 a[188:189], v11 offset:10240
    ds_read_b64_tr_b16 a[190:191], v11 offset:10752
    v_cvt_pk_bf16_f32 v99, v54, v55
    s_waitcnt lgkmcnt(8)
    v_mfma_f32_32x32x16_bf16 v[16:31], a[160:163], a[12:15], v[16:31]
    ds_read_b64_tr_b16 a[192:193], v8 offset:11264
    ds_read_b64_tr_b16 a[194:195], v8 offset:11776
    ds_read_b64_tr_b16 a[196:197], v11 offset:11264
    s_waitcnt vmcnt(7)
    v_mov_b32 v240, 5
    buffer_store_dword v240, v241, s[20:23], s62 offen sc1
    v_mfma_f32_32x32x16_bf16 v[32:47], a[164:167], a[12:15], v[32:47]
    ds_read_b64_tr_b16 a[198:199], v11 offset:11776
    ds_read_b64_tr_b16 a[200:201], v8 offset:16384
    v_mfma_f32_32x32x16_bf16 v[16:31], a[168:171], a[16:19], v[16:31]
    ds_read_b64_tr_b16 a[202:203], v8 offset:16896
    buffer_store_dwordx4 v[96:99], v14, s[20:23], s56 offen offset:0 sc1
    v_mfma_f32_32x32x16_bf16 v[32:47], a[172:175], a[16:19], v[32:47]
    ds_read_b64_tr_b16 a[204:205], v11 offset:16384
    ds_read_b64_tr_b16 a[206:207], v11 offset:16896
    buffer_load_dwordx4 v6, s[16:19], s54 offen offset:1024 lds
    v_cvt_pk_bf16_f32 v100, v56, v57
    s_waitcnt lgkmcnt(8)
    v_mfma_f32_32x32x16_bf16 v[16:31], a[176:179], a[20:23], v[16:31]
    ds_read_b64_tr_b16 a[160:161], v8 offset:17408
    ds_read_b64_tr_b16 a[162:163], v8 offset:17920
    v_cvt_pk_bf16_f32 v101, v58, v59
    v_mfma_f32_32x32x16_bf16 v[32:47], a[180:183], a[20:23], v[32:47]
    ds_read_b64_tr_b16 a[164:165], v11 offset:17408
    ds_read_b64_tr_b16 a[166:167], v11 offset:17920
    v_cvt_pk_bf16_f32 v102, v60, v61
    v_mfma_f32_32x32x16_bf16 v[16:31], a[184:187], a[24:27], v[16:31]
    ds_read_b64_tr_b16 a[168:169], v8 offset:18432
    ds_read_b64_tr_b16 a[170:171], v8 offset:18944
    v_cvt_pk_bf16_f32 v103, v62, v63
    v_mfma_f32_32x32x16_bf16 v[32:47], a[188:191], a[24:27], v[32:47]
    ds_read_b64_tr_b16 a[172:173], v11 offset:18432
    ds_read_b64_tr_b16 a[174:175], v11 offset:18944
    ds_read_b64_tr_b16 a[176:177], v8 offset:19456
    s_waitcnt lgkmcnt(9)
    v_mfma_f32_32x32x16_bf16 v[16:31], a[192:195], a[28:31], v[16:31]
    ds_read_b64_tr_b16 a[178:179], v8 offset:19968
    ds_read_b64_tr_b16 a[180:181], v11 offset:19456
    v_mfma_f32_32x32x16_bf16 v[32:47], a[196:199], a[28:31], v[32:47]
    ds_read_b64_tr_b16 a[182:183], v11 offset:19968
    buffer_store_dwordx4 v[100:103], v14, s[20:23], s56 offen offset:1024 sc1
    v_mfma_f32_32x32x16_bf16 v[16:31], a[200:203], a[32:35], v[16:31]
    s_barrier
    ds_read_b64_tr_b16 a[184:185], v8 offset:24576
    ds_read_b64_tr_b16 a[186:187], v8 offset:25088
    buffer_load_dwordx4 v7, s[16:19], s54 offen offset:2048 lds
    v_cvt_pk_bf16_f32 v104, v64, v65
    buffer_load_dword v238, v236, s[20:23], s97 offen sc1
    v_mfma_f32_32x32x16_bf16 v[32:47], a[204:207], a[32:35], v[32:47]
    ds_read_b64_tr_b16 a[188:189], v11 offset:24576
    ds_read_b64_tr_b16 a[190:191], v11 offset:25088
    s_add_u32 m0, s47, 122880
    s_add_u32 s54, s92, 221184
    v_cvt_pk_bf16_f32 v105, v66, v67
    s_waitcnt lgkmcnt(8)
    v_mfma_f32_32x32x16_bf16 v[16:31], a[160:163], a[36:39], v[16:31]
    ds_read_b64_tr_b16 a[192:193], v8 offset:25600
    ds_read_b64_tr_b16 a[194:195], v8 offset:26112
    v_cvt_pk_bf16_f32 v106, v68, v69
    v_mfma_f32_32x32x16_bf16 v[32:47], a[164:167], a[36:39], v[32:47]
    ds_read_b64_tr_b16 a[196:197], v11 offset:25600
    ds_read_b64_tr_b16 a[198:199], v11 offset:26112
    buffer_load_dwordx4 v5, s[16:19], s54 offen offset:0 lds
    v_cvt_pk_bf16_f32 v107, v70, v71
    v_mfma_f32_32x32x16_bf16 v[16:31], a[168:171], a[40:43], v[16:31]
    ds_read_b64_tr_b16 a[200:201], v8 offset:26624
    ds_read_b64_tr_b16 a[202:203], v8 offset:27136
    ds_read_b64_tr_b16 a[204:205], v11 offset:26624
    v_mfma_f32_32x32x16_bf16 v[32:47], a[172:175], a[40:43], v[32:47]
    ds_read_b64_tr_b16 a[206:207], v11 offset:27136
    ds_read_b64_tr_b16 a[160:161], v8 offset:27648
    s_waitcnt lgkmcnt(9)
    v_mfma_f32_32x32x16_bf16 v[16:31], a[176:179], a[44:47], v[16:31]
    ds_read_b64_tr_b16 a[162:163], v8 offset:28160
    buffer_store_dwordx4 v[104:107], v14, s[20:23], s56 offen offset:2048 sc1
    v_mfma_f32_32x32x16_bf16 v[32:47], a[180:183], a[44:47], v[32:47]
    ds_read_b64_tr_b16 a[164:165], v11 offset:27648
    ds_read_b64_tr_b16 a[166:167], v11 offset:28160
    buffer_load_dwordx4 v6, s[16:19], s54 offen offset:1024 lds
    v_cvt_pk_bf16_f32 v108, v72, v73
    v_mfma_f32_32x32x16_bf16 v[16:31], a[184:187], a[48:51], v[16:31]
    ds_read_b64_tr_b16 a[168:169], v8 offset:32768
    ds_read_b64_tr_b16 a[170:171], v8 offset:33280
    v_cvt_pk_bf16_f32 v109, v74, v75
    v_mfma_f32_32x32x16_bf16 v[32:47], a[188:191], a[48:51], v[32:47]
    ds_read_b64_tr_b16 a[172:173], v11 offset:32768
    ds_read_b64_tr_b16 a[174:175], v11 offset:33280
    v_cvt_pk_bf16_f32 v110, v76, v77
    s_waitcnt lgkmcnt(8)
    v_mfma_f32_32x32x16_bf16 v[16:31], a[192:195], a[52:55], v[16:31]
    ds_read_b64_tr_b16 a[176:177], v8 offset:33792
    ds_read_b64_tr_b16 a[178:179], v8 offset:34304
    buffer_load_dwordx4 v7, s[16:19], s54 offen offset:2048 lds
    v_cvt_pk_bf16_f32 v111, v78, v79
    v_mfma_f32_32x32x16_bf16 v[32:47], a[196:199], a[52:55], v[32:47]
    ds_read_b64_tr_b16 a[180:181], v11 offset:33792
    ds_read_b64_tr_b16 a[182:183], v11 offset:34304
    ds_read_b64_tr_b16 a[184:185], v8 offset:34816
    v_mfma_f32_32x32x16_bf16 v[16:31], a[200:203], a[56:59], v[16:31]
    ds_read_b64_tr_b16 a[186:187], v8 offset:35328
    ds_read_b64_tr_b16 a[188:189], v11 offset:34816
    v_mfma_f32_32x32x16_bf16 v[32:47], a[204:207], a[56:59], v[32:47]
    ds_read_b64_tr_b16 a[190:191], v11 offset:35328
    buffer_store_dwordx4 v[108:111], v14, s[20:23], s56 offen offset:3072 sc1
    s_waitcnt lgkmcnt(8)
    v_mfma_f32_32x32x16_bf16 v[16:31], a[160:163], a[60:63], v[16:31]
    ds_read_b64_tr_b16 a[192:193], v8 offset:35840
    ds_read_b64_tr_b16 a[194:195], v8 offset:36352
    s_add_u32 m0, s47, 125952
    s_add_u32 s54, s92, 248832
    v_mfma_f32_32x32x16_bf16 v[32:47], a[164:167], a[60:63], v[32:47]
    ds_read_b64_tr_b16 a[196:197], v11 offset:35840
    ds_read_b64_tr_b16 a[198:199], v11 offset:36352
    buffer_load_dwordx4 v5, s[16:19], s54 offen offset:0 lds
    v_mfma_f32_32x32x16_bf16 v[16:31], a[168:171], a[64:67], v[16:31]
    ds_read_b64_tr_b16 a[200:201], v8 offset:40960
    ds_read_b64_tr_b16 a[202:203], v8 offset:41472
    v_mfma_f32_32x32x16_bf16 v[32:47], a[172:175], a[64:67], v[32:47]
    ds_read_b64_tr_b16 a[204:205], v11 offset:40960
    ds_read_b64_tr_b16 a[206:207], v11 offset:41472
    s_waitcnt lgkmcnt(8)
    v_mfma_f32_32x32x16_bf16 v[16:31], a[176:179], a[68:71], v[16:31]
    ds_read_b64_tr_b16 a[160:161], v8 offset:41984
    ds_read_b64_tr_b16 a[162:163], v8 offset:42496
    buffer_load_dwordx4 v6, s[16:19], s54 offen offset:1024 lds
    v_mfma_f32_32x32x16_bf16 v[32:47], a[180:183], a[68:71], v[32:47]
    ds_read_b64_tr_b16 a[164:165], v11 offset:41984
    ds_read_b64_tr_b16 a[166:167], v11 offset:42496
    v_mfma_f32_32x32x16_bf16 v[16:31], a[184:187], a[72:75], v[16:31]
    ds_read_b64_tr_b16 a[168:169], v8 offset:43008
    ds_read_b64_tr_b16 a[170:171], v8 offset:43520
    v_mfma_f32_32x32x16_bf16 v[32:47], a[188:191], a[72:75], v[32:47]
    ds_read_b64_tr_b16 a[172:173], v11 offset:43008
    ds_read_b64_tr_b16 a[174:175], v11 offset:43520
    buffer_load_dwordx4 v7, s[16:19], s54 offen offset:2048 lds
    s_waitcnt lgkmcnt(8)
    v_mfma_f32_32x32x16_bf16 v[16:31], a[192:195], a[76:79], v[16:31]
    ds_read_b64_tr_b16 a[176:177], v8 offset:44032
    ds_read_b64_tr_b16 a[178:179], v8 offset:44544
    v_mfma_f32_32x32x16_bf16 v[32:47], a[196:199], a[76:79], v[32:47]
    ds_read_b64_tr_b16 a[180:181], v11 offset:44032
    ds_read_b64_tr_b16 a[182:183], v11 offset:44544
    v_mfma_f32_32x32x16_bf16 v[16:31], a[200:203], a[80:83], v[16:31]
    s_barrier
    ds_read_b64_tr_b16 a[184:185], v8 offset:49152
    ds_read_b64_tr_b16 a[186:187], v8 offset:49664
    v_mfma_f32_32x32x16_bf16 v[32:47], a[204:207], a[80:83], v[32:47]
    ds_read_b64_tr_b16 a[188:189], v11 offset:49152
    ds_read_b64_tr_b16 a[190:191], v11 offset:49664
    s_waitcnt lgkmcnt(8)
    v_mfma_f32_32x32x16_bf16 v[16:31], a[160:163], a[84:87], v[16:31]
    ds_read_b64_tr_b16 a[192:193], v8 offset:50176
    ds_read_b64_tr_b16 a[194:195], v8 offset:50688
    v_mfma_f32_32x32x16_bf16 v[32:47], a[164:167], a[84:87], v[32:47]
    ds_read_b64_tr_b16 a[196:197], v11 offset:50176
    ds_read_b64_tr_b16 a[198:199], v11 offset:50688
    s_add_u32 m0, s98, 0
    s_add_u32 s54, s42, 0
    s_and_b32 s54, s54, 3
    s_mul_i32 s54, s54, 165888
    s_add_u32 s54, s54, s48
    buffer_load_dwordx4 v224, s[32:35], s54 offen lds
    v_mfma_f32_32x32x16_bf16 v[16:31], a[168:171], a[88:91], v[16:31]
    ds_read_b64_tr_b16 a[200:201], v8 offset:51200
    ds_read_b64_tr_b16 a[202:203], v8 offset:51712
    v_mfma_f32_32x32x16_bf16 v[32:47], a[172:175], a[88:91], v[32:47]
    ds_read_b64_tr_b16 a[204:205], v11 offset:51200
    ds_read_b64_tr_b16 a[206:207], v11 offset:51712
    s_waitcnt lgkmcnt(8)
    v_mfma_f32_32x32x16_bf16 v[16:31], a[176:179], a[92:95], v[16:31]
    ds_read_b64_tr_b16 a[160:161], v8 offset:52224
    ds_read_b64_tr_b16 a[162:163], v8 offset:52736
    v_mfma_f32_32x32x16_bf16 v[32:47], a[180:183], a[92:95], v[32:47]
    ds_read_b64_tr_b16 a[164:165], v11 offset:52224
    ds_read_b64_tr_b16 a[166:167], v11 offset:52736
    s_add_u32 m0, s98, 1024
    s_nop 0
    buffer_load_dwordx4 v225, s[32:35], s54 offen lds
    v_mfma_f32_32x32x16_bf16 v[48:63], a[184:187], a[0:3], 0
    ds_read_b64_tr_b16 a[168:169], v8 offset:57344
    ds_read_b64_tr_b16 a[170:171], v8 offset:57856
    v_mfma_f32_32x32x16_bf16 v[64:79], a[188:191], a[0:3], 0
    ds_read_b64_tr_b16 a[172:173], v11 offset:57344
    ds_read_b64_tr_b16 a[174:175], v11 offset:57856
    s_mul_i32 s56, s90, 1536
    s_add_u32 s56, s56, s93
    s_waitcnt lgkmcnt(8)
    v_mfma_f32_32x32x16_bf16 v[48:63], a[192:195], a[4:7], v[48:63]
    ds_read_b64_tr_b16 a[176:177], v8 offset:58368
    ds_read_b64_tr_b16 a[178:179], v8 offset:58880
    v_cvt_pk_bf16_f32 v80, v16, v17
    v_mfma_f32_32x32x16_bf16 v[64:79], a[196:199], a[4:7], v[64:79]
    ds_read_b64_tr_b16 a[180:181], v11 offset:58368
    ds_read_b64_tr_b16 a[182:183], v11 offset:58880
    s_add_u32 m0, s98, 2048
    s_nop 0
    buffer_load_dwordx4 v226, s[32:35], s54 offen lds
    v_cvt_pk_bf16_f32 v81, v18, v19
    s_mov_b32 s96, 0
    v_mfma_f32_32x32x16_bf16 v[48:63], a[200:203], a[8:11], v[48:63]
    ds_read_b64_tr_b16 a[184:185], v8 offset:59392
    ds_read_b64_tr_b16 a[186:187], v8 offset:59904
    v_cvt_pk_bf16_f32 v82, v20, v21
    s_sub_u32 s51, s64, s57
    s_lshr_b32 s51, s51, 14
    s_bitset1_b32 s96, s51
    v_mfma_f32_32x32x16_bf16 v[64:79], a[204:207], a[8:11], v[64:79]
    ds_read_b64_tr_b16 a[188:189], v11 offset:59392
    ds_read_b64_tr_b16 a[190:191], v11 offset:59904
    v_cvt_pk_bf16_f32 v83, v22, v23
    s_sub_u32 s51, s65, s57
    s_lshr_b32 s51, s51, 14
    s_bitset1_b32 s96, s51
    s_waitcnt lgkmcnt(8)
    v_mfma_f32_32x32x16_bf16 v[48:63], a[160:163], a[12:15], v[48:63]
    ds_read_b64_tr_b16 a[192:193], v8 offset:60416
    ds_read_b64_tr_b16 a[194:195], v8 offset:60928
    ds_read_b64_tr_b16 a[196:197], v11 offset:60416
    s_waitcnt vmcnt(6)
    v_mov_b32 v240, 6
    buffer_store_dword v240, v241, s[20:23], s62 offen sc1
    s_sub_u32 s51, s66, s57
    s_lshr_b32 s51, s51, 14
    s_bitset1_b32 s96, s51
    v_mfma_f32_32x32x16_bf16 v[64:79], a[164:167], a[12:15], v[64:79]
    ds_read_b64_tr_b16 a[198:199], v11 offset:60928
    ds_read_b64_tr_b16 a[200:201], v9 offset:0
    s_sub_u32 s51, s67, s57
    s_lshr_b32 s51, s51, 14
    s_bitset1_b32 s96, s51
    v_mfma_f32_32x32x16_bf16 v[48:63], a[168:171], a[16:19], v[48:63]
    ds_read_b64_tr_b16 a[202:203], v9 offset:512
    buffer_store_dwordx4 v[80:83], v14, s[20:23], s56 offen offset:0 sc1
    v_cmp_ge_u32 vcc, v238, v237
    s_nop 1
    s_and_b32 s50, vcc_lo, s96
    s_cmp_eq_u32 s50, s96
    s_cbranch_scc0 L_sp1
L_ok1:
    v_mfma_f32_32x32x16_bf16 v[64:79], a[172:175], a[16:19], v[64:79]
    ds_read_b64_tr_b16 a[204:205], v12 offset:0
    ds_read_b64_tr_b16 a[206:207], v12 offset:512
    s_add_u32 m0, s98, 3072
    s_nop 0
    buffer_load_dwordx4 v227, s[32:35], s54 offen lds
    v_cvt_pk_bf16_f32 v84, v24, v25
    buffer_load_dwordx4 a[96:99], v14, s[20:23], s64 offen offset:0 sc1
    s_waitcnt lgkmcnt(8)
    v_mfma_f32_32x32x16_bf16 v[48:63], a[176:179], a[20:23], v[48:63]
    ds_read_b64_tr_b16 a[160:161], v9 offset:1024
    ds_read_b64_tr_b16 a[162:163], v9 offset:1536
    v_cvt_pk_bf16_f32 v85, v26, v27
    v_mfma_f32_32x32x16_bf16 v[64:79], a[180:183], a[20:23], v[64:79]
    ds_read_b64_tr_b16 a[164:165], v12 offset:1024
    ds_read_b64_tr_b16 a[166:167], v12 offset:1536
    v_cvt_pk_bf16_f32 v86, v28, v29
    v_mfma_f32_32x32x16_bf16 v[48:63], a[184:187], a[24:27], v[48:63]
    ds_read_b64_tr_b16 a[168:169], v9 offset:2048
    ds_read_b64_tr_b16 a[170:171], v9 offset:2560
    v_cvt_pk_bf16_f32 v87, v30, v31
    v_mfma_f32_32x32x16_bf16 v[64:79], a[188:191], a[24:27], v[64:79]
    ds_read_b64_tr_b16 a[172:173], v12 offset:2048
    ds_read_b64_tr_b16 a[174:175], v12 offset:2560
    ds_read_b64_tr_b16 a[176:177], v9 offset:3072
    s_waitcnt lgkmcnt(9)
    v_mfma_f32_32x32x16_bf16 v[48:63], a[192:195], a[28:31], v[48:63]
    ds_read_b64_tr_b16 a[178:179], v9 offset:3584
    ds_read_b64_tr_b16 a[180:181], v12 offset:3072
    buffer_load_dwordx4 a[100:103], v14, s[20:23], s64 offen offset:1024 sc1
    v_mfma_f32_32x32x16_bf16 v[64:79], a[196:199], a[28:31], v[64:79]
    ds_read_b64_tr_b16 a[182:183], v12 offset:3584
    buffer_store_dwordx4 v[84:87], v14, s[20:23], s56 offen offset:1024 sc1
    v_mfma_f32_32x32x16_bf16 v[48:63], a[200:203], a[32:35], v[48:63]
    s_barrier
    ds_read_b64_tr_b16 a[184:185], v9 offset:8192
    ds_read_b64_tr_b16 a[186:187], v9 offset:8704
    s_add_u32 m0, s98, 4096
    s_nop 0
    buffer_load_dwordx4 v228, s[32:35], s54 offen lds
    v_cvt_pk_bf16_f32 v88, v32, v33
    v_mfma_f32_32x32x16_bf16 v[64:79], a[204:207], a[32:35], v[64:79]
    ds_read_b64_tr_b16 a[188:189], v12 offset:8192
    ds_read_b64_tr_b16 a[190:191], v12 offset:8704
    v_cvt_pk_bf16_f32 v89, v34, v35
    s_waitcnt lgkmcnt(8)
    v_mfma_f32_32x32x16_bf16 v[48:63], a[160:163], a[36:39], v[48:63]
    ds_read_b64_tr_b16 a[192:193], v9 offset:9216
    ds_read_b64_tr_b16 a[194:195], v9 offset:9728
    v_cvt_pk_bf16_f32 v90, v36, v37
    v_mfma_f32_32x32x16_bf16 v[64:79], a[164:167], a[36:39], v[64:79]
    ds_read_b64_tr_b16 a[196:197], v12 offset:9216
    ds_read_b64_tr_b16 a[198:199], v12 offset:9728
    v_cvt_pk_bf16_f32 v91, v38, v39
    buffer_load_dwordx4 a[104:107], v14, s[20:23], s64 offen offset:2048 sc1
    v_mfma_f32_32x32x16_bf16 v[48:63], a[168:171], a[40:43], v[48:63]
    ds_read_b64_tr_b16 a[200:201], v9 offset:10240
    ds_read_b64_tr_b16 a[202:203], v9 offset:10752
    ds_read_b64_tr_b16 a[204:205], v12 offset:10240
    v_mfma_f32_32x32x16_bf16 v[64:79], a[172:175], a[40:43], v[64:79]
    ds_read_b64_tr_b16 a[206:207], v12 offset:10752
    ds_read_b64_tr_b16 a[160:161], v9 offset:11264
    s_waitcnt lgkmcnt(9)
    v_mfma_f32_32x32x16_bf16 v[48:63], a[176:179], a[44:47], v[48:63]
    ds_read_b64_tr_b16 a[162:163], v9 offset:11776
    buffer_store_dwordx4 v[88:91], v14, s[20:23], s56 offen offset:2048 sc1
    v_mfma_f32_32x32x16_bf16 v[64:79], a[180:183], a[44:47], v[64:79]
    ds_read_b64_tr_b16 a[164:165], v12 offset:11264
    ds_read_b64_tr_b16 a[166:167], v12 offset:11776
    s_add_u32 m0, s98, 24576
    s_add_u32 s54, s42, 1
    s_and_b32 s54, s54, 3
    s_mul_i32 s54, s54, 165888
    s_add_u32 s54, s54, s48
    buffer_load_dwordx4 v224, s[32:35], s54 offen lds
    v_cvt_pk_bf16_f32 v92, v40, v41
    v_mfma_f32_32x32x16_bf16 v[48:63], a[184:187], a[48:51], v[48:63]
    ds_read_b64_tr_b16 a[168:169], v9 offset:16384
    ds_read_b64_tr_b16 a[170:171], v9 offset:16896
    v_cvt_pk_bf16_f32 v93, v42, v43
    buffer_load_dwordx4 a[108:111], v14, s[20:23], s64 offen offset:3072 sc1
    v_mfma_f32_32x32x16_bf16 v[64:79], a[188:191], a[48:51], v[64:79]
    ds_read_b64_tr_b16 a[172:173], v12 offset:16384
    ds_read_b64_tr_b16 a[174:175], v12 offset:16896
    v_cvt_pk_bf16_f32 v94, v44, v45
    s_waitcnt lgkmcnt(8)
    v_mfma_f32_32x32x16_bf16 v[48:63], a[192:195], a[52:55], v[48:63]
    ds_read_b64_tr_b16 a[176:177], v9 offset:17408
    ds_read_b64_tr_b16 a[178:179], v9 offset:17920
    s_add_u32 m0, s98, 25600
    s_nop 0
    buffer_load_dwordx4 v225, s[32:35], s54 offen lds
    v_cvt_pk_bf16_f32 v95, v46, v47
    v_mfma_f32_32x32x16_bf16 v[64:79], a[196:199], a[52:55], v[64:79]
    ds_read_b64_tr_b16 a[180:181], v12 offset:17408
    ds_read_b64_tr_b16 a[182:183], v12 offset:17920
    ds_read_b64_tr_b16 a[184:185], v9 offset:18432
    v_mfma_f32_32x32x16_bf16 v[48:63], a[200:203], a[56:59], v[48:63]
    ds_read_b64_tr_b16 a[186:187], v9 offset:18944
    ds_read_b64_tr_b16 a[188:189], v12 offset:18432
    v_mfma_f32_32x32x16_bf16 v[64:79], a[204:207], a[56:59], v[64:79]
    ds_read_b64_tr_b16 a[190:191], v12 offset:18944
    buffer_store_dwordx4 v[92:95], v14, s[20:23], s56 offen offset:3072 sc1
    buffer_load_dwordx4 a[112:115], v14, s[20:23], s65 offen offset:0 sc1
    s_waitcnt lgkmcnt(8)
    v_mfma_f32_32x32x16_bf16 v[48:63], a[160:163], a[60:63], v[48:63]
    ds_read_b64_tr_b16 a[192:193], v9 offset:19456
    ds_read_b64_tr_b16 a[194:195], v9 offset:19968
    s_add_u32 m0, s98, 26624
    s_nop 0
    buffer_load_dwordx4 v226, s[32:35], s54 offen lds
    v_mfma_f32_32x32x16_bf16 v[64:79], a[164:167], a[60:63], v[64:79]
    ds_read_b64_tr_b16 a[196:197], v12 offset:19456
    ds_read_b64_tr_b16 a[198:199], v12 offset:19968
    v_mfma_f32_32x32x16_bf16 v[48:63], a[168:171], a[64:67], v[48:63]
    ds_read_b64_tr_b16 a[200:201], v9 offset:24576
    ds_read_b64_tr_b16 a[202:203], v9 offset:25088
    v_mfma_f32_32x32x16_bf16 v[64:79], a[172:175], a[64:67], v[64:79]
    ds_read_b64_tr_b16 a[204:205], v12 offset:24576
    ds_read_b64_tr_b16 a[206:207], v12 offset:25088
    s_add_u32 m0, s98, 27648
    s_nop 0
    buffer_load_dwordx4 v227, s[32:35], s54 offen lds
    s_waitcnt lgkmcnt(8)
    v_mfma_f32_32x32x16_bf16 v[48:63], a[176:179], a[68:71], v[48:63]
    ds_read_b64_tr_b16 a[160:161], v9 offset:25600
    ds_read_b64_tr_b16 a[162:163], v9 offset:26112
    buffer_load_dwordx4 a[116:119], v14, s[20:23], s65 offen offset:1024 sc1
    v_mfma_f32_32x32x16_bf16 v[64:79], a[180:183], a[68:71], v[64:79]
    ds_read_b64_tr_b16 a[164:165], v12 offset:25600
    ds_read_b64_tr_b16 a[166:167], v12 offset:26112
    v_mfma_f32_32x32x16_bf16 v[48:63], a[184:187], a[72:75], v[48:63]
    ds_read_b64_tr_b16 a[168:169], v9 offset:26624
    ds_read_b64_tr_b16 a[170:171], v9 offset:27136
    v_mfma_f32_32x32x16_bf16 v[64:79], a[188:191], a[72:75], v[64:79]
    ds_read_b64_tr_b16 a[172:173], v12 offset:26624
    ds_read_b64_tr_b16 a[174:175], v12 offset:27136
    s_add_u32 m0, s98, 28672
    s_nop 0
    buffer_load_dwordx4 v228, s[32:35], s54 offen lds
    s_waitcnt lgkmcnt(8)
    v_mfma_f32_32x32x16_bf16 v[48:63], a[192:195], a[76:79], v[48:63]
    ds_read_b64_tr_b16 a[176:177], v9 offset:27648
    ds_read_b64_tr_b16 a[178:179], v9 offset:28160
    v_mfma_f32_32x32x16_bf16 v[64:79], a[196:199], a[76:79], v[64:79]
    ds_read_b64_tr_b16 a[180:181], v12 offset:27648
    ds_read_b64_tr_b16 a[182:183], v12 offset:28160
    buffer_load_dwordx4 a[120:123], v14, s[20:23], s65 offen offset:2048 sc1
    v_mfma_f32_32x32x16_bf16 v[48:63], a[200:203], a[80:83], v[48:63]
    s_barrier
    ds_read_b64_tr_b16 a[184:185], v9 offset:32768
    ds_read_b64_tr_b16 a[186:187], v9 offset:33280
    v_mfma_f32_32x32x16_bf16 v[64:79], a[204:207], a[80:83], v[64:79]
    ds_read_b64_tr_b16 a[188:189], v12 offset:32768
    ds_read_b64_tr_b16 a[190:191], v12 offset:33280
    s_waitcnt lgkmcnt(8)
    v_mfma_f32_32x32x16_bf16 v[48:63], a[160:163], a[84:87], v[48:63]
    ds_read_b64_tr_b16 a[192:193], v9 offset:33792
    ds_read_b64_tr_b16 a[194:195], v9 offset:34304
    v_mfma_f32_32x32x16_bf16 v[64:79], a[164:167], a[84:87], v[64:79]
    ds_read_b64_tr_b16 a[196:197], v12 offset:33792
    ds_read_b64_tr_b16 a[198:199], v12 offset:34304
    s_add_u32 m0, s98, 49152
    s_add_u32 s54, s42, 2
    s_and_b32 s54, s54, 3
    s_mul_i32 s54, s54, 165888
    s_add_u32 s54, s54, s48
    buffer_load_dwordx4 v224, s[32:35], s54 offen lds
    v_mfma_f32_32x32x16_bf16 v[48:63], a[168:171], a[88:91], v[48:63]
    ds_read_b64_tr_b16 a[200:201], v9 offset:34816
    ds_read_b64_tr_b16 a[202:203], v9 offset:35328
    buffer_load_dwordx4 a[124:127], v14, s[20:23], s65 offen offset:3072 sc1
    v_mfma_f32_32x32x16_bf16 v[64:79], a[172:175], a[88:91], v[64:79]
    ds_read_b64_tr_b16 a[204:205], v12 offset:34816
    ds_read_b64_tr_b16 a[206:207], v12 offset:35328
    s_waitcnt lgkmcnt(8)
    v_mfma_f32_32x32x16_bf16 v[48:63], a[176:179], a[92:95], v[48:63]
    ds_read_b64_tr_b16 a[160:161], v9 offset:35840
    ds_read_b64_tr_b16 a[162:163], v9 offset:36352
    v_mfma_f32_32x32x16_bf16 v[64:79], a[180:183], a[92:95], v[64:79]
    ds_read_b64_tr_b16 a[164:165], v12 offset:35840
    ds_read_b64_tr_b16 a[166:167], v12 offset:36352
    s_add_u32 m0, s98, 50176
    s_nop 0
    buffer_load_dwordx4 v225, s[32:35], s54 offen lds
    v_mfma_f32_32x32x16_bf16 v[112:127], a[184:187], a[0:3], 0
    ds_read_b64_tr_b16 a[168:169], v9 offset:40960
    ds_read_b64_tr_b16 a[170:171], v9 offset:41472
    ds_read_b64_tr_b16 a[172:173], v12 offset:40960
    v_mfma_f32_32x32x16_bf16 v[128:143], a[188:191], a[0:3], 0
    ds_read_b64_tr_b16 a[174:175], v12 offset:41472
    ds_read_b64_tr_b16 a[176:177], v9 offset:41984
    s_mul_i32 s56, s91, 1536
    s_add_u32 s56, s56, s93
    v_cvt_pk_bf16_f32 v96, v48, v49
    v_cvt_pk_bf16_f32 v97, v50, v51
    v_cvt_pk_bf16_f32 v98, v52, v53
    buffer_load_dwordx4 a[208:211], v14, s[20:23], s66 offen offset:0 sc1
    s_waitcnt lgkmcnt(9)
    v_mfma_f32_32x32x16_bf16 v[112:127], a[192:195], a[4:7], v[112:127]
    ds_read_b64_tr_b16 a[178:179], v9 offset:42496
    v_cvt_pk_bf16_f32 v99, v54, v55
    buffer_store_dwordx4 v[96:99], v14, s[20:23], s56 offen offset:0 sc1
    v_mfma_f32_32x32x16_bf16 v[128:143], a[196:199], a[4:7], v[128:143]
    ds_read_b64_tr_b16 a[180:181], v12 offset:41984
    ds_read_b64_tr_b16 a[182:183], v12 offset:42496
    ds_read_b64_tr_b16 a[184:185], v9 offset:43008
    v_cvt_pk_bf16_f32 v100, v56, v57
    v_cvt_pk_bf16_f32 v101, v58, v59
    v_mfma_f32_32x32x16_bf16 v[112:127], a[200:203], a[8:11], v[112:127]
    ds_read_b64_tr_b16 a[186:187], v9 offset:43520
    ds_read_b64_tr_b16 a[188:189], v12 offset:43008
    v_cvt_pk_bf16_f32 v102, v60, v61
    v_cvt_pk_bf16_f32 v103, v62, v63
    v_mfma_f32_32x32x16_bf16 v[128:143], a[204:207], a[8:11], v[128:143]
    ds_read_b64_tr_b16 a[190:191], v12 offset:43520
    buffer_store_dwordx4 v[100:103], v14, s[20:23], s56 offen offset:1024 sc1
    v_cvt_pk_bf16_f32 v104, v64, v65
    v_cvt_pk_bf16_f32 v105, v66, v67
    s_waitcnt lgkmcnt(8)
    v_mfma_f32_32x32x16_bf16 v[112:127], a[160:163], a[12:15], v[112:127]
    ds_read_b64_tr_b16 a[192:193], v9 offset:44032
    ds_read_b64_tr_b16 a[194:195], v9 offset:44544
    ds_read_b64_tr_b16 a[196:197], v12 offset:44032
    s_waitcnt vmcnt(12)
    v_mov_b32 v240, 7
    buffer_store_dword v240, v241, s[20:23], s62 offen sc1
    v_cvt_pk_bf16_f32 v106, v68, v69
    v_cvt_pk_bf16_f32 v107, v70, v71
    buffer_load_dwordx4 a[212:215], v14, s[20:23], s66 offen offset:1024 sc1
    v_mfma_f32_32x32x16_bf16 v[128:143], a[164:167], a[12:15], v[128:143]
    ds_read_b64_tr_b16 a[198:199], v12 offset:44544
    buffer_store_dwordx4 v[104:107], v14, s[20:23], s56 offen offset:2048 sc1
    v_cvt_pk_bf16_f32 v108, v72, v73
    v_mfma_f32_32x32x16_bf16 v[112:127], a[168:171], a[16:19], v[112:127]
    ds_read_b64_tr_b16 a[200:201], v9 offset:49152
    ds_read_b64_tr_b16 a[202:203], v9 offset:49664
    ds_read_b64_tr_b16 a[204:205], v12 offset:49152
    v_cvt_pk_bf16_f32 v109, v74, v75
    v_cvt_pk_bf16_f32 v110, v76, v77
    v_cvt_pk_bf16_f32 v111, v78, v79
    v_mfma_f32_32x32x16_bf16 v[128:143], a[172:175], a[16:19], v[128:143]
    ds_read_b64_tr_b16 a[206:207], v12 offset:49664
    buffer_store_dwordx4 v[108:111], v14, s[20:23], s56 offen offset:3072 sc1
    s_waitcnt lgkmcnt(8)
    v_mfma_f32_32x32x16_bf16 v[112:127], a[176:179], a[20:23], v[112:127]
    ds_read_b64_tr_b16 a[160:161], v9 offset:50176
    ds_read_b64_tr_b16 a[162:163], v9 offset:50688
    s_add_u32 m0, s98, 51200
    s_nop 0
    buffer_load_dwordx4 v226, s[32:35], s54 offen lds
    v_mfma_f32_32x32x16_bf16 v[128:143], a[180:183], a[20:23], v[128:143]
    ds_read_b64_tr_b16 a[164:165], v12 offset:50176
    ds_read_b64_tr_b16 a[166:167], v12 offset:50688
    buffer_load_dwordx4 a[216:219], v14, s[20:23], s66 offen offset:2048 sc1
    v_mfma_f32_32x32x16_bf16 v[112:127], a[184:187], a[24:27], v[112:127]
    ds_read_b64_tr_b16 a[168:169], v9 offset:51200
    ds_read_b64_tr_b16 a[170:171], v9 offset:51712
    s_add_u32 m0, s98, 52224
    s_nop 0
    buffer_load_dwordx4 v227, s[32:35], s54 offen lds
    v_mfma_f32_32x32x16_bf16 v[128:143], a[188:191], a[24:27], v[128:143]
    ds_read_b64_tr_b16 a[172:173], v12 offset:51200
    ds_read_b64_tr_b16 a[174:175], v12 offset:51712
    s_waitcnt lgkmcnt(8)
    v_mfma_f32_32x32x16_bf16 v[112:127], a[192:195], a[28:31], v[112:127]
    ds_read_b64_tr_b16 a[176:177], v9 offset:52224
    ds_read_b64_tr_b16 a[178:179], v9 offset:52736
    s_add_u32 m0, s98, 53248
    s_nop 0
    buffer_load_dwordx4 v228, s[32:35], s54 offen lds
    v_mfma_f32_32x32x16_bf16 v[128:143], a[196:199], a[28:31], v[128:143]
    ds_read_b64_tr_b16 a[180:181], v12 offset:52224
    ds_read_b64_tr_b16 a[182:183], v12 offset:52736
    v_mfma_f32_32x32x16_bf16 v[112:127], a[200:203], a[32:35], v[112:127]
    s_barrier
    ds_read_b64_tr_b16 a[184:185], v9 offset:57344
    ds_read_b64_tr_b16 a[186:187], v9 offset:57856
    buffer_load_dwordx4 a[220:223], v14, s[20:23], s66 offen offset:3072 sc1
    v_mfma_f32_32x32x16_bf16 v[128:143], a[204:207], a[32:35], v[128:143]
    ds_read_b64_tr_b16 a[188:189], v12 offset:57344
    ds_read_b64_tr_b16 a[190:191], v12 offset:57856
    s_waitcnt lgkmcnt(8)
    v_mfma_f32_32x32x16_bf16 v[112:127], a[160:163], a[36:39], v[112:127]
    ds_read_b64_tr_b16 a[192:193], v9 offset:58368
    ds_read_b64_tr_b16 a[194:195], v9 offset:58880
    v_mfma_f32_32x32x16_bf16 v[128:143], a[164:167], a[36:39], v[128:143]
    ds_read_b64_tr_b16 a[196:197], v12 offset:58368
    ds_read_b64_tr_b16 a[198:199], v12 offset:58880
    s_add_u32 m0, s98, 73728
    s_add_u32 s54, s42, 3
    s_and_b32 s54, s54, 3
    s_mul_i32 s54, s54, 165888
    s_add_u32 s54, s54, s48
    buffer_load_dwordx4 v224, s[32:35], s54 offen lds
    v_mfma_f32_32x32x16_bf16 v[112:127], a[168:171], a[40:43], v[112:127]
    ds_read_b64_tr_b16 a[200:201], v9 offset:59392
    ds_read_b64_tr_b16 a[202:203], v9 offset:59904
    v_mfma_f32_32x32x16_bf16 v[128:143], a[172:175], a[40:43], v[128:143]
    ds_read_b64_tr_b16 a[204:205], v12 offset:59392
    ds_read_b64_tr_b16 a[206:207], v12 offset:59904
    buffer_load_dwordx4 a[128:131], v14, s[20:23], s67 offen offset:0 sc1
    s_waitcnt lgkmcnt(8)
    v_mfma_f32_32x32x16_bf16 v[112:127], a[176:179], a[44:47], v[112:127]
    ds_read_b64_tr_b16 a[160:161], v9 offset:60416
    ds_read_b64_tr_b16 a[162:163], v9 offset:60928
    v_mfma_f32_32x32x16_bf16 v[128:143], a[180:183], a[44:47], v[128:143]
    ds_read_b64_tr_b16 a[164:165], v12 offset:60416
    ds_read_b64_tr_b16 a[166:167], v12 offset:60928
    s_add_u32 m0, s98, 74752
    s_nop 0
    buffer_load_dwordx4 v225, s[32:35], s54 offen lds
    v_mfma_f32_32x32x16_bf16 v[112:127], a[184:187], a[48:51], v[112:127]
    ds_read_b64_tr_b16 a[168:169], v10 offset:0
    ds_read_b64_tr_b16 a[170:171], v10 offset:512
    buffer_load_dword v238, v236, s[20:23], s97 offen sc1
    v_mfma_f32_32x32x16_bf16 v[128:143], a[188:191], a[48:51], v[128:143]
    ds_read_b64_tr_b16 a[172:173], v13 offset:0
    ds_read_b64_tr_b16 a[174:175], v13 offset:512
    s_waitcnt lgkmcnt(8)
    v_mfma_f32_32x32x16_bf16 v[112:127], a[192:195], a[52:55], v[112:127]
    ds_read_b64_tr_b16 a[176:177], v10 offset:1024
    ds_read_b64_tr_b16 a[178:179], v10 offset:1536
    buffer_load_dwordx4 a[132:135], v14, s[20:23], s67 offen offset:1024 sc1
    v_mfma_f32_32x32x16_bf16 v[128:143], a[196:199], a[52:55], v[128:143]
    ds_read_b64_tr_b16 a[180:181], v13 offset:1024
    ds_read_b64_tr_b16 a[182:183], v13 offset:1536
    s_add_u32 m0, s98, 75776
    s_nop 0
    buffer_load_dwordx4 v226, s[32:35], s54 offen lds
    v_mfma_f32_32x32x16_bf16 v[112:127], a[200:203], a[56:59], v[112:127]
    ds_read_b64_tr_b16 a[184:185], v10 offset:2048
    ds_read_b64_tr_b16 a[186:187], v10 offset:2560
    v_mfma_f32_32x32x16_bf16 v[128:143], a[204:207], a[56:59], v[128:143]
    ds_read_b64_tr_b16 a[188:189], v13 offset:2048
    ds_read_b64_tr_b16 a[190:191], v13 offset:2560
    s_waitcnt lgkmcnt(8)
    v_mfma_f32_32x32x16_bf16 v[112:127], a[160:163], a[60:63], v[112:127]
    ds_read_b64_tr_b16 a[192:193], v10 offset:3072
    ds_read_b64_tr_b16 a[194:195], v10 offset:3584
    v_mfma_f32_32x32x16_bf16 v[128:143], a[164:167], a[60:63], v[128:143]
    ds_read_b64_tr_b16 a[196:197], v13 offset:3072
    ds_read_b64_tr_b16 a[198:199], v13 offset:3584
    s_add_u32 m0, s98, 76800
    s_nop 0
    buffer_load_dwordx4 v227, s[32:35], s54 offen lds
    buffer_load_dwordx4 a[136:139], v14, s[20:23], s67 offen offset:2048 sc1
    v_mfma_f32_32x32x16_bf16 v[112:127], a[168:171], a[64:67], v[112:127]
    ds_read_b64_tr_b16 a[200:201], v10 offset:8192
    ds_read_b64_tr_b16 a[202:203], v10 offset:8704
    v_mfma_f32_32x32x16_bf16 v[128:143], a[172:175], a[64:67], v[128:143]
    ds_read_b64_tr_b16 a[204:205], v13 offset:8192
    ds_read_b64_tr_b16 a[206:207], v13 offset:8704
    s_waitcnt lgkmcnt(8)
    v_mfma_f32_32x32x16_bf16 v[112:127], a[176:179], a[68:71], v[112:127]
    ds_read_b64_tr_b16 a[160:161], v10 offset:9216
    ds_read_b64_tr_b16 a[162:163], v10 offset:9728
    s_waitcnt vmcnt(13)
    v_mov_b32 v240, 8
    buffer_store_dword v240, v241, s[20:23], s62 offen sc1
    v_mfma_f32_32x32x16_bf16 v[128:143], a[180:183], a[68:71], v[128:143]
    ds_read_b64_tr_b16 a[164:165], v13 offset:9216
    ds_read_b64_tr_b16 a[166:167], v13 offset:9728
    s_add_u32 m0, s98, 77824
    s_nop 0
    buffer_load_dwordx4 v228, s[32:35], s54 offen lds
    v_mfma_f32_32x32x16_bf16 v[112:127], a[184:187], a[72:75], v[112:127]
    ds_read_b64_tr_b16 a[168:169], v10 offset:10240
    ds_read_b64_tr_b16 a[170:171], v10 offset:10752
    buffer_load_dwordx4 a[140:143], v14, s[20:23], s67 offen offset:3072 sc1
    v_mfma_f32_32x32x16_bf16 v[128:143], a[188:191], a[72:75], v[128:143]
    ds_read_b64_tr_b16 a[172:173], v13 offset:10240
    ds_read_b64_tr_b16 a[174:175], v13 offset:10752
    s_waitcnt lgkmcnt(8)
    v_mfma_f32_32x32x16_bf16 v[112:127], a[192:195], a[76:79], v[112:127]
    ds_read_b64_tr_b16 a[176:177], v10 offset:11264
    ds_read_b64_tr_b16 a[178:179], v10 offset:11776
    v_mfma_f32_32x32x16_bf16 v[128:143], a[196:199], a[76:79], v[128:143]
    ds_read_b64_tr_b16 a[180:181], v13 offset:11264
    ds_read_b64_tr_b16 a[182:183], v13 offset:11776
    v_mfma_f32_32x32x16_bf16 v[112:127], a[200:203], a[80:83], v[112:127]
    v_mfma_f32_32x32x16_bf16 v[128:143], a[204:207], a[80:83], v[128:143]
    s_waitcnt lgkmcnt(4)
    v_mfma_f32_32x32x16_bf16 v[112:127], a[160:163], a[84:87], v[112:127]
    v_mfma_f32_32x32x16_bf16 v[128:143], a[164:167], a[84:87], v[128:143]
    v_mfma_f32_32x32x16_bf16 v[112:127], a[168:171], a[88:91], v[112:127]
    v_mfma_f32_32x32x16_bf16 v[128:143], a[172:175], a[88:91], v[128:143]
    s_waitcnt lgkmcnt(0)
    v_mfma_f32_32x32x16_bf16 v[112:127], a[176:179], a[92:95], v[112:127]
    v_mfma_f32_32x32x16_bf16 v[128:143], a[180:183], a[92:95], v[128:143]
    s_cmp_lt_u32 s72, 9
    s_cbranch_scc0 L_nonowner
    s_waitcnt vmcnt(7)
    v_cmp_ge_u32 vcc, v238, v237
    s_nop 1
    s_and_b32 s50, vcc_lo, s78
    s_cmp_eq_u32 s50, s78
    s_cbranch_scc0 L_sp2
L_ok2:
    buffer_load_dwordx4 a[0:3], v14, s[20:23], s68 offen offset:0 sc1
    buffer_load_dwordx4 a[4:7], v14, s[20:23], s68 offen offset:1024 sc1
    buffer_load_dwordx4 a[8:11], v14, s[20:23], s68 offen offset:2048 sc1
    buffer_load_dwordx4 a[12:15], v14, s[20:23], s68 offen offset:3072 sc1
    buffer_load_dword v238, v236, s[20:23], s97 offen sc1
    v_mfma_f32_32x32x16_bf16 v[112:127], a[232:235], a[96:99], v[112:127]
    v_mfma_f32_32x32x16_bf16 v[112:127], a[236:239], a[100:103], v[112:127]
    v_mfma_f32_32x32x16_bf16 v[128:143], a[232:235], a[104:107], v[128:143]
    v_mfma_f32_32x32x16_bf16 v[128:143], a[236:239], a[108:111], v[128:143]
    s_waitcnt vmcnt(0)
    v_cmp_ge_u32 vcc, v238, v237
    s_nop 1
    s_and_b32 s50, vcc_lo, 61440
    s_cmp_eq_u32 s50, 61440
    s_cbranch_scc0 L_sp3
L_ok3:
    s_add_u32 s53, s42, 0
    s_and_b32 s53, s53, 3
    s_mul_i32 s53, s53, 9216
    s_add_u32 s53, s53, s73
    buffer_load_dwordx4 v[192:195], v14, s[20:23], s53 offen offset:0 sc1
    buffer_load_dwordx4 v[196:199], v14, s[20:23], s53 offen offset:1024 sc1
    buffer_load_dwordx4 v[200:203], v14, s[20:23], s53 offen offset:2048 sc1
    buffer_load_dwordx4 v[204:207], v14, s[20:23], s53 offen offset:3072 sc1
    s_add_u32 s53, s53, 4096
    buffer_load_dwordx4 v[208:211], v14, s[20:23], s53 offen offset:0 sc1
    buffer_load_dwordx4 v[212:215], v14, s[20:23], s53 offen offset:1024 sc1
    buffer_load_dwordx4 v[216:219], v14, s[20:23], s53 offen offset:2048 sc1
    buffer_load_dwordx4 v[220:223], v14, s[20:23], s53 offen offset:3072 sc1
    s_add_u32 s53, s53, 4096
    buffer_load_dwordx4 v[144:147], v14, s[20:23], s53 offen offset:0 sc1
    s_add_u32 s53, s42, 1
    s_and_b32 s53, s53, 3
    s_mul_i32 s53, s53, 9216
    s_add_u32 s53, s53, s73
    buffer_load_dwordx4 v[148:151], v14, s[20:23], s53 offen offset:0 sc1
    v_mfma_f32_32x32x16_bf16 v[112:127], a[232:235], a[112:115], v[112:127]
    v_mfma_f32_32x32x16_bf16 v[112:127], a[236:239], a[116:119], v[112:127]
    v_mfma_f32_32x32x16_bf16 v[128:143], a[232:235], a[120:123], v[128:143]
    v_mfma_f32_32x32x16_bf16 v[128:143], a[236:239], a[124:127], v[128:143]
    v_mfma_f32_32x32x16_bf16 v[112:127], a[232:235], a[208:211], v[112:127]
    v_mfma_f32_32x32x16_bf16 v[112:127], a[236:239], a[212:215], v[112:127]
    v_mfma_f32_32x32x16_bf16 v[128:143], a[232:235], a[216:219], v[128:143]
    v_mfma_f32_32x32x16_bf16 v[128:143], a[236:239], a[220:223], v[128:143]
    v_mfma_f32_32x32x16_bf16 v[112:127], a[232:235], a[128:131], v[112:127]
    v_mfma_f32_32x32x16_bf16 v[112:127], a[236:239], a[132:135], v[112:127]
    v_mfma_f32_32x32x16_bf16 v[128:143], a[232:235], a[136:139], v[128:143]
    v_mfma_f32_32x32x16_bf16 v[128:143], a[236:239], a[140:143], v[128:143]
    v_mfma_f32_32x32x16_bf16 v[112:127], a[232:235], a[0:3], v[112:127]
    v_mfma_f32_32x32x16_bf16 v[112:127], a[236:239], a[4:7], v[112:127]
    v_mfma_f32_32x32x16_bf16 v[128:143], a[232:235], a[8:11], v[128:143]
    v_mfma_f32_32x32x16_bf16 v[128:143], a[236:239], a[12:15], v[128:143]
    s_barrier
    ds_read_b64_tr_b16 a[160:161], v229 offset:0
    ds_read_b64_tr_b16 a[162:163], v229 offset:512
    ds_read_b64_tr_b16 a[164:165], v232 offset:0
    ds_read_b64_tr_b16 a[166:167], v232 offset:512
    ds_read_b64_tr_b16 a[168:169], v229 offset:1024
    ds_read_b64_tr_b16 a[170:171], v229 offset:1536
    ds_read_b64_tr_b16 a[172:173], v232 offset:1024
    ds_read_b64_tr_b16 a[174:175], v232 offset:1536
    ds_read_b64_tr_b16 a[176:177], v229 offset:2048
    ds_read_b64_tr_b16 a[178:179], v229 offset:2560
    ds_read_b64_tr_b16 a[180:181], v232 offset:2048
    ds_read_b64_tr_b16 a[182:183], v232 offset:2560
    ds_read_b64_tr_b16 a[184:185], v229 offset:3072
    ds_read_b64_tr_b16 a[186:187], v229 offset:3584
    ds_read_b64_tr_b16 a[188:189], v232 offset:3072
    ds_read_b64_tr_b16 a[190:191], v232 offset:3584
    s_waitcnt lgkmcnt(8)
    s_waitcnt vmcnt(9)
    v_mfma_f32_32x32x16_bf16 v[160:175], a[160:163], v[192:195], 0
    ds_read_b64_tr_b16 a[192:193], v229 offset:4096
    ds_read_b64_tr_b16 a[194:195], v229 offset:4608
    buffer_load_dwordx4 v[152:155], v14, s[20:23], s53 offen offset:1024 sc1
    v_mfma_f32_32x32x16_bf16 v[176:191], a[164:167], v[192:195], 0
    ds_read_b64_tr_b16 a[196:197], v232 offset:4096
    ds_read_b64_tr_b16 a[198:199], v232 offset:4608
    s_waitcnt vmcnt(9)
    v_mfma_f32_32x32x16_bf16 v[160:175], a[168:171], v[196:199], v[160:175]
    ds_read_b64_tr_b16 a[200:201], v229 offset:5120
    ds_read_b64_tr_b16 a[202:203], v229 offset:5632
    buffer_load_dwordx4 v[156:159], v14, s[20:23], s53 offen offset:2048 sc1
    v_mfma_f32_32x32x16_bf16 v[176:191], a[172:175], v[196:199], v[176:191]
    ds_read_b64_tr_b16 a[204:205], v232 offset:5120
    ds_read_b64_tr_b16 a[206:207], v232 offset:5632
    s_waitcnt lgkmcnt(8)
    s_waitcnt vmcnt(9)
    v_mfma_f32_32x32x16_bf16 v[160:175], a[176:179], v[200:203], v[160:175]
    ds_read_b64_tr_b16 a[160:161], v229 offset:6144
    ds_read_b64_tr_b16 a[162:163], v229 offset:6656
    buffer_load_dwordx4 v[16:19], v14, s[20:23], s53 offen offset:3072 sc1
    v_mfma_f32_32x32x16_bf16 v[176:191], a[180:183], v[200:203], v[176:191]
    ds_read_b64_tr_b16 a[164:165], v232 offset:6144
    ds_read_b64_tr_b16 a[166:167], v232 offset:6656
    s_waitcnt vmcnt(9)
    v_mfma_f32_32x32x16_bf16 v[160:175], a[184:187], v[204:207], v[160:175]
    ds_read_b64_tr_b16 a[168:169], v229 offset:7168
    ds_read_b64_tr_b16 a[170:171], v229 offset:7680
    s_add_u32 s53, s53, 4096
    buffer_load_dwordx4 v[20:23], v14, s[20:23], s53 offen offset:0 sc1
    v_mfma_f32_32x32x16_bf16 v[176:191], a[188:191], v[204:207], v[176:191]
    ds_read_b64_tr_b16 a[172:173], v232 offset:7168
    ds_read_b64_tr_b16 a[174:175], v232 offset:7680
    s_waitcnt lgkmcnt(8)
    s_waitcnt vmcnt(9)
    v_mfma_f32_32x32x16_bf16 v[160:175], a[192:195], v[208:211], v[160:175]
    ds_read_b64_tr_b16 a[176:177], v229 offset:8192
    ds_read_b64_tr_b16 a[178:179], v229 offset:8704
    buffer_load_dwordx4 v[24:27], v14, s[20:23], s53 offen offset:1024 sc1
    v_mfma_f32_32x32x16_bf16 v[176:191], a[196:199], v[208:211], v[176:191]
    ds_read_b64_tr_b16 a[180:181], v232 offset:8192
    ds_read_b64_tr_b16 a[182:183], v232 offset:8704
    s_waitcnt vmcnt(9)
    v_mfma_f32_32x32x16_bf16 v[160:175], a[200:203], v[212:215], v[160:175]
    s_barrier
    ds_read_b64_tr_b16 a[184:185], v229 offset:24576
    ds_read_b64_tr_b16 a[186:187], v229 offset:25088
    buffer_load_dwordx4 v[28:31], v14, s[20:23], s53 offen offset:2048 sc1
    v_mfma_f32_32x32x16_bf16 v[176:191], a[204:207], v[212:215], v[176:191]
    ds_read_b64_tr_b16 a[188:189], v232 offset:24576
    ds_read_b64_tr_b16 a[190:191], v232 offset:25088
    s_waitcnt lgkmcnt(8)
    s_waitcnt vmcnt(9)
    v_mfma_f32_32x32x16_bf16 v[160:175], a[160:163], v[216:219], v[160:175]
    ds_read_b64_tr_b16 a[192:193], v229 offset:25600
    ds_read_b64_tr_b16 a[194:195], v229 offset:26112
    buffer_load_dwordx4 v[32:35], v14, s[20:23], s53 offen offset:3072 sc1
    v_mfma_f32_32x32x16_bf16 v[176:191], a[164:167], v[216:219], v[176:191]
    ds_read_b64_tr_b16 a[196:197], v232 offset:25600
    ds_read_b64_tr_b16 a[198:199], v232 offset:26112
    s_waitcnt vmcnt(9)
    v_mfma_f32_32x32x16_bf16 v[160:175], a[168:171], v[220:223], v[160:175]
    ds_read_b64_tr_b16 a[200:201], v229 offset:26624
    ds_read_b64_tr_b16 a[202:203], v229 offset:27136
    s_add_u32 s53, s53, 4096
    buffer_load_dwordx4 v[36:39], v14, s[20:23], s53 offen offset:0 sc1
    v_mfma_f32_32x32x16_bf16 v[176:191], a[172:175], v[220:223], v[176:191]
    ds_read_b64_tr_b16 a[204:205], v232 offset:26624
    ds_read_b64_tr_b16 a[206:207], v232 offset:27136
    s_waitcnt lgkmcnt(8)
    s_waitcnt vmcnt(9)
    v_mfma_f32_32x32x16_bf16 v[160:175], a[176:179], v[144:147], v[160:175]
    ds_read_b64_tr_b16 a[160:161], v229 offset:27648
    ds_read_b64_tr_b16 a[162:163], v229 offset:28160
    s_add_u32 s53, s42, 2
    s_and_b32 s53, s53, 3
    s_mul_i32 s53, s53, 9216
    s_add_u32 s53, s53, s73
    buffer_load_dwordx4 v[40:43], v14, s[20:23], s53 offen offset:0 sc1
    v_mfma_f32_32x32x16_bf16 v[176:191], a[180:183], v[144:147], v[176:191]
    ds_read_b64_tr_b16 a[164:165], v232 offset:27648
    ds_read_b64_tr_b16 a[166:167], v232 offset:28160
    s_waitcnt vmcnt(9)
    v_mfma_f32_32x32x16_bf16 v[160:175], a[184:187], v[148:151], v[160:175]
    ds_read_b64_tr_b16 a[168:169], v229 offset:28672
    ds_read_b64_tr_b16 a[170:171], v229 offset:29184
    buffer_load_dwordx4 v[44:47], v14, s[20:23], s53 offen offset:1024 sc1
    v_mfma_f32_32x32x16_bf16 v[176:191], a[188:191], v[148:151], v[176:191]
    ds_read_b64_tr_b16 a[172:173], v232 offset:28672
    ds_read_b64_tr_b16 a[174:175], v232 offset:29184
    s_waitcnt lgkmcnt(8)
    s_waitcnt vmcnt(9)
    v_mfma_f32_32x32x16_bf16 v[160:175], a[192:195], v[152:155], v[160:175]
    ds_read_b64_tr_b16 a[176:177], v229 offset:29696
    ds_read_b64_tr_b16 a[178:179], v229 offset:30208
    buffer_load_dwordx4 v[48:51], v14, s[20:23], s53 offen offset:2048 sc1
    v_mfma_f32_32x32x16_bf16 v[176:191], a[196:199], v[152:155], v[176:191]
    ds_read_b64_tr_b16 a[180:181], v232 offset:29696
    ds_read_b64_tr_b16 a[182:183], v232 offset:30208
    s_waitcnt vmcnt(9)
    v_mfma_f32_32x32x16_bf16 v[160:175], a[200:203], v[156:159], v[160:175]
    ds_read_b64_tr_b16 a[184:185], v229 offset:30720
    ds_read_b64_tr_b16 a[186:187], v229 offset:31232
    buffer_load_dwordx4 v[52:55], v14, s[20:23], s53 offen offset:3072 sc1
    v_mfma_f32_32x32x16_bf16 v[176:191], a[204:207], v[156:159], v[176:191]
    ds_read_b64_tr_b16 a[188:189], v232 offset:30720
    ds_read_b64_tr_b16 a[190:191], v232 offset:31232
    s_waitcnt lgkmcnt(8)
    s_waitcnt vmcnt(9)
    v_mfma_f32_32x32x16_bf16 v[160:175], a[160:163], v[16:19], v[160:175]
    ds_read_b64_tr_b16 a[192:193], v229 offset:31744
    ds_read_b64_tr_b16 a[194:195], v229 offset:32256
    s_add_u32 s53, s53, 4096
    buffer_load_dwordx4 v[56:59], v14, s[20:23], s53 offen offset:0 sc1
    v_mfma_f32_32x32x16_bf16 v[176:191], a[164:167], v[16:19], v[176:191]
    ds_read_b64_tr_b16 a[196:197], v232 offset:31744
    ds_read_b64_tr_b16 a[198:199], v232 offset:32256
    s_waitcnt vmcnt(9)
    v_mfma_f32_32x32x16_bf16 v[160:175], a[168:171], v[20:23], v[160:175]
    ds_read_b64_tr_b16 a[200:201], v229 offset:32768
    ds_read_b64_tr_b16 a[202:203], v229 offset:33280
    buffer_load_dwordx4 v[60:63], v14, s[20:23], s53 offen offset:1024 sc1
    v_mfma_f32_32x32x16_bf16 v[176:191], a[172:175], v[20:23], v[176:191]
    ds_read_b64_tr_b16 a[204:205], v232 offset:32768
    ds_read_b64_tr_b16 a[206:207], v232 offset:33280
    s_waitcnt lgkmcnt(8)
    s_waitcnt vmcnt(9)
    v_mfma_f32_32x32x16_bf16 v[160:175], a[176:179], v[24:27], v[160:175]
    s_barrier
    ds_read_b64_tr_b16 a[160:161], v229 offset:49152
    ds_read_b64_tr_b16 a[162:163], v229 offset:49664
    buffer_load_dwordx4 v[64:67], v14, s[20:23], s53 offen offset:2048 sc1
    v_mfma_f32_32x32x16_bf16 v[176:191], a[180:183], v[24:27], v[176:191]
    ds_read_b64_tr_b16 a[164:165], v232 offset:49152
    ds_read_b64_tr_b16 a[166:167], v232 offset:49664
    s_waitcnt vmcnt(9)
    v_mfma_f32_32x32x16_bf16 v[160:175], a[184:187], v[28:31], v[160:175]
    ds_read_b64_tr_b16 a[168:169], v229 offset:50176
    ds_read_b64_tr_b16 a[170:171], v229 offset:50688
    buffer_load_dwordx4 v[68:71], v14, s[20:23], s53 offen offset:3072 sc1
    v_mfma_f32_32x32x16_bf16 v[176:191], a[188:191], v[28:31], v[176:191]
    ds_read_b64_tr_b16 a[172:173], v232 offset:50176
    ds_read_b64_tr_b16 a[174:175], v232 offset:50688
    s_waitcnt lgkmcnt(8)
    s_waitcnt vmcnt(9)
    v_mfma_f32_32x32x16_bf16 v[160:175], a[192:195], v[32:35], v[160:175]
    ds_read_b64_tr_b16 a[176:177], v229 offset:51200
    ds_read_b64_tr_b16 a[178:179], v229 offset:51712
    s_add_u32 s53, s53, 4096
    buffer_load_dwordx4 v[72:75], v14, s[20:23], s53 offen offset:0 sc1
    v_mfma_f32_32x32x16_bf16 v[176:191], a[196:199], v[32:35], v[176:191]
    ds_read_b64_tr_b16 a[180:181], v232 offset:51200
    ds_read_b64_tr_b16 a[182:183], v232 offset:51712
    s_waitcnt vmcnt(9)
    v_mfma_f32_32x32x16_bf16 v[160:175], a[200:203], v[36:39], v[160:175]
    ds_read_b64_tr_b16 a[184:185], v229 offset:52224
    ds_read_b64_tr_b16 a[186:187], v229 offset:52736
    s_add_u32 s53, s42, 3
    s_and_b32 s53, s53, 3
    s_mul_i32 s53, s53, 9216
    s_add_u32 s53, s53, s73
    buffer_load_dwordx4 v[76:79], v14, s[20:23], s53 offen offset:0 sc1
    v_mfma_f32_32x32x16_bf16 v[176:191], a[204:207], v[36:39], v[176:191]
    ds_read_b64_tr_b16 a[188:189], v232 offset:52224
    ds_read_b64_tr_b16 a[190:191], v232 offset:52736
    s_waitcnt lgkmcnt(8)
    s_waitcnt vmcnt(9)
    v_mfma_f32_32x32x16_bf16 v[160:175], a[160:163], v[40:43], v[160:175]
    ds_read_b64_tr_b16 a[192:193], v229 offset:53248
    ds_read_b64_tr_b16 a[194:195], v229 offset:53760
    buffer_load_dwordx4 v[80:83], v14, s[20:23], s53 offen offset:1024 sc1
    v_mfma_f32_32x32x16_bf16 v[176:191], a[164:167], v[40:43], v[176:191]
    ds_read_b64_tr_b16 a[196:197], v232 offset:53248
    ds_read_b64_tr_b16 a[198:199], v232 offset:53760
    s_waitcnt vmcnt(9)
    v_mfma_f32_32x32x16_bf16 v[160:175], a[168:171], v[44:47], v[160:175]
    ds_read_b64_tr_b16 a[200:201], v229 offset:54272
    ds_read_b64_tr_b16 a[202:203], v229 offset:54784
    buffer_load_dwordx4 v[84:87], v14, s[20:23], s53 offen offset:2048 sc1
    buffer_load_dword v238, v236, s[20:23], s97 offen sc1
    v_mfma_f32_32x32x16_bf16 v[176:191], a[172:175], v[44:47], v[176:191]
    ds_read_b64_tr_b16 a[204:205], v232 offset:54272
    ds_read_b64_tr_b16 a[206:207], v232 offset:54784
    s_waitcnt lgkmcnt(8)
    s_waitcnt vmcnt(10)
    v_mfma_f32_32x32x16_bf16 v[160:175], a[176:179], v[48:51], v[160:175]
    ds_read_b64_tr_b16 a[160:161], v229 offset:55296
    ds_read_b64_tr_b16 a[162:163], v229 offset:55808
    buffer_load_dwordx4 v[88:91], v14, s[20:23], s53 offen offset:3072 sc1
    v_accvgpr_read_b32 v224, a224
    v_mfma_f32_32x32x16_bf16 v[176:191], a[180:183], v[48:51], v[176:191]
    ds_read_b64_tr_b16 a[164:165], v232 offset:55296
    ds_read_b64_tr_b16 a[166:167], v232 offset:55808
    v_lshlrev_b32 v192, 16, v224
    v_and_b32 v193, s46, v224
    s_waitcnt vmcnt(10)
    v_mfma_f32_32x32x16_bf16 v[160:175], a[184:187], v[52:55], v[160:175]
    ds_read_b64_tr_b16 a[168:169], v229 offset:56320
    ds_read_b64_tr_b16 a[170:171], v229 offset:56832
    s_add_u32 s53, s53, 4096
    buffer_load_dwordx4 v[92:95], v14, s[20:23], s53 offen offset:0 sc1
    v_accvgpr_read_b32 v225, a225
    v_mfma_f32_32x32x16_bf16 v[176:191], a[188:191], v[52:55], v[176:191]
    ds_read_b64_tr_b16 a[172:173], v232 offset:56320
    ds_read_b64_tr_b16 a[174:175], v232 offset:56832
    v_lshlrev_b32 v194, 16, v225
    v_and_b32 v195, s46, v225
    s_waitcnt lgkmcnt(8)
    s_waitcnt vmcnt(10)
    v_mfma_f32_32x32x16_bf16 v[160:175], a[192:195], v[56:59], v[160:175]
    ds_read_b64_tr_b16 a[176:177], v229 offset:57344
    ds_read_b64_tr_b16 a[178:179], v229 offset:57856
    buffer_load_dwordx4 v[96:99], v14, s[20:23], s53 offen offset:1024 sc1
    v_accvgpr_read_b32 v224, a226
    v_mfma_f32_32x32x16_bf16 v[176:191], a[196:199], v[56:59], v[176:191]
    ds_read_b64_tr_b16 a[180:181], v232 offset:57344
    ds_read_b64_tr_b16 a[182:183], v232 offset:57856
    v_lshlrev_b32 v196, 16, v224
    v_and_b32 v197, s46, v224
    s_waitcnt vmcnt(10)
    v_mfma_f32_32x32x16_bf16 v[160:175], a[200:203], v[60:63], v[160:175]
    s_barrier
    ds_read_b64_tr_b16 a[184:185], v230 offset:8192
    ds_read_b64_tr_b16 a[186:187], v230 offset:8704
    buffer_load_dwordx4 v[100:103], v14, s[20:23], s53 offen offset:2048 sc1
    v_accvgpr_read_b32 v225, a227
    v_mfma_f32_32x32x16_bf16 v[176:191], a[204:207], v[60:63], v[176:191]
    ds_read_b64_tr_b16 a[188:189], v233 offset:8192
    ds_read_b64_tr_b16 a[190:191], v233 offset:8704
    v_lshlrev_b32 v198, 16, v225
    v_and_b32 v199, s46, v225
    s_waitcnt lgkmcnt(8)
    s_waitcnt vmcnt(10)
    v_mfma_f32_32x32x16_bf16 v[160:175], a[160:163], v[64:67], v[160:175]
    ds_read_b64_tr_b16 a[192:193], v230 offset:9216
    ds_read_b64_tr_b16 a[194:195], v230 offset:9728
    buffer_load_dwordx4 v[104:107], v14, s[20:23], s53 offen offset:3072 sc1
    v_accvgpr_read_b32 v224, a228
    v_mfma_f32_32x32x16_bf16 v[176:191], a[164:167], v[64:67], v[176:191]
    ds_read_b64_tr_b16 a[196:197], v233 offset:9216
    ds_read_b64_tr_b16 a[198:199], v233 offset:9728
    v_lshlrev_b32 v200, 16, v224
    v_and_b32 v201, s46, v224
    s_waitcnt vmcnt(10)
    v_mfma_f32_32x32x16_bf16 v[160:175], a[168:171], v[68:71], v[160:175]
    ds_read_b64_tr_b16 a[200:201], v230 offset:10240
    ds_read_b64_tr_b16 a[202:203], v230 offset:10752
    s_add_u32 s53, s53, 4096
    buffer_load_dwordx4 v[108:111], v14, s[20:23], s53 offen offset:0 sc1
    v_accvgpr_read_b32 v225, a229
    v_mfma_f32_32x32x16_bf16 v[176:191], a[172:175], v[68:71], v[176:191]
    ds_read_b64_tr_b16 a[204:205], v233 offset:10240
    ds_read_b64_tr_b16 a[206:207], v233 offset:10752
    buffer_load_dwordx4 a[16:19], v14, s[20:23], s69 offen offset:0 sc1
    buffer_load_dwordx4 a[20:23], v14, s[20:23], s69 offen offset:1024 sc1
    buffer_load_dwordx4 a[24:27], v14, s[20:23], s69 offen offset:2048 sc1
    buffer_load_dwordx4 a[28:31], v14, s[20:23], s69 offen offset:3072 sc1
    v_lshlrev_b32 v202, 16, v225
    v_and_b32 v203, s46, v225
    s_waitcnt lgkmcnt(8)
    s_waitcnt vmcnt(14)
    v_mfma_f32_32x32x16_bf16 v[160:175], a[176:179], v[72:75], v[160:175]
    ds_read_b64_tr_b16 a[160:161], v230 offset:11264
    ds_read_b64_tr_b16 a[162:163], v230 offset:11776
    buffer_load_dwordx4 a[32:35], v14, s[20:23], s70 offen offset:0 sc1
    buffer_load_dwordx4 a[36:39], v14, s[20:23], s70 offen offset:1024 sc1
    buffer_load_dwordx4 a[40:43], v14, s[20:23], s70 offen offset:2048 sc1
    buffer_load_dwordx4 a[44:47], v14, s[20:23], s70 offen offset:3072 sc1
    v_accvgpr_read_b32 v224, a230
    v_mfma_f32_32x32x16_bf16 v[176:191], a[180:183], v[72:75], v[176:191]
    ds_read_b64_tr_b16 a[164:165], v233 offset:11264
    ds_read_b64_tr_b16 a[166:167], v233 offset:11776
    buffer_load_dwordx4 a[48:51], v14, s[20:23], s71 offen offset:0 sc1
    buffer_load_dwordx4 a[52:55], v14, s[20:23], s71 offen offset:1024 sc1
    buffer_load_dwordx4 a[56:59], v14, s[20:23], s71 offen offset:2048 sc1
    buffer_load_dwordx4 a[60:63], v14, s[20:23], s71 offen offset:3072 sc1
    v_lshlrev_b32 v204, 16, v224
    v_and_b32 v205, s46, v224
    s_waitcnt vmcnt(21)
    v_mfma_f32_32x32x16_bf16 v[160:175], a[184:187], v[76:79], v[160:175]
    ds_read_b64_tr_b16 a[168:169], v230 offset:12288
    ds_read_b64_tr_b16 a[170:171], v230 offset:12800
    buffer_load_dwordx4 a[64:67], v14, s[20:23], s75 offen offset:0 sc1
    buffer_load_dwordx4 a[68:71], v14, s[20:23], s75 offen offset:1024 sc1
    buffer_load_dwordx4 a[72:75], v14, s[20:23], s75 offen offset:2048 sc1
    buffer_load_dwordx4 a[76:79], v14, s[20:23], s75 offen offset:3072 sc1
    v_accvgpr_read_b32 v225, a231
    v_mfma_f32_32x32x16_bf16 v[176:191], a[188:191], v[76:79], v[176:191]
    ds_read_b64_tr_b16 a[172:173], v233 offset:12288
    ds_read_b64_tr_b16 a[174:175], v233 offset:12800
    s_waitcnt vmcnt(22)
    v_cmp_ge_u32 vcc, v238, v237
    s_nop 1
    s_and_b32 s50, vcc_lo, s79
    s_cmp_eq_u32 s50, s79
    s_cbranch_scc0 L_sp4
L_ok4:
    v_lshlrev_b32 v206, 16, v225
    v_and_b32 v207, s46, v225
    s_waitcnt lgkmcnt(8)
    v_mfma_f32_32x32x16_bf16 v[160:175], a[192:195], v[80:83], v[160:175]
    ds_read_b64_tr_b16 a[176:177], v230 offset:13312
    ds_read_b64_tr_b16 a[178:179], v230 offset:13824
    buffer_load_dwordx4 a[80:83], v14, s[20:23], s76 offen offset:0 sc1
    buffer_load_dwordx4 a[84:87], v14, s[20:23], s76 offen offset:1024 sc1
    buffer_load_dwordx4 a[88:91], v14, s[20:23], s76 offen offset:2048 sc1
    buffer_load_dwordx4 a[92:95], v14, s[20:23], s76 offen offset:3072 sc1
    v_accvgpr_read_b32 v224, a244
    v_mfma_f32_32x32x16_bf16 v[176:191], a[196:199], v[80:83], v[176:191]
    ds_read_b64_tr_b16 a[180:181], v233 offset:13312
    ds_read_b64_tr_b16 a[182:183], v233 offset:13824
    buffer_load_dwordx4 a[96:99], v14, s[20:23], s77 offen offset:0 sc1
    buffer_load_dwordx4 a[100:103], v14, s[20:23], s77 offen offset:1024 sc1
    buffer_load_dwordx4 a[104:107], v14, s[20:23], s77 offen offset:2048 sc1
    buffer_load_dwordx4 a[108:111], v14, s[20:23], s77 offen offset:3072 sc1
    v_lshlrev_b32 v208, 16, v224
    v_and_b32 v209, s46, v224
    v_mfma_f32_32x32x16_bf16 v[160:175], a[200:203], v[84:87], v[160:175]
    ds_read_b64_tr_b16 a[184:185], v230 offset:14336
    ds_read_b64_tr_b16 a[186:187], v230 offset:14848
    v_accvgpr_read_b32 v225, a245
    v_mfma_f32_32x32x16_bf16 v[176:191], a[204:207], v[84:87], v[176:191]
    ds_read_b64_tr_b16 a[188:189], v233 offset:14336
    ds_read_b64_tr_b16 a[190:191], v233 offset:14848
    v_lshlrev_b32 v210, 16, v225
    v_and_b32 v211, s46, v225
    s_waitcnt lgkmcnt(8)
    s_waitcnt vmcnt(29)
    v_mfma_f32_32x32x16_bf16 v[160:175], a[160:163], v[88:91], v[160:175]
    ds_read_b64_tr_b16 a[192:193], v230 offset:15360
    ds_read_b64_tr_b16 a[194:195], v230 offset:15872
    v_accvgpr_read_b32 v224, a246
    v_mfma_f32_32x32x16_bf16 v[176:191], a[164:167], v[88:91], v[176:191]
    ds_read_b64_tr_b16 a[196:197], v233 offset:15360
    ds_read_b64_tr_b16 a[198:199], v233 offset:15872
    v_lshlrev_b32 v212, 16, v224
    v_and_b32 v213, s46, v224
    s_waitcnt vmcnt(28)
    v_mfma_f32_32x32x16_bf16 v[160:175], a[168:171], v[92:95], v[160:175]
    ds_read_b64_tr_b16 a[200:201], v230 offset:16384
    ds_read_b64_tr_b16 a[202:203], v230 offset:16896
    v_accvgpr_read_b32 v225, a247
    v_mfma_f32_32x32x16_bf16 v[176:191], a[172:175], v[92:95], v[176:191]
    ds_read_b64_tr_b16 a[204:205], v233 offset:16384
    ds_read_b64_tr_b16 a[206:207], v233 offset:16896
    v_lshlrev_b32 v214, 16, v225
    v_and_b32 v215, s46, v225
    s_waitcnt lgkmcnt(8)
    s_waitcnt vmcnt(27)
    v_mfma_f32_32x32x16_bf16 v[160:175], a[176:179], v[96:99], v[160:175]
    v_accvgpr_read_b32 v224, a248
    v_mfma_f32_32x32x16_bf16 v[176:191], a[180:183], v[96:99], v[176:191]
    v_lshlrev_b32 v216, 16, v224
    v_and_b32 v217, s46, v224
    s_waitcnt vmcnt(26)
    v_mfma_f32_32x32x16_bf16 v[160:175], a[184:187], v[100:103], v[160:175]
    v_accvgpr_read_b32 v225, a249
    v_mfma_f32_32x32x16_bf16 v[176:191], a[188:191], v[100:103], v[176:191]
    v_lshlrev_b32 v218, 16, v225
    v_and_b32 v219, s46, v225
    s_waitcnt lgkmcnt(0)
    s_waitcnt vmcnt(25)
    v_mfma_f32_32x32x16_bf16 v[160:175], a[192:195], v[104:107], v[160:175]
    v_accvgpr_read_b32 v224, a250
    v_mfma_f32_32x32x16_bf16 v[176:191], a[196:199], v[104:107], v[176:191]
    v_lshlrev_b32 v220, 16, v224
    v_and_b32 v221, s46, v224
    s_waitcnt vmcnt(24)
    v_mfma_f32_32x32x16_bf16 v[160:175], a[200:203], v[108:111], v[160:175]
    v_accvgpr_read_b32 v225, a251
    v_mfma_f32_32x32x16_bf16 v[176:191], a[204:207], v[108:111], v[176:191]
    v_lshlrev_b32 v222, 16, v225
    v_and_b32 v223, s46, v225
    s_waitcnt vmcnt(20)
    v_mfma_f32_32x32x16_bf16 v[112:127], a[232:235], a[16:19], v[112:127]
    v_mfma_f32_32x32x16_bf16 v[112:127], a[236:239], a[20:23], v[112:127]
    v_mfma_f32_32x32x16_bf16 v[128:143], a[232:235], a[24:27], v[128:143]
    v_mfma_f32_32x32x16_bf16 v[128:143], a[236:239], a[28:31], v[128:143]
    s_waitcnt vmcnt(16)
    v_mfma_f32_32x32x16_bf16 v[112:127], a[232:235], a[32:35], v[112:127]
    v_mfma_f32_32x32x16_bf16 v[112:127], a[236:239], a[36:39], v[112:127]
    v_mfma_f32_32x32x16_bf16 v[128:143], a[232:235], a[40:43], v[128:143]
    v_mfma_f32_32x32x16_bf16 v[128:143], a[236:239], a[44:47], v[128:143]
    s_waitcnt vmcnt(12)
    v_mfma_f32_32x32x16_bf16 v[112:127], a[232:235], a[48:51], v[112:127]
    v_mfma_f32_32x32x16_bf16 v[112:127], a[236:239], a[52:55], v[112:127]
    v_mfma_f32_32x32x16_bf16 v[128:143], a[232:235], a[56:59], v[128:143]
    v_mfma_f32_32x32x16_bf16 v[128:143], a[236:239], a[60:63], v[128:143]
    s_waitcnt vmcnt(8)
    v_mfma_f32_32x32x16_bf16 v[112:127], a[232:235], a[64:67], v[112:127]
    v_mfma_f32_32x32x16_bf16 v[112:127], a[236:239], a[68:71], v[112:127]
    v_mfma_f32_32x32x16_bf16 v[128:143], a[232:235], a[72:75], v[128:143]
    v_mfma_f32_32x32x16_bf16 v[128:143], a[236:239], a[76:79], v[128:143]
    s_waitcnt vmcnt(4)
    v_mfma_f32_32x32x16_bf16 v[112:127], a[232:235], a[80:83], v[112:127]
    v_mfma_f32_32x32x16_bf16 v[112:127], a[236:239], a[84:87], v[112:127]
    v_mfma_f32_32x32x16_bf16 v[128:143], a[232:235], a[88:91], v[128:143]
    v_mfma_f32_32x32x16_bf16 v[128:143], a[236:239], a[92:95], v[128:143]
    s_waitcnt vmcnt(0)
    v_mfma_f32_32x32x16_bf16 v[112:127], a[232:235], a[96:99], v[112:127]
    v_mfma_f32_32x32x16_bf16 v[112:127], a[236:239], a[100:103], v[112:127]
    v_mfma_f32_32x32x16_bf16 v[128:143], a[232:235], a[104:107], v[128:143]
    v_mfma_f32_32x32x16_bf16 v[128:143], a[236:239], a[108:111], v[128:143]
    v_mov_b32 v224, 1.0
    v_accvgpr_read_b32 v226, a241
    s_nop 7
    v_pk_mul_f32 v[112:113], v[112:113], v[226:227] op_sel_hi:[1,0]
    v_pk_mul_f32 v[114:115], v[114:115], v[226:227] op_sel_hi:[1,0]
    v_pk_mul_f32 v[116:117], v[116:117], v[226:227] op_sel_hi:[1,0]
    v_pk_mul_f32 v[118:119], v[118:119], v[226:227] op_sel_hi:[1,0]
    v_exp_f32 v16, -v112
    v_exp_f32 v17, -v113
    v_exp_f32 v18, -v114
    v_exp_f32 v19, -v115
    v_exp_f32 v20, -v116
    v_exp_f32 v21, -v117
    v_exp_f32 v22, -v118
    v_exp_f32 v23, -v119
    v_pk_mul_f32 v[160:161], v[160:161], v[112:113]
    v_pk_mul_f32 v[162:163], v[162:163], v[114:115]
    v_pk_mul_f32 v[164:165], v[164:165], v[116:117]
    v_pk_mul_f32 v[166:167], v[166:167], v[118:119]
    v_pk_add_f32 v[16:17], v[16:17], v[224:225] op_sel_hi:[1,0]
    v_pk_add_f32 v[18:19], v[18:19], v[224:225] op_sel_hi:[1,0]
    v_pk_add_f32 v[20:21], v[20:21], v[224:225] op_sel_hi:[1,0]
    v_pk_add_f32 v[22:23], v[22:23], v[224:225] op_sel_hi:[1,0]
    v_rcp_f32 v16, v16
    v_rcp_f32 v17, v17
    v_rcp_f32 v18, v18
    v_rcp_f32 v19, v19
    v_rcp_f32 v20, v20
    v_rcp_f32 v21, v21
    v_rcp_f32 v22, v22
    v_rcp_f32 v23, v23
    v_pk_fma_f32 v[192:193], v[160:161], v[16:17], v[192:193]
    v_pk_fma_f32 v[194:195], v[162:163], v[18:19], v[194:195]
    v_pk_fma_f32 v[196:197], v[164:165], v[20:21], v[196:197]
    v_pk_fma_f32 v[198:199], v[166:167], v[22:23], v[198:199]
    v_cvt_pk_bf16_f32 v16, v192, v193
    v_cvt_pk_bf16_f32 v17, v194, v195
    v_cvt_pk_bf16_f32 v18, v196, v197
    v_cvt_pk_bf16_f32 v19, v198, v199
    buffer_store_dwordx4 v[16:19], v235, s[4:7], s74 offen offset:0
    v_pk_mul_f32 v[120:121], v[120:121], v[226:227] op_sel_hi:[1,0]
    v_pk_mul_f32 v[122:123], v[122:123], v[226:227] op_sel_hi:[1,0]
    v_pk_mul_f32 v[124:125], v[124:125], v[226:227] op_sel_hi:[1,0]
    v_pk_mul_f32 v[126:127], v[126:127], v[226:227] op_sel_hi:[1,0]
    v_exp_f32 v24, -v120
    v_exp_f32 v25, -v121
    v_exp_f32 v26, -v122
    v_exp_f32 v27, -v123
    v_exp_f32 v28, -v124
    v_exp_f32 v29, -v125
    v_exp_f32 v30, -v126
    v_exp_f32 v31, -v127
    v_pk_mul_f32 v[168:169], v[168:169], v[120:121]
    v_pk_mul_f32 v[170:171], v[170:171], v[122:123]
    v_pk_mul_f32 v[172:173], v[172:173], v[124:125]
    v_pk_mul_f32 v[174:175], v[174:175], v[126:127]
    v_pk_add_f32 v[24:25], v[24:25], v[224:225] op_sel_hi:[1,0]
    v_pk_add_f32 v[26:27], v[26:27], v[224:225] op_sel_hi:[1,0]
    v_pk_add_f32 v[28:29], v[28:29], v[224:225] op_sel_hi:[1,0]
    v_pk_add_f32 v[30:31], v[30:31], v[224:225] op_sel_hi:[1,0]
    v_rcp_f32 v24, v24
    v_rcp_f32 v25, v25
    v_rcp_f32 v26, v26
    v_rcp_f32 v27, v27
    v_rcp_f32 v28, v28
    v_rcp_f32 v29, v29
    v_rcp_f32 v30, v30
    v_rcp_f32 v31, v31
    v_pk_fma_f32 v[200:201], v[168:169], v[24:25], v[200:201]
    v_pk_fma_f32 v[202:203], v[170:171], v[26:27], v[202:203]
    v_pk_fma_f32 v[204:205], v[172:173], v[28:29], v[204:205]
    v_pk_fma_f32 v[206:207], v[174:175], v[30:31], v[206:207]
    v_cvt_pk_bf16_f32 v24, v200, v201
    v_cvt_pk_bf16_f32 v25, v202, v203
    v_cvt_pk_bf16_f32 v26, v204, v205
    v_cvt_pk_bf16_f32 v27, v206, v207
    buffer_store_dwordx4 v[24:27], v235, s[4:7], s74 offen offset:16
    v_pk_mul_f32 v[128:129], v[128:129], v[226:227] op_sel_hi:[1,0]
    v_pk_mul_f32 v[130:131], v[130:131], v[226:227] op_sel_hi:[1,0]
    v_pk_mul_f32 v[132:133], v[132:133], v[226:227] op_sel_hi:[1,0]
    v_pk_mul_f32 v[134:135], v[134:135], v[226:227] op_sel_hi:[1,0]
    v_exp_f32 v32, -v128
    v_exp_f32 v33, -v129
    v_exp_f32 v34, -v130
    v_exp_f32 v35, -v131
    v_exp_f32 v36, -v132
    v_exp_f32 v37, -v133
    v_exp_f32 v38, -v134
    v_exp_f32 v39, -v135
    v_pk_mul_f32 v[176:177], v[176:177], v[128:129]
    v_pk_mul_f32 v[178:179], v[178:179], v[130:131]
    v_pk_mul_f32 v[180:181], v[180:181], v[132:133]
    v_pk_mul_f32 v[182:183], v[182:183], v[134:135]
    v_pk_add_f32 v[32:33], v[32:33], v[224:225] op_sel_hi:[1,0]
    v_pk_add_f32 v[34:35], v[34:35], v[224:225] op_sel_hi:[1,0]
    v_pk_add_f32 v[36:37], v[36:37], v[224:225] op_sel_hi:[1,0]
    v_pk_add_f32 v[38:39], v[38:39], v[224:225] op_sel_hi:[1,0]
    v_rcp_f32 v32, v32
    v_rcp_f32 v33, v33
    v_rcp_f32 v34, v34
    v_rcp_f32 v35, v35
    v_rcp_f32 v36, v36
    v_rcp_f32 v37, v37
    v_rcp_f32 v38, v38
    v_rcp_f32 v39, v39
    v_pk_fma_f32 v[208:209], v[176:177], v[32:33], v[208:209]
    v_pk_fma_f32 v[210:211], v[178:179], v[34:35], v[210:211]
    v_pk_fma_f32 v[212:213], v[180:181], v[36:37], v[212:213]
    v_pk_fma_f32 v[214:215], v[182:183], v[38:39], v[214:215]
    v_cvt_pk_bf16_f32 v32, v208, v209
    v_cvt_pk_bf16_f32 v33, v210, v211
    v_cvt_pk_bf16_f32 v34, v212, v213
    v_cvt_pk_bf16_f32 v35, v214, v215
    buffer_store_dwordx4 v[32:35], v235, s[4:7], s74 offen offset:32
    v_pk_mul_f32 v[136:137], v[136:137], v[226:227] op_sel_hi:[1,0]
    v_pk_mul_f32 v[138:139], v[138:139], v[226:227] op_sel_hi:[1,0]
    v_pk_mul_f32 v[140:141], v[140:141], v[226:227] op_sel_hi:[1,0]
    v_pk_mul_f32 v[142:143], v[142:143], v[226:227] op_sel_hi:[1,0]
    v_exp_f32 v40, -v136
    v_exp_f32 v41, -v137
    v_exp_f32 v42, -v138
    v_exp_f32 v43, -v139
    v_exp_f32 v44, -v140
    v_exp_f32 v45, -v141
    v_exp_f32 v46, -v142
    v_exp_f32 v47, -v143
    v_pk_mul_f32 v[184:185], v[184:185], v[136:137]
    v_pk_mul_f32 v[186:187], v[186:187], v[138:139]
    v_pk_mul_f32 v[188:189], v[188:189], v[140:141]
    v_pk_mul_f32 v[190:191], v[190:191], v[142:143]
    v_pk_add_f32 v[40:41], v[40:41], v[224:225] op_sel_hi:[1,0]
    v_pk_add_f32 v[42:43], v[42:43], v[224:225] op_sel_hi:[1,0]
    v_pk_add_f32 v[44:45], v[44:45], v[224:225] op_sel_hi:[1,0]
    v_pk_add_f32 v[46:47], v[46:47], v[224:225] op_sel_hi:[1,0]
    v_rcp_f32 v40, v40
    v_rcp_f32 v41, v41
    v_rcp_f32 v42, v42
    v_rcp_f32 v43, v43
    v_rcp_f32 v44, v44
    v_rcp_f32 v45, v45
    v_rcp_f32 v46, v46
    v_rcp_f32 v47, v47
    v_pk_fma_f32 v[216:217], v[184:185], v[40:41], v[216:217]
    v_pk_fma_f32 v[218:219], v[186:187], v[42:43], v[218:219]
    v_pk_fma_f32 v[220:221], v[188:189], v[44:45], v[220:221]
    v_pk_fma_f32 v[222:223], v[190:191], v[46:47], v[222:223]
    v_cvt_pk_bf16_f32 v40, v216, v217
    v_cvt_pk_bf16_f32 v41, v218, v219
    v_cvt_pk_bf16_f32 v42, v220, v221
    v_cvt_pk_bf16_f32 v43, v222, v223
    buffer_store_dwordx4 v[40:43], v235, s[4:7], s74 offen offset:48
    s_endpgm
L_nonowner:
    s_nop 15
    s_mul_i32 s56, s92, 1536
    s_add_u32 s56, s56, s93
    v_cvt_pk_bf16_f32 v80, v112, v113
    v_cvt_pk_bf16_f32 v81, v114, v115
    v_cvt_pk_bf16_f32 v82, v116, v117
    v_cvt_pk_bf16_f32 v83, v118, v119
    buffer_store_dwordx4 v[80:83], v14, s[20:23], s56 offen offset:0 sc1
    v_cvt_pk_bf16_f32 v84, v120, v121
    v_cvt_pk_bf16_f32 v85, v122, v123
    v_cvt_pk_bf16_f32 v86, v124, v125
    v_cvt_pk_bf16_f32 v87, v126, v127
    buffer_store_dwordx4 v[84:87], v14, s[20:23], s56 offen offset:1024 sc1
    v_cvt_pk_bf16_f32 v88, v128, v129
    v_cvt_pk_bf16_f32 v89, v130, v131
    v_cvt_pk_bf16_f32 v90, v132, v133
    v_cvt_pk_bf16_f32 v91, v134, v135
    buffer_store_dwordx4 v[88:91], v14, s[20:23], s56 offen offset:2048 sc1
    v_cvt_pk_bf16_f32 v92, v136, v137
    v_cvt_pk_bf16_f32 v93, v138, v139
    v_cvt_pk_bf16_f32 v94, v140, v141
    v_cvt_pk_bf16_f32 v95, v142, v143
    buffer_store_dwordx4 v[92:95], v14, s[20:23], s56 offen offset:3072 sc1
    s_waitcnt vmcnt(0) lgkmcnt(0)
    v_mov_b32 v240, 9
    buffer_store_dword v240, v241, s[20:23], s62 offen sc1
    s_endpgm
L_attn:
    s_nop 7
    s_mul_i32 s48, s40, 55296
    s_mul_i32 s50, s43, 288
    s_add_u32 s48, s48, s50
    s_mul_i32 s47, s40, 9216
    s_mul_i32 s50, s3, 221184
    s_add_u32 s84, s48, s50
    s_add_u32 s50, s50, 221184
    s_cmp_ge_u32 s50, 1990656
    s_cselect_b32 s50, 0, s50
    s_add_u32 s85, s48, s50
    s_add_u32 s50, s50, 221184
    s_cmp_ge_u32 s50, 1990656
    s_cselect_b32 s50, 0, s50
    s_add_u32 s86, s48, s50
    s_add_u32 s50, s50, 221184
    s_cmp_ge_u32 s50, 1990656
    s_cselect_b32 s50, 0, s50
    s_add_u32 s87, s48, s50
    s_add_u32 s50, s50, 221184
    s_cmp_ge_u32 s50, 1990656
    s_cselect_b32 s50, 0, s50
    s_add_u32 s88, s48, s50
    s_add_u32 s50, s50, 221184
    s_cmp_ge_u32 s50, 1990656
    s_cselect_b32 s50, 0, s50
    s_add_u32 s89, s48, s50
    s_add_u32 s50, s50, 221184
    s_cmp_ge_u32 s50, 1990656
    s_cselect_b32 s50, 0, s50
    s_add_u32 s90, s48, s50
    s_add_u32 s50, s50, 221184
    s_cmp_ge_u32 s50, 1990656
    s_cselect_b32 s50, 0, s50
    s_add_u32 s91, s48, s50
    s_add_u32 s50, s50, 221184
    s_cmp_ge_u32 s50, 1990656
    s_cselect_b32 s50, 0, s50
    s_add_u32 s92, s48, s50
    s_barrier
    s_add_u32 m0, s47, 0
    s_nop 0
    buffer_load_dwordx4 v2, s[24:27], s84 offen offset:0 lds
    buffer_load_dwordx4 v3, s[24:27], s84 offen offset:1024 lds
    buffer_load_dwordx4 v4, s[24:27], s84 offen offset:2048 lds
    s_waitcnt vmcnt(13)
    ds_read_b128 v[80:83], v166 offset:6144
    ds_read_b128 v[84:87], v167 offset:6160
    ds_read_b128 v[88:91], v166 offset:6176
    ds_read_b128 v[92:95], v167 offset:6192
    ds_read_b128 v[96:99], v166 offset:6272
    ds_read_b128 v[100:103], v167 offset:6288
    ds_read_b128 v[104:107], v166 offset:6304
    ds_read_b128 v[108:111], v167 offset:6320
    ds_read_b128 v[112:115], v166 offset:6400
    ds_read_b128 v[116:119], v167 offset:6416
    ds_read_b128 v[120:123], v166 offset:6432
    ds_read_b128 v[124:127], v167 offset:6448
    ds_read_b128 v[128:131], v166 offset:6528
    ds_read_b128 v[132:135], v167 offset:6544
    ds_read_b128 v[136:139], v166 offset:6560
    ds_read_b128 v[140:143], v167 offset:6576
    ds_read_b128 v[144:147], v162
    ds_read_b128 v[148:151], v163
    ds_read_b128 v[152:155], v164
    ds_read_b128 v[156:159], v165
    s_waitcnt lgkmcnt(15)
    v_dot2c_f32_bf16 v168, s45, v80
    v_dot2c_f32_bf16 v170, v80, v80
    v_dot2c_f32_bf16 v169, s45, v81
    v_dot2c_f32_bf16 v171, v81, v81
    v_dot2c_f32_bf16 v168, s45, v82
    v_dot2c_f32_bf16 v170, v82, v82
    v_dot2c_f32_bf16 v169, s45, v83
    v_dot2c_f32_bf16 v171, v83, v83
    buffer_load_dwordx4 v5, s[24:27], s84 offen offset:3072 lds
    v_dot2c_f32_bf16 v168, s45, v84
    v_dot2c_f32_bf16 v170, v84, v84
    v_dot2c_f32_bf16 v169, s45, v85
    v_dot2c_f32_bf16 v171, v85, v85
    v_dot2c_f32_bf16 v168, s45, v86
    v_dot2c_f32_bf16 v170, v86, v86
    v_dot2c_f32_bf16 v169, s45, v87
    v_dot2c_f32_bf16 v171, v87, v87
    v_dot2c_f32_bf16 v168, s45, v88
    v_dot2c_f32_bf16 v170, v88, v88
    v_dot2c_f32_bf16 v169, s45, v89
    v_dot2c_f32_bf16 v171, v89, v89
    v_dot2c_f32_bf16 v168, s45, v90
    v_dot2c_f32_bf16 v170, v90, v90
    v_dot2c_f32_bf16 v169, s45, v91
    v_dot2c_f32_bf16 v171, v91, v91
    s_add_u32 m0, s47, 4096
    s_nop 0
    buffer_load_dwordx4 v6, s[24:27], s84 offen offset:0 lds
    v_dot2c_f32_bf16 v168, s45, v92
    v_dot2c_f32_bf16 v170, v92, v92
    v_dot2c_f32_bf16 v169, s45, v93
    v_dot2c_f32_bf16 v171, v93, v93
    v_dot2c_f32_bf16 v168, s45, v94
    v_dot2c_f32_bf16 v170, v94, v94
    v_dot2c_f32_bf16 v169, s45, v95
    v_dot2c_f32_bf16 v171, v95, v95
    v_dot2c_f32_bf16 v168, s45, v96
    v_dot2c_f32_bf16 v170, v96, v96
    v_dot2c_f32_bf16 v169, s45, v97
    v_dot2c_f32_bf16 v171, v97, v97
    v_dot2c_f32_bf16 v168, s45, v98
    v_dot2c_f32_bf16 v170, v98, v98
    v_dot2c_f32_bf16 v169, s45, v99
    v_dot2c_f32_bf16 v171, v99, v99
    buffer_load_dwordx4 v7, s[24:27], s84 offen offset:1024 lds
    s_waitcnt lgkmcnt(14)
    v_dot2c_f32_bf16 v168, s45, v100
    v_dot2c_f32_bf16 v170, v100, v100
    v_dot2c_f32_bf16 v169, s45, v101
    v_dot2c_f32_bf16 v171, v101, v101
    v_dot2c_f32_bf16 v168, s45, v102
    v_dot2c_f32_bf16 v170, v102, v102
    v_dot2c_f32_bf16 v169, s45, v103
    v_dot2c_f32_bf16 v171, v103, v103
    s_waitcnt lgkmcnt(13)
    v_dot2c_f32_bf16 v168, s45, v104
    v_dot2c_f32_bf16 v170, v104, v104
    v_dot2c_f32_bf16 v169, s45, v105
    v_dot2c_f32_bf16 v171, v105, v105
    v_dot2c_f32_bf16 v168, s45, v106
    v_dot2c_f32_bf16 v170, v106, v106
    v_dot2c_f32_bf16 v169, s45, v107
    v_dot2c_f32_bf16 v171, v107, v107
    buffer_load_dwordx4 v8, s[24:27], s84 offen offset:2048 lds
    s_waitcnt lgkmcnt(12)
    v_dot2c_f32_bf16 v168, s45, v108
    v_dot2c_f32_bf16 v170, v108, v108
    v_dot2c_f32_bf16 v169, s45, v109
    v_dot2c_f32_bf16 v171, v109, v109
    v_dot2c_f32_bf16 v168, s45, v110
    v_dot2c_f32_bf16 v170, v110, v110
    v_dot2c_f32_bf16 v169, s45, v111
    v_dot2c_f32_bf16 v171, v111, v111
    s_waitcnt lgkmcnt(11)
    v_dot2c_f32_bf16 v168, s45, v112
    v_dot2c_f32_bf16 v170, v112, v112
    v_dot2c_f32_bf16 v169, s45, v113
    v_dot2c_f32_bf16 v171, v113, v113
    v_dot2c_f32_bf16 v168, s45, v114
    v_dot2c_f32_bf16 v170, v114, v114
    v_dot2c_f32_bf16 v169, s45, v115
    v_dot2c_f32_bf16 v171, v115, v115
    buffer_load_dwordx4 v9, s[24:27], s84 offen offset:3072 lds
    s_waitcnt lgkmcnt(10)
    v_dot2c_f32_bf16 v168, s45, v116
    v_dot2c_f32_bf16 v170, v116, v116
    v_dot2c_f32_bf16 v169, s45, v117
    v_dot2c_f32_bf16 v171, v117, v117
    v_dot2c_f32_bf16 v168, s45, v118
    v_dot2c_f32_bf16 v170, v118, v118
    v_dot2c_f32_bf16 v169, s45, v119
    v_dot2c_f32_bf16 v171, v119, v119
    s_waitcnt lgkmcnt(9)
    v_dot2c_f32_bf16 v168, s45, v120
    v_dot2c_f32_bf16 v170, v120, v120
    v_dot2c_f32_bf16 v169, s45, v121
    v_dot2c_f32_bf16 v171, v121, v121
    v_dot2c_f32_bf16 v168, s45, v122
    v_dot2c_f32_bf16 v170, v122, v122
    v_dot2c_f32_bf16 v169, s45, v123
    v_dot2c_f32_bf16 v171, v123, v123
    s_add_u32 m0, s47, 8192
    s_nop 0
    buffer_load_dwordx4 v10, s[24:27], s84 offen offset:0 lds
    s_waitcnt lgkmcnt(8)
    v_dot2c_f32_bf16 v168, s45, v124
    v_dot2c_f32_bf16 v170, v124, v124
    v_dot2c_f32_bf16 v169, s45, v125
    v_dot2c_f32_bf16 v171, v125, v125
    v_dot2c_f32_bf16 v168, s45, v126
    v_dot2c_f32_bf16 v170, v126, v126
    v_dot2c_f32_bf16 v169, s45, v127
    v_dot2c_f32_bf16 v171, v127, v127
    s_waitcnt lgkmcnt(7)
    v_dot2c_f32_bf16 v168, s45, v128
    v_dot2c_f32_bf16 v170, v128, v128
    v_dot2c_f32_bf16 v169, s45, v129
    v_dot2c_f32_bf16 v171, v129, v129
    v_dot2c_f32_bf16 v168, s45, v130
    v_dot2c_f32_bf16 v170, v130, v130
    v_dot2c_f32_bf16 v169, s45, v131
    v_dot2c_f32_bf16 v171, v131, v131
    s_add_u32 m0, s47, 36864
    s_nop 0
    buffer_load_dwordx4 v2, s[24:27], s85 offen offset:0 lds
    s_waitcnt lgkmcnt(6)
    v_dot2c_f32_bf16 v168, s45, v132
    v_dot2c_f32_bf16 v170, v132, v132
    v_dot2c_f32_bf16 v169, s45, v133
    v_dot2c_f32_bf16 v171, v133, v133
    v_dot2c_f32_bf16 v168, s45, v134
    v_dot2c_f32_bf16 v170, v134, v134
    v_dot2c_f32_bf16 v169, s45, v135
    v_dot2c_f32_bf16 v171, v135, v135
    s_waitcnt lgkmcnt(5)
    v_dot2c_f32_bf16 v168, s45, v136
    v_dot2c_f32_bf16 v170, v136, v136
    v_dot2c_f32_bf16 v169, s45, v137
    v_dot2c_f32_bf16 v171, v137, v137
    v_dot2c_f32_bf16 v168, s45, v138
    v_dot2c_f32_bf16 v170, v138, v138
    v_dot2c_f32_bf16 v169, s45, v139
    v_dot2c_f32_bf16 v171, v139, v139
    buffer_load_dwordx4 v3, s[24:27], s85 offen offset:1024 lds
    s_waitcnt lgkmcnt(4)
    v_dot2c_f32_bf16 v168, s45, v140
    v_dot2c_f32_bf16 v170, v140, v140
    v_dot2c_f32_bf16 v169, s45, v141
    v_dot2c_f32_bf16 v171, v141, v141
    v_dot2c_f32_bf16 v168, s45, v142
    v_dot2c_f32_bf16 v170, v142, v142
    v_dot2c_f32_bf16 v169, s45, v143
    v_dot2c_f32_bf16 v171, v143, v143
    s_waitcnt lgkmcnt(3)
    v_dot2c_f32_bf16 v168, s45, v144
    v_dot2c_f32_bf16 v170, v144, v144
    v_dot2c_f32_bf16 v169, s45, v145
    v_dot2c_f32_bf16 v171, v145, v145
    v_dot2c_f32_bf16 v168, s45, v146
    v_dot2c_f32_bf16 v170, v146, v146
    v_dot2c_f32_bf16 v169, s45, v147
    v_dot2c_f32_bf16 v171, v147, v147
    s_waitcnt lgkmcnt(2)
    v_dot2c_f32_bf16 v168, s45, v148
    v_dot2c_f32_bf16 v170, v148, v148
    v_dot2c_f32_bf16 v169, s45, v149
    v_dot2c_f32_bf16 v171, v149, v149
    v_dot2c_f32_bf16 v168, s45, v150
    v_dot2c_f32_bf16 v170, v150, v150
    v_dot2c_f32_bf16 v169, s45, v151
    v_dot2c_f32_bf16 v171, v151, v151
    s_waitcnt lgkmcnt(1)
    v_dot2c_f32_bf16 v168, s45, v152
    v_dot2c_f32_bf16 v170, v152, v152
    v_dot2c_f32_bf16 v169, s45, v153
    v_dot2c_f32_bf16 v171, v153, v153
    v_dot2c_f32_bf16 v168, s45, v154
    v_dot2c_f32_bf16 v170, v154, v154
    v_dot2c_f32_bf16 v169, s45, v155
    v_dot2c_f32_bf16 v171, v155, v155
    s_waitcnt lgkmcnt(0)
    v_dot2c_f32_bf16 v168, s45, v156
    v_dot2c_f32_bf16 v170, v156, v156
    v_dot2c_f32_bf16 v169, s45, v157
    v_dot2c_f32_bf16 v171, v157, v157
    v_dot2c_f32_bf16 v168, s45, v158
    v_dot2c_f32_bf16 v170, v158, v158
    v_dot2c_f32_bf16 v169, s45, v159
    v_dot2c_f32_bf16 v171, v159, v159
    s_nop 1
    v_add_f32 v172, v168, v169
    v_add_f32 v174, v170, v171
    v_mov_b32 v173, v172
    v_mov_b32 v175, v174
    s_nop 0
    v_permlane32_swap_b32 v172, v173
    v_add_f32 v172, v172, v173
    v_mul_f32 v172, 0xbae38e39, v172
    v_cvt_pk_bf16_f32 v173, v172, v172
    v_and_b32 v173, s46, v173
    v_mov_b32 v224, v173
    v_mov_b32 v225, v173
    v_mov_b32 v226, v173
    v_mov_b32 v227, v173
    v_mov_b32 v228, v173
    v_mov_b32 v229, v173
    v_mov_b32 v230, v173
    v_mov_b32 v231, v173
    v_mov_b32 v232, v173
    v_mov_b32 v233, v173
    v_mov_b32 v234, v173
    v_mov_b32 v235, v173
    v_mov_b32 v236, v173
    v_mov_b32 v237, v173
    v_mov_b32 v238, v173
    v_mov_b32 v239, v173
    s_waitcnt vmcnt(11)
    s_nop 0
    v_mfma_f32_32x32x16_bf16 v[176:191], a[232:235], v[16:19], v[224:239]
    v_permlane32_swap_b32 v174, v175
    v_add_f32 v174, v174, v175
    v_mul_f32 v174, 0x3ae38e39, v174
    v_fma_f32 v174, -v172, v172, v174
    v_mfma_f32_32x32x16_bf16 v[176:191], a[236:239], v[20:23], v[176:191]
    v_max_f32 v174, 0, v174
    v_cvt_pk_bf16_f32 v174, v174, v174
    v_and_b32 v174, s46, v174
    v_add_f32 v174, 0x3727c5ac, v174
    v_mfma_f32_32x32x16_bf16 v[192:207], a[232:235], v[24:27], v[224:239]
    v_cvt_pk_bf16_f32 v174, v174, v174
    v_and_b32 v174, s46, v174
    v_sqrt_f32 v174, v174
    s_nop 0
    v_mfma_f32_32x32x16_bf16 v[192:207], a[236:239], v[28:31], v[192:207]
    v_cvt_pk_bf16_f32 v174, v174, v174
    v_and_b32 v255, s46, v174
    v_rcp_f32 v174, v255
    s_nop 0
    buffer_load_dwordx4 v4, s[24:27], s85 offen offset:2048 lds
    v_mfma_f32_32x32x16_bf16 v[208:223], a[232:235], v[32:35], v[224:239]
    v_cvt_pk_bf16_f32 v16, v176, v177
    v_cvt_pk_bf16_f32 v17, v178, v179
    v_cvt_pk_bf16_f32 v18, v180, v181
    v_cvt_pk_bf16_f32 v19, v182, v183
    v_mfma_f32_32x32x16_bf16 v[208:223], a[236:239], v[36:39], v[208:223]
    v_cvt_pk_bf16_f32 v20, v184, v185
    v_cvt_pk_bf16_f32 v21, v186, v187
    v_cvt_pk_bf16_f32 v22, v188, v189
    v_cvt_pk_bf16_f32 v23, v190, v191
    v_mfma_f32_32x32x16_bf16 v[176:191], a[232:235], v[40:43], v[224:239]
    v_cvt_pk_bf16_f32 v24, v192, v193
    v_cvt_pk_bf16_f32 v25, v194, v195
    v_cvt_pk_bf16_f32 v26, v196, v197
    v_cvt_pk_bf16_f32 v27, v198, v199
    v_mfma_f32_32x32x16_bf16 v[176:191], a[236:239], v[44:47], v[176:191]
    v_cvt_pk_bf16_f32 v28, v200, v201
    v_cvt_pk_bf16_f32 v29, v202, v203
    v_cvt_pk_bf16_f32 v30, v204, v205
    v_cvt_pk_bf16_f32 v31, v206, v207
    buffer_load_dwordx4 v5, s[24:27], s85 offen offset:3072 lds
    v_mfma_f32_32x32x16_bf16 v[192:207], a[232:235], v[48:51], v[224:239]
    v_cvt_pk_bf16_f32 v32, v208, v209
    v_cvt_pk_bf16_f32 v33, v210, v211
    v_cvt_pk_bf16_f32 v34, v212, v213
    v_cvt_pk_bf16_f32 v35, v214, v215
    v_mfma_f32_32x32x16_bf16 v[192:207], a[236:239], v[52:55], v[192:207]
    v_cvt_pk_bf16_f32 v36, v216, v217
    v_cvt_pk_bf16_f32 v37, v218, v219
    v_cvt_pk_bf16_f32 v38, v220, v221
    v_cvt_pk_bf16_f32 v39, v222, v223
    v_mfma_f32_32x32x16_bf16 v[208:223], a[232:235], v[56:59], v[224:239]
    v_cvt_pk_bf16_f32 v40, v176, v177
    v_cvt_pk_bf16_f32 v41, v178, v179
    v_cvt_pk_bf16_f32 v42, v180, v181
    v_cvt_pk_bf16_f32 v43, v182, v183
    v_mfma_f32_32x32x16_bf16 v[208:223], a[236:239], v[60:63], v[208:223]
    v_cvt_pk_bf16_f32 v44, v184, v185
    v_cvt_pk_bf16_f32 v45, v186, v187
    v_cvt_pk_bf16_f32 v46, v188, v189
    v_cvt_pk_bf16_f32 v47, v190, v191
    s_add_u32 m0, s47, 40960
    s_nop 0
    buffer_load_dwordx4 v6, s[24:27], s85 offen offset:0 lds
    v_mfma_f32_32x32x16_bf16 v[176:191], a[232:235], v[64:67], v[224:239]
    v_cvt_pk_bf16_f32 v48, v192, v193
    v_cvt_pk_bf16_f32 v49, v194, v195
    v_cvt_pk_bf16_f32 v50, v196, v197
    v_cvt_pk_bf16_f32 v51, v198, v199
    v_mfma_f32_32x32x16_bf16 v[176:191], a[236:239], v[68:71], v[176:191]
    v_cvt_pk_bf16_f32 v52, v200, v201
    v_cvt_pk_bf16_f32 v53, v202, v203
    v_cvt_pk_bf16_f32 v54, v204, v205
    v_cvt_pk_bf16_f32 v55, v206, v207
    v_mfma_f32_32x32x16_bf16 v[192:207], a[232:235], v[72:75], v[224:239]
    v_cvt_pk_bf16_f32 v56, v208, v209
    v_cvt_pk_bf16_f32 v57, v210, v211
    v_cvt_pk_bf16_f32 v58, v212, v213
    v_cvt_pk_bf16_f32 v59, v214, v215
    v_mfma_f32_32x32x16_bf16 v[192:207], a[236:239], v[76:79], v[192:207]
    v_cvt_pk_bf16_f32 v60, v216, v217
    v_cvt_pk_bf16_f32 v61, v218, v219
    v_cvt_pk_bf16_f32 v62, v220, v221
    v_cvt_pk_bf16_f32 v63, v222, v223
    buffer_load_dwordx4 v7, s[24:27], s85 offen offset:1024 lds
    v_mfma_f32_32x32x16_bf16 v[208:223], a[232:235], v[80:83], v[224:239]
    v_cvt_pk_bf16_f32 v64, v176, v177
    v_cvt_pk_bf16_f32 v65, v178, v179
    v_cvt_pk_bf16_f32 v66, v180, v181
    v_cvt_pk_bf16_f32 v67, v182, v183
    v_mfma_f32_32x32x16_bf16 v[208:223], a[236:239], v[84:87], v[208:223]
    v_cvt_pk_bf16_f32 v68, v184, v185
    v_cvt_pk_bf16_f32 v69, v186, v187
    v_cvt_pk_bf16_f32 v70, v188, v189
    v_cvt_pk_bf16_f32 v71, v190, v191
    v_mfma_f32_32x32x16_bf16 v[176:191], a[232:235], v[88:91], v[224:239]
    v_cvt_pk_bf16_f32 v72, v192, v193
    v_cvt_pk_bf16_f32 v73, v194, v195
    v_cvt_pk_bf16_f32 v74, v196, v197
    v_cvt_pk_bf16_f32 v75, v198, v199
    v_mfma_f32_32x32x16_bf16 v[176:191], a[236:239], v[92:95], v[176:191]
    v_cvt_pk_bf16_f32 v76, v200, v201
    v_cvt_pk_bf16_f32 v77, v202, v203
    v_cvt_pk_bf16_f32 v78, v204, v205
    v_cvt_pk_bf16_f32 v79, v206, v207
    buffer_load_dwordx4 v8, s[24:27], s85 offen offset:2048 lds
    v_mfma_f32_32x32x16_bf16 v[192:207], a[232:235], v[96:99], v[224:239]
    v_cvt_pk_bf16_f32 v80, v208, v209
    v_cvt_pk_bf16_f32 v81, v210, v211
    v_cvt_pk_bf16_f32 v82, v212, v213
    v_cvt_pk_bf16_f32 v83, v214, v215
    v_mfma_f32_32x32x16_bf16 v[192:207], a[236:239], v[100:103], v[192:207]
    v_cvt_pk_bf16_f32 v84, v216, v217
    v_cvt_pk_bf16_f32 v85, v218, v219
    v_cvt_pk_bf16_f32 v86, v220, v221
    v_cvt_pk_bf16_f32 v87, v222, v223
    v_mfma_f32_32x32x16_bf16 v[208:223], a[232:235], v[104:107], v[224:239]
    v_cvt_pk_bf16_f32 v88, v176, v177
    v_cvt_pk_bf16_f32 v89, v178, v179
    v_cvt_pk_bf16_f32 v90, v180, v181
    v_cvt_pk_bf16_f32 v91, v182, v183
    v_mfma_f32_32x32x16_bf16 v[208:223], a[236:239], v[108:111], v[208:223]
    v_cvt_pk_bf16_f32 v92, v184, v185
    v_cvt_pk_bf16_f32 v93, v186, v187
    v_cvt_pk_bf16_f32 v94, v188, v189
    v_cvt_pk_bf16_f32 v95, v190, v191
    buffer_load_dwordx4 v9, s[24:27], s85 offen offset:3072 lds
    v_mfma_f32_32x32x16_bf16 v[176:191], a[232:235], v[112:115], v[224:239]
    v_cvt_pk_bf16_f32 v96, v192, v193
    v_cvt_pk_bf16_f32 v97, v194, v195
    v_cvt_pk_bf16_f32 v98, v196, v197
    v_cvt_pk_bf16_f32 v99, v198, v199
    v_mfma_f32_32x32x16_bf16 v[176:191], a[236:239], v[116:119], v[176:191]
    v_cvt_pk_bf16_f32 v100, v200, v201
    v_cvt_pk_bf16_f32 v101, v202, v203
    v_cvt_pk_bf16_f32 v102, v204, v205
    v_cvt_pk_bf16_f32 v103, v206, v207
    v_mfma_f32_32x32x16_bf16 v[192:207], a[232:235], v[120:123], v[224:239]
    v_cvt_pk_bf16_f32 v104, v208, v209
    v_cvt_pk_bf16_f32 v105, v210, v211
    v_cvt_pk_bf16_f32 v106, v212, v213
    v_cvt_pk_bf16_f32 v107, v214, v215
    v_mfma_f32_32x32x16_bf16 v[192:207], a[236:239], v[124:127], v[192:207]
    v_cvt_pk_bf16_f32 v108, v216, v217
    v_cvt_pk_bf16_f32 v109, v218, v219
    v_cvt_pk_bf16_f32 v110, v220, v221
    v_cvt_pk_bf16_f32 v111, v222, v223
    s_add_u32 m0, s47, 45056
    s_nop 0
    buffer_load_dwordx4 v10, s[24:27], s85 offen offset:0 lds
    v_mfma_f32_32x32x16_bf16 v[208:223], a[232:235], v[128:131], v[224:239]
    v_cvt_pk_bf16_f32 v112, v176, v177
    v_cvt_pk_bf16_f32 v113, v178, v179
    v_cvt_pk_bf16_f32 v114, v180, v181
    v_cvt_pk_bf16_f32 v115, v182, v183
    v_mfma_f32_32x32x16_bf16 v[208:223], a[236:239], v[132:135], v[208:223]
    v_cvt_pk_bf16_f32 v116, v184, v185
    v_cvt_pk_bf16_f32 v117, v186, v187
    v_cvt_pk_bf16_f32 v118, v188, v189
    v_cvt_pk_bf16_f32 v119, v190, v191
    v_mfma_f32_32x32x16_bf16 v[176:191], a[232:235], v[136:139], v[224:239]
    v_cvt_pk_bf16_f32 v120, v192, v193
    v_cvt_pk_bf16_f32 v121, v194, v195
    v_cvt_pk_bf16_f32 v122, v196, v197
    v_cvt_pk_bf16_f32 v123, v198, v199
    v_mfma_f32_32x32x16_bf16 v[176:191], a[236:239], v[140:143], v[176:191]
    v_cvt_pk_bf16_f32 v124, v200, v201
    v_cvt_pk_bf16_f32 v125, v202, v203
    v_cvt_pk_bf16_f32 v126, v204, v205
    v_cvt_pk_bf16_f32 v127, v206, v207
    v_mfma_f32_32x32x16_bf16 v[192:207], a[232:235], v[144:147], v[224:239]
    v_cvt_pk_bf16_f32 v128, v208, v209
    v_cvt_pk_bf16_f32 v129, v210, v211
    v_cvt_pk_bf16_f32 v130, v212, v213
    v_cvt_pk_bf16_f32 v131, v214, v215
    v_mfma_f32_32x32x16_bf16 v[192:207], a[236:239], v[148:151], v[192:207]
    v_cvt_pk_bf16_f32 v132, v216, v217
    v_cvt_pk_bf16_f32 v133, v218, v219
    v_cvt_pk_bf16_f32 v134, v220, v221
    v_cvt_pk_bf16_f32 v135, v222, v223
    v_mfma_f32_32x32x16_bf16 v[208:223], a[232:235], v[152:155], v[224:239]
    v_cvt_pk_bf16_f32 v136, v176, v177
    v_cvt_pk_bf16_f32 v137, v178, v179
    v_cvt_pk_bf16_f32 v138, v180, v181
    v_cvt_pk_bf16_f32 v139, v182, v183
    v_mfma_f32_32x32x16_bf16 v[208:223], a[236:239], v[156:159], v[208:223]
    v_cvt_pk_bf16_f32 v140, v184, v185
    v_cvt_pk_bf16_f32 v141, v186, v187
    v_cvt_pk_bf16_f32 v142, v188, v189
    v_cvt_pk_bf16_f32 v143, v190, v191
    v_mul_f32 v254, 0x3fb8aa3b, v174
    v_cvt_pk_bf16_f32 v144, v192, v193
    v_cvt_pk_bf16_f32 v145, v194, v195
    v_cvt_pk_bf16_f32 v146, v196, v197
    v_cvt_pk_bf16_f32 v147, v198, v199
    v_cvt_pk_bf16_f32 v148, v200, v201
    v_cvt_pk_bf16_f32 v149, v202, v203
    v_cvt_pk_bf16_f32 v150, v204, v205
    v_cvt_pk_bf16_f32 v151, v206, v207
    v_cvt_pk_bf16_f32 v152, v208, v209
    v_cvt_pk_bf16_f32 v153, v210, v211
    v_cvt_pk_bf16_f32 v154, v212, v213
    v_cvt_pk_bf16_f32 v155, v214, v215
    v_cvt_pk_bf16_f32 v156, v216, v217
    v_cvt_pk_bf16_f32 v157, v218, v219
    v_cvt_pk_bf16_f32 v158, v220, v221
    v_cvt_pk_bf16_f32 v159, v222, v223
    s_waitcnt vmcnt(9)
    s_barrier
    ds_read_b64_tr_b16 a[0:1], v11 offset:0
    ds_read_b64_tr_b16 a[2:3], v11 offset:2304
    ds_read_b64_tr_b16 a[4:5], v11 offset:64
    ds_read_b64_tr_b16 a[6:7], v11 offset:2368
    ds_read_b64_tr_b16 a[8:9], v11 offset:128
    ds_read_b64_tr_b16 a[10:11], v11 offset:2432
    ds_read_b64_tr_b16 a[12:13], v11 offset:192
    ds_read_b64_tr_b16 a[14:15], v11 offset:2496
    ds_read_b64_tr_b16 a[16:17], v11 offset:256
    ds_read_b64_tr_b16 a[18:19], v11 offset:2560
    ds_read_b64_tr_b16 a[20:21], v11 offset:320
    ds_read_b64_tr_b16 a[22:23], v11 offset:2624
    ds_read_b64_tr_b16 a[24:25], v11 offset:384
    ds_read_b64_tr_b16 a[26:27], v11 offset:2688
    ds_read_b64_tr_b16 a[28:29], v11 offset:448
    ds_read_b64_tr_b16 a[30:31], v11 offset:2752
    s_waitcnt lgkmcnt(8)
    v_mfma_f32_32x32x16_bf16 v[160:175], a[0:3], v[16:19], 0
    ds_read_b64_tr_b16 a[32:33], v11 offset:512
    ds_read_b64_tr_b16 a[34:35], v11 offset:2816
    v_mov_b32 v248, 0
    v_mfma_f32_32x32x16_bf16 v[176:191], a[4:7], v[16:19], 0
    ds_read_b64_tr_b16 a[36:37], v11 offset:4608
    ds_read_b64_tr_b16 a[38:39], v11 offset:6912
    v_mov_b32 v249, 0
    v_mfma_f32_32x32x16_bf16 v[192:207], a[8:11], v[16:19], 0
    ds_read_b64_tr_b16 a[40:41], v11 offset:4672
    ds_read_b64_tr_b16 a[42:43], v11 offset:6976
    s_add_u32 m0, s47, 73728
    s_nop 0
    buffer_load_dwordx4 v2, s[24:27], s86 offen offset:0 lds
    s_mul_i32 s50, s43, 5184
    s_add_u32 s51, s50, 4096
    v_lshlrev_b32 v15, 2, v0
    buffer_load_dword a240, v15, s[28:31], s50 offen offset:0
    buffer_load_dword a241, v15, s[28:31], s50 offen offset:1024
    buffer_load_dword a242, v15, s[28:31], s50 offen offset:2048
    buffer_load_dword a243, v15, s[28:31], s50 offen offset:3072
    buffer_load_dword a244, v15, s[28:31], s51 offen offset:0
    buffer_load_dword a245, v15, s[28:31], s51 offen offset:1024
    v_mov_b32 v250, 0
    v_mfma_f32_32x32x16_bf16 v[208:223], a[12:15], v[16:19], 0
    ds_read_b64_tr_b16 a[44:45], v11 offset:4736
    ds_read_b64_tr_b16 a[46:47], v11 offset:7040
    v_mov_b32 v251, 0
    s_waitcnt lgkmcnt(8)
    v_mfma_f32_32x32x16_bf16 v[224:239], a[16:19], v[16:19], 0
    ds_read_b64_tr_b16 a[0:1], v11 offset:4800
    ds_read_b64_tr_b16 a[2:3], v11 offset:7104
    v_accvgpr_read_b32 v252, a150
    v_mfma_f32_32x32x16_bf16 a[168:183], a[20:23], v[16:19], 0
    ds_read_b64_tr_b16 a[4:5], v11 offset:4864
    ds_read_b64_tr_b16 a[6:7], v11 offset:7168
    buffer_load_dwordx4 v3, s[24:27], s86 offen offset:1024 lds
    ds_write_b128 v252, v[248:251] offset:0
    v_mfma_f32_32x32x16_bf16 a[184:199], a[24:27], v[16:19], 0
    ds_read_b64_tr_b16 a[8:9], v11 offset:4928
    ds_read_b64_tr_b16 a[10:11], v11 offset:7232
    v_mfma_f32_32x32x16_bf16 a[200:215], a[28:31], v[16:19], 0
    ds_read_b64_tr_b16 a[12:13], v11 offset:4992
    ds_read_b64_tr_b16 a[14:15], v11 offset:7296
    ds_write_b128 v252, v[248:251] offset:4096
    s_waitcnt lgkmcnt(10)
    v_mfma_f32_32x32x16_bf16 a[216:231], a[32:35], v[16:19], 0
    ds_read_b64_tr_b16 a[16:17], v11 offset:5056
    ds_read_b64_tr_b16 a[18:19], v11 offset:7360
    buffer_load_dwordx4 v4, s[24:27], s86 offen offset:2048 lds
    v_mfma_f32_32x32x16_bf16 v[160:175], a[36:39], v[20:23], v[160:175]
    ds_read_b64_tr_b16 a[20:21], v11 offset:5120
    ds_read_b64_tr_b16 a[22:23], v11 offset:7424
    ds_write_b128 v252, v[248:251] offset:8192
    v_mfma_f32_32x32x16_bf16 v[176:191], a[40:43], v[20:23], v[176:191]
    ds_read_b64_tr_b16 a[24:25], v11 offset:9216
    ds_read_b64_tr_b16 a[26:27], v11 offset:11520
    v_mfma_f32_32x32x16_bf16 v[192:207], a[44:47], v[20:23], v[192:207]
    ds_read_b64_tr_b16 a[28:29], v11 offset:9280
    ds_read_b64_tr_b16 a[30:31], v11 offset:11584
    buffer_load_dwordx4 v5, s[24:27], s86 offen offset:3072 lds
    ds_write_b128 v252, v[248:251] offset:12288
    s_waitcnt lgkmcnt(11)
    v_mfma_f32_32x32x16_bf16 v[208:223], a[0:3], v[20:23], v[208:223]
    ds_read_b64_tr_b16 a[32:33], v11 offset:9344
    ds_read_b64_tr_b16 a[34:35], v11 offset:11648
    v_mfma_f32_32x32x16_bf16 v[224:239], a[4:7], v[20:23], v[224:239]
    ds_read_b64_tr_b16 a[36:37], v11 offset:9408
    ds_read_b64_tr_b16 a[38:39], v11 offset:11712
    v_mfma_f32_32x32x16_bf16 a[168:183], a[8:11], v[20:23], a[168:183]
    ds_read_b64_tr_b16 a[40:41], v11 offset:9472
    ds_read_b64_tr_b16 a[42:43], v11 offset:11776
    s_add_u32 m0, s47, 77824
    s_nop 0
    buffer_load_dwordx4 v6, s[24:27], s86 offen offset:0 lds
    v_mfma_f32_32x32x16_bf16 a[184:199], a[12:15], v[20:23], a[184:199]
    ds_read_b64_tr_b16 a[44:45], v11 offset:9536
    ds_read_b64_tr_b16 a[46:47], v11 offset:11840
    s_waitcnt lgkmcnt(9)
    v_mfma_f32_32x32x16_bf16 a[200:215], a[16:19], v[20:23], a[200:215]
    ds_read_b64_tr_b16 a[0:1], v11 offset:9600
    ds_read_b64_tr_b16 a[2:3], v11 offset:11904
    v_mfma_f32_32x32x16_bf16 a[216:231], a[20:23], v[20:23], a[216:231]
    ds_read_b64_tr_b16 a[4:5], v11 offset:9664
    ds_read_b64_tr_b16 a[6:7], v11 offset:11968
    buffer_load_dwordx4 v7, s[24:27], s86 offen offset:1024 lds
    v_mfma_f32_32x32x16_bf16 v[160:175], a[24:27], v[24:27], v[160:175]
    ds_read_b64_tr_b16 a[8:9], v11 offset:9728
    ds_read_b64_tr_b16 a[10:11], v11 offset:12032
    v_mfma_f32_32x32x16_bf16 v[176:191], a[28:31], v[24:27], v[176:191]
    ds_read_b64_tr_b16 a[12:13], v11 offset:13824
    ds_read_b64_tr_b16 a[14:15], v11 offset:16128
    s_waitcnt lgkmcnt(8)
    v_mfma_f32_32x32x16_bf16 v[192:207], a[32:35], v[24:27], v[192:207]
    ds_read_b64_tr_b16 a[16:17], v11 offset:13888
    ds_read_b64_tr_b16 a[18:19], v11 offset:16192
    buffer_load_dwordx4 v8, s[24:27], s86 offen offset:2048 lds
    v_mfma_f32_32x32x16_bf16 v[208:223], a[36:39], v[24:27], v[208:223]
    ds_read_b64_tr_b16 a[20:21], v11 offset:13952
    ds_read_b64_tr_b16 a[22:23], v11 offset:16256
    v_mfma_f32_32x32x16_bf16 v[224:239], a[40:43], v[24:27], v[224:239]
    ds_read_b64_tr_b16 a[24:25], v11 offset:14016
    ds_read_b64_tr_b16 a[26:27], v11 offset:16320
    v_mfma_f32_32x32x16_bf16 a[168:183], a[44:47], v[24:27], a[168:183]
    ds_read_b64_tr_b16 a[28:29], v11 offset:14080
    ds_read_b64_tr_b16 a[30:31], v11 offset:16384
    buffer_load_dwordx4 v9, s[24:27], s86 offen offset:3072 lds
    s_waitcnt lgkmcnt(8)
    v_mfma_f32_32x32x16_bf16 a[184:199], a[0:3], v[24:27], a[184:199]
    ds_read_b64_tr_b16 a[32:33], v11 offset:14144
    ds_read_b64_tr_b16 a[34:35], v11 offset:16448
    v_mfma_f32_32x32x16_bf16 a[200:215], a[4:7], v[24:27], a[200:215]
    ds_read_b64_tr_b16 a[36:37], v11 offset:14208
    ds_read_b64_tr_b16 a[38:39], v11 offset:16512
    v_mfma_f32_32x32x16_bf16 a[216:231], a[8:11], v[24:27], a[216:231]
    ds_read_b64_tr_b16 a[40:41], v11 offset:14272
    ds_read_b64_tr_b16 a[42:43], v11 offset:16576
    s_add_u32 m0, s47, 81920
    s_nop 0
    buffer_load_dwordx4 v10, s[24:27], s86 offen offset:0 lds
    v_mfma_f32_32x32x16_bf16 v[160:175], a[12:15], v[28:31], v[160:175]
    ds_read_b64_tr_b16 a[44:45], v11 offset:14336
    ds_read_b64_tr_b16 a[46:47], v11 offset:16640
    s_waitcnt lgkmcnt(8)
    v_mfma_f32_32x32x16_bf16 v[176:191], a[16:19], v[28:31], v[176:191]
    s_waitcnt vmcnt(15)
    s_barrier
    ds_read_b64_tr_b16 a[0:1], v11 offset:36864
    ds_read_b64_tr_b16 a[2:3], v11 offset:39168
    v_mfma_f32_32x32x16_bf16 v[192:207], a[20:23], v[28:31], v[192:207]
    ds_read_b64_tr_b16 a[4:5], v11 offset:36928
    ds_read_b64_tr_b16 a[6:7], v11 offset:39232
    s_add_u32 m0, s47, 110592
    s_nop 0
    buffer_load_dwordx4 v2, s[24:27], s87 offen offset:0 lds
    v_mfma_f32_32x32x16_bf16 v[208:223], a[24:27], v[28:31], v[208:223]
    ds_read_b64_tr_b16 a[8:9], v11 offset:36992
    ds_read_b64_tr_b16 a[10:11], v11 offset:39296
    v_mfma_f32_32x32x16_bf16 v[224:239], a[28:31], v[28:31], v[224:239]
    ds_read_b64_tr_b16 a[12:13], v11 offset:37056
    ds_read_b64_tr_b16 a[14:15], v11 offset:39360
    s_waitcnt lgkmcnt(8)
    v_mfma_f32_32x32x16_bf16 a[168:183], a[32:35], v[28:31], a[168:183]
    ds_read_b64_tr_b16 a[16:17], v11 offset:37120
    ds_read_b64_tr_b16 a[18:19], v11 offset:39424
    v_mfma_f32_32x32x16_bf16 a[184:199], a[36:39], v[28:31], a[184:199]
    ds_read_b64_tr_b16 a[20:21], v11 offset:37184
    ds_read_b64_tr_b16 a[22:23], v11 offset:39488
    buffer_load_dwordx4 v3, s[24:27], s87 offen offset:1024 lds
    v_mfma_f32_32x32x16_bf16 a[200:215], a[40:43], v[28:31], a[200:215]
    ds_read_b64_tr_b16 a[24:25], v11 offset:37248
    ds_read_b64_tr_b16 a[26:27], v11 offset:39552
    v_mfma_f32_32x32x16_bf16 a[216:231], a[44:47], v[28:31], a[216:231]
    ds_read_b64_tr_b16 a[28:29], v11 offset:37312
    ds_read_b64_tr_b16 a[30:31], v11 offset:39616
    s_waitcnt lgkmcnt(8)
    v_mfma_f32_32x32x16_bf16 v[160:175], a[0:3], v[32:35], v[160:175]
    ds_read_b64_tr_b16 a[32:33], v11 offset:37376
    ds_read_b64_tr_b16 a[34:35], v11 offset:39680
    v_mfma_f32_32x32x16_bf16 v[176:191], a[4:7], v[32:35], v[176:191]
    ds_read_b64_tr_b16 a[36:37], v11 offset:41472
    ds_read_b64_tr_b16 a[38:39], v11 offset:43776
    buffer_load_dwordx4 v4, s[24:27], s87 offen offset:2048 lds
    v_mfma_f32_32x32x16_bf16 v[192:207], a[8:11], v[32:35], v[192:207]
    ds_read_b64_tr_b16 a[40:41], v11 offset:41536
    ds_read_b64_tr_b16 a[42:43], v11 offset:43840
    v_mfma_f32_32x32x16_bf16 v[208:223], a[12:15], v[32:35], v[208:223]
    ds_read_b64_tr_b16 a[44:45], v11 offset:41600
    ds_read_b64_tr_b16 a[46:47], v11 offset:43904
    s_waitcnt lgkmcnt(8)
    v_mfma_f32_32x32x16_bf16 v[224:239], a[16:19], v[32:35], v[224:239]
    ds_read_b64_tr_b16 a[0:1], v11 offset:41664
    ds_read_b64_tr_b16 a[2:3], v11 offset:43968
    v_mfma_f32_32x32x16_bf16 a[168:183], a[20:23], v[32:35], a[168:183]
    ds_read_b64_tr_b16 a[4:5], v11 offset:41728
    ds_read_b64_tr_b16 a[6:7], v11 offset:44032
    buffer_load_dwordx4 v5, s[24:27], s87 offen offset:3072 lds
    v_mfma_f32_32x32x16_bf16 a[184:199], a[24:27], v[32:35], a[184:199]
    ds_read_b64_tr_b16 a[8:9], v11 offset:41792
    ds_read_b64_tr_b16 a[10:11], v11 offset:44096
    v_mfma_f32_32x32x16_bf16 a[200:215], a[28:31], v[32:35], a[200:215]
    ds_read_b64_tr_b16 a[12:13], v11 offset:41856
    ds_read_b64_tr_b16 a[14:15], v11 offset:44160
    s_waitcnt lgkmcnt(8)
    v_mfma_f32_32x32x16_bf16 a[216:231], a[32:35], v[32:35], a[216:231]
    ds_read_b64_tr_b16 a[16:17], v11 offset:41920
    ds_read_b64_tr_b16 a[18:19], v11 offset:44224
    s_waitcnt vmcnt(12)
    v_accvgpr_read_b32 v248, a144
    v_mfma_f32_32x32x16_bf16 v[160:175], a[36:39], v[36:39], v[160:175]
    ds_read_b64_tr_b16 a[20:21], v11 offset:41984
    ds_read_b64_tr_b16 a[22:23], v11 offset:44288
    s_add_u32 m0, s47, 114688
    s_nop 0
    buffer_load_dwordx4 v6, s[24:27], s87 offen offset:0 lds
    ds_write_b32 v248, a240
    v_mfma_f32_32x32x16_bf16 v[176:191], a[40:43], v[36:39], v[176:191]
    ds_read_b64_tr_b16 a[24:25], v11 offset:46080
    ds_read_b64_tr_b16 a[26:27], v11 offset:48384
    v_accvgpr_read_b32 v249, a145
    ds_write_b32 v249, a241
    v_mfma_f32_32x32x16_bf16 v[192:207], a[44:47], v[36:39], v[192:207]
    ds_read_b64_tr_b16 a[28:29], v11 offset:46144
    ds_read_b64_tr_b16 a[30:31], v11 offset:48448
    v_accvgpr_read_b32 v248, a146
    s_waitcnt lgkmcnt(10)
    v_mfma_f32_32x32x16_bf16 v[208:223], a[0:3], v[36:39], v[208:223]
    ds_read_b64_tr_b16 a[32:33], v11 offset:46208
    ds_read_b64_tr_b16 a[34:35], v11 offset:48512
    ds_write_b32 v248, a242
    v_mfma_f32_32x32x16_bf16 v[224:239], a[4:7], v[36:39], v[224:239]
    ds_read_b64_tr_b16 a[36:37], v11 offset:46272
    ds_read_b64_tr_b16 a[38:39], v11 offset:48576
    buffer_load_dwordx4 v7, s[24:27], s87 offen offset:1024 lds
    v_accvgpr_read_b32 v249, a147
    ds_write_b32 v249, a243
    v_mfma_f32_32x32x16_bf16 a[168:183], a[8:11], v[36:39], a[168:183]
    ds_read_b64_tr_b16 a[40:41], v11 offset:46336
    ds_read_b64_tr_b16 a[42:43], v11 offset:48640
    v_accvgpr_read_b32 v248, a148
    v_mfma_f32_32x32x16_bf16 a[184:199], a[12:15], v[36:39], a[184:199]
    ds_read_b64_tr_b16 a[44:45], v11 offset:46400
    ds_read_b64_tr_b16 a[46:47], v11 offset:48704
    ds_write_b32 v248, a244
    s_waitcnt lgkmcnt(11)
    v_mfma_f32_32x32x16_bf16 a[200:215], a[16:19], v[36:39], a[200:215]
    ds_read_b64_tr_b16 a[0:1], v11 offset:46464
    ds_read_b64_tr_b16 a[2:3], v11 offset:48768
    v_accvgpr_read_b32 v249, a149
    ds_write_b32 v249, a245
    v_mfma_f32_32x32x16_bf16 a[216:231], a[20:23], v[36:39], a[216:231]
    ds_read_b64_tr_b16 a[4:5], v11 offset:46528
    ds_read_b64_tr_b16 a[6:7], v11 offset:48832
    buffer_load_dwordx4 v8, s[24:27], s87 offen offset:2048 lds
    v_accvgpr_read_b32 v251, a138
    v_mfma_f32_32x32x16_bf16 v[160:175], a[24:27], v[40:43], v[160:175]
    ds_read_b64_tr_b16 a[8:9], v11 offset:46592
    ds_read_b64_tr_b16 a[10:11], v11 offset:48896
    v_mfma_f32_32x32x16_bf16 v[176:191], a[28:31], v[40:43], v[176:191]
    ds_read_b64_tr_b16 a[12:13], v11 offset:50688
    ds_read_b64_tr_b16 a[14:15], v11 offset:52992
    s_waitcnt lgkmcnt(10)
    v_mfma_f32_32x32x16_bf16 v[192:207], a[32:35], v[40:43], v[192:207]
    ds_read_b64_tr_b16 a[16:17], v11 offset:50752
    ds_read_b64_tr_b16 a[18:19], v11 offset:53056
    v_mfma_f32_32x32x16_bf16 v[208:223], a[36:39], v[40:43], v[208:223]
    ds_read_b64_tr_b16 a[20:21], v11 offset:50816
    ds_read_b64_tr_b16 a[22:23], v11 offset:53120
    buffer_load_dwordx4 v9, s[24:27], s87 offen offset:3072 lds
    v_mfma_f32_32x32x16_bf16 v[224:239], a[40:43], v[40:43], v[224:239]
    ds_read_b64_tr_b16 a[24:25], v11 offset:50880
    ds_read_b64_tr_b16 a[26:27], v11 offset:53184
    v_mfma_f32_32x32x16_bf16 a[168:183], a[44:47], v[40:43], a[168:183]
    ds_read_b64_tr_b16 a[28:29], v11 offset:50944
    ds_read_b64_tr_b16 a[30:31], v11 offset:53248
    s_waitcnt lgkmcnt(8)
    v_mfma_f32_32x32x16_bf16 a[184:199], a[0:3], v[40:43], a[184:199]
    ds_read_b64_tr_b16 a[32:33], v11 offset:51008
    ds_read_b64_tr_b16 a[34:35], v11 offset:53312
    v_mfma_f32_32x32x16_bf16 a[200:215], a[4:7], v[40:43], a[200:215]
    ds_read_b64_tr_b16 a[36:37], v11 offset:51072
    ds_read_b64_tr_b16 a[38:39], v11 offset:53376
    s_add_u32 m0, s47, 118784
    s_nop 0
    buffer_load_dwordx4 v10, s[24:27], s87 offen offset:0 lds
    v_mfma_f32_32x32x16_bf16 a[216:231], a[8:11], v[40:43], a[216:231]
    ds_read_b64_tr_b16 a[40:41], v11 offset:51136
    ds_read_b64_tr_b16 a[42:43], v11 offset:53440
    v_mfma_f32_32x32x16_bf16 v[160:175], a[12:15], v[44:47], v[160:175]
    ds_read_b64_tr_b16 a[44:45], v11 offset:51200
    ds_read_b64_tr_b16 a[46:47], v11 offset:53504
    s_waitcnt lgkmcnt(8)
    v_mfma_f32_32x32x16_bf16 v[176:191], a[16:19], v[44:47], v[176:191]
    s_waitcnt vmcnt(9)
    s_barrier
    ds_read_b64_tr_b16 a[0:1], v12 offset:8192
    ds_read_b64_tr_b16 a[2:3], v12 offset:10496
    v_mfma_f32_32x32x16_bf16 v[192:207], a[20:23], v[44:47], v[192:207]
    ds_read_b64_tr_b16 a[4:5], v12 offset:8256
    ds_read_b64_tr_b16 a[6:7], v12 offset:10560
    v_mfma_f32_32x32x16_bf16 v[208:223], a[24:27], v[44:47], v[208:223]
    ds_read_b64_tr_b16 a[8:9], v12 offset:8320
    ds_read_b64_tr_b16 a[10:11], v12 offset:10624
    s_add_u32 m0, s47, 0
    s_nop 0
    buffer_load_dwordx4 v2, s[24:27], s88 offen offset:0 lds
    ds_read_b64_tr_b16 a[48:49], v251 offset:0
    v_mfma_f32_32x32x16_bf16 v[224:239], a[28:31], v[44:47], v[224:239]
    ds_read_b64_tr_b16 a[12:13], v12 offset:8384
    ds_read_b64_tr_b16 a[14:15], v12 offset:10688
    s_waitcnt lgkmcnt(9)
    v_mfma_f32_32x32x16_bf16 a[168:183], a[32:35], v[44:47], a[168:183]
    ds_read_b64_tr_b16 a[16:17], v12 offset:8448
    ds_read_b64_tr_b16 a[18:19], v12 offset:10752
    v_mfma_f32_32x32x16_bf16 a[184:199], a[36:39], v[44:47], a[184:199]
    ds_read_b64_tr_b16 a[20:21], v12 offset:8512
    ds_read_b64_tr_b16 a[22:23], v12 offset:10816
    buffer_load_dwordx4 v3, s[24:27], s88 offen offset:1024 lds
    ds_read_b64_tr_b16 a[50:51], v251 offset:384
    v_mfma_f32_32x32x16_bf16 a[200:215], a[40:43], v[44:47], a[200:215]
    ds_read_b64_tr_b16 a[24:25], v12 offset:8576
    ds_read_b64_tr_b16 a[26:27], v12 offset:10880
    v_mfma_f32_32x32x16_bf16 a[216:231], a[44:47], v[44:47], a[216:231]
    ds_read_b64_tr_b16 a[28:29], v12 offset:8640
    ds_read_b64_tr_b16 a[30:31], v12 offset:10944
    s_waitcnt lgkmcnt(9)
    v_mfma_f32_32x32x16_bf16 v[160:175], a[0:3], v[48:51], v[160:175]
    ds_read_b64_tr_b16 a[32:33], v12 offset:8704
    ds_read_b64_tr_b16 a[34:35], v12 offset:11008
    ds_read_b64_tr_b16 a[52:53], v251 offset:768
    v_mfma_f32_32x32x16_bf16 v[176:191], a[4:7], v[48:51], v[176:191]
    ds_read_b64_tr_b16 a[36:37], v12 offset:12800
    ds_read_b64_tr_b16 a[38:39], v12 offset:15104
    buffer_load_dwordx4 v4, s[24:27], s88 offen offset:2048 lds
    v_mfma_f32_32x32x16_bf16 v[192:207], a[8:11], v[48:51], v[192:207]
    ds_read_b64_tr_b16 a[40:41], v12 offset:12864
    ds_read_b64_tr_b16 a[42:43], v12 offset:15168
    v_mfma_f32_32x32x16_bf16 v[208:223], a[12:15], v[48:51], v[208:223]
    ds_read_b64_tr_b16 a[44:45], v12 offset:12928
    ds_read_b64_tr_b16 a[46:47], v12 offset:15232
    ds_read_b64_tr_b16 a[54:55], v251 offset:1152
    s_waitcnt lgkmcnt(10)
    v_mfma_f32_32x32x16_bf16 v[224:239], a[16:19], v[48:51], v[224:239]
    ds_read_b64_tr_b16 a[0:1], v12 offset:12992
    ds_read_b64_tr_b16 a[2:3], v12 offset:15296
    v_mfma_f32_32x32x16_bf16 a[168:183], a[20:23], v[48:51], a[168:183]
    ds_read_b64_tr_b16 a[4:5], v12 offset:13056
    ds_read_b64_tr_b16 a[6:7], v12 offset:15360
    buffer_load_dwordx4 v5, s[24:27], s88 offen offset:3072 lds
    v_mfma_f32_32x32x16_bf16 a[184:199], a[24:27], v[48:51], a[184:199]
    ds_read_b64_tr_b16 a[8:9], v12 offset:13120
    ds_read_b64_tr_b16 a[10:11], v12 offset:15424
    ds_read_b64_tr_b16 a[56:57], v251 offset:1536
    v_mfma_f32_32x32x16_bf16 a[200:215], a[28:31], v[48:51], a[200:215]
    ds_read_b64_tr_b16 a[12:13], v12 offset:13184
    ds_read_b64_tr_b16 a[14:15], v12 offset:15488
    s_waitcnt lgkmcnt(10)
    v_mfma_f32_32x32x16_bf16 a[216:231], a[32:35], v[48:51], a[216:231]
    ds_read_b64_tr_b16 a[16:17], v12 offset:13248
    ds_read_b64_tr_b16 a[18:19], v12 offset:15552
    v_mfma_f32_32x32x16_bf16 v[160:175], a[36:39], v[52:55], v[160:175]
    ds_read_b64_tr_b16 a[20:21], v12 offset:13312
    ds_read_b64_tr_b16 a[22:23], v12 offset:15616
    s_add_u32 m0, s47, 4096
    s_nop 0
    buffer_load_dwordx4 v6, s[24:27], s88 offen offset:0 lds
    ds_read_b64_tr_b16 a[58:59], v251 offset:1920
    v_mfma_f32_32x32x16_bf16 v[176:191], a[40:43], v[52:55], v[176:191]
    ds_read_b64_tr_b16 a[24:25], v12 offset:17408
    ds_read_b64_tr_b16 a[26:27], v12 offset:19712
    v_mfma_f32_32x32x16_bf16 v[192:207], a[44:47], v[52:55], v[192:207]
    ds_read_b64_tr_b16 a[28:29], v12 offset:17472
    ds_read_b64_tr_b16 a[30:31], v12 offset:19776
    s_waitcnt lgkmcnt(9)
    v_mfma_f32_32x32x16_bf16 v[208:223], a[0:3], v[52:55], v[208:223]
    ds_read_b64_tr_b16 a[32:33], v12 offset:17536
    ds_read_b64_tr_b16 a[34:35], v12 offset:19840
    ds_read_b64_tr_b16 a[60:61], v251 offset:32
    v_mfma_f32_32x32x16_bf16 v[224:239], a[4:7], v[52:55], v[224:239]
    ds_read_b64_tr_b16 a[36:37], v12 offset:17600
    ds_read_b64_tr_b16 a[38:39], v12 offset:19904
    buffer_load_dwordx4 v7, s[24:27], s88 offen offset:1024 lds
    v_mfma_f32_32x32x16_bf16 a[168:183], a[8:11], v[52:55], a[168:183]
    ds_read_b64_tr_b16 a[40:41], v12 offset:17664
    ds_read_b64_tr_b16 a[42:43], v12 offset:19968
    v_mfma_f32_32x32x16_bf16 a[184:199], a[12:15], v[52:55], a[184:199]
    ds_read_b64_tr_b16 a[44:45], v12 offset:17728
    ds_read_b64_tr_b16 a[46:47], v12 offset:20032
    ds_read_b64_tr_b16 a[62:63], v251 offset:416
    s_waitcnt lgkmcnt(10)
    v_mfma_f32_32x32x16_bf16 a[200:215], a[16:19], v[52:55], a[200:215]
    ds_read_b64_tr_b16 a[0:1], v12 offset:17792
    ds_read_b64_tr_b16 a[2:3], v12 offset:20096
    v_mfma_f32_32x32x16_bf16 a[216:231], a[20:23], v[52:55], a[216:231]
    ds_read_b64_tr_b16 a[4:5], v12 offset:17856
    ds_read_b64_tr_b16 a[6:7], v12 offset:20160
    buffer_load_dwordx4 v8, s[24:27], s88 offen offset:2048 lds
    v_mfma_f32_32x32x16_bf16 v[160:175], a[24:27], v[56:59], v[160:175]
    ds_read_b64_tr_b16 a[8:9], v12 offset:17920
    ds_read_b64_tr_b16 a[10:11], v12 offset:20224
    ds_read_b64_tr_b16 a[64:65], v251 offset:800
    v_mfma_f32_32x32x16_bf16 v[176:191], a[28:31], v[56:59], v[176:191]
    ds_read_b64_tr_b16 a[12:13], v12 offset:22016
    ds_read_b64_tr_b16 a[14:15], v12 offset:24320
    s_waitcnt lgkmcnt(10)
    v_mfma_f32_32x32x16_bf16 v[192:207], a[32:35], v[56:59], v[192:207]
    ds_read_b64_tr_b16 a[16:17], v12 offset:22080
    ds_read_b64_tr_b16 a[18:19], v12 offset:24384
    v_mfma_f32_32x32x16_bf16 v[208:223], a[36:39], v[56:59], v[208:223]
    ds_read_b64_tr_b16 a[20:21], v12 offset:22144
    ds_read_b64_tr_b16 a[22:23], v12 offset:24448
    buffer_load_dwordx4 v9, s[24:27], s88 offen offset:3072 lds
    ds_read_b64_tr_b16 a[66:67], v251 offset:1184
    v_mfma_f32_32x32x16_bf16 v[224:239], a[40:43], v[56:59], v[224:239]
    ds_read_b64_tr_b16 a[24:25], v12 offset:22208
    ds_read_b64_tr_b16 a[26:27], v12 offset:24512
    v_mfma_f32_32x32x16_bf16 a[168:183], a[44:47], v[56:59], a[168:183]
    ds_read_b64_tr_b16 a[28:29], v12 offset:22272
    ds_read_b64_tr_b16 a[30:31], v12 offset:24576
    s_waitcnt lgkmcnt(9)
    v_mfma_f32_32x32x16_bf16 a[184:199], a[0:3], v[56:59], a[184:199]
    ds_read_b64_tr_b16 a[32:33], v12 offset:22336
    ds_read_b64_tr_b16 a[34:35], v12 offset:24640
    ds_read_b64_tr_b16 a[68:69], v251 offset:1568
    v_mfma_f32_32x32x16_bf16 a[200:215], a[4:7], v[56:59], a[200:215]
    ds_read_b64_tr_b16 a[36:37], v12 offset:22400
    ds_read_b64_tr_b16 a[38:39], v12 offset:24704
    s_add_u32 m0, s47, 8192
    s_nop 0
    buffer_load_dwordx4 v10, s[24:27], s88 offen offset:0 lds
    v_mfma_f32_32x32x16_bf16 a[216:231], a[8:11], v[56:59], a[216:231]
    ds_read_b64_tr_b16 a[40:41], v12 offset:22464
    ds_read_b64_tr_b16 a[42:43], v12 offset:24768
    v_mfma_f32_32x32x16_bf16 v[160:175], a[12:15], v[60:63], v[160:175]
    ds_read_b64_tr_b16 a[44:45], v12 offset:22528
    ds_read_b64_tr_b16 a[46:47], v12 offset:24832
    ds_read_b64_tr_b16 a[70:71], v251 offset:1952
    s_waitcnt lgkmcnt(10)
    v_mfma_f32_32x32x16_bf16 v[176:191], a[16:19], v[60:63], v[176:191]
    s_waitcnt vmcnt(9)
    s_barrier
    ds_read_b64_tr_b16 a[0:1], v12 offset:45056
    ds_read_b64_tr_b16 a[2:3], v12 offset:47360
    v_mfma_f32_32x32x16_bf16 v[192:207], a[20:23], v[60:63], v[192:207]
    ds_read_b64_tr_b16 a[4:5], v12 offset:45120
    ds_read_b64_tr_b16 a[6:7], v12 offset:47424
    v_mfma_f32_32x32x16_bf16 v[208:223], a[24:27], v[60:63], v[208:223]
    ds_read_b64_tr_b16 a[8:9], v12 offset:45184
    ds_read_b64_tr_b16 a[10:11], v12 offset:47488
    s_add_u32 m0, s47, 36864
    s_nop 0
    buffer_load_dwordx4 v2, s[24:27], s89 offen offset:0 lds
    ds_read_b64_tr_b16 a[72:73], v251 offset:2304
    v_mfma_f32_32x32x16_bf16 v[224:239], a[28:31], v[60:63], v[224:239]
    ds_read_b64_tr_b16 a[12:13], v12 offset:45248
    ds_read_b64_tr_b16 a[14:15], v12 offset:47552
    s_waitcnt lgkmcnt(10)
    v_mfma_f32_32x32x16_bf16 a[168:183], a[32:35], v[60:63], a[168:183]
    ds_read_b64_tr_b16 a[16:17], v12 offset:45312
    ds_read_b64_tr_b16 a[18:19], v12 offset:47616
    v_mfma_f32_32x32x16_bf16 a[184:199], a[36:39], v[60:63], a[184:199]
    ds_read_b64_tr_b16 a[20:21], v12 offset:45376
    ds_read_b64_tr_b16 a[22:23], v12 offset:47680
    buffer_load_dwordx4 v3, s[24:27], s89 offen offset:1024 lds
    ds_read_b64_tr_b16 a[74:75], v251 offset:2688
    v_mfma_f32_32x32x16_bf16 a[200:215], a[40:43], v[60:63], a[200:215]
    ds_read_b64_tr_b16 a[24:25], v12 offset:45440
    ds_read_b64_tr_b16 a[26:27], v12 offset:47744
    v_mfma_f32_32x32x16_bf16 a[216:231], a[44:47], v[60:63], a[216:231]
    ds_read_b64_tr_b16 a[28:29], v12 offset:45504
    ds_read_b64_tr_b16 a[30:31], v12 offset:47808
    s_waitcnt lgkmcnt(9)
    v_mfma_f32_32x32x16_bf16 v[160:175], a[0:3], v[64:67], v[160:175]
    ds_read_b64_tr_b16 a[32:33], v12 offset:45568
    ds_read_b64_tr_b16 a[34:35], v12 offset:47872
    ds_read_b64_tr_b16 a[76:77], v251 offset:3072
    v_mfma_f32_32x32x16_bf16 v[176:191], a[4:7], v[64:67], v[176:191]
    ds_read_b64_tr_b16 a[36:37], v12 offset:49664
    ds_read_b64_tr_b16 a[38:39], v12 offset:51968
    buffer_load_dwordx4 v4, s[24:27], s89 offen offset:2048 lds
    v_mfma_f32_32x32x16_bf16 v[192:207], a[8:11], v[64:67], v[192:207]
    ds_read_b64_tr_b16 a[40:41], v12 offset:49728
    ds_read_b64_tr_b16 a[42:43], v12 offset:52032
    v_mfma_f32_32x32x16_bf16 v[208:223], a[12:15], v[64:67], v[208:223]
    ds_read_b64_tr_b16 a[44:45], v12 offset:49792
    ds_read_b64_tr_b16 a[46:47], v12 offset:52096
    ds_read_b64_tr_b16 a[78:79], v251 offset:3456
    s_waitcnt lgkmcnt(10)
    v_mfma_f32_32x32x16_bf16 v[224:239], a[16:19], v[64:67], v[224:239]
    ds_read_b64_tr_b16 a[0:1], v12 offset:49856
    ds_read_b64_tr_b16 a[2:3], v12 offset:52160
    v_mfma_f32_32x32x16_bf16 a[168:183], a[20:23], v[64:67], a[168:183]
    ds_read_b64_tr_b16 a[4:5], v12 offset:49920
    ds_read_b64_tr_b16 a[6:7], v12 offset:52224
    buffer_load_dwordx4 v5, s[24:27], s89 offen offset:3072 lds
    v_mfma_f32_32x32x16_bf16 a[184:199], a[24:27], v[64:67], a[184:199]
    ds_read_b64_tr_b16 a[8:9], v12 offset:49984
    ds_read_b64_tr_b16 a[10:11], v12 offset:52288
    ds_read_b64_tr_b16 a[80:81], v251 offset:1600
    v_mfma_f32_32x32x16_bf16 a[200:215], a[28:31], v[64:67], a[200:215]
    ds_read_b64_tr_b16 a[12:13], v12 offset:50048
    ds_read_b64_tr_b16 a[14:15], v12 offset:52352
    s_waitcnt lgkmcnt(10)
    v_mfma_f32_32x32x16_bf16 a[216:231], a[32:35], v[64:67], a[216:231]
    ds_read_b64_tr_b16 a[16:17], v12 offset:50112
    ds_read_b64_tr_b16 a[18:19], v12 offset:52416
    v_mfma_f32_32x32x16_bf16 v[160:175], a[36:39], v[68:71], v[160:175]
    ds_read_b64_tr_b16 a[20:21], v12 offset:50176
    ds_read_b64_tr_b16 a[22:23], v12 offset:52480
    s_add_u32 m0, s47, 40960
    s_nop 0
    buffer_load_dwordx4 v6, s[24:27], s89 offen offset:0 lds
    ds_read_b64_tr_b16 a[82:83], v251 offset:1984
    v_mfma_f32_32x32x16_bf16 v[176:191], a[40:43], v[68:71], v[176:191]
    ds_read_b64_tr_b16 a[24:25], v12 offset:54272
    ds_read_b64_tr_b16 a[26:27], v12 offset:56576
    v_mfma_f32_32x32x16_bf16 v[192:207], a[44:47], v[68:71], v[192:207]
    ds_read_b64_tr_b16 a[28:29], v12 offset:54336
    ds_read_b64_tr_b16 a[30:31], v12 offset:56640
    s_waitcnt lgkmcnt(9)
    v_mfma_f32_32x32x16_bf16 v[208:223], a[0:3], v[68:71], v[208:223]
    ds_read_b64_tr_b16 a[32:33], v12 offset:54400
    ds_read_b64_tr_b16 a[34:35], v12 offset:56704
    ds_read_b64_tr_b16 a[84:85], v251 offset:2336
    v_mfma_f32_32x32x16_bf16 v[224:239], a[4:7], v[68:71], v[224:239]
    ds_read_b64_tr_b16 a[36:37], v12 offset:54464
    ds_read_b64_tr_b16 a[38:39], v12 offset:56768
    buffer_load_dwordx4 v7, s[24:27], s89 offen offset:1024 lds
    v_mfma_f32_32x32x16_bf16 a[168:183], a[8:11], v[68:71], a[168:183]
    ds_read_b64_tr_b16 a[40:41], v12 offset:54528
    ds_read_b64_tr_b16 a[42:43], v12 offset:56832
    v_mfma_f32_32x32x16_bf16 a[184:199], a[12:15], v[68:71], a[184:199]
    ds_read_b64_tr_b16 a[44:45], v12 offset:54592
    ds_read_b64_tr_b16 a[46:47], v12 offset:56896
    ds_read_b64_tr_b16 a[86:87], v251 offset:2720
    s_waitcnt lgkmcnt(10)
    v_mfma_f32_32x32x16_bf16 a[200:215], a[16:19], v[68:71], a[200:215]
    ds_read_b64_tr_b16 a[0:1], v12 offset:54656
    ds_read_b64_tr_b16 a[2:3], v12 offset:56960
    v_mfma_f32_32x32x16_bf16 a[216:231], a[20:23], v[68:71], a[216:231]
    ds_read_b64_tr_b16 a[4:5], v12 offset:54720
    ds_read_b64_tr_b16 a[6:7], v12 offset:57024
    buffer_load_dwordx4 v8, s[24:27], s89 offen offset:2048 lds
    v_mfma_f32_32x32x16_bf16 v[160:175], a[24:27], v[72:75], v[160:175]
    ds_read_b64_tr_b16 a[8:9], v12 offset:54784
    ds_read_b64_tr_b16 a[10:11], v12 offset:57088
    ds_read_b64_tr_b16 a[88:89], v251 offset:3104
    v_accvgpr_mov_b32 a232, a156
    v_mfma_f32_32x32x16_bf16 v[176:191], a[28:31], v[72:75], v[176:191]
    ds_read_b64_tr_b16 a[12:13], v12 offset:58880
    ds_read_b64_tr_b16 a[14:15], v12 offset:61184
    s_waitcnt lgkmcnt(10)
    v_mfma_f32_32x32x16_bf16 v[192:207], a[32:35], v[72:75], v[192:207]
    ds_read_b64_tr_b16 a[16:17], v12 offset:58944
    ds_read_b64_tr_b16 a[18:19], v12 offset:61248
    v_accvgpr_mov_b32 a233, a157
    v_mfma_f32_32x32x16_bf16 v[208:223], a[36:39], v[72:75], v[208:223]
    ds_read_b64_tr_b16 a[20:21], v12 offset:59008
    ds_read_b64_tr_b16 a[22:23], v12 offset:61312
    buffer_load_dwordx4 v9, s[24:27], s89 offen offset:3072 lds
    ds_read_b64_tr_b16 a[90:91], v251 offset:3488
    v_mfma_f32_32x32x16_bf16 v[224:239], a[40:43], v[72:75], v[224:239]
    ds_read_b64_tr_b16 a[24:25], v12 offset:59072
    ds_read_b64_tr_b16 a[26:27], v12 offset:61376
    v_accvgpr_mov_b32 a234, a158
    v_mfma_f32_32x32x16_bf16 a[168:183], a[44:47], v[72:75], a[168:183]
    ds_read_b64_tr_b16 a[28:29], v12 offset:59136
    ds_read_b64_tr_b16 a[30:31], v12 offset:61440
    s_waitcnt lgkmcnt(9)
    v_mfma_f32_32x32x16_bf16 a[184:199], a[0:3], v[72:75], a[184:199]
    ds_read_b64_tr_b16 a[32:33], v12 offset:59200
    ds_read_b64_tr_b16 a[34:35], v12 offset:61504
    ds_read_b64_tr_b16 a[92:93], v251 offset:3840
    v_accvgpr_mov_b32 a235, a159
    v_mfma_f32_32x32x16_bf16 a[200:215], a[4:7], v[72:75], a[200:215]
    ds_read_b64_tr_b16 a[36:37], v12 offset:59264
    ds_read_b64_tr_b16 a[38:39], v12 offset:61568
    s_add_u32 m0, s47, 45056
    s_nop 0
    buffer_load_dwordx4 v10, s[24:27], s89 offen offset:0 lds
    v_accvgpr_mov_b32 a236, a160
    v_mfma_f32_32x32x16_bf16 a[216:231], a[8:11], v[72:75], a[216:231]
    ds_read_b64_tr_b16 a[40:41], v12 offset:59328
    ds_read_b64_tr_b16 a[42:43], v12 offset:61632
    v_mfma_f32_32x32x16_bf16 v[160:175], a[12:15], v[76:79], v[160:175]
    ds_read_b64_tr_b16 a[44:45], v12 offset:59392
    ds_read_b64_tr_b16 a[46:47], v12 offset:61696
    ds_read_b64_tr_b16 a[94:95], v251 offset:4224
    v_accvgpr_mov_b32 a237, a161
    s_waitcnt lgkmcnt(10)
    v_mfma_f32_32x32x16_bf16 v[176:191], a[16:19], v[76:79], v[176:191]
    s_waitcnt vmcnt(9)
    s_barrier
    ds_read_b64_tr_b16 a[0:1], v11 offset:0
    ds_read_b64_tr_b16 a[2:3], v11 offset:2304
    v_mfma_f32_32x32x16_bf16 v[192:207], a[20:23], v[76:79], v[192:207]
    ds_read_b64_tr_b16 a[4:5], v11 offset:64
    ds_read_b64_tr_b16 a[6:7], v11 offset:2368
    v_accvgpr_mov_b32 a238, a162
    v_mfma_f32_32x32x16_bf16 v[208:223], a[24:27], v[76:79], v[208:223]
    ds_read_b64_tr_b16 a[8:9], v11 offset:128
    ds_read_b64_tr_b16 a[10:11], v11 offset:2432
    s_add_u32 m0, s47, 73728
    s_nop 0
    buffer_load_dwordx4 v2, s[24:27], s90 offen offset:0 lds
    ds_read_b64_tr_b16 a[96:97], v251 offset:4608
    v_mfma_f32_32x32x16_bf16 v[224:239], a[28:31], v[76:79], v[224:239]
    ds_read_b64_tr_b16 a[12:13], v11 offset:192
    ds_read_b64_tr_b16 a[14:15], v11 offset:2496
    v_accvgpr_mov_b32 a239, a163
    s_waitcnt lgkmcnt(10)
    v_mfma_f32_32x32x16_bf16 a[168:183], a[32:35], v[76:79], a[168:183]
    ds_read_b64_tr_b16 a[16:17], v11 offset:256
    ds_read_b64_tr_b16 a[18:19], v11 offset:2560
    v_mfma_f32_32x32x16_bf16 a[184:199], a[36:39], v[76:79], a[184:199]
    ds_read_b64_tr_b16 a[20:21], v11 offset:320
    ds_read_b64_tr_b16 a[22:23], v11 offset:2624
    buffer_load_dwordx4 v3, s[24:27], s90 offen offset:1024 lds
    ds_read_b64_tr_b16 a[98:99], v251 offset:4992
    v_mfma_f32_32x32x16_bf16 a[200:215], a[40:43], v[76:79], a[200:215]
    ds_read_b64_tr_b16 a[24:25], v11 offset:384
    ds_read_b64_tr_b16 a[26:27], v11 offset:2688
    v_mfma_f32_32x32x16_bf16 a[216:231], a[44:47], v[76:79], a[216:231]
    ds_read_b64_tr_b16 a[28:29], v11 offset:448
    ds_read_b64_tr_b16 a[30:31], v11 offset:2752
    s_waitcnt lgkmcnt(9)
    v_mfma_f32_32x32x16_bf16 v[160:175], a[0:3], v[80:83], v[160:175]
    ds_read_b64_tr_b16 a[32:33], v11 offset:512
    ds_read_b64_tr_b16 a[34:35], v11 offset:2816
    ds_read_b64_tr_b16 a[100:101], v251 offset:3136
    v_mfma_f32_32x32x16_bf16 v[176:191], a[4:7], v[80:83], v[176:191]
    ds_read_b64_tr_b16 a[36:37], v11 offset:4608
    ds_read_b64_tr_b16 a[38:39], v11 offset:6912
    buffer_load_dwordx4 v4, s[24:27], s90 offen offset:2048 lds
    v_mfma_f32_32x32x16_bf16 v[192:207], a[8:11], v[80:83], v[192:207]
    ds_read_b64_tr_b16 a[40:41], v11 offset:4672
    ds_read_b64_tr_b16 a[42:43], v11 offset:6976
    v_mfma_f32_32x32x16_bf16 v[208:223], a[12:15], v[80:83], v[208:223]
    ds_read_b64_tr_b16 a[44:45], v11 offset:4736
    ds_read_b64_tr_b16 a[46:47], v11 offset:7040
    ds_read_b64_tr_b16 a[102:103], v251 offset:3520
    s_waitcnt lgkmcnt(10)
    v_mfma_f32_32x32x16_bf16 v[224:239], a[16:19], v[80:83], v[224:239]
    ds_read_b64_tr_b16 a[0:1], v11 offset:4800
    ds_read_b64_tr_b16 a[2:3], v11 offset:7104
    v_mfma_f32_32x32x16_bf16 a[168:183], a[20:23], v[80:83], a[168:183]
    ds_read_b64_tr_b16 a[4:5], v11 offset:4864
    ds_read_b64_tr_b16 a[6:7], v11 offset:7168
    buffer_load_dwordx4 v5, s[24:27], s90 offen offset:3072 lds
    v_mfma_f32_32x32x16_bf16 a[184:199], a[24:27], v[80:83], a[184:199]
    ds_read_b64_tr_b16 a[8:9], v11 offset:4928
    ds_read_b64_tr_b16 a[10:11], v11 offset:7232
    ds_read_b64_tr_b16 a[104:105], v251 offset:3872
    v_mfma_f32_32x32x16_bf16 a[200:215], a[28:31], v[80:83], a[200:215]
    ds_read_b64_tr_b16 a[12:13], v11 offset:4992
    ds_read_b64_tr_b16 a[14:15], v11 offset:7296
    s_waitcnt lgkmcnt(10)
    v_mfma_f32_32x32x16_bf16 a[216:231], a[32:35], v[80:83], a[216:231]
    ds_read_b64_tr_b16 a[16:17], v11 offset:5056
    ds_read_b64_tr_b16 a[18:19], v11 offset:7360
    v_mfma_f32_32x32x16_bf16 v[160:175], a[36:39], v[84:87], v[160:175]
    ds_read_b64_tr_b16 a[20:21], v11 offset:5120
    ds_read_b64_tr_b16 a[22:23], v11 offset:7424
    s_add_u32 m0, s47, 77824
    s_nop 0
    buffer_load_dwordx4 v6, s[24:27], s90 offen offset:0 lds
    ds_read_b64_tr_b16 a[106:107], v251 offset:4256
    v_mfma_f32_32x32x16_bf16 v[176:191], a[40:43], v[84:87], v[176:191]
    ds_read_b64_tr_b16 a[24:25], v11 offset:9216
    ds_read_b64_tr_b16 a[26:27], v11 offset:11520
    v_mfma_f32_32x32x16_bf16 v[192:207], a[44:47], v[84:87], v[192:207]
    ds_read_b64_tr_b16 a[28:29], v11 offset:9280
    ds_read_b64_tr_b16 a[30:31], v11 offset:11584
    s_waitcnt lgkmcnt(9)
    v_mfma_f32_32x32x16_bf16 v[208:223], a[0:3], v[84:87], v[208:223]
    ds_read_b64_tr_b16 a[32:33], v11 offset:9344
    ds_read_b64_tr_b16 a[34:35], v11 offset:11648
    ds_read_b64_tr_b16 a[108:109], v251 offset:4640
    v_mfma_f32_32x32x16_bf16 v[224:239], a[4:7], v[84:87], v[224:239]
    ds_read_b64_tr_b16 a[36:37], v11 offset:9408
    ds_read_b64_tr_b16 a[38:39], v11 offset:11712
    buffer_load_dwordx4 v7, s[24:27], s90 offen offset:1024 lds
    v_mfma_f32_32x32x16_bf16 a[168:183], a[8:11], v[84:87], a[168:183]
    ds_read_b64_tr_b16 a[40:41], v11 offset:9472
    ds_read_b64_tr_b16 a[42:43], v11 offset:11776
    v_mfma_f32_32x32x16_bf16 a[184:199], a[12:15], v[84:87], a[184:199]
    ds_read_b64_tr_b16 a[44:45], v11 offset:9536
    ds_read_b64_tr_b16 a[46:47], v11 offset:11840
    ds_read_b64_tr_b16 a[110:111], v251 offset:5024
    s_waitcnt lgkmcnt(10)
    v_mfma_f32_32x32x16_bf16 a[200:215], a[16:19], v[84:87], a[200:215]
    ds_read_b64_tr_b16 a[0:1], v11 offset:9600
    ds_read_b64_tr_b16 a[2:3], v11 offset:11904
    v_mfma_f32_32x32x16_bf16 a[216:231], a[20:23], v[84:87], a[216:231]
    ds_read_b64_tr_b16 a[4:5], v11 offset:9664
    ds_read_b64_tr_b16 a[6:7], v11 offset:11968
    buffer_load_dwordx4 v8, s[24:27], s90 offen offset:2048 lds
    v_mfma_f32_32x32x16_bf16 v[160:175], a[24:27], v[88:91], v[160:175]
    ds_read_b64_tr_b16 a[8:9], v11 offset:9728
    ds_read_b64_tr_b16 a[10:11], v11 offset:12032
    ds_read_b64_tr_b16 a[112:113], v251 offset:5376
    v_mfma_f32_32x32x16_bf16 v[176:191], a[28:31], v[88:91], v[176:191]
    ds_read_b64_tr_b16 a[12:13], v11 offset:13824
    ds_read_b64_tr_b16 a[14:15], v11 offset:16128
    s_waitcnt lgkmcnt(10)
    v_mfma_f32_32x32x16_bf16 v[192:207], a[32:35], v[88:91], v[192:207]
    ds_read_b64_tr_b16 a[16:17], v11 offset:13888
    ds_read_b64_tr_b16 a[18:19], v11 offset:16192
    v_mfma_f32_32x32x16_bf16 v[208:223], a[36:39], v[88:91], v[208:223]
    ds_read_b64_tr_b16 a[20:21], v11 offset:13952
    ds_read_b64_tr_b16 a[22:23], v11 offset:16256
    buffer_load_dwordx4 v9, s[24:27], s90 offen offset:3072 lds
    ds_read_b64_tr_b16 a[114:115], v251 offset:5760
    v_mfma_f32_32x32x16_bf16 v[224:239], a[40:43], v[88:91], v[224:239]
    ds_read_b64_tr_b16 a[24:25], v11 offset:14016
    ds_read_b64_tr_b16 a[26:27], v11 offset:16320
    v_mfma_f32_32x32x16_bf16 a[168:183], a[44:47], v[88:91], a[168:183]
    ds_read_b64_tr_b16 a[28:29], v11 offset:14080
    ds_read_b64_tr_b16 a[30:31], v11 offset:16384
    s_waitcnt lgkmcnt(9)
    v_mfma_f32_32x32x16_bf16 a[184:199], a[0:3], v[88:91], a[184:199]
    ds_read_b64_tr_b16 a[32:33], v11 offset:14144
    ds_read_b64_tr_b16 a[34:35], v11 offset:16448
    ds_read_b64_tr_b16 a[116:117], v251 offset:6144
    v_mfma_f32_32x32x16_bf16 a[200:215], a[4:7], v[88:91], a[200:215]
    ds_read_b64_tr_b16 a[36:37], v11 offset:14208
    ds_read_b64_tr_b16 a[38:39], v11 offset:16512
    s_add_u32 m0, s47, 81920
    s_nop 0
    buffer_load_dwordx4 v10, s[24:27], s90 offen offset:0 lds
    v_mfma_f32_32x32x16_bf16 a[216:231], a[8:11], v[88:91], a[216:231]
    ds_read_b64_tr_b16 a[40:41], v11 offset:14272
    ds_read_b64_tr_b16 a[42:43], v11 offset:16576
    v_accvgpr_read_b32 v248, a238
    s_nop 0
    buffer_load_dword v249, v248, s[36:39], 0 offen sc1
    v_mfma_f32_32x32x16_bf16 v[160:175], a[12:15], v[92:95], v[160:175]
    ds_read_b64_tr_b16 a[44:45], v11 offset:14336
    ds_read_b64_tr_b16 a[46:47], v11 offset:16640
    ds_read_b64_tr_b16 a[118:119], v251 offset:6528
    s_waitcnt lgkmcnt(10)
    v_mfma_f32_32x32x16_bf16 v[176:191], a[16:19], v[92:95], v[176:191]
    s_waitcnt vmcnt(10)
    s_barrier
    ds_read_b64_tr_b16 a[0:1], v11 offset:36864
    ds_read_b64_tr_b16 a[2:3], v11 offset:39168
    v_mfma_f32_32x32x16_bf16 v[192:207], a[20:23], v[92:95], v[192:207]
    ds_read_b64_tr_b16 a[4:5], v11 offset:36928
    ds_read_b64_tr_b16 a[6:7], v11 offset:39232
    v_mfma_f32_32x32x16_bf16 v[208:223], a[24:27], v[92:95], v[208:223]
    ds_read_b64_tr_b16 a[8:9], v11 offset:36992
    ds_read_b64_tr_b16 a[10:11], v11 offset:39296
    s_add_u32 m0, s47, 110592
    s_nop 0
    buffer_load_dwordx4 v2, s[24:27], s91 offen offset:0 lds
    ds_read_b64_tr_b16 a[120:121], v251 offset:4672
    v_mfma_f32_32x32x16_bf16 v[224:239], a[28:31], v[92:95], v[224:239]
    ds_read_b64_tr_b16 a[12:13], v11 offset:37056
    ds_read_b64_tr_b16 a[14:15], v11 offset:39360
    s_waitcnt lgkmcnt(10)
    v_mfma_f32_32x32x16_bf16 a[168:183], a[32:35], v[92:95], a[168:183]
    ds_read_b64_tr_b16 a[16:17], v11 offset:37120
    ds_read_b64_tr_b16 a[18:19], v11 offset:39424
    v_mfma_f32_32x32x16_bf16 a[184:199], a[36:39], v[92:95], a[184:199]
    ds_read_b64_tr_b16 a[20:21], v11 offset:37184
    ds_read_b64_tr_b16 a[22:23], v11 offset:39488
    buffer_load_dwordx4 v3, s[24:27], s91 offen offset:1024 lds
    ds_read_b64_tr_b16 a[122:123], v251 offset:5056
    v_mfma_f32_32x32x16_bf16 a[200:215], a[40:43], v[92:95], a[200:215]
    ds_read_b64_tr_b16 a[24:25], v11 offset:37248
    ds_read_b64_tr_b16 a[26:27], v11 offset:39552
    v_mfma_f32_32x32x16_bf16 a[216:231], a[44:47], v[92:95], a[216:231]
    ds_read_b64_tr_b16 a[28:29], v11 offset:37312
    ds_read_b64_tr_b16 a[30:31], v11 offset:39616
    s_waitcnt lgkmcnt(9)
    v_mfma_f32_32x32x16_bf16 v[160:175], a[0:3], v[96:99], v[160:175]
    ds_read_b64_tr_b16 a[32:33], v11 offset:37376
    ds_read_b64_tr_b16 a[34:35], v11 offset:39680
    ds_read_b64_tr_b16 a[124:125], v251 offset:5408
    v_mfma_f32_32x32x16_bf16 v[176:191], a[4:7], v[96:99], v[176:191]
    ds_read_b64_tr_b16 a[36:37], v11 offset:41472
    ds_read_b64_tr_b16 a[38:39], v11 offset:43776
    buffer_load_dwordx4 v4, s[24:27], s91 offen offset:2048 lds
    v_mfma_f32_32x32x16_bf16 v[192:207], a[8:11], v[96:99], v[192:207]
    ds_read_b64_tr_b16 a[40:41], v11 offset:41536
    ds_read_b64_tr_b16 a[42:43], v11 offset:43840
    v_mfma_f32_32x32x16_bf16 v[208:223], a[12:15], v[96:99], v[208:223]
    ds_read_b64_tr_b16 a[44:45], v11 offset:41600
    ds_read_b64_tr_b16 a[46:47], v11 offset:43904
    ds_read_b64_tr_b16 a[126:127], v251 offset:5792
    s_waitcnt lgkmcnt(10)
    v_mfma_f32_32x32x16_bf16 v[224:239], a[16:19], v[96:99], v[224:239]
    ds_read_b64_tr_b16 a[0:1], v11 offset:41664
    ds_read_b64_tr_b16 a[2:3], v11 offset:43968
    v_mfma_f32_32x32x16_bf16 a[168:183], a[20:23], v[96:99], a[168:183]
    ds_read_b64_tr_b16 a[4:5], v11 offset:41728
    ds_read_b64_tr_b16 a[6:7], v11 offset:44032
    buffer_load_dwordx4 v5, s[24:27], s91 offen offset:3072 lds
    v_mfma_f32_32x32x16_bf16 a[184:199], a[24:27], v[96:99], a[184:199]
    ds_read_b64_tr_b16 a[8:9], v11 offset:41792
    ds_read_b64_tr_b16 a[10:11], v11 offset:44096
    ds_read_b64_tr_b16 a[128:129], v251 offset:6176
    v_mfma_f32_32x32x16_bf16 a[200:215], a[28:31], v[96:99], a[200:215]
    ds_read_b64_tr_b16 a[12:13], v11 offset:41856
    ds_read_b64_tr_b16 a[14:15], v11 offset:44160
    s_waitcnt lgkmcnt(10)
    v_mfma_f32_32x32x16_bf16 a[216:231], a[32:35], v[96:99], a[216:231]
    ds_read_b64_tr_b16 a[16:17], v11 offset:41920
    ds_read_b64_tr_b16 a[18:19], v11 offset:44224
    v_mfma_f32_32x32x16_bf16 v[160:175], a[36:39], v[100:103], v[160:175]
    ds_read_b64_tr_b16 a[20:21], v11 offset:41984
    ds_read_b64_tr_b16 a[22:23], v11 offset:44288
    s_add_u32 m0, s47, 114688
    s_nop 0
    buffer_load_dwordx4 v6, s[24:27], s91 offen offset:0 lds
    ds_read_b64_tr_b16 a[130:131], v251 offset:6560
    v_mfma_f32_32x32x16_bf16 v[176:191], a[40:43], v[100:103], v[176:191]
    ds_read_b64_tr_b16 a[24:25], v11 offset:46080
    ds_read_b64_tr_b16 a[26:27], v11 offset:48384
    v_mfma_f32_32x32x16_bf16 v[192:207], a[44:47], v[100:103], v[192:207]
    ds_read_b64_tr_b16 a[28:29], v11 offset:46144
    ds_read_b64_tr_b16 a[30:31], v11 offset:48448
    s_waitcnt lgkmcnt(9)
    v_mfma_f32_32x32x16_bf16 v[208:223], a[0:3], v[100:103], v[208:223]
    ds_read_b64_tr_b16 a[32:33], v11 offset:46208
    ds_read_b64_tr_b16 a[34:35], v11 offset:48512
    v_mfma_f32_32x32x16_bf16 v[224:239], a[4:7], v[100:103], v[224:239]
    ds_read_b64_tr_b16 a[36:37], v11 offset:46272
    ds_read_b64_tr_b16 a[38:39], v11 offset:48576
    buffer_load_dwordx4 v7, s[24:27], s91 offen offset:1024 lds
    v_mfma_f32_32x32x16_bf16 a[168:183], a[8:11], v[100:103], a[168:183]
    ds_read_b64_tr_b16 a[40:41], v11 offset:46336
    ds_read_b64_tr_b16 a[42:43], v11 offset:48640
    v_mfma_f32_32x32x16_bf16 a[184:199], a[12:15], v[100:103], a[184:199]
    ds_read_b64_tr_b16 a[44:45], v11 offset:46400
    ds_read_b64_tr_b16 a[46:47], v11 offset:48704
    s_waitcnt lgkmcnt(8)
    v_mfma_f32_32x32x16_bf16 a[200:215], a[16:19], v[100:103], a[200:215]
    ds_read_b64_tr_b16 a[0:1], v11 offset:46464
    ds_read_b64_tr_b16 a[2:3], v11 offset:48768
    v_mfma_f32_32x32x16_bf16 a[216:231], a[20:23], v[100:103], a[216:231]
    ds_read_b64_tr_b16 a[4:5], v11 offset:46528
    ds_read_b64_tr_b16 a[6:7], v11 offset:48832
    buffer_load_dwordx4 v8, s[24:27], s91 offen offset:2048 lds
    v_mfma_f32_32x32x16_bf16 v[160:175], a[24:27], v[104:107], v[160:175]
    ds_read_b64_tr_b16 a[8:9], v11 offset:46592
    ds_read_b64_tr_b16 a[10:11], v11 offset:48896
    v_mfma_f32_32x32x16_bf16 v[176:191], a[28:31], v[104:107], v[176:191]
    ds_read_b64_tr_b16 a[12:13], v11 offset:50688
    ds_read_b64_tr_b16 a[14:15], v11 offset:52992
    s_waitcnt lgkmcnt(8)
    v_mfma_f32_32x32x16_bf16 v[192:207], a[32:35], v[104:107], v[192:207]
    ds_read_b64_tr_b16 a[16:17], v11 offset:50752
    ds_read_b64_tr_b16 a[18:19], v11 offset:53056
    v_mfma_f32_32x32x16_bf16 v[208:223], a[36:39], v[104:107], v[208:223]
    ds_read_b64_tr_b16 a[20:21], v11 offset:50816
    ds_read_b64_tr_b16 a[22:23], v11 offset:53120
    buffer_load_dwordx4 v9, s[24:27], s91 offen offset:3072 lds
    v_mfma_f32_32x32x16_bf16 v[224:239], a[40:43], v[104:107], v[224:239]
    ds_read_b64_tr_b16 a[24:25], v11 offset:50880
    ds_read_b64_tr_b16 a[26:27], v11 offset:53184
    v_mfma_f32_32x32x16_bf16 a[168:183], a[44:47], v[104:107], a[168:183]
    ds_read_b64_tr_b16 a[28:29], v11 offset:50944
    ds_read_b64_tr_b16 a[30:31], v11 offset:53248
    s_waitcnt lgkmcnt(8)
    v_mfma_f32_32x32x16_bf16 a[184:199], a[0:3], v[104:107], a[184:199]
    ds_read_b64_tr_b16 a[32:33], v11 offset:51008
    ds_read_b64_tr_b16 a[34:35], v11 offset:53312
    v_mfma_f32_32x32x16_bf16 a[200:215], a[4:7], v[104:107], a[200:215]
    ds_read_b64_tr_b16 a[36:37], v11 offset:51072
    ds_read_b64_tr_b16 a[38:39], v11 offset:53376
    s_add_u32 m0, s47, 118784
    s_nop 0
    buffer_load_dwordx4 v10, s[24:27], s91 offen offset:0 lds
    v_mfma_f32_32x32x16_bf16 a[216:231], a[8:11], v[104:107], a[216:231]
    ds_read_b64_tr_b16 a[40:41], v11 offset:51136
    ds_read_b64_tr_b16 a[42:43], v11 offset:53440
    v_mfma_f32_32x32x16_bf16 v[160:175], a[12:15], v[108:111], v[160:175]
    ds_read_b64_tr_b16 a[44:45], v11 offset:51200
    ds_read_b64_tr_b16 a[46:47], v11 offset:53504
    s_waitcnt lgkmcnt(8)
    v_mfma_f32_32x32x16_bf16 v[176:191], a[16:19], v[108:111], v[176:191]
    s_waitcnt vmcnt(10)
    s_barrier
    ds_read_b64_tr_b16 a[0:1], v12 offset:8192
    ds_read_b64_tr_b16 a[2:3], v12 offset:10496
    v_mfma_f32_32x32x16_bf16 v[192:207], a[20:23], v[108:111], v[192:207]
    ds_read_b64_tr_b16 a[4:5], v12 offset:8256
    ds_read_b64_tr_b16 a[6:7], v12 offset:10560
    v_mfma_f32_32x32x16_bf16 v[208:223], a[24:27], v[108:111], v[208:223]
    ds_read_b64_tr_b16 a[8:9], v12 offset:8320
    ds_read_b64_tr_b16 a[10:11], v12 offset:10624
    s_add_u32 m0, s47, 0
    s_nop 0
    buffer_load_dwordx4 v2, s[24:27], s92 offen offset:0 lds
    v_mfma_f32_32x32x16_bf16 v[224:239], a[28:31], v[108:111], v[224:239]
    ds_read_b64_tr_b16 a[12:13], v12 offset:8384
    ds_read_b64_tr_b16 a[14:15], v12 offset:10688
    s_waitcnt lgkmcnt(8)
    v_mfma_f32_32x32x16_bf16 a[168:183], a[32:35], v[108:111], a[168:183]
    ds_read_b64_tr_b16 a[16:17], v12 offset:8448
    ds_read_b64_tr_b16 a[18:19], v12 offset:10752
    v_mfma_f32_32x32x16_bf16 a[184:199], a[36:39], v[108:111], a[184:199]
    ds_read_b64_tr_b16 a[20:21], v12 offset:8512
    ds_read_b64_tr_b16 a[22:23], v12 offset:10816
    buffer_load_dwordx4 v3, s[24:27], s92 offen offset:1024 lds
    v_mfma_f32_32x32x16_bf16 a[200:215], a[40:43], v[108:111], a[200:215]
    ds_read_b64_tr_b16 a[24:25], v12 offset:8576
    ds_read_b64_tr_b16 a[26:27], v12 offset:10880
    v_mfma_f32_32x32x16_bf16 a[216:231], a[44:47], v[108:111], a[216:231]
    ds_read_b64_tr_b16 a[28:29], v12 offset:8640
    ds_read_b64_tr_b16 a[30:31], v12 offset:10944
    s_waitcnt lgkmcnt(8)
    v_mfma_f32_32x32x16_bf16 v[160:175], a[0:3], v[112:115], v[160:175]
    ds_read_b64_tr_b16 a[32:33], v12 offset:8704
    ds_read_b64_tr_b16 a[34:35], v12 offset:11008
    v_mfma_f32_32x32x16_bf16 v[176:191], a[4:7], v[112:115], v[176:191]
    ds_read_b64_tr_b16 a[36:37], v12 offset:12800
    ds_read_b64_tr_b16 a[38:39], v12 offset:15104
    buffer_load_dwordx4 v4, s[24:27], s92 offen offset:2048 lds
    v_mfma_f32_32x32x16_bf16 v[192:207], a[8:11], v[112:115], v[192:207]
    ds_read_b64_tr_b16 a[40:41], v12 offset:12864
    ds_read_b64_tr_b16 a[42:43], v12 offset:15168
    v_mfma_f32_32x32x16_bf16 v[208:223], a[12:15], v[112:115], v[208:223]
    ds_read_b64_tr_b16 a[44:45], v12 offset:12928
    ds_read_b64_tr_b16 a[46:47], v12 offset:15232
    s_waitcnt lgkmcnt(8)
    v_mfma_f32_32x32x16_bf16 v[224:239], a[16:19], v[112:115], v[224:239]
    ds_read_b64_tr_b16 a[0:1], v12 offset:12992
    ds_read_b64_tr_b16 a[2:3], v12 offset:15296
    v_mfma_f32_32x32x16_bf16 a[168:183], a[20:23], v[112:115], a[168:183]
    ds_read_b64_tr_b16 a[4:5], v12 offset:13056
    ds_read_b64_tr_b16 a[6:7], v12 offset:15360
    buffer_load_dwordx4 v5, s[24:27], s92 offen offset:3072 lds
    v_mfma_f32_32x32x16_bf16 a[184:199], a[24:27], v[112:115], a[184:199]
    ds_read_b64_tr_b16 a[8:9], v12 offset:13120
    ds_read_b64_tr_b16 a[10:11], v12 offset:15424
    v_mfma_f32_32x32x16_bf16 a[200:215], a[28:31], v[112:115], a[200:215]
    ds_read_b64_tr_b16 a[12:13], v12 offset:13184
    ds_read_b64_tr_b16 a[14:15], v12 offset:15488
    s_waitcnt lgkmcnt(8)
    v_mfma_f32_32x32x16_bf16 a[216:231], a[32:35], v[112:115], a[216:231]
    ds_read_b64_tr_b16 a[16:17], v12 offset:13248
    ds_read_b64_tr_b16 a[18:19], v12 offset:15552
    v_mfma_f32_32x32x16_bf16 v[160:175], a[36:39], v[116:119], v[160:175]
    ds_read_b64_tr_b16 a[20:21], v12 offset:13312
    ds_read_b64_tr_b16 a[22:23], v12 offset:15616
    s_add_u32 m0, s47, 4096
    s_nop 0
    buffer_load_dwordx4 v6, s[24:27], s92 offen offset:0 lds
    v_mfma_f32_32x32x16_bf16 v[176:191], a[40:43], v[116:119], v[176:191]
    ds_read_b64_tr_b16 a[24:25], v12 offset:17408
    ds_read_b64_tr_b16 a[26:27], v12 offset:19712
    v_mfma_f32_32x32x16_bf16 v[192:207], a[44:47], v[116:119], v[192:207]
    ds_read_b64_tr_b16 a[28:29], v12 offset:17472
    ds_read_b64_tr_b16 a[30:31], v12 offset:19776
    s_waitcnt lgkmcnt(8)
    v_mfma_f32_32x32x16_bf16 v[208:223], a[0:3], v[116:119], v[208:223]
    ds_read_b64_tr_b16 a[32:33], v12 offset:17536
    ds_read_b64_tr_b16 a[34:35], v12 offset:19840
    v_mfma_f32_32x32x16_bf16 v[224:239], a[4:7], v[116:119], v[224:239]
    ds_read_b64_tr_b16 a[36:37], v12 offset:17600
    ds_read_b64_tr_b16 a[38:39], v12 offset:19904
    buffer_load_dwordx4 v7, s[24:27], s92 offen offset:1024 lds
    v_mfma_f32_32x32x16_bf16 a[168:183], a[8:11], v[116:119], a[168:183]
    ds_read_b64_tr_b16 a[40:41], v12 offset:17664
    ds_read_b64_tr_b16 a[42:43], v12 offset:19968
    v_mfma_f32_32x32x16_bf16 a[184:199], a[12:15], v[116:119], a[184:199]
    ds_read_b64_tr_b16 a[44:45], v12 offset:17728
    ds_read_b64_tr_b16 a[46:47], v12 offset:20032
    s_waitcnt lgkmcnt(8)
    v_mfma_f32_32x32x16_bf16 a[200:215], a[16:19], v[116:119], a[200:215]
    ds_read_b64_tr_b16 a[0:1], v12 offset:17792
    ds_read_b64_tr_b16 a[2:3], v12 offset:20096
    v_mfma_f32_32x32x16_bf16 a[216:231], a[20:23], v[116:119], a[216:231]
    ds_read_b64_tr_b16 a[4:5], v12 offset:17856
    ds_read_b64_tr_b16 a[6:7], v12 offset:20160
    buffer_load_dwordx4 v8, s[24:27], s92 offen offset:2048 lds
    v_mfma_f32_32x32x16_bf16 v[160:175], a[24:27], v[120:123], v[160:175]
    ds_read_b64_tr_b16 a[8:9], v12 offset:17920
    ds_read_b64_tr_b16 a[10:11], v12 offset:20224
    v_mfma_f32_32x32x16_bf16 v[176:191], a[28:31], v[120:123], v[176:191]
    ds_read_b64_tr_b16 a[12:13], v12 offset:22016
    ds_read_b64_tr_b16 a[14:15], v12 offset:24320
    s_waitcnt lgkmcnt(8)
    v_mfma_f32_32x32x16_bf16 v[192:207], a[32:35], v[120:123], v[192:207]
    ds_read_b64_tr_b16 a[16:17], v12 offset:22080
    ds_read_b64_tr_b16 a[18:19], v12 offset:24384
    v_mfma_f32_32x32x16_bf16 v[208:223], a[36:39], v[120:123], v[208:223]
    ds_read_b64_tr_b16 a[20:21], v12 offset:22144
    ds_read_b64_tr_b16 a[22:23], v12 offset:24448
    buffer_load_dwordx4 v9, s[24:27], s92 offen offset:3072 lds
    v_mfma_f32_32x32x16_bf16 v[224:239], a[40:43], v[120:123], v[224:239]
    ds_read_b64_tr_b16 a[24:25], v12 offset:22208
    ds_read_b64_tr_b16 a[26:27], v12 offset:24512
    v_mfma_f32_32x32x16_bf16 a[168:183], a[44:47], v[120:123], a[168:183]
    ds_read_b64_tr_b16 a[28:29], v12 offset:22272
    ds_read_b64_tr_b16 a[30:31], v12 offset:24576
    s_waitcnt lgkmcnt(8)
    v_mfma_f32_32x32x16_bf16 a[184:199], a[0:3], v[120:123], a[184:199]
    ds_read_b64_tr_b16 a[32:33], v12 offset:22336
    ds_read_b64_tr_b16 a[34:35], v12 offset:24640
    s_waitcnt vmcnt(17)
    v_cmp_ne_u32 vcc, 0, v249
    s_nop 1
    s_cmp_eq_u64 vcc, -1
    s_cbranch_scc0 L_sp5
L_ok5:
    v_mfma_f32_32x32x16_bf16 a[200:215], a[4:7], v[120:123], a[200:215]
    ds_read_b64_tr_b16 a[36:37], v12 offset:22400
    ds_read_b64_tr_b16 a[38:39], v12 offset:24704
    s_add_u32 m0, s47, 8192
    s_nop 0
    buffer_load_dwordx4 v10, s[24:27], s92 offen offset:0 lds
    v_mfma_f32_32x32x16_bf16 a[216:231], a[8:11], v[120:123], a[216:231]
    ds_read_b64_tr_b16 a[40:41], v12 offset:22464
    ds_read_b64_tr_b16 a[42:43], v12 offset:24768
    v_mfma_f32_32x32x16_bf16 v[160:175], a[12:15], v[124:127], v[160:175]
    ds_read_b64_tr_b16 a[44:45], v12 offset:22528
    ds_read_b64_tr_b16 a[46:47], v12 offset:24832
    s_waitcnt lgkmcnt(8)
    v_mfma_f32_32x32x16_bf16 v[176:191], a[16:19], v[124:127], v[176:191]
    s_waitcnt vmcnt(9)
    s_barrier
    ds_read_b64_tr_b16 a[0:1], v12 offset:45056
    ds_read_b64_tr_b16 a[2:3], v12 offset:47360
    v_mfma_f32_32x32x16_bf16 v[192:207], a[20:23], v[124:127], v[192:207]
    ds_read_b64_tr_b16 a[4:5], v12 offset:45120
    ds_read_b64_tr_b16 a[6:7], v12 offset:47424
    v_mfma_f32_32x32x16_bf16 v[208:223], a[24:27], v[124:127], v[208:223]
    ds_read_b64_tr_b16 a[8:9], v12 offset:45184
    ds_read_b64_tr_b16 a[10:11], v12 offset:47488
    v_mfma_f32_32x32x16_bf16 v[224:239], a[28:31], v[124:127], v[224:239]
    ds_read_b64_tr_b16 a[12:13], v12 offset:45248
    ds_read_b64_tr_b16 a[14:15], v12 offset:47552
    s_waitcnt lgkmcnt(8)
    v_mfma_f32_32x32x16_bf16 a[168:183], a[32:35], v[124:127], a[168:183]
    ds_read_b64_tr_b16 a[16:17], v12 offset:45312
    ds_read_b64_tr_b16 a[18:19], v12 offset:47616
    v_mfma_f32_32x32x16_bf16 a[184:199], a[36:39], v[124:127], a[184:199]
    ds_read_b64_tr_b16 a[20:21], v12 offset:45376
    ds_read_b64_tr_b16 a[22:23], v12 offset:47680
    v_mfma_f32_32x32x16_bf16 a[200:215], a[40:43], v[124:127], a[200:215]
    ds_read_b64_tr_b16 a[24:25], v12 offset:45440
    ds_read_b64_tr_b16 a[26:27], v12 offset:47744
    v_mfma_f32_32x32x16_bf16 a[216:231], a[44:47], v[124:127], a[216:231]
    ds_read_b64_tr_b16 a[28:29], v12 offset:45504
    ds_read_b64_tr_b16 a[30:31], v12 offset:47808
    s_waitcnt lgkmcnt(8)
    v_mfma_f32_32x32x16_bf16 v[160:175], a[0:3], v[128:131], v[160:175]
    ds_read_b64_tr_b16 a[32:33], v12 offset:45568
    ds_read_b64_tr_b16 a[34:35], v12 offset:47872
    v_mfma_f32_32x32x16_bf16 v[176:191], a[4:7], v[128:131], v[176:191]
    ds_read_b64_tr_b16 a[36:37], v12 offset:49664
    ds_read_b64_tr_b16 a[38:39], v12 offset:51968
    v_mfma_f32_32x32x16_bf16 v[192:207], a[8:11], v[128:131], v[192:207]
    ds_read_b64_tr_b16 a[40:41], v12 offset:49728
    ds_read_b64_tr_b16 a[42:43], v12 offset:52032
    v_mfma_f32_32x32x16_bf16 v[208:223], a[12:15], v[128:131], v[208:223]
    ds_read_b64_tr_b16 a[44:45], v12 offset:49792
    ds_read_b64_tr_b16 a[46:47], v12 offset:52096
    s_waitcnt lgkmcnt(8)
    v_mfma_f32_32x32x16_bf16 v[224:239], a[16:19], v[128:131], v[224:239]
    ds_read_b64_tr_b16 a[0:1], v12 offset:49856
    ds_read_b64_tr_b16 a[2:3], v12 offset:52160
    v_mfma_f32_32x32x16_bf16 a[168:183], a[20:23], v[128:131], a[168:183]
    ds_read_b64_tr_b16 a[4:5], v12 offset:49920
    ds_read_b64_tr_b16 a[6:7], v12 offset:52224
    v_mfma_f32_32x32x16_bf16 a[184:199], a[24:27], v[128:131], a[184:199]
    ds_read_b64_tr_b16 a[8:9], v12 offset:49984
    ds_read_b64_tr_b16 a[10:11], v12 offset:52288
    v_mfma_f32_32x32x16_bf16 a[200:215], a[28:31], v[128:131], a[200:215]
    ds_read_b64_tr_b16 a[12:13], v12 offset:50048
    ds_read_b64_tr_b16 a[14:15], v12 offset:52352
    s_waitcnt lgkmcnt(8)
    v_mfma_f32_32x32x16_bf16 a[216:231], a[32:35], v[128:131], a[216:231]
    ds_read_b64_tr_b16 a[16:17], v12 offset:50112
    ds_read_b64_tr_b16 a[18:19], v12 offset:52416
    v_mfma_f32_32x32x16_bf16 v[160:175], a[36:39], v[132:135], v[160:175]
    ds_read_b64_tr_b16 a[20:21], v12 offset:50176
    ds_read_b64_tr_b16 a[22:23], v12 offset:52480
    v_mfma_f32_32x32x16_bf16 v[176:191], a[40:43], v[132:135], v[176:191]
    ds_read_b64_tr_b16 a[24:25], v12 offset:54272
    ds_read_b64_tr_b16 a[26:27], v12 offset:56576
    v_mfma_f32_32x32x16_bf16 v[192:207], a[44:47], v[132:135], v[192:207]
    ds_read_b64_tr_b16 a[28:29], v12 offset:54336
    ds_read_b64_tr_b16 a[30:31], v12 offset:56640
    s_waitcnt lgkmcnt(8)
    v_mfma_f32_32x32x16_bf16 v[208:223], a[0:3], v[132:135], v[208:223]
    ds_read_b64_tr_b16 a[32:33], v12 offset:54400
    ds_read_b64_tr_b16 a[34:35], v12 offset:56704
    v_mfma_f32_32x32x16_bf16 v[224:239], a[4:7], v[132:135], v[224:239]
    ds_read_b64_tr_b16 a[36:37], v12 offset:54464
    ds_read_b64_tr_b16 a[38:39], v12 offset:56768
    v_mfma_f32_32x32x16_bf16 a[168:183], a[8:11], v[132:135], a[168:183]
    ds_read_b64_tr_b16 a[40:41], v12 offset:54528
    ds_read_b64_tr_b16 a[42:43], v12 offset:56832
    v_mfma_f32_32x32x16_bf16 a[184:199], a[12:15], v[132:135], a[184:199]
    ds_read_b64_tr_b16 a[44:45], v12 offset:54592
    ds_read_b64_tr_b16 a[46:47], v12 offset:56896
    s_waitcnt lgkmcnt(8)
    v_mfma_f32_32x32x16_bf16 a[200:215], a[16:19], v[132:135], a[200:215]
    ds_read_b64_tr_b16 a[0:1], v12 offset:54656
    ds_read_b64_tr_b16 a[2:3], v12 offset:56960
    v_mfma_f32_32x32x16_bf16 a[216:231], a[20:23], v[132:135], a[216:231]
    ds_read_b64_tr_b16 a[4:5], v12 offset:54720
    ds_read_b64_tr_b16 a[6:7], v12 offset:57024
    v_mfma_f32_32x32x16_bf16 v[160:175], a[24:27], v[136:139], v[160:175]
    ds_read_b64_tr_b16 a[8:9], v12 offset:54784
    ds_read_b64_tr_b16 a[10:11], v12 offset:57088
    v_mfma_f32_32x32x16_bf16 v[176:191], a[28:31], v[136:139], v[176:191]
    ds_read_b64_tr_b16 a[12:13], v12 offset:58880
    ds_read_b64_tr_b16 a[14:15], v12 offset:61184
    s_waitcnt lgkmcnt(8)
    v_mfma_f32_32x32x16_bf16 v[192:207], a[32:35], v[136:139], v[192:207]
    ds_read_b64_tr_b16 a[16:17], v12 offset:58944
    ds_read_b64_tr_b16 a[18:19], v12 offset:61248
    v_mfma_f32_32x32x16_bf16 v[208:223], a[36:39], v[136:139], v[208:223]
    ds_read_b64_tr_b16 a[20:21], v12 offset:59008
    ds_read_b64_tr_b16 a[22:23], v12 offset:61312
    v_mfma_f32_32x32x16_bf16 v[224:239], a[40:43], v[136:139], v[224:239]
    ds_read_b64_tr_b16 a[24:25], v12 offset:59072
    ds_read_b64_tr_b16 a[26:27], v12 offset:61376
    v_mfma_f32_32x32x16_bf16 a[168:183], a[44:47], v[136:139], a[168:183]
    ds_read_b64_tr_b16 a[28:29], v12 offset:59136
    ds_read_b64_tr_b16 a[30:31], v12 offset:61440
    s_waitcnt lgkmcnt(8)
    v_mfma_f32_32x32x16_bf16 a[184:199], a[0:3], v[136:139], a[184:199]
    ds_read_b64_tr_b16 a[32:33], v12 offset:59200
    ds_read_b64_tr_b16 a[34:35], v12 offset:61504
    v_mfma_f32_32x32x16_bf16 a[200:215], a[4:7], v[136:139], a[200:215]
    ds_read_b64_tr_b16 a[36:37], v12 offset:59264
    ds_read_b64_tr_b16 a[38:39], v12 offset:61568
    v_mfma_f32_32x32x16_bf16 a[216:231], a[8:11], v[136:139], a[216:231]
    ds_read_b64_tr_b16 a[40:41], v12 offset:59328
    ds_read_b64_tr_b16 a[42:43], v12 offset:61632
    v_mfma_f32_32x32x16_bf16 v[160:175], a[12:15], v[140:143], v[160:175]
    ds_read_b64_tr_b16 a[44:45], v12 offset:59392
    ds_read_b64_tr_b16 a[46:47], v12 offset:61696
    s_waitcnt lgkmcnt(8)
    v_mfma_f32_32x32x16_bf16 v[176:191], a[16:19], v[140:143], v[176:191]
    s_waitcnt vmcnt(0)
    s_barrier
    ds_read_b64_tr_b16 a[0:1], v11 offset:0
    ds_read_b64_tr_b16 a[2:3], v11 offset:2304
    v_mfma_f32_32x32x16_bf16 v[192:207], a[20:23], v[140:143], v[192:207]
    ds_read_b64_tr_b16 a[4:5], v11 offset:64
    ds_read_b64_tr_b16 a[6:7], v11 offset:2368
    v_mfma_f32_32x32x16_bf16 v[208:223], a[24:27], v[140:143], v[208:223]
    ds_read_b64_tr_b16 a[8:9], v11 offset:128
    ds_read_b64_tr_b16 a[10:11], v11 offset:2432
    v_mfma_f32_32x32x16_bf16 v[224:239], a[28:31], v[140:143], v[224:239]
    ds_read_b64_tr_b16 a[12:13], v11 offset:192
    ds_read_b64_tr_b16 a[14:15], v11 offset:2496
    s_waitcnt lgkmcnt(8)
    v_mfma_f32_32x32x16_bf16 a[168:183], a[32:35], v[140:143], a[168:183]
    ds_read_b64_tr_b16 a[16:17], v11 offset:256
    ds_read_b64_tr_b16 a[18:19], v11 offset:2560
    v_mfma_f32_32x32x16_bf16 a[184:199], a[36:39], v[140:143], a[184:199]
    ds_read_b64_tr_b16 a[20:21], v11 offset:320
    ds_read_b64_tr_b16 a[22:23], v11 offset:2624
    v_mfma_f32_32x32x16_bf16 a[200:215], a[40:43], v[140:143], a[200:215]
    ds_read_b64_tr_b16 a[24:25], v11 offset:384
    ds_read_b64_tr_b16 a[26:27], v11 offset:2688
    v_mfma_f32_32x32x16_bf16 a[216:231], a[44:47], v[140:143], a[216:231]
    ds_read_b64_tr_b16 a[28:29], v11 offset:448
    ds_read_b64_tr_b16 a[30:31], v11 offset:2752
    s_waitcnt lgkmcnt(8)
    v_mfma_f32_32x32x16_bf16 v[160:175], a[0:3], v[144:147], v[160:175]
    ds_read_b64_tr_b16 a[32:33], v11 offset:512
    ds_read_b64_tr_b16 a[34:35], v11 offset:2816
    v_mfma_f32_32x32x16_bf16 v[176:191], a[4:7], v[144:147], v[176:191]
    ds_read_b64_tr_b16 a[36:37], v11 offset:4608
    ds_read_b64_tr_b16 a[38:39], v11 offset:6912
    v_mfma_f32_32x32x16_bf16 v[192:207], a[8:11], v[144:147], v[192:207]
    ds_read_b64_tr_b16 a[40:41], v11 offset:4672
    ds_read_b64_tr_b16 a[42:43], v11 offset:6976
    v_accvgpr_read_b32 v2, a132
    v_mfma_f32_32x32x16_bf16 v[208:223], a[12:15], v[144:147], v[208:223]
    ds_read_b64_tr_b16 a[44:45], v11 offset:4736
    ds_read_b64_tr_b16 a[46:47], v11 offset:7040
    s_waitcnt lgkmcnt(8)
    v_mfma_f32_32x32x16_bf16 v[224:239], a[16:19], v[144:147], v[224:239]
    ds_read_b64_tr_b16 a[0:1], v11 offset:4800
    ds_read_b64_tr_b16 a[2:3], v11 offset:7104
    v_accvgpr_read_b32 v3, a133
    v_mfma_f32_32x32x16_bf16 a[168:183], a[20:23], v[144:147], a[168:183]
    ds_read_b64_tr_b16 a[4:5], v11 offset:4864
    ds_read_b64_tr_b16 a[6:7], v11 offset:7168
    v_accvgpr_read_b32 v4, a134
    v_mfma_f32_32x32x16_bf16 a[184:199], a[24:27], v[144:147], a[184:199]
    ds_read_b64_tr_b16 a[8:9], v11 offset:4928
    ds_read_b64_tr_b16 a[10:11], v11 offset:7232
    v_mfma_f32_32x32x16_bf16 a[200:215], a[28:31], v[144:147], a[200:215]
    ds_read_b64_tr_b16 a[12:13], v11 offset:4992
    ds_read_b64_tr_b16 a[14:15], v11 offset:7296
    v_accvgpr_read_b32 v5, a135
    s_waitcnt lgkmcnt(8)
    v_mfma_f32_32x32x16_bf16 a[216:231], a[32:35], v[144:147], a[216:231]
    ds_read_b64_tr_b16 a[16:17], v11 offset:5056
    ds_read_b64_tr_b16 a[18:19], v11 offset:7360
    v_accvgpr_read_b32 v6, a136
    v_mfma_f32_32x32x16_bf16 v[160:175], a[36:39], v[148:151], v[160:175]
    ds_read_b64_tr_b16 a[20:21], v11 offset:5120
    ds_read_b64_tr_b16 a[22:23], v11 offset:7424
    v_mfma_f32_32x32x16_bf16 v[176:191], a[40:43], v[148:151], v[176:191]
    ds_read_b64_tr_b16 a[24:25], v11 offset:9216
    ds_read_b64_tr_b16 a[26:27], v11 offset:11520
    v_accvgpr_read_b32 v10, a142
    v_mfma_f32_32x32x16_bf16 v[192:207], a[44:47], v[148:151], v[192:207]
    ds_read_b64_tr_b16 a[28:29], v11 offset:9280
    ds_read_b64_tr_b16 a[30:31], v11 offset:11584
    v_accvgpr_read_b32 v250, a143
    s_waitcnt lgkmcnt(8)
    v_mfma_f32_32x32x16_bf16 v[208:223], a[0:3], v[148:151], v[208:223]
    ds_read_b64_tr_b16 a[32:33], v11 offset:9344
    ds_read_b64_tr_b16 a[34:35], v11 offset:11648
    v_mfma_f32_32x32x16_bf16 v[224:239], a[4:7], v[148:151], v[224:239]
    ds_read_b64_tr_b16 a[36:37], v11 offset:9408
    ds_read_b64_tr_b16 a[38:39], v11 offset:11712
    v_accvgpr_write_b32 a252, v250
    v_mfma_f32_32x32x16_bf16 a[168:183], a[8:11], v[148:151], a[168:183]
    ds_read_b64_tr_b16 a[40:41], v11 offset:9472
    ds_read_b64_tr_b16 a[42:43], v11 offset:11776
    v_accvgpr_read_b32 v248, a152
    v_mfma_f32_32x32x16_bf16 a[184:199], a[12:15], v[148:151], a[184:199]
    ds_read_b64_tr_b16 a[44:45], v11 offset:9536
    ds_read_b64_tr_b16 a[46:47], v11 offset:11840
    s_waitcnt lgkmcnt(8)
    v_mfma_f32_32x32x16_bf16 a[200:215], a[16:19], v[148:151], a[200:215]
    ds_read_b64_tr_b16 a[0:1], v11 offset:9600
    ds_read_b64_tr_b16 a[2:3], v11 offset:11904
    v_accvgpr_write_b32 a239, v248
    v_mfma_f32_32x32x16_bf16 a[216:231], a[20:23], v[148:151], a[216:231]
    ds_read_b64_tr_b16 a[4:5], v11 offset:9664
    ds_read_b64_tr_b16 a[6:7], v11 offset:11968
    v_accvgpr_read_b32 v7, a139
    v_mfma_f32_32x32x16_bf16 v[160:175], a[24:27], v[152:155], v[160:175]
    ds_read_b64_tr_b16 a[8:9], v11 offset:9728
    ds_read_b64_tr_b16 a[10:11], v11 offset:12032
    v_mfma_f32_32x32x16_bf16 v[176:191], a[28:31], v[152:155], v[176:191]
    ds_read_b64_tr_b16 a[12:13], v11 offset:13824
    ds_read_b64_tr_b16 a[14:15], v11 offset:16128
    v_accvgpr_read_b32 v8, a140
    s_waitcnt lgkmcnt(8)
    v_mfma_f32_32x32x16_bf16 v[192:207], a[32:35], v[152:155], v[192:207]
    ds_read_b64_tr_b16 a[16:17], v11 offset:13888
    ds_read_b64_tr_b16 a[18:19], v11 offset:16192
    v_accvgpr_read_b32 v15, a137
    v_mfma_f32_32x32x16_bf16 v[208:223], a[36:39], v[152:155], v[208:223]
    ds_read_b64_tr_b16 a[20:21], v11 offset:13952
    ds_read_b64_tr_b16 a[22:23], v11 offset:16256
    v_mfma_f32_32x32x16_bf16 v[224:239], a[40:43], v[152:155], v[224:239]
    ds_read_b64_tr_b16 a[24:25], v11 offset:14016
    ds_read_b64_tr_b16 a[26:27], v11 offset:16320
    s_mul_i32 s50, s40, 18944
    v_add_u32 v7, s50, v7
    v_mfma_f32_32x32x16_bf16 a[168:183], a[44:47], v[152:155], a[168:183]
    ds_read_b64_tr_b16 a[28:29], v11 offset:14080
    ds_read_b64_tr_b16 a[30:31], v11 offset:16384
    s_waitcnt lgkmcnt(8)
    v_mfma_f32_32x32x16_bf16 a[184:199], a[0:3], v[152:155], a[184:199]
    ds_read_b64_tr_b16 a[32:33], v11 offset:14144
    ds_read_b64_tr_b16 a[34:35], v11 offset:16448
    s_mul_i32 s50, s40, 10752
    v_add_u32 v8, s50, v8
    v_mfma_f32_32x32x16_bf16 a[200:215], a[4:7], v[152:155], a[200:215]
    ds_read_b64_tr_b16 a[36:37], v11 offset:14208
    ds_read_b64_tr_b16 a[38:39], v11 offset:16512
    v_mfma_f32_32x32x16_bf16 a[216:231], a[8:11], v[152:155], a[216:231]
    ds_read_b64_tr_b16 a[40:41], v11 offset:14272
    ds_read_b64_tr_b16 a[42:43], v11 offset:16576
    v_mov_b32 v9, v255
    v_mfma_f32_32x32x16_bf16 v[160:175], a[12:15], v[156:159], v[160:175]
    ds_read_b64_tr_b16 a[44:45], v11 offset:14336
    ds_read_b64_tr_b16 a[46:47], v11 offset:16640
    v_mov_b32 v0, v254
    s_waitcnt lgkmcnt(8)
    v_mfma_f32_32x32x16_bf16 v[176:191], a[16:19], v[156:159], v[176:191]
    v_mfma_f32_32x32x16_bf16 v[192:207], a[20:23], v[156:159], v[192:207]
    s_mul_i32 s73, s40, 5120
    v_mfma_f32_32x32x16_bf16 v[208:223], a[24:27], v[156:159], v[208:223]
    s_mul_i32 s57, s43, 655360
    v_mfma_f32_32x32x16_bf16 v[224:239], a[28:31], v[156:159], v[224:239]
    s_add_u32 s57, s57, 30670848
    s_waitcnt lgkmcnt(0)
    v_mfma_f32_32x32x16_bf16 a[168:183], a[32:35], v[156:159], a[168:183]
    v_mfma_f32_32x32x16_bf16 a[184:199], a[36:39], v[156:159], a[184:199]
    v_mfma_f32_32x32x16_bf16 a[200:215], a[40:43], v[156:159], a[200:215]
    v_mfma_f32_32x32x16_bf16 a[216:231], a[44:47], v[156:159], a[216:231]
    v_mov_b32 v11, v15
    v_add_u32 v12, 65536, v15
    v_add_u32 v13, 131072, v15
    s_nop 2
    v_accvgpr_write_b32 a244, v232
    v_accvgpr_write_b32 a245, v233
    v_accvgpr_write_b32 a246, v234
    v_accvgpr_write_b32 a247, v235
    v_accvgpr_write_b32 a248, v236
    v_accvgpr_write_b32 a249, v237
    v_accvgpr_write_b32 a250, v238
    v_accvgpr_write_b32 a251, v239
    s_barrier
    v_cvt_pk_bf16_f32 v240, v160, v161
    v_accvgpr_write_b32 a132, v240
    v_cvt_pk_bf16_f32 v241, v162, v163
    v_accvgpr_write_b32 a133, v241
    v_cvt_pk_bf16_f32 v242, v164, v165
    v_accvgpr_write_b32 a134, v242
    v_cvt_pk_bf16_f32 v243, v166, v167
    v_accvgpr_write_b32 a135, v243
    v_cvt_pk_bf16_f32 v240, v168, v169
    v_accvgpr_write_b32 a136, v240
    v_cvt_pk_bf16_f32 v241, v170, v171
    v_accvgpr_write_b32 a137, v241
    s_add_u32 m0, s73, 43008
    s_nop 0
    buffer_load_dwordx4 v2, s[24:27], s84 offen offset:0 lds
    v_cvt_pk_bf16_f32 v242, v172, v173
    v_accvgpr_write_b32 a138, v242
    v_cvt_pk_bf16_f32 v243, v174, v175
    v_accvgpr_write_b32 a139, v243
    v_cvt_pk_bf16_f32 v240, v176, v177
    v_accvgpr_write_b32 a140, v240
    v_cvt_pk_bf16_f32 v241, v178, v179
    v_accvgpr_write_b32 a141, v241
    v_cvt_pk_bf16_f32 v242, v180, v181
    v_accvgpr_write_b32 a142, v242
    v_cvt_pk_bf16_f32 v243, v182, v183
    v_accvgpr_write_b32 a143, v243
    buffer_load_dwordx4 v3, s[24:27], s84 offen offset:1024 lds
    v_cvt_pk_bf16_f32 v240, v184, v185
    v_accvgpr_write_b32 a144, v240
    v_cvt_pk_bf16_f32 v241, v186, v187
    v_accvgpr_write_b32 a145, v241
    v_cvt_pk_bf16_f32 v242, v188, v189
    v_accvgpr_write_b32 a146, v242
    v_cvt_pk_bf16_f32 v243, v190, v191
    v_accvgpr_write_b32 a147, v243
    v_cvt_pk_bf16_f32 v240, v192, v193
    v_accvgpr_write_b32 a148, v240
    v_cvt_pk_bf16_f32 v241, v194, v195
    v_accvgpr_write_b32 a149, v241
    buffer_load_dwordx4 v4, s[24:27], s84 offen offset:2048 lds
    v_cvt_pk_bf16_f32 v242, v196, v197
    v_accvgpr_write_b32 a150, v242
    v_cvt_pk_bf16_f32 v243, v198, v199
    v_accvgpr_write_b32 a151, v243
    v_cvt_pk_bf16_f32 v240, v200, v201
    v_accvgpr_write_b32 a152, v240
    v_cvt_pk_bf16_f32 v241, v202, v203
    v_accvgpr_write_b32 a153, v241
    v_cvt_pk_bf16_f32 v242, v204, v205
    v_accvgpr_write_b32 a154, v242
    v_cvt_pk_bf16_f32 v243, v206, v207
    v_accvgpr_write_b32 a155, v243
    buffer_load_dwordx4 v5, s[24:27], s84 offen offset:3072 lds
    v_cvt_pk_bf16_f32 v240, v208, v209
    v_accvgpr_write_b32 a156, v240
    v_cvt_pk_bf16_f32 v241, v210, v211
    v_accvgpr_write_b32 a157, v241
    v_cvt_pk_bf16_f32 v242, v212, v213
    v_accvgpr_write_b32 a158, v242
    v_cvt_pk_bf16_f32 v243, v214, v215
    v_accvgpr_write_b32 a159, v243
    v_cvt_pk_bf16_f32 v240, v216, v217
    v_accvgpr_write_b32 a160, v240
    v_cvt_pk_bf16_f32 v241, v218, v219
    v_accvgpr_write_b32 a161, v241
    s_add_u32 m0, s73, 47104
    s_nop 0
    buffer_load_dwordx4 v6, s[24:27], s84 offen offset:0 lds
    v_cvt_pk_bf16_f32 v242, v220, v221
    v_accvgpr_write_b32 a162, v242
    v_cvt_pk_bf16_f32 v243, v222, v223
    v_accvgpr_write_b32 a163, v243
    v_cvt_pk_bf16_f32 v240, v224, v225
    v_accvgpr_write_b32 a164, v240
    v_cvt_pk_bf16_f32 v241, v226, v227
    v_accvgpr_write_b32 a165, v241
    v_cvt_pk_bf16_f32 v242, v228, v229
    v_accvgpr_write_b32 a166, v242
    v_cvt_pk_bf16_f32 v243, v230, v231
    v_accvgpr_write_b32 a167, v243
    s_add_u32 m0, s73, 63488
    s_nop 0
    buffer_load_dwordx4 v2, s[24:27], s85 offen offset:0 lds
    v_mfma_f32_32x32x16_bf16 v[160:175], a[48:51], a[132:135], 0
    v_accvgpr_read_b32 v240, a244
    v_accvgpr_read_b32 v241, a245
    v_cvt_pk_bf16_f32 v244, v240, v241
    v_accvgpr_read_b32 v242, a246
    v_accvgpr_read_b32 v243, a247
    v_mfma_f32_32x32x16_bf16 v[160:175], a[52:55], a[136:139], v[160:175]
    v_cvt_pk_bf16_f32 v245, v242, v243
    v_accvgpr_read_b32 v240, a169
    v_accvgpr_read_b32 v241, a170
    v_cvt_pk_bf16_f32 v246, v240, v241
    v_accvgpr_read_b32 v242, a171
    v_mfma_f32_32x32x16_bf16 v[160:175], a[56:59], a[140:143], v[160:175]
    v_accvgpr_read_b32 v243, a172
    v_cvt_pk_bf16_f32 v247, v242, v243
    v_accvgpr_read_b32 v240, a248
    v_accvgpr_read_b32 v241, a249
    v_cvt_pk_bf16_f32 v248, v240, v241
    v_mfma_f32_32x32x16_bf16 v[176:191], a[60:63], a[132:135], 0
    v_accvgpr_read_b32 v242, a250
    v_accvgpr_read_b32 v243, a251
    v_cvt_pk_bf16_f32 v249, v242, v243
    v_accvgpr_read_b32 v240, a173
    v_accvgpr_read_b32 v241, a174
    v_mfma_f32_32x32x16_bf16 v[176:191], a[64:67], a[136:139], v[176:191]
    v_cvt_pk_bf16_f32 v250, v240, v241
    v_accvgpr_read_b32 v242, a175
    v_accvgpr_read_b32 v243, a176
    v_cvt_pk_bf16_f32 v251, v242, v243
    v_accvgpr_read_b32 v240, a168
    v_mfma_f32_32x32x16_bf16 v[176:191], a[68:71], a[140:143], v[176:191]
    v_cvt_pk_bf16_f32 v252, v240, v9
    v_accvgpr_read_b32 v242, a177
    v_cvt_pk_bf16_f32 v253, v242, v9
    v_accvgpr_read_b32 v240, a178
    v_accvgpr_read_b32 v241, a179
    v_mfma_f32_32x32x16_bf16 v[176:191], a[72:75], a[144:147], v[176:191]
    v_cvt_pk_bf16_f32 v254, v240, v241
    v_accvgpr_read_b32 v242, a180
    v_accvgpr_read_b32 v243, a181
    v_cvt_pk_bf16_f32 v255, v242, v243
    ds_write_b128 v8, v[244:247] offset:0
    v_mfma_f32_32x32x16_bf16 v[176:191], a[76:79], a[148:151], v[176:191]
    ds_write_b128 v8, v[248:251] offset:16
    ds_write_b128 v8, v[252:255] offset:32
    v_accvgpr_read_b32 v240, a187
    v_accvgpr_read_b32 v241, a188
    v_cvt_pk_bf16_f32 v244, v240, v241
    v_mfma_f32_32x32x16_bf16 v[192:207], a[80:83], a[140:143], 0
    v_accvgpr_read_b32 v242, a189
    v_accvgpr_read_b32 v243, a190
    v_cvt_pk_bf16_f32 v245, v242, v243
    v_accvgpr_read_b32 v240, a182
    v_accvgpr_read_b32 v241, a183
    v_mfma_f32_32x32x16_bf16 v[192:207], a[84:87], a[144:147], v[192:207]
    v_cvt_pk_bf16_f32 v246, v240, v241
    v_accvgpr_read_b32 v242, a184
    v_accvgpr_read_b32 v243, a185
    v_cvt_pk_bf16_f32 v247, v242, v243
    v_accvgpr_read_b32 v240, a191
    v_mfma_f32_32x32x16_bf16 v[192:207], a[88:91], a[148:151], v[192:207]
    v_accvgpr_read_b32 v241, a192
    v_cvt_pk_bf16_f32 v248, v240, v241
    v_accvgpr_read_b32 v242, a193
    v_accvgpr_read_b32 v243, a194
    v_cvt_pk_bf16_f32 v249, v242, v243
    v_mfma_f32_32x32x16_bf16 v[192:207], a[92:95], a[152:155], v[192:207]
    v_accvgpr_read_b32 v240, a186
    v_cvt_pk_bf16_f32 v250, v240, v9
    v_accvgpr_read_b32 v242, a195
    v_cvt_pk_bf16_f32 v251, v242, v9
    v_accvgpr_read_b32 v240, a196
    v_mfma_f32_32x32x16_bf16 v[192:207], a[96:99], a[156:159], v[192:207]
    v_accvgpr_read_b32 v241, a197
    v_cvt_pk_bf16_f32 v252, v240, v241
    v_accvgpr_read_b32 v242, a198
    v_accvgpr_read_b32 v243, a199
    v_cvt_pk_bf16_f32 v253, v242, v243
    v_mfma_f32_32x32x16_bf16 v[208:223], a[100:103], a[148:151], 0
    v_accvgpr_read_b32 v240, a205
    v_accvgpr_read_b32 v241, a206
    v_cvt_pk_bf16_f32 v254, v240, v241
    v_accvgpr_read_b32 v242, a207
    v_accvgpr_read_b32 v243, a208
    v_mfma_f32_32x32x16_bf16 v[208:223], a[104:107], a[152:155], v[208:223]
    v_cvt_pk_bf16_f32 v255, v242, v243
    ds_write_b128 v8, v[244:247] offset:48
    ds_write_b128 v8, v[248:251] offset:64
    ds_write_b128 v8, v[252:255] offset:80
    v_accvgpr_read_b32 v240, a200
    v_mfma_f32_32x32x16_bf16 v[208:223], a[108:111], a[156:159], v[208:223]
    v_accvgpr_read_b32 v241, a201
    v_cvt_pk_bf16_f32 v244, v240, v241
    v_accvgpr_read_b32 v242, a202
    v_accvgpr_read_b32 v243, a203
    v_cvt_pk_bf16_f32 v245, v242, v243
    v_mfma_f32_32x32x16_bf16 v[208:223], a[112:115], a[160:163], v[208:223]
    v_accvgpr_read_b32 v240, a209
    v_accvgpr_read_b32 v241, a210
    v_cvt_pk_bf16_f32 v246, v240, v241
    v_accvgpr_read_b32 v242, a211
    v_accvgpr_read_b32 v243, a212
    v_mfma_f32_32x32x16_bf16 v[208:223], a[116:119], a[164:167], v[208:223]
    v_cvt_pk_bf16_f32 v247, v242, v243
    v_accvgpr_read_b32 v240, a204
    v_cvt_pk_bf16_f32 v248, v240, v9
    v_accvgpr_read_b32 v242, a213
    v_cvt_pk_bf16_f32 v249, v242, v9
    v_mfma_f32_32x32x16_bf16 v[224:239], a[120:123], a[156:159], 0
    v_accvgpr_read_b32 v240, a214
    v_accvgpr_read_b32 v241, a215
    v_cvt_pk_bf16_f32 v250, v240, v241
    v_accvgpr_read_b32 v242, a216
    v_accvgpr_read_b32 v243, a217
    v_mfma_f32_32x32x16_bf16 v[224:239], a[124:127], a[160:163], v[224:239]
    v_cvt_pk_bf16_f32 v251, v242, v243
    v_accvgpr_read_b32 v240, a223
    v_accvgpr_read_b32 v241, a224
    v_cvt_pk_bf16_f32 v252, v240, v241
    v_accvgpr_read_b32 v242, a225
    v_mfma_f32_32x32x16_bf16 v[224:239], a[128:131], a[164:167], v[224:239]
    v_accvgpr_read_b32 v243, a226
    v_cvt_pk_bf16_f32 v253, v242, v243
    v_accvgpr_read_b32 v240, a218
    v_accvgpr_read_b32 v241, a219
    v_cvt_pk_bf16_f32 v254, v240, v241
    v_accvgpr_read_b32 v242, a220
    v_accvgpr_read_b32 v243, a221
    v_cvt_pk_bf16_f32 v255, v242, v243
    ds_write_b128 v8, v[244:247] offset:96
    ds_write_b128 v8, v[248:251] offset:112
    ds_write_b128 v8, v[252:255] offset:128
    v_accvgpr_read_b32 v240, a227
    v_accvgpr_read_b32 v241, a228
    v_cvt_pk_bf16_f32 v244, v240, v241
    v_accvgpr_read_b32 v242, a229
    v_accvgpr_read_b32 v243, a230
    v_cvt_pk_bf16_f32 v245, v242, v243
    v_accvgpr_read_b32 v240, a222
    v_cvt_pk_bf16_f32 v246, v240, v9
    v_accvgpr_read_b32 v242, a231
    v_cvt_pk_bf16_f32 v247, v242, v9
    ds_write_b128 v8, v[244:247] offset:144
    buffer_load_dwordx4 v3, s[24:27], s85 offen offset:1024 lds
    buffer_load_dwordx4 v4, s[24:27], s85 offen offset:2048 lds
    buffer_load_dwordx4 v5, s[24:27], s85 offen offset:3072 lds
    s_add_u32 m0, s73, 67584
    s_nop 0
    buffer_load_dwordx4 v6, s[24:27], s85 offen offset:0 lds
    v_max3_f32 v250, v160, v161, v162
    v_min3_f32 v252, v160, v161, v162
    v_max3_f32 v250, v250, v163, v164
    v_min3_f32 v252, v252, v163, v164
    v_max3_f32 v250, v250, v165, v166
    v_min3_f32 v252, v252, v165, v166
    v_max3_f32 v250, v250, v167, v168
    v_min3_f32 v252, v252, v167, v168
    v_max3_f32 v250, v250, v169, v170
    v_min3_f32 v252, v252, v169, v170
    v_max3_f32 v250, v250, v171, v172
    v_min3_f32 v252, v252, v171, v172
    v_max3_f32 v250, v250, v173, v174
    v_min3_f32 v252, v252, v173, v174
    v_max3_f32 v250, v250, v175, v176
    v_min3_f32 v252, v252, v175, v176
    v_max_f32 v250, v250, v177
    v_min_f32 v252, v252, v177
    v_mul_f32 v250, v0, v250
    v_mul_f32 v252, v0, v252
    v_pk_fma_f32 v[232:233], v[160:161], v[0:1], v[250:251] op_sel_hi:[1,0,0] neg_lo:[0,0,1] neg_hi:[0,0,1]
    v_pk_fma_f32 v[160:161], v[160:161], v[0:1], v[252:253] op_sel_hi:[1,0,0] neg_lo:[1,0,0] neg_hi:[1,0,0]
    v_pk_fma_f32 v[234:235], v[162:163], v[0:1], v[250:251] op_sel_hi:[1,0,0] neg_lo:[0,0,1] neg_hi:[0,0,1]
    v_pk_fma_f32 v[162:163], v[162:163], v[0:1], v[252:253] op_sel_hi:[1,0,0] neg_lo:[1,0,0] neg_hi:[1,0,0]
    v_pk_fma_f32 v[236:237], v[164:165], v[0:1], v[250:251] op_sel_hi:[1,0,0] neg_lo:[0,0,1] neg_hi:[0,0,1]
    v_pk_fma_f32 v[164:165], v[164:165], v[0:1], v[252:253] op_sel_hi:[1,0,0] neg_lo:[1,0,0] neg_hi:[1,0,0]
    v_pk_fma_f32 v[238:239], v[166:167], v[0:1], v[250:251] op_sel_hi:[1,0,0] neg_lo:[0,0,1] neg_hi:[0,0,1]
    v_pk_fma_f32 v[166:167], v[166:167], v[0:1], v[252:253] op_sel_hi:[1,0,0] neg_lo:[1,0,0] neg_hi:[1,0,0]
    v_pk_fma_f32 v[240:241], v[168:169], v[0:1], v[250:251] op_sel_hi:[1,0,0] neg_lo:[0,0,1] neg_hi:[0,0,1]
    v_pk_fma_f32 v[168:169], v[168:169], v[0:1], v[252:253] op_sel_hi:[1,0,0] neg_lo:[1,0,0] neg_hi:[1,0,0]
    v_pk_fma_f32 v[242:243], v[170:171], v[0:1], v[250:251] op_sel_hi:[1,0,0] neg_lo:[0,0,1] neg_hi:[0,0,1]
    v_pk_fma_f32 v[170:171], v[170:171], v[0:1], v[252:253] op_sel_hi:[1,0,0] neg_lo:[1,0,0] neg_hi:[1,0,0]
    v_pk_fma_f32 v[244:245], v[172:173], v[0:1], v[250:251] op_sel_hi:[1,0,0] neg_lo:[0,0,1] neg_hi:[0,0,1]
    v_pk_fma_f32 v[172:173], v[172:173], v[0:1], v[252:253] op_sel_hi:[1,0,0] neg_lo:[1,0,0] neg_hi:[1,0,0]
    v_pk_fma_f32 v[246:247], v[174:175], v[0:1], v[250:251] op_sel_hi:[1,0,0] neg_lo:[0,0,1] neg_hi:[0,0,1]
    v_pk_fma_f32 v[174:175], v[174:175], v[0:1], v[252:253] op_sel_hi:[1,0,0] neg_lo:[1,0,0] neg_hi:[1,0,0]
    v_pk_fma_f32 v[248:249], v[176:177], v[0:1], v[250:251] op_sel_hi:[1,0,0] neg_lo:[0,0,1] neg_hi:[0,0,1]
    v_pk_fma_f32 v[176:177], v[176:177], v[0:1], v[252:253] op_sel_hi:[1,0,0] neg_lo:[1,0,0] neg_hi:[1,0,0]
    v_exp_f32 v232, v232
    v_exp_f32 v160, v160
    v_exp_f32 v233, v233
    v_exp_f32 v161, v161
    v_exp_f32 v234, v234
    v_exp_f32 v162, v162
    v_exp_f32 v235, v235
    v_exp_f32 v163, v163
    v_exp_f32 v236, v236
    v_exp_f32 v164, v164
    v_exp_f32 v237, v237
    v_exp_f32 v165, v165
    v_exp_f32 v238, v238
    v_exp_f32 v166, v166
    v_exp_f32 v239, v239
    v_exp_f32 v167, v167
    v_exp_f32 v240, v240
    v_exp_f32 v168, v168
    v_exp_f32 v241, v241
    v_exp_f32 v169, v169
    v_exp_f32 v242, v242
    v_exp_f32 v170, v170
    v_exp_f32 v243, v243
    v_exp_f32 v171, v171
    v_exp_f32 v244, v244
    v_exp_f32 v172, v172
    v_exp_f32 v245, v245
    v_exp_f32 v173, v173
    v_exp_f32 v246, v246
    v_exp_f32 v174, v174
    v_exp_f32 v247, v247
    v_exp_f32 v175, v175
    v_exp_f32 v248, v248
    v_exp_f32 v176, v176
    v_exp_f32 v249, v249
    v_exp_f32 v177, v177
    v_pk_add_f32 v[250:251], v[232:233], v[234:235]
    v_pk_add_f32 v[252:253], v[160:161], v[162:163]
    v_pk_add_f32 v[250:251], v[250:251], v[236:237]
    v_pk_add_f32 v[252:253], v[252:253], v[164:165]
    v_pk_add_f32 v[250:251], v[250:251], v[238:239]
    v_pk_add_f32 v[252:253], v[252:253], v[166:167]
    v_pk_add_f32 v[250:251], v[250:251], v[240:241]
    v_pk_add_f32 v[252:253], v[252:253], v[168:169]
    v_pk_add_f32 v[250:251], v[250:251], v[242:243]
    v_pk_add_f32 v[252:253], v[252:253], v[170:171]
    v_pk_add_f32 v[250:251], v[250:251], v[244:245]
    v_pk_add_f32 v[252:253], v[252:253], v[172:173]
    v_pk_add_f32 v[250:251], v[250:251], v[246:247]
    v_pk_add_f32 v[252:253], v[252:253], v[174:175]
    v_pk_add_f32 v[250:251], v[250:251], v[248:249]
    v_pk_add_f32 v[252:253], v[252:253], v[176:177]
    v_add_f32 v250, v250, v251
    v_add_f32 v252, v252, v253
    v_rcp_f32 v250, v250
    v_rcp_f32 v252, v252
    s_nop 0
    v_mul_f32 v250, v0, v250
    v_mul_f32 v252, v0, v252
    v_pk_mul_f32 v[232:233], v[232:233], v[250:251] op_sel_hi:[1,0]
    v_pk_mul_f32 v[160:161], v[160:161], v[252:253] op_sel_hi:[1,0]
    v_pk_mul_f32 v[234:235], v[234:235], v[250:251] op_sel_hi:[1,0]
    v_pk_mul_f32 v[162:163], v[162:163], v[252:253] op_sel_hi:[1,0]
    v_pk_mul_f32 v[236:237], v[236:237], v[250:251] op_sel_hi:[1,0]
    v_pk_mul_f32 v[164:165], v[164:165], v[252:253] op_sel_hi:[1,0]
    v_pk_mul_f32 v[238:239], v[238:239], v[250:251] op_sel_hi:[1,0]
    v_pk_mul_f32 v[166:167], v[166:167], v[252:253] op_sel_hi:[1,0]
    v_pk_mul_f32 v[240:241], v[240:241], v[250:251] op_sel_hi:[1,0]
    v_pk_mul_f32 v[168:169], v[168:169], v[252:253] op_sel_hi:[1,0]
    v_pk_mul_f32 v[242:243], v[242:243], v[250:251] op_sel_hi:[1,0]
    v_pk_mul_f32 v[170:171], v[170:171], v[252:253] op_sel_hi:[1,0]
    v_pk_mul_f32 v[244:245], v[244:245], v[250:251] op_sel_hi:[1,0]
    v_pk_mul_f32 v[172:173], v[172:173], v[252:253] op_sel_hi:[1,0]
    v_pk_mul_f32 v[246:247], v[246:247], v[250:251] op_sel_hi:[1,0]
    v_pk_mul_f32 v[174:175], v[174:175], v[252:253] op_sel_hi:[1,0]
    v_pk_mul_f32 v[248:249], v[248:249], v[250:251] op_sel_hi:[1,0]
    v_pk_mul_f32 v[176:177], v[176:177], v[252:253] op_sel_hi:[1,0]
    v_cvt_pk_bf16_f32 v160, v160, v161
    v_cvt_pk_bf16_f32 v161, v162, v163
    v_cvt_pk_bf16_f32 v162, v164, v165
    v_cvt_pk_bf16_f32 v163, v166, v167
    v_cvt_pk_bf16_f32 v164, v168, v169
    v_cvt_pk_bf16_f32 v165, v170, v171
    v_cvt_pk_bf16_f32 v166, v172, v173
    v_cvt_pk_bf16_f32 v167, v174, v175
    v_cvt_pk_bf16_f32 v168, v176, v177
    v_cvt_pk_bf16_f32 v169, v232, v233
    v_cvt_pk_bf16_f32 v170, v234, v235
    v_cvt_pk_bf16_f32 v171, v236, v237
    v_cvt_pk_bf16_f32 v172, v238, v239
    v_cvt_pk_bf16_f32 v173, v240, v241
    v_cvt_pk_bf16_f32 v174, v242, v243
    v_cvt_pk_bf16_f32 v175, v244, v245
    v_cvt_pk_bf16_f32 v176, v246, v247
    v_cvt_pk_bf16_f32 v177, v248, v249
    v_max3_f32 v250, v178, v179, v180
    v_min3_f32 v252, v178, v179, v180
    v_max3_f32 v250, v250, v181, v182
    v_min3_f32 v252, v252, v181, v182
    v_max3_f32 v250, v250, v183, v184
    v_min3_f32 v252, v252, v183, v184
    v_max3_f32 v250, v250, v185, v186
    v_min3_f32 v252, v252, v185, v186
    v_max3_f32 v250, v250, v187, v188
    v_min3_f32 v252, v252, v187, v188
    v_max3_f32 v250, v250, v189, v190
    v_min3_f32 v252, v252, v189, v190
    v_max3_f32 v250, v250, v191, v192
    v_min3_f32 v252, v252, v191, v192
    v_max3_f32 v250, v250, v193, v194
    v_min3_f32 v252, v252, v193, v194
    v_max_f32 v250, v250, v195
    v_min_f32 v252, v252, v195
    v_mul_f32 v250, v0, v250
    v_mul_f32 v252, v0, v252
    v_pk_fma_f32 v[232:233], v[178:179], v[0:1], v[250:251] op_sel_hi:[1,0,0] neg_lo:[0,0,1] neg_hi:[0,0,1]
    v_pk_fma_f32 v[178:179], v[178:179], v[0:1], v[252:253] op_sel_hi:[1,0,0] neg_lo:[1,0,0] neg_hi:[1,0,0]
    v_pk_fma_f32 v[234:235], v[180:181], v[0:1], v[250:251] op_sel_hi:[1,0,0] neg_lo:[0,0,1] neg_hi:[0,0,1]
    v_pk_fma_f32 v[180:181], v[180:181], v[0:1], v[252:253] op_sel_hi:[1,0,0] neg_lo:[1,0,0] neg_hi:[1,0,0]
    v_pk_fma_f32 v[236:237], v[182:183], v[0:1], v[250:251] op_sel_hi:[1,0,0] neg_lo:[0,0,1] neg_hi:[0,0,1]
    v_pk_fma_f32 v[182:183], v[182:183], v[0:1], v[252:253] op_sel_hi:[1,0,0] neg_lo:[1,0,0] neg_hi:[1,0,0]
    v_pk_fma_f32 v[238:239], v[184:185], v[0:1], v[250:251] op_sel_hi:[1,0,0] neg_lo:[0,0,1] neg_hi:[0,0,1]
    v_pk_fma_f32 v[184:185], v[184:185], v[0:1], v[252:253] op_sel_hi:[1,0,0] neg_lo:[1,0,0] neg_hi:[1,0,0]
    v_pk_fma_f32 v[240:241], v[186:187], v[0:1], v[250:251] op_sel_hi:[1,0,0] neg_lo:[0,0,1] neg_hi:[0,0,1]
    v_pk_fma_f32 v[186:187], v[186:187], v[0:1], v[252:253] op_sel_hi:[1,0,0] neg_lo:[1,0,0] neg_hi:[1,0,0]
    v_pk_fma_f32 v[242:243], v[188:189], v[0:1], v[250:251] op_sel_hi:[1,0,0] neg_lo:[0,0,1] neg_hi:[0,0,1]
    v_pk_fma_f32 v[188:189], v[188:189], v[0:1], v[252:253] op_sel_hi:[1,0,0] neg_lo:[1,0,0] neg_hi:[1,0,0]
    v_pk_fma_f32 v[244:245], v[190:191], v[0:1], v[250:251] op_sel_hi:[1,0,0] neg_lo:[0,0,1] neg_hi:[0,0,1]
    v_pk_fma_f32 v[190:191], v[190:191], v[0:1], v[252:253] op_sel_hi:[1,0,0] neg_lo:[1,0,0] neg_hi:[1,0,0]
    v_pk_fma_f32 v[246:247], v[192:193], v[0:1], v[250:251] op_sel_hi:[1,0,0] neg_lo:[0,0,1] neg_hi:[0,0,1]
    v_pk_fma_f32 v[192:193], v[192:193], v[0:1], v[252:253] op_sel_hi:[1,0,0] neg_lo:[1,0,0] neg_hi:[1,0,0]
    v_pk_fma_f32 v[248:249], v[194:195], v[0:1], v[250:251] op_sel_hi:[1,0,0] neg_lo:[0,0,1] neg_hi:[0,0,1]
    v_pk_fma_f32 v[194:195], v[194:195], v[0:1], v[252:253] op_sel_hi:[1,0,0] neg_lo:[1,0,0] neg_hi:[1,0,0]
    v_exp_f32 v232, v232
    v_exp_f32 v178, v178
    v_exp_f32 v233, v233
    v_exp_f32 v179, v179
    v_exp_f32 v234, v234
    v_exp_f32 v180, v180
    v_exp_f32 v235, v235
    v_exp_f32 v181, v181
    v_exp_f32 v236, v236
    v_exp_f32 v182, v182
    v_exp_f32 v237, v237
    v_exp_f32 v183, v183
    v_exp_f32 v238, v238
    v_exp_f32 v184, v184
    v_exp_f32 v239, v239
    v_exp_f32 v185, v185
    v_exp_f32 v240, v240
    v_exp_f32 v186, v186
    v_exp_f32 v241, v241
    v_exp_f32 v187, v187
    v_exp_f32 v242, v242
    v_exp_f32 v188, v188
    v_exp_f32 v243, v243
    v_exp_f32 v189, v189
    v_exp_f32 v244, v244
    v_exp_f32 v190, v190
    v_exp_f32 v245, v245
    v_exp_f32 v191, v191
    v_exp_f32 v246, v246
    v_exp_f32 v192, v192
    v_exp_f32 v247, v247
    v_exp_f32 v193, v193
    v_exp_f32 v248, v248
    v_exp_f32 v194, v194
    v_exp_f32 v249, v249
    v_exp_f32 v195, v195
    v_pk_add_f32 v[250:251], v[232:233], v[234:235]
    v_pk_add_f32 v[252:253], v[178:179], v[180:181]
    v_pk_add_f32 v[250:251], v[250:251], v[236:237]
    v_pk_add_f32 v[252:253], v[252:253], v[182:183]
    v_pk_add_f32 v[250:251], v[250:251], v[238:239]
    v_pk_add_f32 v[252:253], v[252:253], v[184:185]
    v_pk_add_f32 v[250:251], v[250:251], v[240:241]
    v_pk_add_f32 v[252:253], v[252:253], v[186:187]
    v_pk_add_f32 v[250:251], v[250:251], v[242:243]
    v_pk_add_f32 v[252:253], v[252:253], v[188:189]
    v_pk_add_f32 v[250:251], v[250:251], v[244:245]
    v_pk_add_f32 v[252:253], v[252:253], v[190:191]
    v_pk_add_f32 v[250:251], v[250:251], v[246:247]
    v_pk_add_f32 v[252:253], v[252:253], v[192:193]
    v_pk_add_f32 v[250:251], v[250:251], v[248:249]
    v_pk_add_f32 v[252:253], v[252:253], v[194:195]
    v_add_f32 v250, v250, v251
    v_add_f32 v252, v252, v253
    v_rcp_f32 v250, v250
    v_rcp_f32 v252, v252
    s_nop 0
    v_mul_f32 v250, v0, v250
    v_mul_f32 v252, v0, v252
    v_pk_mul_f32 v[232:233], v[232:233], v[250:251] op_sel_hi:[1,0]
    v_pk_mul_f32 v[178:179], v[178:179], v[252:253] op_sel_hi:[1,0]
    v_pk_mul_f32 v[234:235], v[234:235], v[250:251] op_sel_hi:[1,0]
    v_pk_mul_f32 v[180:181], v[180:181], v[252:253] op_sel_hi:[1,0]
    v_pk_mul_f32 v[236:237], v[236:237], v[250:251] op_sel_hi:[1,0]
    v_pk_mul_f32 v[182:183], v[182:183], v[252:253] op_sel_hi:[1,0]
    v_pk_mul_f32 v[238:239], v[238:239], v[250:251] op_sel_hi:[1,0]
    v_pk_mul_f32 v[184:185], v[184:185], v[252:253] op_sel_hi:[1,0]
    v_pk_mul_f32 v[240:241], v[240:241], v[250:251] op_sel_hi:[1,0]
    v_pk_mul_f32 v[186:187], v[186:187], v[252:253] op_sel_hi:[1,0]
    v_pk_mul_f32 v[242:243], v[242:243], v[250:251] op_sel_hi:[1,0]
    v_pk_mul_f32 v[188:189], v[188:189], v[252:253] op_sel_hi:[1,0]
    v_pk_mul_f32 v[244:245], v[244:245], v[250:251] op_sel_hi:[1,0]
    v_pk_mul_f32 v[190:191], v[190:191], v[252:253] op_sel_hi:[1,0]
    v_pk_mul_f32 v[246:247], v[246:247], v[250:251] op_sel_hi:[1,0]
    v_pk_mul_f32 v[192:193], v[192:193], v[252:253] op_sel_hi:[1,0]
    v_pk_mul_f32 v[248:249], v[248:249], v[250:251] op_sel_hi:[1,0]
    v_pk_mul_f32 v[194:195], v[194:195], v[252:253] op_sel_hi:[1,0]
    v_cvt_pk_bf16_f32 v178, v178, v179
    v_cvt_pk_bf16_f32 v179, v180, v181
    v_cvt_pk_bf16_f32 v180, v182, v183
    v_cvt_pk_bf16_f32 v181, v184, v185
    v_cvt_pk_bf16_f32 v182, v186, v187
    v_cvt_pk_bf16_f32 v183, v188, v189
    v_cvt_pk_bf16_f32 v184, v190, v191
    v_cvt_pk_bf16_f32 v185, v192, v193
    v_cvt_pk_bf16_f32 v186, v194, v195
    v_cvt_pk_bf16_f32 v187, v232, v233
    v_cvt_pk_bf16_f32 v188, v234, v235
    v_cvt_pk_bf16_f32 v189, v236, v237
    v_cvt_pk_bf16_f32 v190, v238, v239
    v_cvt_pk_bf16_f32 v191, v240, v241
    v_cvt_pk_bf16_f32 v192, v242, v243
    v_cvt_pk_bf16_f32 v193, v244, v245
    v_cvt_pk_bf16_f32 v194, v246, v247
    v_cvt_pk_bf16_f32 v195, v248, v249
    ds_write_b128 v7, v[160:163] offset:0
    ds_write_b128 v7, v[164:167] offset:16
    ds_write_b128 v7, v[168:171] offset:32
    ds_write_b128 v7, v[172:175] offset:48
    ds_write_b128 v7, v[176:179] offset:64
    ds_write_b128 v7, v[180:183] offset:80
    ds_write_b128 v7, v[184:187] offset:96
    ds_write_b128 v7, v[188:191] offset:112
    ds_write_b128 v7, v[192:195] offset:128
    v_max3_f32 v250, v196, v197, v198
    v_min3_f32 v252, v196, v197, v198
    v_max3_f32 v250, v250, v199, v200
    v_min3_f32 v252, v252, v199, v200
    v_max3_f32 v250, v250, v201, v202
    v_min3_f32 v252, v252, v201, v202
    v_max3_f32 v250, v250, v203, v204
    v_min3_f32 v252, v252, v203, v204
    v_max3_f32 v250, v250, v205, v206
    v_min3_f32 v252, v252, v205, v206
    v_max3_f32 v250, v250, v207, v208
    v_min3_f32 v252, v252, v207, v208
    v_max3_f32 v250, v250, v209, v210
    v_min3_f32 v252, v252, v209, v210
    v_max3_f32 v250, v250, v211, v212
    v_min3_f32 v252, v252, v211, v212
    v_max_f32 v250, v250, v213
    v_min_f32 v252, v252, v213
    v_mul_f32 v250, v0, v250
    v_mul_f32 v252, v0, v252
    v_pk_fma_f32 v[232:233], v[196:197], v[0:1], v[250:251] op_sel_hi:[1,0,0] neg_lo:[0,0,1] neg_hi:[0,0,1]
    v_pk_fma_f32 v[196:197], v[196:197], v[0:1], v[252:253] op_sel_hi:[1,0,0] neg_lo:[1,0,0] neg_hi:[1,0,0]
    v_pk_fma_f32 v[234:235], v[198:199], v[0:1], v[250:251] op_sel_hi:[1,0,0] neg_lo:[0,0,1] neg_hi:[0,0,1]
    v_pk_fma_f32 v[198:199], v[198:199], v[0:1], v[252:253] op_sel_hi:[1,0,0] neg_lo:[1,0,0] neg_hi:[1,0,0]
    v_pk_fma_f32 v[236:237], v[200:201], v[0:1], v[250:251] op_sel_hi:[1,0,0] neg_lo:[0,0,1] neg_hi:[0,0,1]
    v_pk_fma_f32 v[200:201], v[200:201], v[0:1], v[252:253] op_sel_hi:[1,0,0] neg_lo:[1,0,0] neg_hi:[1,0,0]
    v_pk_fma_f32 v[238:239], v[202:203], v[0:1], v[250:251] op_sel_hi:[1,0,0] neg_lo:[0,0,1] neg_hi:[0,0,1]
    v_pk_fma_f32 v[202:203], v[202:203], v[0:1], v[252:253] op_sel_hi:[1,0,0] neg_lo:[1,0,0] neg_hi:[1,0,0]
    v_pk_fma_f32 v[240:241], v[204:205], v[0:1], v[250:251] op_sel_hi:[1,0,0] neg_lo:[0,0,1] neg_hi:[0,0,1]
    v_pk_fma_f32 v[204:205], v[204:205], v[0:1], v[252:253] op_sel_hi:[1,0,0] neg_lo:[1,0,0] neg_hi:[1,0,0]
    v_pk_fma_f32 v[242:243], v[206:207], v[0:1], v[250:251] op_sel_hi:[1,0,0] neg_lo:[0,0,1] neg_hi:[0,0,1]
    v_pk_fma_f32 v[206:207], v[206:207], v[0:1], v[252:253] op_sel_hi:[1,0,0] neg_lo:[1,0,0] neg_hi:[1,0,0]
    v_pk_fma_f32 v[244:245], v[208:209], v[0:1], v[250:251] op_sel_hi:[1,0,0] neg_lo:[0,0,1] neg_hi:[0,0,1]
    v_pk_fma_f32 v[208:209], v[208:209], v[0:1], v[252:253] op_sel_hi:[1,0,0] neg_lo:[1,0,0] neg_hi:[1,0,0]
    v_pk_fma_f32 v[246:247], v[210:211], v[0:1], v[250:251] op_sel_hi:[1,0,0] neg_lo:[0,0,1] neg_hi:[0,0,1]
    v_pk_fma_f32 v[210:211], v[210:211], v[0:1], v[252:253] op_sel_hi:[1,0,0] neg_lo:[1,0,0] neg_hi:[1,0,0]
    v_pk_fma_f32 v[248:249], v[212:213], v[0:1], v[250:251] op_sel_hi:[1,0,0] neg_lo:[0,0,1] neg_hi:[0,0,1]
    v_pk_fma_f32 v[212:213], v[212:213], v[0:1], v[252:253] op_sel_hi:[1,0,0] neg_lo:[1,0,0] neg_hi:[1,0,0]
    v_exp_f32 v232, v232
    v_exp_f32 v196, v196
    v_exp_f32 v233, v233
    v_exp_f32 v197, v197
    v_exp_f32 v234, v234
    v_exp_f32 v198, v198
    v_exp_f32 v235, v235
    v_exp_f32 v199, v199
    v_exp_f32 v236, v236
    v_exp_f32 v200, v200
    v_exp_f32 v237, v237
    v_exp_f32 v201, v201
    v_exp_f32 v238, v238
    v_exp_f32 v202, v202
    v_exp_f32 v239, v239
    v_exp_f32 v203, v203
    v_exp_f32 v240, v240
    v_exp_f32 v204, v204
    v_exp_f32 v241, v241
    v_exp_f32 v205, v205
    v_exp_f32 v242, v242
    v_exp_f32 v206, v206
    v_exp_f32 v243, v243
    v_exp_f32 v207, v207
    v_exp_f32 v244, v244
    v_exp_f32 v208, v208
    v_exp_f32 v245, v245
    v_exp_f32 v209, v209
    v_exp_f32 v246, v246
    v_exp_f32 v210, v210
    v_exp_f32 v247, v247
    v_exp_f32 v211, v211
    v_exp_f32 v248, v248
    v_exp_f32 v212, v212
    v_exp_f32 v249, v249
    v_exp_f32 v213, v213
    v_pk_add_f32 v[250:251], v[232:233], v[234:235]
    v_pk_add_f32 v[252:253], v[196:197], v[198:199]
    v_pk_add_f32 v[250:251], v[250:251], v[236:237]
    v_pk_add_f32 v[252:253], v[252:253], v[200:201]
    v_pk_add_f32 v[250:251], v[250:251], v[238:239]
    v_pk_add_f32 v[252:253], v[252:253], v[202:203]
    v_pk_add_f32 v[250:251], v[250:251], v[240:241]
    v_pk_add_f32 v[252:253], v[252:253], v[204:205]
    v_pk_add_f32 v[250:251], v[250:251], v[242:243]
    v_pk_add_f32 v[252:253], v[252:253], v[206:207]
    v_pk_add_f32 v[250:251], v[250:251], v[244:245]
    v_pk_add_f32 v[252:253], v[252:253], v[208:209]
    v_pk_add_f32 v[250:251], v[250:251], v[246:247]
    v_pk_add_f32 v[252:253], v[252:253], v[210:211]
    v_pk_add_f32 v[250:251], v[250:251], v[248:249]
    v_pk_add_f32 v[252:253], v[252:253], v[212:213]
    v_add_f32 v250, v250, v251
    v_add_f32 v252, v252, v253
    v_rcp_f32 v250, v250
    v_rcp_f32 v252, v252
    s_nop 0
    v_mul_f32 v250, v0, v250
    v_mul_f32 v252, v0, v252
    v_pk_mul_f32 v[232:233], v[232:233], v[250:251] op_sel_hi:[1,0]
    v_pk_mul_f32 v[196:197], v[196:197], v[252:253] op_sel_hi:[1,0]
    v_pk_mul_f32 v[234:235], v[234:235], v[250:251] op_sel_hi:[1,0]
    v_pk_mul_f32 v[198:199], v[198:199], v[252:253] op_sel_hi:[1,0]
    v_pk_mul_f32 v[236:237], v[236:237], v[250:251] op_sel_hi:[1,0]
    v_pk_mul_f32 v[200:201], v[200:201], v[252:253] op_sel_hi:[1,0]
    v_pk_mul_f32 v[238:239], v[238:239], v[250:251] op_sel_hi:[1,0]
    v_pk_mul_f32 v[202:203], v[202:203], v[252:253] op_sel_hi:[1,0]
    v_pk_mul_f32 v[240:241], v[240:241], v[250:251] op_sel_hi:[1,0]
    v_pk_mul_f32 v[204:205], v[204:205], v[252:253] op_sel_hi:[1,0]
    v_pk_mul_f32 v[242:243], v[242:243], v[250:251] op_sel_hi:[1,0]
    v_pk_mul_f32 v[206:207], v[206:207], v[252:253] op_sel_hi:[1,0]
    v_pk_mul_f32 v[244:245], v[244:245], v[250:251] op_sel_hi:[1,0]
    v_pk_mul_f32 v[208:209], v[208:209], v[252:253] op_sel_hi:[1,0]
    v_pk_mul_f32 v[246:247], v[246:247], v[250:251] op_sel_hi:[1,0]
    v_pk_mul_f32 v[210:211], v[210:211], v[252:253] op_sel_hi:[1,0]
    v_pk_mul_f32 v[248:249], v[248:249], v[250:251] op_sel_hi:[1,0]
    v_pk_mul_f32 v[212:213], v[212:213], v[252:253] op_sel_hi:[1,0]
    v_cvt_pk_bf16_f32 v196, v196, v197
    v_cvt_pk_bf16_f32 v197, v198, v199
    v_cvt_pk_bf16_f32 v198, v200, v201
    v_cvt_pk_bf16_f32 v199, v202, v203
    v_cvt_pk_bf16_f32 v200, v204, v205
    v_cvt_pk_bf16_f32 v201, v206, v207
    v_cvt_pk_bf16_f32 v202, v208, v209
    v_cvt_pk_bf16_f32 v203, v210, v211
    v_cvt_pk_bf16_f32 v204, v212, v213
    v_cvt_pk_bf16_f32 v205, v232, v233
    v_cvt_pk_bf16_f32 v206, v234, v235
    v_cvt_pk_bf16_f32 v207, v236, v237
    v_cvt_pk_bf16_f32 v208, v238, v239
    v_cvt_pk_bf16_f32 v209, v240, v241
    v_cvt_pk_bf16_f32 v210, v242, v243
    v_cvt_pk_bf16_f32 v211, v244, v245
    v_cvt_pk_bf16_f32 v212, v246, v247
    v_cvt_pk_bf16_f32 v213, v248, v249
    v_max3_f32 v250, v214, v215, v216
    v_min3_f32 v252, v214, v215, v216
    v_max3_f32 v250, v250, v217, v218
    v_min3_f32 v252, v252, v217, v218
    v_max3_f32 v250, v250, v219, v220
    v_min3_f32 v252, v252, v219, v220
    v_max3_f32 v250, v250, v221, v222
    v_min3_f32 v252, v252, v221, v222
    v_max3_f32 v250, v250, v223, v224
    v_min3_f32 v252, v252, v223, v224
    v_max3_f32 v250, v250, v225, v226
    v_min3_f32 v252, v252, v225, v226
    v_max3_f32 v250, v250, v227, v228
    v_min3_f32 v252, v252, v227, v228
    v_max3_f32 v250, v250, v229, v230
    v_min3_f32 v252, v252, v229, v230
    v_max_f32 v250, v250, v231
    v_min_f32 v252, v252, v231
    v_mul_f32 v250, v0, v250
    v_mul_f32 v252, v0, v252
    v_pk_fma_f32 v[232:233], v[214:215], v[0:1], v[250:251] op_sel_hi:[1,0,0] neg_lo:[0,0,1] neg_hi:[0,0,1]
    v_pk_fma_f32 v[214:215], v[214:215], v[0:1], v[252:253] op_sel_hi:[1,0,0] neg_lo:[1,0,0] neg_hi:[1,0,0]
    v_pk_fma_f32 v[234:235], v[216:217], v[0:1], v[250:251] op_sel_hi:[1,0,0] neg_lo:[0,0,1] neg_hi:[0,0,1]
    v_pk_fma_f32 v[216:217], v[216:217], v[0:1], v[252:253] op_sel_hi:[1,0,0] neg_lo:[1,0,0] neg_hi:[1,0,0]
    v_pk_fma_f32 v[236:237], v[218:219], v[0:1], v[250:251] op_sel_hi:[1,0,0] neg_lo:[0,0,1] neg_hi:[0,0,1]
    v_pk_fma_f32 v[218:219], v[218:219], v[0:1], v[252:253] op_sel_hi:[1,0,0] neg_lo:[1,0,0] neg_hi:[1,0,0]
    v_pk_fma_f32 v[238:239], v[220:221], v[0:1], v[250:251] op_sel_hi:[1,0,0] neg_lo:[0,0,1] neg_hi:[0,0,1]
    v_pk_fma_f32 v[220:221], v[220:221], v[0:1], v[252:253] op_sel_hi:[1,0,0] neg_lo:[1,0,0] neg_hi:[1,0,0]
    v_pk_fma_f32 v[240:241], v[222:223], v[0:1], v[250:251] op_sel_hi:[1,0,0] neg_lo:[0,0,1] neg_hi:[0,0,1]
    v_pk_fma_f32 v[222:223], v[222:223], v[0:1], v[252:253] op_sel_hi:[1,0,0] neg_lo:[1,0,0] neg_hi:[1,0,0]
    v_pk_fma_f32 v[242:243], v[224:225], v[0:1], v[250:251] op_sel_hi:[1,0,0] neg_lo:[0,0,1] neg_hi:[0,0,1]
    v_pk_fma_f32 v[224:225], v[224:225], v[0:1], v[252:253] op_sel_hi:[1,0,0] neg_lo:[1,0,0] neg_hi:[1,0,0]
    v_pk_fma_f32 v[244:245], v[226:227], v[0:1], v[250:251] op_sel_hi:[1,0,0] neg_lo:[0,0,1] neg_hi:[0,0,1]
    v_pk_fma_f32 v[226:227], v[226:227], v[0:1], v[252:253] op_sel_hi:[1,0,0] neg_lo:[1,0,0] neg_hi:[1,0,0]
    v_pk_fma_f32 v[246:247], v[228:229], v[0:1], v[250:251] op_sel_hi:[1,0,0] neg_lo:[0,0,1] neg_hi:[0,0,1]
    v_pk_fma_f32 v[228:229], v[228:229], v[0:1], v[252:253] op_sel_hi:[1,0,0] neg_lo:[1,0,0] neg_hi:[1,0,0]
    v_pk_fma_f32 v[248:249], v[230:231], v[0:1], v[250:251] op_sel_hi:[1,0,0] neg_lo:[0,0,1] neg_hi:[0,0,1]
    v_pk_fma_f32 v[230:231], v[230:231], v[0:1], v[252:253] op_sel_hi:[1,0,0] neg_lo:[1,0,0] neg_hi:[1,0,0]
    v_exp_f32 v232, v232
    v_exp_f32 v214, v214
    v_exp_f32 v233, v233
    v_exp_f32 v215, v215
    v_exp_f32 v234, v234
    v_exp_f32 v216, v216
    v_exp_f32 v235, v235
    v_exp_f32 v217, v217
    v_exp_f32 v236, v236
    v_exp_f32 v218, v218
    v_exp_f32 v237, v237
    v_exp_f32 v219, v219
    v_exp_f32 v238, v238
    v_exp_f32 v220, v220
    v_exp_f32 v239, v239
    v_exp_f32 v221, v221
    v_exp_f32 v240, v240
    v_exp_f32 v222, v222
    v_exp_f32 v241, v241
    v_exp_f32 v223, v223
    v_exp_f32 v242, v242
    v_exp_f32 v224, v224
    v_exp_f32 v243, v243
    v_exp_f32 v225, v225
    v_exp_f32 v244, v244
    v_exp_f32 v226, v226
    v_exp_f32 v245, v245
    v_exp_f32 v227, v227
    v_exp_f32 v246, v246
    v_exp_f32 v228, v228
    v_exp_f32 v247, v247
    v_exp_f32 v229, v229
    v_exp_f32 v248, v248
    v_exp_f32 v230, v230
    v_exp_f32 v249, v249
    v_exp_f32 v231, v231
    v_pk_add_f32 v[250:251], v[232:233], v[234:235]
    v_pk_add_f32 v[252:253], v[214:215], v[216:217]
    v_pk_add_f32 v[250:251], v[250:251], v[236:237]
    v_pk_add_f32 v[252:253], v[252:253], v[218:219]
    v_pk_add_f32 v[250:251], v[250:251], v[238:239]
    v_pk_add_f32 v[252:253], v[252:253], v[220:221]
    v_pk_add_f32 v[250:251], v[250:251], v[240:241]
    v_pk_add_f32 v[252:253], v[252:253], v[222:223]
    v_pk_add_f32 v[250:251], v[250:251], v[242:243]
    v_pk_add_f32 v[252:253], v[252:253], v[224:225]
    v_pk_add_f32 v[250:251], v[250:251], v[244:245]
    v_pk_add_f32 v[252:253], v[252:253], v[226:227]
    v_pk_add_f32 v[250:251], v[250:251], v[246:247]
    v_pk_add_f32 v[252:253], v[252:253], v[228:229]
    v_pk_add_f32 v[250:251], v[250:251], v[248:249]
    v_pk_add_f32 v[252:253], v[252:253], v[230:231]
    v_add_f32 v250, v250, v251
    v_add_f32 v252, v252, v253
    v_rcp_f32 v250, v250
    v_rcp_f32 v252, v252
    s_nop 0
    v_mul_f32 v250, v0, v250
    v_mul_f32 v252, v0, v252
    v_pk_mul_f32 v[232:233], v[232:233], v[250:251] op_sel_hi:[1,0]
    v_pk_mul_f32 v[214:215], v[214:215], v[252:253] op_sel_hi:[1,0]
    v_pk_mul_f32 v[234:235], v[234:235], v[250:251] op_sel_hi:[1,0]
    v_pk_mul_f32 v[216:217], v[216:217], v[252:253] op_sel_hi:[1,0]
    v_pk_mul_f32 v[236:237], v[236:237], v[250:251] op_sel_hi:[1,0]
    v_pk_mul_f32 v[218:219], v[218:219], v[252:253] op_sel_hi:[1,0]
    v_pk_mul_f32 v[238:239], v[238:239], v[250:251] op_sel_hi:[1,0]
    v_pk_mul_f32 v[220:221], v[220:221], v[252:253] op_sel_hi:[1,0]
    v_pk_mul_f32 v[240:241], v[240:241], v[250:251] op_sel_hi:[1,0]
    v_pk_mul_f32 v[222:223], v[222:223], v[252:253] op_sel_hi:[1,0]
    v_pk_mul_f32 v[242:243], v[242:243], v[250:251] op_sel_hi:[1,0]
    v_pk_mul_f32 v[224:225], v[224:225], v[252:253] op_sel_hi:[1,0]
    v_pk_mul_f32 v[244:245], v[244:245], v[250:251] op_sel_hi:[1,0]
    v_pk_mul_f32 v[226:227], v[226:227], v[252:253] op_sel_hi:[1,0]
    v_pk_mul_f32 v[246:247], v[246:247], v[250:251] op_sel_hi:[1,0]
    v_pk_mul_f32 v[228:229], v[228:229], v[252:253] op_sel_hi:[1,0]
    v_pk_mul_f32 v[248:249], v[248:249], v[250:251] op_sel_hi:[1,0]
    v_pk_mul_f32 v[230:231], v[230:231], v[252:253] op_sel_hi:[1,0]
    v_cvt_pk_bf16_f32 v214, v214, v215
    v_cvt_pk_bf16_f32 v215, v216, v217
    v_cvt_pk_bf16_f32 v216, v218, v219
    v_cvt_pk_bf16_f32 v217, v220, v221
    v_cvt_pk_bf16_f32 v218, v222, v223
    v_cvt_pk_bf16_f32 v219, v224, v225
    v_cvt_pk_bf16_f32 v220, v226, v227
    v_cvt_pk_bf16_f32 v221, v228, v229
    v_cvt_pk_bf16_f32 v222, v230, v231
    v_cvt_pk_bf16_f32 v223, v232, v233
    v_cvt_pk_bf16_f32 v224, v234, v235
    v_cvt_pk_bf16_f32 v225, v236, v237
    v_cvt_pk_bf16_f32 v226, v238, v239
    v_cvt_pk_bf16_f32 v227, v240, v241
    v_cvt_pk_bf16_f32 v228, v242, v243
    v_cvt_pk_bf16_f32 v229, v244, v245
    v_cvt_pk_bf16_f32 v230, v246, v247
    v_cvt_pk_bf16_f32 v231, v248, v249
    ds_write_b128 v7, v[196:199] offset:144
    ds_write_b128 v7, v[200:203] offset:160
    ds_write_b128 v7, v[204:207] offset:176
    ds_write_b128 v7, v[208:211] offset:192
    ds_write_b128 v7, v[212:215] offset:208
    ds_write_b128 v7, v[216:219] offset:224
    ds_write_b128 v7, v[220:223] offset:240
    ds_write_b128 v7, v[224:227] offset:256
    ds_write_b128 v7, v[228:231] offset:272
    s_mul_i32 s50, s40, 144
    s_mul_i32 s51, s40, 80
    v_accvgpr_read_b32 v240, a232
    v_accvgpr_read_b32 v242, a233
    v_accvgpr_read_b32 v244, a234
    v_add_u32 v240, s50, v240
    v_add_u32 v242, s50, v242
    v_add_u32 v244, s51, v244
    v_add_u32 v241, 37888, v240
    v_add_u32 v243, 37888, v242
    v_accvgpr_read_b32 v9, a252
    s_waitcnt lgkmcnt(0)
    s_barrier
    ds_read_b64_tr_b16 a[0:1], v244 offset:0
    ds_read_b64_tr_b16 a[8:9], v240 offset:0
    ds_read_b64_tr_b16 a[4:5], v244 offset:40
    ds_read_b64_tr_b16 a[12:13], v240 offset:72
    ds_read_b64_tr_b16 a[16:17], v242 offset:0
    ds_read_b64_tr_b16 a[2:3], v244 offset:336
    ds_read_b64_tr_b16 a[10:11], v240 offset:592
    ds_read_b64_tr_b16 a[6:7], v244 offset:376
    ds_read_b64_tr_b16 a[14:15], v240 offset:664
    ds_read_b64_tr_b16 a[18:19], v242 offset:592
    ds_read_b64_tr_b16 a[20:21], v244 offset:5376
    ds_read_b64_tr_b16 a[28:29], v240 offset:9472
    ds_read_b64_tr_b16 a[24:25], v244 offset:5416
    ds_read_b64_tr_b16 a[32:33], v240 offset:9544
    ds_read_b64_tr_b16 a[36:37], v242 offset:9472
    ds_read_b64_tr_b16 a[22:23], v244 offset:5712
    ds_read_b64_tr_b16 a[30:31], v240 offset:10064
    ds_read_b64_tr_b16 a[26:27], v244 offset:5752
    ds_read_b64_tr_b16 a[34:35], v240 offset:10136
    ds_read_b64_tr_b16 a[38:39], v242 offset:10064
    s_waitcnt lgkmcnt(10)
    v_mfma_f32_32x32x16_bf16 a[132:147], a[8:11], a[0:3], 0
    v_mfma_f32_32x32x16_bf16 a[168:183], a[16:19], a[0:3], 0
    ds_read_b64_tr_b16 a[208:209], v244 offset:10752
    ds_read_b64_tr_b16 a[216:217], v240 offset:18944
    ds_read_b64_tr_b16 a[212:213], v244 offset:10792
    ds_read_b64_tr_b16 a[220:221], v240 offset:19016
    ds_read_b64_tr_b16 a[224:225], v242 offset:18944
    ds_read_b64_tr_b16 a[210:211], v244 offset:11088
    ds_read_b64_tr_b16 a[218:219], v240 offset:19536
    ds_read_b64_tr_b16 a[214:215], v244 offset:11128
    ds_read_b64_tr_b16 a[222:223], v240 offset:19608
    ds_read_b64_tr_b16 a[226:227], v242 offset:19536
    v_mfma_f32_32x32x16_bf16 a[148:163], a[12:15], a[4:7], 0
    v_mfma_f32_32x32x16_bf16 a[184:199], a[16:19], a[4:7], 0
    s_waitcnt lgkmcnt(10)
    v_mfma_f32_32x32x16_bf16 a[132:147], a[28:31], a[20:23], a[132:147]
    v_mfma_f32_32x32x16_bf16 a[168:183], a[36:39], a[20:23], a[168:183]
    ds_read_b64_tr_b16 a[0:1], v244 offset:16128
    ds_read_b64_tr_b16 a[8:9], v240 offset:28416
    ds_read_b64_tr_b16 a[4:5], v244 offset:16168
    ds_read_b64_tr_b16 a[12:13], v240 offset:28488
    ds_read_b64_tr_b16 a[16:17], v242 offset:28416
    ds_read_b64_tr_b16 a[2:3], v244 offset:16464
    ds_read_b64_tr_b16 a[10:11], v240 offset:29008
    ds_read_b64_tr_b16 a[6:7], v244 offset:16504
    ds_read_b64_tr_b16 a[14:15], v240 offset:29080
    ds_read_b64_tr_b16 a[18:19], v242 offset:29008
    v_mfma_f32_32x32x16_bf16 a[148:163], a[32:35], a[24:27], a[148:163]
    v_mfma_f32_32x32x16_bf16 a[184:199], a[36:39], a[24:27], a[184:199]
    s_waitcnt lgkmcnt(10)
    v_mfma_f32_32x32x16_bf16 a[132:147], a[216:219], a[208:211], a[132:147]
    v_mfma_f32_32x32x16_bf16 a[168:183], a[224:227], a[208:211], a[168:183]
    ds_read_b64_tr_b16 a[20:21], v244 offset:21504
    ds_read_b64_tr_b16 a[28:29], v241 offset:0
    ds_read_b64_tr_b16 a[24:25], v244 offset:21544
    ds_read_b64_tr_b16 a[32:33], v241 offset:72
    ds_read_b64_tr_b16 a[36:37], v243 offset:0
    ds_read_b64_tr_b16 a[22:23], v244 offset:21840
    ds_read_b64_tr_b16 a[30:31], v241 offset:592
    ds_read_b64_tr_b16 a[26:27], v244 offset:21880
    ds_read_b64_tr_b16 a[34:35], v241 offset:664
    ds_read_b64_tr_b16 a[38:39], v243 offset:592
    v_mfma_f32_32x32x16_bf16 a[148:163], a[220:223], a[212:215], a[148:163]
    v_mfma_f32_32x32x16_bf16 a[184:199], a[224:227], a[212:215], a[184:199]
    s_waitcnt lgkmcnt(10)
    v_mfma_f32_32x32x16_bf16 a[132:147], a[8:11], a[0:3], a[132:147]
    v_mfma_f32_32x32x16_bf16 a[168:183], a[16:19], a[0:3], a[168:183]
    ds_read_b64_tr_b16 a[208:209], v244 offset:26880
    ds_read_b64_tr_b16 a[216:217], v241 offset:9472
    ds_read_b64_tr_b16 a[212:213], v244 offset:26920
    ds_read_b64_tr_b16 a[220:221], v241 offset:9544
    ds_read_b64_tr_b16 a[224:225], v243 offset:9472
    ds_read_b64_tr_b16 a[210:211], v244 offset:27216
    ds_read_b64_tr_b16 a[218:219], v241 offset:10064
    ds_read_b64_tr_b16 a[214:215], v244 offset:27256
    ds_read_b64_tr_b16 a[222:223], v241 offset:10136
    ds_read_b64_tr_b16 a[226:227], v243 offset:10064
    v_mfma_f32_32x32x16_bf16 a[148:163], a[12:15], a[4:7], a[148:163]
    v_mfma_f32_32x32x16_bf16 a[184:199], a[16:19], a[4:7], a[184:199]
    s_waitcnt lgkmcnt(10)
    v_mfma_f32_32x32x16_bf16 a[132:147], a[28:31], a[20:23], a[132:147]
    v_mfma_f32_32x32x16_bf16 a[168:183], a[36:39], a[20:23], a[168:183]
    ds_read_b64_tr_b16 a[0:1], v244 offset:32256
    ds_read_b64_tr_b16 a[8:9], v241 offset:18944
    ds_read_b64_tr_b16 a[4:5], v244 offset:32296
    ds_read_b64_tr_b16 a[12:13], v241 offset:19016
    ds_read_b64_tr_b16 a[16:17], v243 offset:18944
    ds_read_b64_tr_b16 a[2:3], v244 offset:32592
    ds_read_b64_tr_b16 a[10:11], v241 offset:19536
    ds_read_b64_tr_b16 a[6:7], v244 offset:32632
    ds_read_b64_tr_b16 a[14:15], v241 offset:19608
    ds_read_b64_tr_b16 a[18:19], v243 offset:19536
    v_mfma_f32_32x32x16_bf16 a[148:163], a[32:35], a[24:27], a[148:163]
    v_mfma_f32_32x32x16_bf16 a[184:199], a[36:39], a[24:27], a[184:199]
    s_waitcnt lgkmcnt(10)
    v_mfma_f32_32x32x16_bf16 a[132:147], a[216:219], a[208:211], a[132:147]
    v_mfma_f32_32x32x16_bf16 a[168:183], a[224:227], a[208:211], a[168:183]
    ds_read_b64_tr_b16 a[20:21], v244 offset:37632
    ds_read_b64_tr_b16 a[28:29], v241 offset:28416
    ds_read_b64_tr_b16 a[24:25], v244 offset:37672
    ds_read_b64_tr_b16 a[32:33], v241 offset:28488
    ds_read_b64_tr_b16 a[36:37], v243 offset:28416
    ds_read_b64_tr_b16 a[22:23], v244 offset:37968
    ds_read_b64_tr_b16 a[30:31], v241 offset:29008
    ds_read_b64_tr_b16 a[26:27], v244 offset:38008
    ds_read_b64_tr_b16 a[34:35], v241 offset:29080
    ds_read_b64_tr_b16 a[38:39], v243 offset:29008
    v_mfma_f32_32x32x16_bf16 a[148:163], a[220:223], a[212:215], a[148:163]
    v_mfma_f32_32x32x16_bf16 a[184:199], a[224:227], a[212:215], a[184:199]
    s_waitcnt lgkmcnt(10)
    v_mfma_f32_32x32x16_bf16 a[132:147], a[8:11], a[0:3], a[132:147]
    v_mfma_f32_32x32x16_bf16 a[168:183], a[16:19], a[0:3], a[168:183]
    v_mfma_f32_32x32x16_bf16 a[148:163], a[12:15], a[4:7], a[148:163]
    v_mfma_f32_32x32x16_bf16 a[184:199], a[16:19], a[4:7], a[184:199]
    s_waitcnt lgkmcnt(0)
    s_barrier
    v_mfma_f32_32x32x16_bf16 a[132:147], a[28:31], a[20:23], a[132:147]
    s_add_u32 m0, s73, 83968
    s_nop 0
    buffer_load_dwordx4 v2, s[24:27], s86 offen offset:0 lds
    v_mfma_f32_32x32x16_bf16 a[168:183], a[36:39], a[20:23], a[168:183]
    buffer_load_dwordx4 v3, s[24:27], s86 offen offset:1024 lds
    v_mfma_f32_32x32x16_bf16 a[148:163], a[32:35], a[24:27], a[148:163]
    buffer_load_dwordx4 v4, s[24:27], s86 offen offset:2048 lds
    v_mfma_f32_32x32x16_bf16 a[184:199], a[36:39], a[24:27], a[184:199]
    buffer_load_dwordx4 v5, s[24:27], s86 offen offset:3072 lds
    s_waitcnt vmcnt(9)
    s_barrier
    ds_read_b64_tr_b16 a[0:1], v11 offset:43008
    ds_read_b64_tr_b16 a[2:3], v11 offset:44288
    ds_read_b64_tr_b16 a[4:5], v11 offset:43072
    ds_read_b64_tr_b16 a[6:7], v11 offset:44352
    ds_read_b64_tr_b16 a[8:9], v11 offset:43136
    ds_read_b64_tr_b16 a[10:11], v11 offset:44416
    ds_read_b64_tr_b16 a[12:13], v11 offset:43200
    ds_read_b64_tr_b16 a[14:15], v11 offset:44480
    ds_read_b64_tr_b16 a[16:17], v11 offset:43264
    ds_read_b64_tr_b16 a[18:19], v11 offset:44544
    ds_read_b64_tr_b16 a[20:21], v11 offset:45568
    ds_read_b64_tr_b16 a[22:23], v11 offset:46848
    ds_read_b64_tr_b16 a[24:25], v11 offset:45632
    ds_read_b64_tr_b16 a[26:27], v11 offset:46912
    ds_read_b64_tr_b16 a[28:29], v11 offset:45696
    ds_read_b64_tr_b16 a[30:31], v11 offset:46976
    s_waitcnt lgkmcnt(8)
    v_mfma_f32_32x32x16_bf16 v[160:175], a[0:3], v[16:19], 0
    ds_read_b64_tr_b16 a[32:33], v11 offset:45760
    ds_read_b64_tr_b16 a[34:35], v11 offset:47040
    ds_read_b64_tr_b16 a[36:37], v11 offset:45824
    s_mul_i32 s74, s40, 163840
    s_add_u32 s74, s74, s57
    s_lshl_b32 s51, s41, 10
    s_add_u32 s74, s74, s51
    v_mfma_f32_32x32x16_bf16 v[176:191], a[4:7], v[16:19], 0
    ds_read_b64_tr_b16 a[38:39], v11 offset:47104
    v_mov_b32 v242, 0
    v_mov_b32 v240, 1
    v_accvgpr_read_b32 v241, a237
    s_lshl_b32 s95, s43, 9
    s_add_u32 s95, s95, 33398784
    buffer_store_dwordx4 a[132:135], v9, s[20:23], s74 offen sc1
    s_add_u32 s74, s74, 16384
    v_mfma_f32_32x32x16_bf16 v[192:207], a[8:11], v[16:19], 0
    ds_read_b64_tr_b16 a[40:41], v11 offset:48128
    ds_read_b64_tr_b16 a[42:43], v11 offset:49408
    ds_read_b64_tr_b16 a[44:45], v11 offset:48192
    s_mul_i32 s96, s41, 10240
    s_add_u32 s96, s96, s95
    s_lshl_b32 s50, s40, 7
    s_add_u32 s96, s96, s50
    v_mfma_f32_32x32x16_bf16 v[208:223], a[12:15], v[16:19], 0
    ds_read_b64_tr_b16 a[46:47], v11 offset:49472
    ds_read_b64_tr_b16 a[0:1], v11 offset:48256
    s_lshl_b32 s97, s40, 4
    s_add_u32 s97, s97, s41
    s_min_u32 s50, s97, 39
    s_mul_i32 s50, s50, 26
    s_lshr_b32 s50, s50, 8
    s_lshl_b32 s50, s50, 7
    s_add_u32 s75, s95, s50
    s_waitcnt lgkmcnt(9)
    v_mfma_f32_32x32x16_bf16 v[224:239], a[16:19], v[16:19], 0
    ds_read_b64_tr_b16 a[2:3], v11 offset:49536
    buffer_store_dwordx4 a[136:139], v9, s[20:23], s74 offen sc1
    s_add_u32 s74, s74, 16384
    v_mfma_f32_32x32x16_bf16 v[160:175], a[20:23], v[20:23], v[160:175]
    ds_read_b64_tr_b16 a[4:5], v11 offset:48320
    ds_read_b64_tr_b16 a[6:7], v11 offset:49600
    ds_read_b64_tr_b16 a[8:9], v11 offset:48384
    v_mfma_f32_32x32x16_bf16 v[176:191], a[24:27], v[20:23], v[176:191]
    ds_read_b64_tr_b16 a[10:11], v11 offset:49664
    ds_read_b64_tr_b16 a[12:13], v11 offset:50688
    v_mfma_f32_32x32x16_bf16 v[192:207], a[28:31], v[20:23], v[192:207]
    ds_read_b64_tr_b16 a[14:15], v11 offset:51968
    buffer_store_dwordx4 a[140:143], v9, s[20:23], s74 offen sc1
    s_add_u32 s74, s74, 16384
    s_waitcnt lgkmcnt(8)
    v_mfma_f32_32x32x16_bf16 v[208:223], a[32:35], v[20:23], v[208:223]
    ds_read_b64_tr_b16 a[16:17], v11 offset:50752
    ds_read_b64_tr_b16 a[18:19], v11 offset:52032
    ds_read_b64_tr_b16 a[20:21], v11 offset:50816
    v_mfma_f32_32x32x16_bf16 v[224:239], a[36:39], v[20:23], v[224:239]
    ds_read_b64_tr_b16 a[22:23], v11 offset:52096
    ds_read_b64_tr_b16 a[24:25], v11 offset:50880
    v_mfma_f32_32x32x16_bf16 v[160:175], a[40:43], v[24:27], v[160:175]
    ds_read_b64_tr_b16 a[26:27], v11 offset:52160
    buffer_store_dwordx4 a[144:147], v9, s[20:23], s74 offen sc1
    s_add_u32 s74, s74, 16384
    v_mfma_f32_32x32x16_bf16 v[176:191], a[44:47], v[24:27], v[176:191]
    ds_read_b64_tr_b16 a[28:29], v11 offset:50944
    ds_read_b64_tr_b16 a[30:31], v11 offset:52224
    s_waitcnt vmcnt(8)
    s_barrier
    ds_read_b64_tr_b16 a[32:33], v11 offset:63488
    s_add_u32 m0, s73, 88064
    s_nop 0
    buffer_load_dwordx4 v6, s[24:27], s86 offen offset:0 lds
    s_waitcnt lgkmcnt(9)
    v_mfma_f32_32x32x16_bf16 v[192:207], a[0:3], v[24:27], v[192:207]
    ds_read_b64_tr_b16 a[34:35], v11 offset:64768
    ds_read_b64_tr_b16 a[36:37], v11 offset:63552
    v_mfma_f32_32x32x16_bf16 v[208:223], a[4:7], v[24:27], v[208:223]
    ds_read_b64_tr_b16 a[38:39], v11 offset:64832
    buffer_store_dwordx4 a[168:171], v9, s[20:23], s74 offen sc1
    s_add_u32 s74, s74, 16384
    v_mfma_f32_32x32x16_bf16 v[224:239], a[8:11], v[24:27], v[224:239]
    ds_read_b64_tr_b16 a[40:41], v11 offset:63616
    ds_read_b64_tr_b16 a[42:43], v11 offset:64896
    ds_read_b64_tr_b16 a[44:45], v11 offset:63680
    v_mfma_f32_32x32x16_bf16 v[160:175], a[12:15], v[28:31], v[160:175]
    ds_read_b64_tr_b16 a[46:47], v11 offset:64960
    ds_read_b64_tr_b16 a[0:1], v11 offset:63744
    s_waitcnt lgkmcnt(9)
    v_mfma_f32_32x32x16_bf16 v[176:191], a[16:19], v[28:31], v[176:191]
    ds_read_b64_tr_b16 a[2:3], v11 offset:65024
    buffer_store_dwordx4 a[148:151], v9, s[20:23], s74 offen sc1
    s_add_u32 s74, s74, 16384
    v_mfma_f32_32x32x16_bf16 v[192:207], a[20:23], v[28:31], v[192:207]
    ds_read_b64_tr_b16 a[4:5], v12 offset:512
    ds_read_b64_tr_b16 a[6:7], v12 offset:1792
    ds_read_b64_tr_b16 a[8:9], v12 offset:576
    v_mfma_f32_32x32x16_bf16 v[208:223], a[24:27], v[28:31], v[208:223]
    ds_read_b64_tr_b16 a[10:11], v12 offset:1856
    ds_read_b64_tr_b16 a[12:13], v12 offset:640
    v_mfma_f32_32x32x16_bf16 v[224:239], a[28:31], v[28:31], v[224:239]
    ds_read_b64_tr_b16 a[14:15], v12 offset:1920
    buffer_store_dwordx4 a[152:155], v9, s[20:23], s74 offen sc1
    s_add_u32 s74, s74, 16384
    s_waitcnt lgkmcnt(8)
    v_mfma_f32_32x32x16_bf16 v[160:175], a[32:35], v[32:35], v[160:175]
    ds_read_b64_tr_b16 a[16:17], v12 offset:704
    ds_read_b64_tr_b16 a[18:19], v12 offset:1984
    ds_read_b64_tr_b16 a[20:21], v12 offset:768
    v_mfma_f32_32x32x16_bf16 v[176:191], a[36:39], v[32:35], v[176:191]
    ds_read_b64_tr_b16 a[22:23], v12 offset:2048
    ds_read_b64_tr_b16 a[24:25], v12 offset:3072
    v_mfma_f32_32x32x16_bf16 v[192:207], a[40:43], v[32:35], v[192:207]
    ds_read_b64_tr_b16 a[26:27], v12 offset:4352
    buffer_store_dwordx4 a[156:159], v9, s[20:23], s74 offen sc1
    s_add_u32 s74, s74, 16384
    v_mfma_f32_32x32x16_bf16 v[208:223], a[44:47], v[32:35], v[208:223]
    ds_read_b64_tr_b16 a[28:29], v12 offset:3136
    ds_read_b64_tr_b16 a[30:31], v12 offset:4416
    ds_read_b64_tr_b16 a[32:33], v12 offset:3200
    s_add_u32 m0, s73, 104448
    s_nop 0
    buffer_load_dwordx4 v2, s[24:27], s87 offen offset:0 lds
    s_waitcnt lgkmcnt(9)
    v_mfma_f32_32x32x16_bf16 v[224:239], a[0:3], v[32:35], v[224:239]
    ds_read_b64_tr_b16 a[34:35], v12 offset:4480
    ds_read_b64_tr_b16 a[36:37], v12 offset:3264
    v_mfma_f32_32x32x16_bf16 v[160:175], a[4:7], v[36:39], v[160:175]
    ds_read_b64_tr_b16 a[38:39], v12 offset:4544
    buffer_load_dwordx4 v3, s[24:27], s87 offen offset:1024 lds
    buffer_store_dwordx4 a[160:163], v9, s[20:23], s74 offen sc1
    s_add_u32 s74, s74, 16384
    v_mfma_f32_32x32x16_bf16 v[176:191], a[8:11], v[36:39], v[176:191]
    ds_read_b64_tr_b16 a[40:41], v12 offset:3328
    ds_read_b64_tr_b16 a[42:43], v12 offset:4608
    ds_read_b64_tr_b16 a[44:45], v12 offset:5632
    v_mfma_f32_32x32x16_bf16 v[192:207], a[12:15], v[36:39], v[192:207]
    ds_read_b64_tr_b16 a[46:47], v12 offset:6912
    ds_read_b64_tr_b16 a[0:1], v12 offset:5696
    buffer_load_dwordx4 v4, s[24:27], s87 offen offset:2048 lds
    s_waitcnt lgkmcnt(9)
    v_mfma_f32_32x32x16_bf16 v[208:223], a[16:19], v[36:39], v[208:223]
    ds_read_b64_tr_b16 a[2:3], v12 offset:6976
    buffer_store_dwordx4 a[188:191], v9, s[20:23], s74 offen sc1
    s_add_u32 s74, s74, 16384
    v_mfma_f32_32x32x16_bf16 v[224:239], a[20:23], v[36:39], v[224:239]
    ds_read_b64_tr_b16 a[4:5], v12 offset:5760
    ds_read_b64_tr_b16 a[6:7], v12 offset:7040
    buffer_load_dwordx4 v5, s[24:27], s87 offen offset:3072 lds
    v_mfma_f32_32x32x16_bf16 v[160:175], a[24:27], v[40:43], v[160:175]
    ds_read_b64_tr_b16 a[8:9], v12 offset:5824
    ds_read_b64_tr_b16 a[10:11], v12 offset:7104
    v_mfma_f32_32x32x16_bf16 v[176:191], a[28:31], v[40:43], v[176:191]
    ds_read_b64_tr_b16 a[12:13], v12 offset:5888
    ds_read_b64_tr_b16 a[14:15], v12 offset:7168
    s_add_u32 m0, s73, 108544
    s_nop 0
    buffer_load_dwordx4 v6, s[24:27], s87 offen offset:0 lds
    s_waitcnt lgkmcnt(8)
    v_mfma_f32_32x32x16_bf16 v[192:207], a[32:35], v[40:43], v[192:207]
    s_waitcnt vmcnt(11)
    s_barrier
    ds_read_b64_tr_b16 a[16:17], v12 offset:18432
    ds_read_b64_tr_b16 a[18:19], v12 offset:19712
    v_mfma_f32_32x32x16_bf16 v[208:223], a[36:39], v[40:43], v[208:223]
    ds_read_b64_tr_b16 a[20:21], v12 offset:18496
    ds_read_b64_tr_b16 a[22:23], v12 offset:19776
    s_add_u32 m0, s73, 0
    s_nop 0
    buffer_load_dwordx4 v2, s[24:27], s88 offen offset:0 lds
    v_mfma_f32_32x32x16_bf16 v[224:239], a[40:43], v[40:43], v[224:239]
    ds_read_b64_tr_b16 a[24:25], v12 offset:18560
    ds_read_b64_tr_b16 a[26:27], v12 offset:19840
    v_mfma_f32_32x32x16_bf16 v[160:175], a[44:47], v[44:47], v[160:175]
    ds_read_b64_tr_b16 a[28:29], v12 offset:18624
    ds_read_b64_tr_b16 a[30:31], v12 offset:19904
    buffer_load_dwordx4 v3, s[24:27], s88 offen offset:1024 lds
    s_waitcnt lgkmcnt(8)
    v_mfma_f32_32x32x16_bf16 v[176:191], a[0:3], v[44:47], v[176:191]
    ds_read_b64_tr_b16 a[32:33], v12 offset:18688
    ds_read_b64_tr_b16 a[34:35], v12 offset:19968
    v_mfma_f32_32x32x16_bf16 v[192:207], a[4:7], v[44:47], v[192:207]
    ds_read_b64_tr_b16 a[36:37], v12 offset:20992
    ds_read_b64_tr_b16 a[38:39], v12 offset:22272
    buffer_load_dwordx4 v4, s[24:27], s88 offen offset:2048 lds
    v_mfma_f32_32x32x16_bf16 v[208:223], a[8:11], v[44:47], v[208:223]
    ds_read_b64_tr_b16 a[40:41], v12 offset:21056
    ds_read_b64_tr_b16 a[42:43], v12 offset:22336
    v_mfma_f32_32x32x16_bf16 v[224:239], a[12:15], v[44:47], v[224:239]
    ds_read_b64_tr_b16 a[44:45], v12 offset:21120
    ds_read_b64_tr_b16 a[46:47], v12 offset:22400
    buffer_load_dwordx4 v5, s[24:27], s88 offen offset:3072 lds
    s_waitcnt lgkmcnt(8)
    v_mfma_f32_32x32x16_bf16 v[160:175], a[16:19], v[48:51], v[160:175]
    ds_read_b64_tr_b16 a[0:1], v12 offset:21184
    ds_read_b64_tr_b16 a[2:3], v12 offset:22464
    v_mfma_f32_32x32x16_bf16 v[176:191], a[20:23], v[48:51], v[176:191]
    ds_read_b64_tr_b16 a[4:5], v12 offset:21248
    ds_read_b64_tr_b16 a[6:7], v12 offset:22528
    s_add_u32 m0, s73, 4096
    s_nop 0
    buffer_load_dwordx4 v6, s[24:27], s88 offen offset:0 lds
    v_mfma_f32_32x32x16_bf16 v[192:207], a[24:27], v[48:51], v[192:207]
    ds_read_b64_tr_b16 a[8:9], v12 offset:23552
    ds_read_b64_tr_b16 a[10:11], v12 offset:24832
    v_mfma_f32_32x32x16_bf16 v[208:223], a[28:31], v[48:51], v[208:223]
    ds_read_b64_tr_b16 a[12:13], v12 offset:23616
    ds_read_b64_tr_b16 a[14:15], v12 offset:24896
    s_add_u32 m0, s73, 20480
    s_nop 0
    buffer_load_dwordx4 v2, s[24:27], s89 offen offset:0 lds
    s_waitcnt lgkmcnt(8)
    v_mfma_f32_32x32x16_bf16 v[224:239], a[32:35], v[48:51], v[224:239]
    ds_read_b64_tr_b16 a[16:17], v12 offset:23680
    ds_read_b64_tr_b16 a[18:19], v12 offset:24960
    v_mfma_f32_32x32x16_bf16 v[160:175], a[36:39], v[52:55], v[160:175]
    ds_read_b64_tr_b16 a[20:21], v12 offset:23744
    ds_read_b64_tr_b16 a[22:23], v12 offset:25024
    buffer_load_dwordx4 v3, s[24:27], s89 offen offset:1024 lds
    v_mfma_f32_32x32x16_bf16 v[176:191], a[40:43], v[52:55], v[176:191]
    ds_read_b64_tr_b16 a[24:25], v12 offset:23808
    ds_read_b64_tr_b16 a[26:27], v12 offset:25088
    v_mfma_f32_32x32x16_bf16 v[192:207], a[44:47], v[52:55], v[192:207]
    ds_read_b64_tr_b16 a[28:29], v12 offset:26112
    ds_read_b64_tr_b16 a[30:31], v12 offset:27392
    buffer_load_dwordx4 v4, s[24:27], s89 offen offset:2048 lds
    s_waitcnt lgkmcnt(8)
    v_mfma_f32_32x32x16_bf16 v[208:223], a[0:3], v[52:55], v[208:223]
    ds_read_b64_tr_b16 a[32:33], v12 offset:26176
    ds_read_b64_tr_b16 a[34:35], v12 offset:27456
    v_mfma_f32_32x32x16_bf16 v[224:239], a[4:7], v[52:55], v[224:239]
    ds_read_b64_tr_b16 a[36:37], v12 offset:26240
    ds_read_b64_tr_b16 a[38:39], v12 offset:27520
    buffer_load_dwordx4 v5, s[24:27], s89 offen offset:3072 lds
    v_mfma_f32_32x32x16_bf16 v[160:175], a[8:11], v[56:59], v[160:175]
    ds_read_b64_tr_b16 a[40:41], v12 offset:26304
    ds_read_b64_tr_b16 a[42:43], v12 offset:27584
    s_waitcnt vmcnt(11)
    buffer_store_dword v240, v242, s[20:23], s96 offen sc1
    v_mfma_f32_32x32x16_bf16 v[176:191], a[12:15], v[56:59], v[176:191]
    ds_read_b64_tr_b16 a[44:45], v12 offset:26368
    ds_read_b64_tr_b16 a[46:47], v12 offset:27648
    s_add_u32 m0, s73, 24576
    s_nop 0
    buffer_load_dwordx4 v6, s[24:27], s89 offen offset:0 lds
    s_waitcnt lgkmcnt(8)
    v_mfma_f32_32x32x16_bf16 v[192:207], a[16:19], v[56:59], v[192:207]
    s_waitcnt vmcnt(11)
    s_barrier
    ds_read_b64_tr_b16 a[0:1], v12 offset:38912
    ds_read_b64_tr_b16 a[2:3], v12 offset:40192
    v_mfma_f32_32x32x16_bf16 v[208:223], a[20:23], v[56:59], v[208:223]
    ds_read_b64_tr_b16 a[4:5], v12 offset:38976
    ds_read_b64_tr_b16 a[6:7], v12 offset:40256
    s_add_u32 m0, s73, 43008
    s_nop 0
    buffer_load_dwordx4 v2, s[24:27], s90 offen offset:0 lds
    v_mfma_f32_32x32x16_bf16 v[224:239], a[24:27], v[56:59], v[224:239]
    ds_read_b64_tr_b16 a[8:9], v12 offset:39040
    ds_read_b64_tr_b16 a[10:11], v12 offset:40320
    v_mfma_f32_32x32x16_bf16 v[160:175], a[28:31], v[60:63], v[160:175]
    ds_read_b64_tr_b16 a[12:13], v12 offset:39104
    ds_read_b64_tr_b16 a[14:15], v12 offset:40384
    buffer_load_dwordx4 v3, s[24:27], s90 offen offset:1024 lds
    s_waitcnt lgkmcnt(8)
    v_mfma_f32_32x32x16_bf16 v[176:191], a[32:35], v[60:63], v[176:191]
    ds_read_b64_tr_b16 a[16:17], v12 offset:39168
    ds_read_b64_tr_b16 a[18:19], v12 offset:40448
    v_mfma_f32_32x32x16_bf16 v[192:207], a[36:39], v[60:63], v[192:207]
    ds_read_b64_tr_b16 a[20:21], v12 offset:41472
    ds_read_b64_tr_b16 a[22:23], v12 offset:42752
    buffer_load_dwordx4 v4, s[24:27], s90 offen offset:2048 lds
    v_mfma_f32_32x32x16_bf16 v[208:223], a[40:43], v[60:63], v[208:223]
    ds_read_b64_tr_b16 a[24:25], v12 offset:41536
    ds_read_b64_tr_b16 a[26:27], v12 offset:42816
    v_mfma_f32_32x32x16_bf16 v[224:239], a[44:47], v[60:63], v[224:239]
    ds_read_b64_tr_b16 a[28:29], v12 offset:41600
    ds_read_b64_tr_b16 a[30:31], v12 offset:42880
    buffer_load_dwordx4 v5, s[24:27], s90 offen offset:3072 lds
    s_waitcnt lgkmcnt(8)
    v_mfma_f32_32x32x16_bf16 v[160:175], a[0:3], v[64:67], v[160:175]
    ds_read_b64_tr_b16 a[32:33], v12 offset:41664
    ds_read_b64_tr_b16 a[34:35], v12 offset:42944
    v_mfma_f32_32x32x16_bf16 v[176:191], a[4:7], v[64:67], v[176:191]
    ds_read_b64_tr_b16 a[36:37], v12 offset:41728
    ds_read_b64_tr_b16 a[38:39], v12 offset:43008
    s_add_u32 m0, s73, 47104
    s_nop 0
    buffer_load_dwordx4 v6, s[24:27], s90 offen offset:0 lds
    v_mfma_f32_32x32x16_bf16 v[192:207], a[8:11], v[64:67], v[192:207]
    ds_read_b64_tr_b16 a[40:41], v12 offset:44032
    ds_read_b64_tr_b16 a[42:43], v12 offset:45312
    v_mfma_f32_32x32x16_bf16 v[208:223], a[12:15], v[64:67], v[208:223]
    ds_read_b64_tr_b16 a[44:45], v12 offset:44096
    ds_read_b64_tr_b16 a[46:47], v12 offset:45376
    s_add_u32 m0, s73, 63488
    s_nop 0
    buffer_load_dwordx4 v2, s[24:27], s91 offen offset:0 lds
    s_waitcnt lgkmcnt(8)
    v_mfma_f32_32x32x16_bf16 v[224:239], a[16:19], v[64:67], v[224:239]
    ds_read_b64_tr_b16 a[0:1], v12 offset:44160
    ds_read_b64_tr_b16 a[2:3], v12 offset:45440
    v_mfma_f32_32x32x16_bf16 v[160:175], a[20:23], v[68:71], v[160:175]
    ds_read_b64_tr_b16 a[4:5], v12 offset:44224
    ds_read_b64_tr_b16 a[6:7], v12 offset:45504
    buffer_load_dwordx4 v3, s[24:27], s91 offen offset:1024 lds
    v_mfma_f32_32x32x16_bf16 v[176:191], a[24:27], v[68:71], v[176:191]
    ds_read_b64_tr_b16 a[8:9], v12 offset:44288
    ds_read_b64_tr_b16 a[10:11], v12 offset:45568
    v_mfma_f32_32x32x16_bf16 v[192:207], a[28:31], v[68:71], v[192:207]
    ds_read_b64_tr_b16 a[12:13], v12 offset:46592
    ds_read_b64_tr_b16 a[14:15], v12 offset:47872
    buffer_load_dwordx4 v4, s[24:27], s91 offen offset:2048 lds
    s_waitcnt lgkmcnt(8)
    v_mfma_f32_32x32x16_bf16 v[208:223], a[32:35], v[68:71], v[208:223]
    ds_read_b64_tr_b16 a[16:17], v12 offset:46656
    ds_read_b64_tr_b16 a[18:19], v12 offset:47936
    v_mfma_f32_32x32x16_bf16 v[224:239], a[36:39], v[68:71], v[224:239]
    ds_read_b64_tr_b16 a[20:21], v12 offset:46720
    ds_read_b64_tr_b16 a[22:23], v12 offset:48000
    buffer_load_dwordx4 v5, s[24:27], s91 offen offset:3072 lds
    v_mfma_f32_32x32x16_bf16 v[160:175], a[40:43], v[72:75], v[160:175]
    ds_read_b64_tr_b16 a[24:25], v12 offset:46784
    ds_read_b64_tr_b16 a[26:27], v12 offset:48064
    buffer_load_dword v243, v241, s[20:23], s75 offen sc1
    v_mfma_f32_32x32x16_bf16 v[176:191], a[44:47], v[72:75], v[176:191]
    ds_read_b64_tr_b16 a[28:29], v12 offset:46848
    ds_read_b64_tr_b16 a[30:31], v12 offset:48128
    s_add_u32 m0, s73, 67584
    s_nop 0
    buffer_load_dwordx4 v6, s[24:27], s91 offen offset:0 lds
    s_waitcnt lgkmcnt(8)
    v_mfma_f32_32x32x16_bf16 v[192:207], a[0:3], v[72:75], v[192:207]
    s_waitcnt vmcnt(17)
    s_barrier
    ds_read_b64_tr_b16 a[32:33], v11 offset:0
    ds_read_b64_tr_b16 a[34:35], v11 offset:1280
    v_mfma_f32_32x32x16_bf16 v[208:223], a[4:7], v[72:75], v[208:223]
    ds_read_b64_tr_b16 a[36:37], v11 offset:64
    ds_read_b64_tr_b16 a[38:39], v11 offset:1344
    v_mfma_f32_32x32x16_bf16 v[224:239], a[8:11], v[72:75], v[224:239]
    ds_read_b64_tr_b16 a[40:41], v11 offset:128
    ds_read_b64_tr_b16 a[42:43], v11 offset:1408
    s_add_u32 m0, s73, 83968
    s_nop 0
    buffer_load_dwordx4 v2, s[24:27], s92 offen offset:0 lds
    v_mfma_f32_32x32x16_bf16 v[160:175], a[12:15], v[76:79], v[160:175]
    ds_read_b64_tr_b16 a[44:45], v11 offset:192
    ds_read_b64_tr_b16 a[46:47], v11 offset:1472
    s_waitcnt lgkmcnt(8)
    v_mfma_f32_32x32x16_bf16 v[176:191], a[16:19], v[76:79], v[176:191]
    ds_read_b64_tr_b16 a[0:1], v11 offset:256
    ds_read_b64_tr_b16 a[2:3], v11 offset:1536
    v_mfma_f32_32x32x16_bf16 v[192:207], a[20:23], v[76:79], v[192:207]
    ds_read_b64_tr_b16 a[4:5], v11 offset:2560
    ds_read_b64_tr_b16 a[6:7], v11 offset:3840
    buffer_load_dwordx4 v3, s[24:27], s92 offen offset:1024 lds
    v_mfma_f32_32x32x16_bf16 v[208:223], a[24:27], v[76:79], v[208:223]
    ds_read_b64_tr_b16 a[8:9], v11 offset:2624
    ds_read_b64_tr_b16 a[10:11], v11 offset:3904
    v_mfma_f32_32x32x16_bf16 v[224:239], a[28:31], v[76:79], v[224:239]
    ds_read_b64_tr_b16 a[12:13], v11 offset:2688
    ds_read_b64_tr_b16 a[14:15], v11 offset:3968
    s_waitcnt lgkmcnt(8)
    v_mfma_f32_32x32x16_bf16 v[160:175], a[32:35], v[80:83], v[160:175]
    ds_read_b64_tr_b16 a[16:17], v11 offset:2752
    ds_read_b64_tr_b16 a[18:19], v11 offset:4032
    v_mfma_f32_32x32x16_bf16 v[176:191], a[36:39], v[80:83], v[176:191]
    ds_read_b64_tr_b16 a[20:21], v11 offset:2816
    ds_read_b64_tr_b16 a[22:23], v11 offset:4096
    buffer_load_dwordx4 v4, s[24:27], s92 offen offset:2048 lds
    v_mfma_f32_32x32x16_bf16 v[192:207], a[40:43], v[80:83], v[192:207]
    ds_read_b64_tr_b16 a[24:25], v11 offset:5120
    ds_read_b64_tr_b16 a[26:27], v11 offset:6400
    v_mfma_f32_32x32x16_bf16 v[208:223], a[44:47], v[80:83], v[208:223]
    ds_read_b64_tr_b16 a[28:29], v11 offset:5184
    ds_read_b64_tr_b16 a[30:31], v11 offset:6464
    s_waitcnt lgkmcnt(8)
    v_mfma_f32_32x32x16_bf16 v[224:239], a[0:3], v[80:83], v[224:239]
    ds_read_b64_tr_b16 a[32:33], v11 offset:5248
    ds_read_b64_tr_b16 a[34:35], v11 offset:6528
    v_mfma_f32_32x32x16_bf16 v[160:175], a[4:7], v[84:87], v[160:175]
    ds_read_b64_tr_b16 a[36:37], v11 offset:5312
    ds_read_b64_tr_b16 a[38:39], v11 offset:6592
    buffer_load_dwordx4 v5, s[24:27], s92 offen offset:3072 lds
    v_mfma_f32_32x32x16_bf16 v[176:191], a[8:11], v[84:87], v[176:191]
    ds_read_b64_tr_b16 a[40:41], v11 offset:5376
    ds_read_b64_tr_b16 a[42:43], v11 offset:6656
    v_mfma_f32_32x32x16_bf16 v[192:207], a[12:15], v[84:87], v[192:207]
    ds_read_b64_tr_b16 a[44:45], v11 offset:7680
    ds_read_b64_tr_b16 a[46:47], v11 offset:8960
    s_waitcnt lgkmcnt(8)
    v_mfma_f32_32x32x16_bf16 v[208:223], a[16:19], v[84:87], v[208:223]
    ds_read_b64_tr_b16 a[0:1], v11 offset:7744
    ds_read_b64_tr_b16 a[2:3], v11 offset:9024
    v_mfma_f32_32x32x16_bf16 v[224:239], a[20:23], v[84:87], v[224:239]
    ds_read_b64_tr_b16 a[4:5], v11 offset:7808
    ds_read_b64_tr_b16 a[6:7], v11 offset:9088
    s_add_u32 m0, s73, 88064
    s_nop 0
    buffer_load_dwordx4 v6, s[24:27], s92 offen offset:0 lds
    v_mfma_f32_32x32x16_bf16 v[160:175], a[24:27], v[88:91], v[160:175]
    ds_read_b64_tr_b16 a[8:9], v11 offset:7872
    ds_read_b64_tr_b16 a[10:11], v11 offset:9152
    v_mfma_f32_32x32x16_bf16 v[176:191], a[28:31], v[88:91], v[176:191]
    ds_read_b64_tr_b16 a[12:13], v11 offset:7936
    ds_read_b64_tr_b16 a[14:15], v11 offset:9216
    s_waitcnt lgkmcnt(8)
    v_mfma_f32_32x32x16_bf16 v[192:207], a[32:35], v[88:91], v[192:207]
    s_waitcnt vmcnt(16)
    s_barrier
    ds_read_b64_tr_b16 a[16:17], v11 offset:20480
    ds_read_b64_tr_b16 a[18:19], v11 offset:21760
    v_mfma_f32_32x32x16_bf16 v[208:223], a[36:39], v[88:91], v[208:223]
    ds_read_b64_tr_b16 a[20:21], v11 offset:20544
    ds_read_b64_tr_b16 a[22:23], v11 offset:21824
    v_mfma_f32_32x32x16_bf16 v[224:239], a[40:43], v[88:91], v[224:239]
    ds_read_b64_tr_b16 a[24:25], v11 offset:20608
    ds_read_b64_tr_b16 a[26:27], v11 offset:21888
    s_waitcnt vmcnt(6)
    v_cmp_ne_u32 vcc, 0, v243
    s_nop 1
    s_cmp_eq_u64 vcc, -1
    s_cbranch_scc0 L_sp6
L_ok6:
    s_lshl_b32 s53, s97, 14
    s_add_u32 s53, s53, s57
    s_cmp_lt_u32 s97, 40
    s_cselect_b32 s53, s53, 1073741824
    v_mfma_f32_32x32x16_bf16 v[160:175], a[44:47], v[92:95], v[160:175]
    ds_read_b64_tr_b16 a[28:29], v11 offset:20672
    ds_read_b64_tr_b16 a[30:31], v11 offset:21952
    buffer_load_dwordx4 a[132:135], v10, s[20:23], s53 offen offset:0 sc1
    s_waitcnt lgkmcnt(8)
    v_mfma_f32_32x32x16_bf16 v[176:191], a[0:3], v[92:95], v[176:191]
    ds_read_b64_tr_b16 a[32:33], v11 offset:20736
    ds_read_b64_tr_b16 a[34:35], v11 offset:22016
    v_mfma_f32_32x32x16_bf16 v[192:207], a[4:7], v[92:95], v[192:207]
    ds_read_b64_tr_b16 a[36:37], v11 offset:23040
    ds_read_b64_tr_b16 a[38:39], v11 offset:24320
    buffer_load_dwordx4 a[136:139], v10, s[20:23], s53 offen offset:1024 sc1
    v_mfma_f32_32x32x16_bf16 v[208:223], a[8:11], v[92:95], v[208:223]
    ds_read_b64_tr_b16 a[40:41], v11 offset:23104
    ds_read_b64_tr_b16 a[42:43], v11 offset:24384
    v_mfma_f32_32x32x16_bf16 v[224:239], a[12:15], v[92:95], v[224:239]
    ds_read_b64_tr_b16 a[44:45], v11 offset:23168
    ds_read_b64_tr_b16 a[46:47], v11 offset:24448
    buffer_load_dwordx4 a[140:143], v10, s[20:23], s53 offen offset:2048 sc1
    s_waitcnt lgkmcnt(8)
    v_mfma_f32_32x32x16_bf16 v[160:175], a[16:19], v[96:99], v[160:175]
    ds_read_b64_tr_b16 a[0:1], v11 offset:23232
    ds_read_b64_tr_b16 a[2:3], v11 offset:24512
    v_mfma_f32_32x32x16_bf16 v[176:191], a[20:23], v[96:99], v[176:191]
    ds_read_b64_tr_b16 a[4:5], v11 offset:23296
    ds_read_b64_tr_b16 a[6:7], v11 offset:24576
    buffer_load_dwordx4 a[144:147], v10, s[20:23], s53 offen offset:3072 sc1
    v_mfma_f32_32x32x16_bf16 v[192:207], a[24:27], v[96:99], v[192:207]
    ds_read_b64_tr_b16 a[8:9], v11 offset:25600
    ds_read_b64_tr_b16 a[10:11], v11 offset:26880
    v_mfma_f32_32x32x16_bf16 v[208:223], a[28:31], v[96:99], v[208:223]
    ds_read_b64_tr_b16 a[12:13], v11 offset:25664
    ds_read_b64_tr_b16 a[14:15], v11 offset:26944
    s_add_u32 s53, s53, 4096
    buffer_load_dwordx4 a[148:151], v10, s[20:23], s53 offen offset:0 sc1
    s_waitcnt lgkmcnt(8)
    v_mfma_f32_32x32x16_bf16 v[224:239], a[32:35], v[96:99], v[224:239]
    ds_read_b64_tr_b16 a[16:17], v11 offset:25728
    ds_read_b64_tr_b16 a[18:19], v11 offset:27008
    v_mfma_f32_32x32x16_bf16 v[160:175], a[36:39], v[100:103], v[160:175]
    ds_read_b64_tr_b16 a[20:21], v11 offset:25792
    ds_read_b64_tr_b16 a[22:23], v11 offset:27072
    buffer_load_dwordx4 a[152:155], v10, s[20:23], s53 offen offset:1024 sc1
    v_mfma_f32_32x32x16_bf16 v[176:191], a[40:43], v[100:103], v[176:191]
    ds_read_b64_tr_b16 a[24:25], v11 offset:25856
    ds_read_b64_tr_b16 a[26:27], v11 offset:27136
    s_mul_i32 s50, s97, 52
    s_lshr_b32 s50, s50, 8
    s_mul_i32 s51, s50, 5
    s_sub_u32 s51, s97, s51
    s_lshl_b32 s74, s50, 11
    s_lshr_b32 s52, s51, 1
    s_lshl_b32 s52, s52, 10
    s_add_u32 s74, s74, s52
    s_and_b32 s52, s51, 1
    s_lshl_b32 s52, s52, 3
    s_add_u32 s74, s74, s52
    s_lshl_b32 s50, s50, 9
    s_add_u32 s50, s50, 16384
    s_cmp_eq_u32 s51, 4
    s_cselect_b32 s74, s50, s74
    s_cselect_b32 s51, 3, 4
    v_lshlrev_b32 v252, s51, v1
    s_mul_i32 s49, s43, 20480
    s_add_u32 s49, s49, 33292288
    s_add_u32 s74, s74, s49
    s_cmp_lt_u32 s97, 40
    s_cselect_b32 s74, s74, 1073741824
    v_mfma_f32_32x32x16_bf16 v[192:207], a[44:47], v[100:103], v[192:207]
    ds_read_b64_tr_b16 a[28:29], v11 offset:28160
    ds_read_b64_tr_b16 a[30:31], v11 offset:29440
    buffer_load_dwordx4 a[156:159], v10, s[20:23], s53 offen offset:2048 sc1
    s_waitcnt lgkmcnt(8)
    v_mfma_f32_32x32x16_bf16 v[208:223], a[0:3], v[100:103], v[208:223]
    ds_read_b64_tr_b16 a[32:33], v11 offset:28224
    ds_read_b64_tr_b16 a[34:35], v11 offset:29504
    v_mfma_f32_32x32x16_bf16 v[224:239], a[4:7], v[100:103], v[224:239]
    ds_read_b64_tr_b16 a[36:37], v11 offset:28288
    ds_read_b64_tr_b16 a[38:39], v11 offset:29568
    buffer_load_dwordx4 a[160:163], v10, s[20:23], s53 offen offset:3072 sc1
    v_mfma_f32_32x32x16_bf16 v[160:175], a[8:11], v[104:107], v[160:175]
    ds_read_b64_tr_b16 a[40:41], v11 offset:28352
    ds_read_b64_tr_b16 a[42:43], v11 offset:29632
    v_mfma_f32_32x32x16_bf16 v[176:191], a[12:15], v[104:107], v[176:191]
    ds_read_b64_tr_b16 a[44:45], v11 offset:28416
    ds_read_b64_tr_b16 a[46:47], v11 offset:29696
    s_add_u32 s53, s53, 4096
    buffer_load_dwordx4 a[168:171], v10, s[20:23], s53 offen offset:0 sc1
    s_waitcnt lgkmcnt(8)
    v_mfma_f32_32x32x16_bf16 v[192:207], a[16:19], v[104:107], v[192:207]
    s_barrier
    ds_read_b64_tr_b16 a[0:1], v11 offset:43008
    ds_read_b64_tr_b16 a[2:3], v11 offset:44288
    v_mfma_f32_32x32x16_bf16 v[208:223], a[20:23], v[104:107], v[208:223]
    ds_read_b64_tr_b16 a[4:5], v11 offset:43072
    ds_read_b64_tr_b16 a[6:7], v11 offset:44352
    buffer_load_dwordx4 a[172:175], v10, s[20:23], s53 offen offset:1024 sc1
    v_mfma_f32_32x32x16_bf16 v[224:239], a[24:27], v[104:107], v[224:239]
    ds_read_b64_tr_b16 a[8:9], v11 offset:43136
    ds_read_b64_tr_b16 a[10:11], v11 offset:44416
    v_mfma_f32_32x32x16_bf16 v[160:175], a[28:31], v[108:111], v[160:175]
    ds_read_b64_tr_b16 a[12:13], v11 offset:43200
    ds_read_b64_tr_b16 a[14:15], v11 offset:44480
    buffer_load_dwordx4 a[176:179], v10, s[20:23], s53 offen offset:2048 sc1
    s_waitcnt lgkmcnt(8)
    v_mfma_f32_32x32x16_bf16 v[176:191], a[32:35], v[108:111], v[176:191]
    ds_read_b64_tr_b16 a[16:17], v11 offset:43264
    ds_read_b64_tr_b16 a[18:19], v11 offset:44544
    v_mfma_f32_32x32x16_bf16 v[192:207], a[36:39], v[108:111], v[192:207]
    ds_read_b64_tr_b16 a[20:21], v11 offset:45568
    ds_read_b64_tr_b16 a[22:23], v11 offset:46848
    buffer_load_dwordx4 a[180:183], v10, s[20:23], s53 offen offset:3072 sc1
    v_mfma_f32_32x32x16_bf16 v[208:223], a[40:43], v[108:111], v[208:223]
    ds_read_b64_tr_b16 a[24:25], v11 offset:45632
    ds_read_b64_tr_b16 a[26:27], v11 offset:46912
    v_mfma_f32_32x32x16_bf16 v[224:239], a[44:47], v[108:111], v[224:239]
    ds_read_b64_tr_b16 a[28:29], v11 offset:45696
    ds_read_b64_tr_b16 a[30:31], v11 offset:46976
    s_add_u32 s53, s53, 4096
    buffer_load_dwordx4 a[184:187], v10, s[20:23], s53 offen offset:0 sc1
    s_waitcnt lgkmcnt(8)
    v_mfma_f32_32x32x16_bf16 v[160:175], a[0:3], v[112:115], v[160:175]
    ds_read_b64_tr_b16 a[32:33], v11 offset:45760
    ds_read_b64_tr_b16 a[34:35], v11 offset:47040
    v_mfma_f32_32x32x16_bf16 v[176:191], a[4:7], v[112:115], v[176:191]
    ds_read_b64_tr_b16 a[36:37], v11 offset:45824
    ds_read_b64_tr_b16 a[38:39], v11 offset:47104
    buffer_load_dwordx4 a[188:191], v10, s[20:23], s53 offen offset:1024 sc1
    v_mfma_f32_32x32x16_bf16 v[192:207], a[8:11], v[112:115], v[192:207]
    ds_read_b64_tr_b16 a[40:41], v11 offset:48128
    ds_read_b64_tr_b16 a[42:43], v11 offset:49408
    v_mfma_f32_32x32x16_bf16 v[208:223], a[12:15], v[112:115], v[208:223]
    ds_read_b64_tr_b16 a[44:45], v11 offset:48192
    ds_read_b64_tr_b16 a[46:47], v11 offset:49472
    buffer_load_dwordx4 a[192:195], v10, s[20:23], s53 offen offset:2048 sc1
    s_waitcnt lgkmcnt(8)
    v_mfma_f32_32x32x16_bf16 v[224:239], a[16:19], v[112:115], v[224:239]
    ds_read_b64_tr_b16 a[0:1], v11 offset:48256
    ds_read_b64_tr_b16 a[2:3], v11 offset:49536
    v_mfma_f32_32x32x16_bf16 v[160:175], a[20:23], v[116:119], v[160:175]
    ds_read_b64_tr_b16 a[4:5], v11 offset:48320
    ds_read_b64_tr_b16 a[6:7], v11 offset:49600
    buffer_load_dwordx4 a[196:199], v10, s[20:23], s53 offen offset:3072 sc1
    v_mfma_f32_32x32x16_bf16 v[176:191], a[24:27], v[116:119], v[176:191]
    ds_read_b64_tr_b16 a[8:9], v11 offset:48384
    ds_read_b64_tr_b16 a[10:11], v11 offset:49664
    v_mfma_f32_32x32x16_bf16 v[192:207], a[28:31], v[116:119], v[192:207]
    ds_read_b64_tr_b16 a[12:13], v11 offset:50688
    ds_read_b64_tr_b16 a[14:15], v11 offset:51968
    s_waitcnt lgkmcnt(8)
    v_mfma_f32_32x32x16_bf16 v[208:223], a[32:35], v[116:119], v[208:223]
    ds_read_b64_tr_b16 a[16:17], v11 offset:50752
    ds_read_b64_tr_b16 a[18:19], v11 offset:52032
    v_mfma_f32_32x32x16_bf16 v[224:239], a[36:39], v[116:119], v[224:239]
    ds_read_b64_tr_b16 a[20:21], v11 offset:50816
    ds_read_b64_tr_b16 a[22:23], v11 offset:52096
    v_mfma_f32_32x32x16_bf16 v[160:175], a[40:43], v[120:123], v[160:175]
    ds_read_b64_tr_b16 a[24:25], v11 offset:50880
    ds_read_b64_tr_b16 a[26:27], v11 offset:52160
    v_mfma_f32_32x32x16_bf16 v[176:191], a[44:47], v[120:123], v[176:191]
    ds_read_b64_tr_b16 a[28:29], v11 offset:50944
    ds_read_b64_tr_b16 a[30:31], v11 offset:52224
    s_waitcnt lgkmcnt(8)
    v_mfma_f32_32x32x16_bf16 v[192:207], a[0:3], v[120:123], v[192:207]
    s_waitcnt vmcnt(21)
    s_barrier
    ds_read_b64_tr_b16 a[32:33], v11 offset:63488
    ds_read_b64_tr_b16 a[34:35], v11 offset:64768
    v_mfma_f32_32x32x16_bf16 v[208:223], a[4:7], v[120:123], v[208:223]
    ds_read_b64_tr_b16 a[36:37], v11 offset:63552
    ds_read_b64_tr_b16 a[38:39], v11 offset:64832
    v_mfma_f32_32x32x16_bf16 v[224:239], a[8:11], v[120:123], v[224:239]
    ds_read_b64_tr_b16 a[40:41], v11 offset:63616
    ds_read_b64_tr_b16 a[42:43], v11 offset:64896
    v_mfma_f32_32x32x16_bf16 v[160:175], a[12:15], v[124:127], v[160:175]
    ds_read_b64_tr_b16 a[44:45], v11 offset:63680
    ds_read_b64_tr_b16 a[46:47], v11 offset:64960
    s_waitcnt lgkmcnt(8)
    v_mfma_f32_32x32x16_bf16 v[176:191], a[16:19], v[124:127], v[176:191]
    ds_read_b64_tr_b16 a[0:1], v11 offset:63744
    ds_read_b64_tr_b16 a[2:3], v11 offset:65024
    v_mfma_f32_32x32x16_bf16 v[192:207], a[20:23], v[124:127], v[192:207]
    ds_read_b64_tr_b16 a[4:5], v12 offset:512
    ds_read_b64_tr_b16 a[6:7], v12 offset:1792
    v_mfma_f32_32x32x16_bf16 v[208:223], a[24:27], v[124:127], v[208:223]
    ds_read_b64_tr_b16 a[8:9], v12 offset:576
    ds_read_b64_tr_b16 a[10:11], v12 offset:1856
    v_mfma_f32_32x32x16_bf16 v[224:239], a[28:31], v[124:127], v[224:239]
    ds_read_b64_tr_b16 a[12:13], v12 offset:640
    ds_read_b64_tr_b16 a[14:15], v12 offset:1920
    s_waitcnt lgkmcnt(8)
    v_mfma_f32_32x32x16_bf16 v[160:175], a[32:35], v[128:131], v[160:175]
    ds_read_b64_tr_b16 a[16:17], v12 offset:704
    ds_read_b64_tr_b16 a[18:19], v12 offset:1984
    v_mfma_f32_32x32x16_bf16 v[176:191], a[36:39], v[128:131], v[176:191]
    ds_read_b64_tr_b16 a[20:21], v12 offset:768
    ds_read_b64_tr_b16 a[22:23], v12 offset:2048
    v_mfma_f32_32x32x16_bf16 v[192:207], a[40:43], v[128:131], v[192:207]
    ds_read_b64_tr_b16 a[24:25], v12 offset:3072
    ds_read_b64_tr_b16 a[26:27], v12 offset:4352
    v_mfma_f32_32x32x16_bf16 v[208:223], a[44:47], v[128:131], v[208:223]
    ds_read_b64_tr_b16 a[28:29], v12 offset:3136
    ds_read_b64_tr_b16 a[30:31], v12 offset:4416
    s_waitcnt lgkmcnt(8)
    v_mfma_f32_32x32x16_bf16 v[224:239], a[0:3], v[128:131], v[224:239]
    ds_read_b64_tr_b16 a[32:33], v12 offset:3200
    ds_read_b64_tr_b16 a[34:35], v12 offset:4480
    s_waitcnt vmcnt(12)
    v_accvgpr_read_b32 v244, a132
    v_accvgpr_read_b32 v245, a133
    v_accvgpr_read_b32 v246, a134
    v_mfma_f32_32x32x16_bf16 v[160:175], a[4:7], v[132:135], v[160:175]
    ds_read_b64_tr_b16 a[36:37], v12 offset:3264
    ds_read_b64_tr_b16 a[38:39], v12 offset:4544
    v_accvgpr_read_b32 v247, a135
    v_accvgpr_read_b32 v248, a136
    v_accvgpr_read_b32 v249, a137
    v_mfma_f32_32x32x16_bf16 v[176:191], a[8:11], v[132:135], v[176:191]
    ds_read_b64_tr_b16 a[40:41], v12 offset:3328
    ds_read_b64_tr_b16 a[42:43], v12 offset:4608
    v_accvgpr_read_b32 v250, a138
    v_accvgpr_read_b32 v251, a139
    v_add_f32 v244, v244, v248
    v_add_f32 v245, v245, v249
    v_mfma_f32_32x32x16_bf16 v[192:207], a[12:15], v[132:135], v[192:207]
    ds_read_b64_tr_b16 a[44:45], v12 offset:5632
    ds_read_b64_tr_b16 a[46:47], v12 offset:6912
    v_add_f32 v246, v246, v250
    v_add_f32 v247, v247, v251
    v_accvgpr_read_b32 v248, a140
    v_accvgpr_read_b32 v249, a141
    s_waitcnt lgkmcnt(8)
    v_mfma_f32_32x32x16_bf16 v[208:223], a[16:19], v[132:135], v[208:223]
    ds_read_b64_tr_b16 a[0:1], v12 offset:5696
    ds_read_b64_tr_b16 a[2:3], v12 offset:6976
    v_accvgpr_read_b32 v250, a142
    v_accvgpr_read_b32 v251, a143
    v_add_f32 v244, v244, v248
    v_add_f32 v245, v245, v249
    v_mfma_f32_32x32x16_bf16 v[224:239], a[20:23], v[132:135], v[224:239]
    ds_read_b64_tr_b16 a[4:5], v12 offset:5760
    ds_read_b64_tr_b16 a[6:7], v12 offset:7040
    v_add_f32 v246, v246, v250
    v_add_f32 v247, v247, v251
    v_accvgpr_read_b32 v248, a144
    v_accvgpr_read_b32 v249, a145
    v_mfma_f32_32x32x16_bf16 v[160:175], a[24:27], v[136:139], v[160:175]
    ds_read_b64_tr_b16 a[8:9], v12 offset:5824
    ds_read_b64_tr_b16 a[10:11], v12 offset:7104
    v_accvgpr_read_b32 v250, a146
    v_accvgpr_read_b32 v251, a147
    v_add_f32 v244, v244, v248
    v_mfma_f32_32x32x16_bf16 v[176:191], a[28:31], v[136:139], v[176:191]
    ds_read_b64_tr_b16 a[12:13], v12 offset:5888
    ds_read_b64_tr_b16 a[14:15], v12 offset:7168
    v_add_f32 v245, v245, v249
    v_add_f32 v246, v246, v250
    v_add_f32 v247, v247, v251
    s_waitcnt vmcnt(8)
    v_accvgpr_read_b32 v248, a148
    s_waitcnt lgkmcnt(8)
    v_mfma_f32_32x32x16_bf16 v[192:207], a[32:35], v[136:139], v[192:207]
    s_barrier
    ds_read_b64_tr_b16 a[16:17], v12 offset:18432
    ds_read_b64_tr_b16 a[18:19], v12 offset:19712
    v_accvgpr_read_b32 v249, a149
    v_accvgpr_read_b32 v250, a150
    v_accvgpr_read_b32 v251, a151
    v_mfma_f32_32x32x16_bf16 v[208:223], a[36:39], v[136:139], v[208:223]
    ds_read_b64_tr_b16 a[20:21], v12 offset:18496
    ds_read_b64_tr_b16 a[22:23], v12 offset:19776
    v_add_f32 v244, v244, v248
    v_add_f32 v245, v245, v249
    v_add_f32 v246, v246, v250
    v_add_f32 v247, v247, v251
    v_mfma_f32_32x32x16_bf16 v[224:239], a[40:43], v[136:139], v[224:239]
    ds_read_b64_tr_b16 a[24:25], v12 offset:18560
    ds_read_b64_tr_b16 a[26:27], v12 offset:19840
    v_accvgpr_read_b32 v248, a152
    v_accvgpr_read_b32 v249, a153
    v_accvgpr_read_b32 v250, a154
    v_accvgpr_read_b32 v251, a155
    v_mfma_f32_32x32x16_bf16 v[160:175], a[44:47], v[140:143], v[160:175]
    ds_read_b64_tr_b16 a[28:29], v12 offset:18624
    ds_read_b64_tr_b16 a[30:31], v12 offset:19904
    v_add_f32 v244, v244, v248
    v_add_f32 v245, v245, v249
    v_add_f32 v246, v246, v250
    v_add_f32 v247, v247, v251
    s_waitcnt lgkmcnt(8)
    v_mfma_f32_32x32x16_bf16 v[176:191], a[0:3], v[140:143], v[176:191]
    ds_read_b64_tr_b16 a[32:33], v12 offset:18688
    ds_read_b64_tr_b16 a[34:35], v12 offset:19968
    v_accvgpr_read_b32 v248, a156
    v_accvgpr_read_b32 v249, a157
    v_accvgpr_read_b32 v250, a158
    v_accvgpr_read_b32 v251, a159
    v_mfma_f32_32x32x16_bf16 v[192:207], a[4:7], v[140:143], v[192:207]
    ds_read_b64_tr_b16 a[36:37], v12 offset:20992
    ds_read_b64_tr_b16 a[38:39], v12 offset:22272
    v_add_f32 v244, v244, v248
    v_add_f32 v245, v245, v249
    v_add_f32 v246, v246, v250
    v_add_f32 v247, v247, v251
    v_mfma_f32_32x32x16_bf16 v[208:223], a[8:11], v[140:143], v[208:223]
    ds_read_b64_tr_b16 a[40:41], v12 offset:21056
    ds_read_b64_tr_b16 a[42:43], v12 offset:22336
    v_accvgpr_read_b32 v248, a160
    v_accvgpr_read_b32 v249, a161
    v_accvgpr_read_b32 v250, a162
    v_mfma_f32_32x32x16_bf16 v[224:239], a[12:15], v[140:143], v[224:239]
    ds_read_b64_tr_b16 a[44:45], v12 offset:21120
    ds_read_b64_tr_b16 a[46:47], v12 offset:22400
    v_accvgpr_read_b32 v251, a163
    v_add_f32 v244, v244, v248
    v_add_f32 v245, v245, v249
    v_add_f32 v246, v246, v250
    s_waitcnt lgkmcnt(8)
    v_mfma_f32_32x32x16_bf16 v[160:175], a[16:19], v[144:147], v[160:175]
    ds_read_b64_tr_b16 a[0:1], v12 offset:21184
    ds_read_b64_tr_b16 a[2:3], v12 offset:22464
    v_add_f32 v247, v247, v251
    s_waitcnt vmcnt(4)
    v_accvgpr_read_b32 v248, a168
    v_accvgpr_read_b32 v249, a169
    v_mfma_f32_32x32x16_bf16 v[176:191], a[20:23], v[144:147], v[176:191]
    ds_read_b64_tr_b16 a[4:5], v12 offset:21248
    ds_read_b64_tr_b16 a[6:7], v12 offset:22528
    v_accvgpr_read_b32 v250, a170
    v_accvgpr_read_b32 v251, a171
    v_add_f32 v244, v244, v248
    v_add_f32 v245, v245, v249
    v_mfma_f32_32x32x16_bf16 v[192:207], a[24:27], v[144:147], v[192:207]
    ds_read_b64_tr_b16 a[8:9], v12 offset:23552
    ds_read_b64_tr_b16 a[10:11], v12 offset:24832
    v_add_f32 v246, v246, v250
    v_add_f32 v247, v247, v251
    v_accvgpr_read_b32 v248, a172
    v_accvgpr_read_b32 v249, a173
    v_mfma_f32_32x32x16_bf16 v[208:223], a[28:31], v[144:147], v[208:223]
    ds_read_b64_tr_b16 a[12:13], v12 offset:23616
    ds_read_b64_tr_b16 a[14:15], v12 offset:24896
    v_accvgpr_read_b32 v250, a174
    v_accvgpr_read_b32 v251, a175
    v_add_f32 v244, v244, v248
    v_add_f32 v245, v245, v249
    s_waitcnt lgkmcnt(8)
    v_mfma_f32_32x32x16_bf16 v[224:239], a[32:35], v[144:147], v[224:239]
    ds_read_b64_tr_b16 a[16:17], v12 offset:23680
    ds_read_b64_tr_b16 a[18:19], v12 offset:24960
    v_add_f32 v246, v246, v250
    v_add_f32 v247, v247, v251
    v_accvgpr_read_b32 v248, a176
    v_accvgpr_read_b32 v249, a177
    v_mfma_f32_32x32x16_bf16 v[160:175], a[36:39], v[148:151], v[160:175]
    ds_read_b64_tr_b16 a[20:21], v12 offset:23744
    ds_read_b64_tr_b16 a[22:23], v12 offset:25024
    v_accvgpr_read_b32 v250, a178
    v_accvgpr_read_b32 v251, a179
    v_add_f32 v244, v244, v248
    v_mfma_f32_32x32x16_bf16 v[176:191], a[40:43], v[148:151], v[176:191]
    ds_read_b64_tr_b16 a[24:25], v12 offset:23808
    ds_read_b64_tr_b16 a[26:27], v12 offset:25088
    v_add_f32 v245, v245, v249
    v_add_f32 v246, v246, v250
    v_add_f32 v247, v247, v251
    v_accvgpr_read_b32 v248, a180
    v_mfma_f32_32x32x16_bf16 v[192:207], a[44:47], v[148:151], v[192:207]
    ds_read_b64_tr_b16 a[28:29], v12 offset:26112
    ds_read_b64_tr_b16 a[30:31], v12 offset:27392
    v_accvgpr_read_b32 v249, a181
    v_accvgpr_read_b32 v250, a182
    v_accvgpr_read_b32 v251, a183
    v_add_f32 v244, v244, v248
    s_waitcnt lgkmcnt(8)
    v_mfma_f32_32x32x16_bf16 v[208:223], a[0:3], v[148:151], v[208:223]
    ds_read_b64_tr_b16 a[32:33], v12 offset:26176
    ds_read_b64_tr_b16 a[34:35], v12 offset:27456
    v_add_f32 v245, v245, v249
    v_add_f32 v246, v246, v250
    v_add_f32 v247, v247, v251
    s_waitcnt vmcnt(0)
    v_mfma_f32_32x32x16_bf16 v[224:239], a[4:7], v[148:151], v[224:239]
    ds_read_b64_tr_b16 a[36:37], v12 offset:26240
    ds_read_b64_tr_b16 a[38:39], v12 offset:27520
    v_accvgpr_read_b32 v248, a184
    v_accvgpr_read_b32 v249, a185
    v_accvgpr_read_b32 v250, a186
    v_accvgpr_read_b32 v251, a187
    v_mfma_f32_32x32x16_bf16 v[160:175], a[8:11], v[152:155], v[160:175]
    ds_read_b64_tr_b16 a[40:41], v12 offset:26304
    ds_read_b64_tr_b16 a[42:43], v12 offset:27584
    v_add_f32 v244, v244, v248
    v_add_f32 v245, v245, v249
    v_add_f32 v246, v246, v250
    v_add_f32 v247, v247, v251
    v_mfma_f32_32x32x16_bf16 v[176:191], a[12:15], v[152:155], v[176:191]
    ds_read_b64_tr_b16 a[44:45], v12 offset:26368
    ds_read_b64_tr_b16 a[46:47], v12 offset:27648
    v_accvgpr_read_b32 v248, a188
    v_accvgpr_read_b32 v249, a189
    v_accvgpr_read_b32 v250, a190
    v_accvgpr_read_b32 v251, a191
    s_waitcnt lgkmcnt(8)
    v_mfma_f32_32x32x16_bf16 v[192:207], a[16:19], v[152:155], v[192:207]
    v_add_f32 v244, v244, v248
    v_add_f32 v245, v245, v249
    v_add_f32 v246, v246, v250
    v_add_f32 v247, v247, v251
    v_mfma_f32_32x32x16_bf16 v[208:223], a[20:23], v[152:155], v[208:223]
    v_accvgpr_read_b32 v248, a192
    v_accvgpr_read_b32 v249, a193
    v_accvgpr_read_b32 v250, a194
    v_mfma_f32_32x32x16_bf16 v[224:239], a[24:27], v[152:155], v[224:239]
    v_accvgpr_read_b32 v251, a195
    v_add_f32 v244, v244, v248
    v_add_f32 v245, v245, v249
    v_add_f32 v246, v246, v250
    v_mfma_f32_32x32x16_bf16 v[160:175], a[28:31], v[156:159], v[160:175]
    v_add_f32 v247, v247, v251
    v_accvgpr_read_b32 v248, a196
    v_accvgpr_read_b32 v249, a197
    v_accvgpr_read_b32 v250, a198
    s_waitcnt lgkmcnt(0)
    v_mfma_f32_32x32x16_bf16 v[176:191], a[32:35], v[156:159], v[176:191]
    v_accvgpr_read_b32 v251, a199
    v_add_f32 v244, v244, v248
    v_add_f32 v245, v245, v249
    v_add_f32 v246, v246, v250
    v_mfma_f32_32x32x16_bf16 v[192:207], a[36:39], v[156:159], v[192:207]
    v_add_f32 v247, v247, v251
    v_cvt_pk_bf16_f32 v248, v244, v245
    v_cvt_pk_bf16_f32 v249, v246, v247
    buffer_store_dwordx2 v[248:249], v252, s[20:23], s74 offen sc1
    v_mfma_f32_32x32x16_bf16 v[208:223], a[40:43], v[156:159], v[208:223]
    v_mfma_f32_32x32x16_bf16 v[224:239], a[44:47], v[156:159], v[224:239]
    v_mov_b32 v6, 1
    v_mov_b32 v7, 0
    v_accvgpr_read_b32 v2, a239
    v_cvt_pk_bf16_f32 v240, v160, v161
    v_accvgpr_write_b32 a132, v240
    v_cvt_pk_bf16_f32 v241, v162, v163
    v_accvgpr_write_b32 a133, v241
    v_cvt_pk_bf16_f32 v242, v164, v165
    v_accvgpr_write_b32 a134, v242
    v_cvt_pk_bf16_f32 v243, v166, v167
    v_accvgpr_write_b32 a135, v243
    v_cvt_pk_bf16_f32 v240, v168, v169
    v_accvgpr_write_b32 a136, v240
    v_cvt_pk_bf16_f32 v241, v170, v171
    v_accvgpr_write_b32 a137, v241
    v_cvt_pk_bf16_f32 v242, v172, v173
    v_accvgpr_write_b32 a138, v242
    v_cvt_pk_bf16_f32 v243, v174, v175
    v_accvgpr_write_b32 a139, v243
    v_cvt_pk_bf16_f32 v240, v176, v177
    v_accvgpr_write_b32 a140, v240
    v_cvt_pk_bf16_f32 v241, v178, v179
    v_accvgpr_write_b32 a141, v241
    v_cvt_pk_bf16_f32 v242, v180, v181
    v_accvgpr_write_b32 a142, v242
    v_cvt_pk_bf16_f32 v243, v182, v183
    v_accvgpr_write_b32 a143, v243
    v_cvt_pk_bf16_f32 v240, v184, v185
    v_accvgpr_write_b32 a144, v240
    v_cvt_pk_bf16_f32 v241, v186, v187
    v_accvgpr_write_b32 a145, v241
    v_cvt_pk_bf16_f32 v242, v188, v189
    v_accvgpr_write_b32 a146, v242
    v_cvt_pk_bf16_f32 v243, v190, v191
    v_accvgpr_write_b32 a147, v243
    v_cvt_pk_bf16_f32 v240, v192, v193
    v_accvgpr_write_b32 a148, v240
    v_cvt_pk_bf16_f32 v241, v194, v195
    v_accvgpr_write_b32 a149, v241
    v_cvt_pk_bf16_f32 v242, v196, v197
    v_accvgpr_write_b32 a150, v242
    v_cvt_pk_bf16_f32 v243, v198, v199
    v_accvgpr_write_b32 a151, v243
    v_cvt_pk_bf16_f32 v240, v200, v201
    v_accvgpr_write_b32 a152, v240
    v_cvt_pk_bf16_f32 v241, v202, v203
    v_accvgpr_write_b32 a153, v241
    v_cvt_pk_bf16_f32 v242, v204, v205
    v_accvgpr_write_b32 a154, v242
    v_cvt_pk_bf16_f32 v243, v206, v207
    v_accvgpr_write_b32 a155, v243
    v_cvt_pk_bf16_f32 v240, v208, v209
    v_accvgpr_write_b32 a156, v240
    v_cvt_pk_bf16_f32 v241, v210, v211
    v_accvgpr_write_b32 a157, v241
    v_cvt_pk_bf16_f32 v242, v212, v213
    v_accvgpr_write_b32 a158, v242
    v_cvt_pk_bf16_f32 v243, v214, v215
    v_accvgpr_write_b32 a159, v243
    v_cvt_pk_bf16_f32 v240, v216, v217
    v_accvgpr_write_b32 a160, v240
    v_cvt_pk_bf16_f32 v241, v218, v219
    v_accvgpr_write_b32 a161, v241
    v_cvt_pk_bf16_f32 v242, v220, v221
    v_accvgpr_write_b32 a162, v242
    v_cvt_pk_bf16_f32 v243, v222, v223
    v_accvgpr_write_b32 a163, v243
    v_cvt_pk_bf16_f32 v240, v224, v225
    v_accvgpr_write_b32 a164, v240
    v_cvt_pk_bf16_f32 v241, v226, v227
    v_accvgpr_write_b32 a165, v241
    v_cvt_pk_bf16_f32 v242, v228, v229
    v_accvgpr_write_b32 a166, v242
    v_cvt_pk_bf16_f32 v243, v230, v231
    v_accvgpr_write_b32 a167, v243
    v_mfma_f32_32x32x16_bf16 v[160:175], a[48:51], a[132:135], 0
    v_accvgpr_write_b32 a177, 0
    v_accvgpr_write_b32 a178, 0
    v_accvgpr_write_b32 a179, 0
    v_accvgpr_write_b32 a188, 0
    v_accvgpr_write_b32 a190, 0
    v_mfma_f32_32x32x16_bf16 v[160:175], a[52:55], a[136:139], v[160:175]
    v_accvgpr_write_b32 a191, 0
    v_accvgpr_write_b32 a200, 0
    v_accvgpr_write_b32 a201, 0
    v_accvgpr_write_b32 a203, 0
    v_accvgpr_write_b32 a212, 0
    v_mfma_f32_32x32x16_bf16 v[160:175], a[56:59], a[140:143], v[160:175]
    v_accvgpr_write_b32 a213, 0
    v_accvgpr_write_b32 a214, 0
    v_accvgpr_write_b32 a225, 0
    v_accvgpr_write_b32 a226, 0
    v_accvgpr_write_b32 a227, 0
    v_mfma_f32_32x32x16_bf16 v[176:191], a[60:63], a[132:135], 0
    v_accvgpr_write_b32 a8, 0
    v_accvgpr_write_b32 a10, 0
    v_accvgpr_write_b32 a11, 0
    v_accvgpr_write_b32 a20, 0
    v_accvgpr_write_b32 a21, 0
    v_mfma_f32_32x32x16_bf16 v[176:191], a[64:67], a[136:139], v[176:191]
    v_accvgpr_write_b32 a23, 0
    v_accvgpr_write_b32 a32, 0
    v_accvgpr_write_b32 a33, 0
    v_accvgpr_write_b32 a34, 0
    v_accvgpr_read_b32 v3, a235
    v_mfma_f32_32x32x16_bf16 v[176:191], a[68:71], a[140:143], v[176:191]
    v_accvgpr_read_b32 v5, a236
    s_mul_i32 s50, s40, 5120
    s_add_u32 s49, s49, s50
    v_mfma_f32_32x32x16_bf16 v[176:191], a[72:75], a[144:147], v[176:191]
    v_mfma_f32_32x32x16_bf16 v[176:191], a[76:79], a[148:151], v[176:191]
    v_mfma_f32_32x32x16_bf16 v[192:207], a[80:83], a[140:143], 0
    v_mfma_f32_32x32x16_bf16 v[192:207], a[84:87], a[144:147], v[192:207]
    v_mfma_f32_32x32x16_bf16 v[192:207], a[88:91], a[148:151], v[192:207]
    v_mfma_f32_32x32x16_bf16 v[192:207], a[92:95], a[152:155], v[192:207]
    v_mfma_f32_32x32x16_bf16 v[192:207], a[96:99], a[156:159], v[192:207]
    v_mfma_f32_32x32x16_bf16 v[208:223], a[100:103], a[148:151], 0
    v_mfma_f32_32x32x16_bf16 v[208:223], a[104:107], a[152:155], v[208:223]
    v_mfma_f32_32x32x16_bf16 v[208:223], a[108:111], a[156:159], v[208:223]
    v_mfma_f32_32x32x16_bf16 v[208:223], a[112:115], a[160:163], v[208:223]
    v_mfma_f32_32x32x16_bf16 v[208:223], a[116:119], a[164:167], v[208:223]
    v_mfma_f32_32x32x16_bf16 v[224:239], a[120:123], a[156:159], 0
    v_mfma_f32_32x32x16_bf16 v[224:239], a[124:127], a[160:163], v[224:239]
    v_mfma_f32_32x32x16_bf16 v[224:239], a[128:131], a[164:167], v[224:239]
    s_waitcnt vmcnt(0)
    buffer_store_dword v6, v7, s[20:23], s96 offen offset:64 sc1
    v_max3_f32 v250, v160, v161, v162
    v_min3_f32 v252, v160, v161, v162
    v_max3_f32 v250, v250, v163, v164
    v_min3_f32 v252, v252, v163, v164
    v_max3_f32 v250, v250, v165, v166
    v_min3_f32 v252, v252, v165, v166
    v_max3_f32 v250, v250, v167, v168
    v_min3_f32 v252, v252, v167, v168
    v_max3_f32 v250, v250, v169, v170
    v_min3_f32 v252, v252, v169, v170
    v_max3_f32 v250, v250, v171, v172
    v_min3_f32 v252, v252, v171, v172
    v_max3_f32 v250, v250, v173, v174
    v_min3_f32 v252, v252, v173, v174
    v_max3_f32 v250, v250, v175, v176
    v_min3_f32 v252, v252, v175, v176
    v_max_f32 v250, v250, v177
    v_min_f32 v252, v252, v177
    v_mul_f32 v250, v0, v250
    v_mul_f32 v252, v0, v252
    v_pk_fma_f32 v[232:233], v[160:161], v[0:1], v[250:251] op_sel_hi:[1,0,0] neg_lo:[0,0,1] neg_hi:[0,0,1]
    v_pk_fma_f32 v[160:161], v[160:161], v[0:1], v[252:253] op_sel_hi:[1,0,0] neg_lo:[1,0,0] neg_hi:[1,0,0]
    v_pk_fma_f32 v[234:235], v[162:163], v[0:1], v[250:251] op_sel_hi:[1,0,0] neg_lo:[0,0,1] neg_hi:[0,0,1]
    v_pk_fma_f32 v[162:163], v[162:163], v[0:1], v[252:253] op_sel_hi:[1,0,0] neg_lo:[1,0,0] neg_hi:[1,0,0]
    v_pk_fma_f32 v[236:237], v[164:165], v[0:1], v[250:251] op_sel_hi:[1,0,0] neg_lo:[0,0,1] neg_hi:[0,0,1]
    v_pk_fma_f32 v[164:165], v[164:165], v[0:1], v[252:253] op_sel_hi:[1,0,0] neg_lo:[1,0,0] neg_hi:[1,0,0]
    v_pk_fma_f32 v[238:239], v[166:167], v[0:1], v[250:251] op_sel_hi:[1,0,0] neg_lo:[0,0,1] neg_hi:[0,0,1]
    v_pk_fma_f32 v[166:167], v[166:167], v[0:1], v[252:253] op_sel_hi:[1,0,0] neg_lo:[1,0,0] neg_hi:[1,0,0]
    v_pk_fma_f32 v[240:241], v[168:169], v[0:1], v[250:251] op_sel_hi:[1,0,0] neg_lo:[0,0,1] neg_hi:[0,0,1]
    v_pk_fma_f32 v[168:169], v[168:169], v[0:1], v[252:253] op_sel_hi:[1,0,0] neg_lo:[1,0,0] neg_hi:[1,0,0]
    v_pk_fma_f32 v[242:243], v[170:171], v[0:1], v[250:251] op_sel_hi:[1,0,0] neg_lo:[0,0,1] neg_hi:[0,0,1]
    v_pk_fma_f32 v[170:171], v[170:171], v[0:1], v[252:253] op_sel_hi:[1,0,0] neg_lo:[1,0,0] neg_hi:[1,0,0]
    v_pk_fma_f32 v[244:245], v[172:173], v[0:1], v[250:251] op_sel_hi:[1,0,0] neg_lo:[0,0,1] neg_hi:[0,0,1]
    v_pk_fma_f32 v[172:173], v[172:173], v[0:1], v[252:253] op_sel_hi:[1,0,0] neg_lo:[1,0,0] neg_hi:[1,0,0]
    v_pk_fma_f32 v[246:247], v[174:175], v[0:1], v[250:251] op_sel_hi:[1,0,0] neg_lo:[0,0,1] neg_hi:[0,0,1]
    v_pk_fma_f32 v[174:175], v[174:175], v[0:1], v[252:253] op_sel_hi:[1,0,0] neg_lo:[1,0,0] neg_hi:[1,0,0]
    v_pk_fma_f32 v[248:249], v[176:177], v[0:1], v[250:251] op_sel_hi:[1,0,0] neg_lo:[0,0,1] neg_hi:[0,0,1]
    v_pk_fma_f32 v[176:177], v[176:177], v[0:1], v[252:253] op_sel_hi:[1,0,0] neg_lo:[1,0,0] neg_hi:[1,0,0]
    v_exp_f32 v232, v232
    v_exp_f32 v160, v160
    v_exp_f32 v233, v233
    v_exp_f32 v161, v161
    v_exp_f32 v234, v234
    v_exp_f32 v162, v162
    v_exp_f32 v235, v235
    v_exp_f32 v163, v163
    v_exp_f32 v236, v236
    v_exp_f32 v164, v164
    v_exp_f32 v237, v237
    v_exp_f32 v165, v165
    v_exp_f32 v238, v238
    v_exp_f32 v166, v166
    v_exp_f32 v239, v239
    v_exp_f32 v167, v167
    v_exp_f32 v240, v240
    v_exp_f32 v168, v168
    v_exp_f32 v241, v241
    v_exp_f32 v169, v169
    v_exp_f32 v242, v242
    v_exp_f32 v170, v170
    v_exp_f32 v243, v243
    v_exp_f32 v171, v171
    v_exp_f32 v244, v244
    v_exp_f32 v172, v172
    v_exp_f32 v245, v245
    v_exp_f32 v173, v173
    v_exp_f32 v246, v246
    v_exp_f32 v174, v174
    v_exp_f32 v247, v247
    v_exp_f32 v175, v175
    v_exp_f32 v248, v248
    v_exp_f32 v176, v176
    v_exp_f32 v249, v249
    v_exp_f32 v177, v177
    v_pk_add_f32 v[250:251], v[232:233], v[234:235]
    v_pk_add_f32 v[252:253], v[160:161], v[162:163]
    v_pk_add_f32 v[250:251], v[250:251], v[236:237]
    v_pk_add_f32 v[252:253], v[252:253], v[164:165]
    v_pk_add_f32 v[250:251], v[250:251], v[238:239]
    v_pk_add_f32 v[252:253], v[252:253], v[166:167]
    v_pk_add_f32 v[250:251], v[250:251], v[240:241]
    v_pk_add_f32 v[252:253], v[252:253], v[168:169]
    v_pk_add_f32 v[250:251], v[250:251], v[242:243]
    v_pk_add_f32 v[252:253], v[252:253], v[170:171]
    v_pk_add_f32 v[250:251], v[250:251], v[244:245]
    v_pk_add_f32 v[252:253], v[252:253], v[172:173]
    v_pk_add_f32 v[250:251], v[250:251], v[246:247]
    v_pk_add_f32 v[252:253], v[252:253], v[174:175]
    v_pk_add_f32 v[250:251], v[250:251], v[248:249]
    v_pk_add_f32 v[252:253], v[252:253], v[176:177]
    v_add_f32 v250, v250, v251
    v_add_f32 v252, v252, v253
    v_rcp_f32 v250, v250
    v_rcp_f32 v252, v252
    s_nop 0
    v_pk_mul_f32 v[232:233], v[232:233], v[250:251] op_sel_hi:[1,0]
    v_pk_mul_f32 v[160:161], v[160:161], v[252:253] op_sel_hi:[1,0]
    v_pk_mul_f32 v[234:235], v[234:235], v[250:251] op_sel_hi:[1,0]
    v_pk_mul_f32 v[162:163], v[162:163], v[252:253] op_sel_hi:[1,0]
    v_pk_mul_f32 v[236:237], v[236:237], v[250:251] op_sel_hi:[1,0]
    v_pk_mul_f32 v[164:165], v[164:165], v[252:253] op_sel_hi:[1,0]
    v_pk_mul_f32 v[238:239], v[238:239], v[250:251] op_sel_hi:[1,0]
    v_pk_mul_f32 v[166:167], v[166:167], v[252:253] op_sel_hi:[1,0]
    v_pk_mul_f32 v[240:241], v[240:241], v[250:251] op_sel_hi:[1,0]
    v_pk_mul_f32 v[168:169], v[168:169], v[252:253] op_sel_hi:[1,0]
    v_pk_mul_f32 v[242:243], v[242:243], v[250:251] op_sel_hi:[1,0]
    v_pk_mul_f32 v[170:171], v[170:171], v[252:253] op_sel_hi:[1,0]
    v_pk_mul_f32 v[244:245], v[244:245], v[250:251] op_sel_hi:[1,0]
    v_pk_mul_f32 v[172:173], v[172:173], v[252:253] op_sel_hi:[1,0]
    v_pk_mul_f32 v[246:247], v[246:247], v[250:251] op_sel_hi:[1,0]
    v_pk_mul_f32 v[174:175], v[174:175], v[252:253] op_sel_hi:[1,0]
    v_pk_mul_f32 v[248:249], v[248:249], v[250:251] op_sel_hi:[1,0]
    v_pk_mul_f32 v[176:177], v[176:177], v[252:253] op_sel_hi:[1,0]
    v_cvt_pk_bf16_f32 v16, v160, v161
    v_cvt_pk_bf16_f32 v17, v162, v163
    v_cvt_pk_bf16_f32 v18, v164, v165
    v_cvt_pk_bf16_f32 v19, v166, v167
    v_cvt_pk_bf16_f32 v20, v168, v169
    v_cvt_pk_bf16_f32 v21, v170, v171
    v_cvt_pk_bf16_f32 v22, v172, v173
    v_cvt_pk_bf16_f32 v23, v174, v175
    v_cvt_pk_bf16_f32 v24, v176, v177
    v_cvt_pk_bf16_f32 v25, v232, v233
    v_cvt_pk_bf16_f32 v26, v234, v235
    v_cvt_pk_bf16_f32 v27, v236, v237
    v_cvt_pk_bf16_f32 v28, v238, v239
    v_cvt_pk_bf16_f32 v29, v240, v241
    v_cvt_pk_bf16_f32 v30, v242, v243
    v_cvt_pk_bf16_f32 v31, v244, v245
    v_cvt_pk_bf16_f32 v80, v246, v247
    v_cvt_pk_bf16_f32 v84, v248, v249
    v_permlane32_swap_b32 v16, v20
    v_permlane32_swap_b32 v17, v21
    v_permlane32_swap_b32 v18, v22
    v_permlane32_swap_b32 v19, v23
    v_permlane32_swap_b32 v24, v28
    v_permlane32_swap_b32 v25, v29
    v_permlane32_swap_b32 v26, v30
    v_permlane32_swap_b32 v27, v31
    v_permlane32_swap_b32 v80, v84
    v_max3_f32 v250, v178, v179, v180
    v_min3_f32 v252, v178, v179, v180
    v_max3_f32 v250, v250, v181, v182
    v_min3_f32 v252, v252, v181, v182
    v_max3_f32 v250, v250, v183, v184
    v_min3_f32 v252, v252, v183, v184
    v_max3_f32 v250, v250, v185, v186
    v_min3_f32 v252, v252, v185, v186
    v_max3_f32 v250, v250, v187, v188
    v_min3_f32 v252, v252, v187, v188
    v_max3_f32 v250, v250, v189, v190
    v_min3_f32 v252, v252, v189, v190
    v_max3_f32 v250, v250, v191, v192
    v_min3_f32 v252, v252, v191, v192
    v_max3_f32 v250, v250, v193, v194
    v_min3_f32 v252, v252, v193, v194
    v_max_f32 v250, v250, v195
    v_min_f32 v252, v252, v195
    v_mul_f32 v250, v0, v250
    v_mul_f32 v252, v0, v252
    v_pk_fma_f32 v[232:233], v[178:179], v[0:1], v[250:251] op_sel_hi:[1,0,0] neg_lo:[0,0,1] neg_hi:[0,0,1]
    v_pk_fma_f32 v[178:179], v[178:179], v[0:1], v[252:253] op_sel_hi:[1,0,0] neg_lo:[1,0,0] neg_hi:[1,0,0]
    v_pk_fma_f32 v[234:235], v[180:181], v[0:1], v[250:251] op_sel_hi:[1,0,0] neg_lo:[0,0,1] neg_hi:[0,0,1]
    v_pk_fma_f32 v[180:181], v[180:181], v[0:1], v[252:253] op_sel_hi:[1,0,0] neg_lo:[1,0,0] neg_hi:[1,0,0]
    v_pk_fma_f32 v[236:237], v[182:183], v[0:1], v[250:251] op_sel_hi:[1,0,0] neg_lo:[0,0,1] neg_hi:[0,0,1]
    v_pk_fma_f32 v[182:183], v[182:183], v[0:1], v[252:253] op_sel_hi:[1,0,0] neg_lo:[1,0,0] neg_hi:[1,0,0]
    v_pk_fma_f32 v[238:239], v[184:185], v[0:1], v[250:251] op_sel_hi:[1,0,0] neg_lo:[0,0,1] neg_hi:[0,0,1]
    v_pk_fma_f32 v[184:185], v[184:185], v[0:1], v[252:253] op_sel_hi:[1,0,0] neg_lo:[1,0,0] neg_hi:[1,0,0]
    v_pk_fma_f32 v[240:241], v[186:187], v[0:1], v[250:251] op_sel_hi:[1,0,0] neg_lo:[0,0,1] neg_hi:[0,0,1]
    v_pk_fma_f32 v[186:187], v[186:187], v[0:1], v[252:253] op_sel_hi:[1,0,0] neg_lo:[1,0,0] neg_hi:[1,0,0]
    v_pk_fma_f32 v[242:243], v[188:189], v[0:1], v[250:251] op_sel_hi:[1,0,0] neg_lo:[0,0,1] neg_hi:[0,0,1]
    v_pk_fma_f32 v[188:189], v[188:189], v[0:1], v[252:253] op_sel_hi:[1,0,0] neg_lo:[1,0,0] neg_hi:[1,0,0]
    v_pk_fma_f32 v[244:245], v[190:191], v[0:1], v[250:251] op_sel_hi:[1,0,0] neg_lo:[0,0,1] neg_hi:[0,0,1]
    v_pk_fma_f32 v[190:191], v[190:191], v[0:1], v[252:253] op_sel_hi:[1,0,0] neg_lo:[1,0,0] neg_hi:[1,0,0]
    v_pk_fma_f32 v[246:247], v[192:193], v[0:1], v[250:251] op_sel_hi:[1,0,0] neg_lo:[0,0,1] neg_hi:[0,0,1]
    v_pk_fma_f32 v[192:193], v[192:193], v[0:1], v[252:253] op_sel_hi:[1,0,0] neg_lo:[1,0,0] neg_hi:[1,0,0]
    v_pk_fma_f32 v[248:249], v[194:195], v[0:1], v[250:251] op_sel_hi:[1,0,0] neg_lo:[0,0,1] neg_hi:[0,0,1]
    v_pk_fma_f32 v[194:195], v[194:195], v[0:1], v[252:253] op_sel_hi:[1,0,0] neg_lo:[1,0,0] neg_hi:[1,0,0]
    v_exp_f32 v232, v232
    v_exp_f32 v178, v178
    v_exp_f32 v233, v233
    v_exp_f32 v179, v179
    v_exp_f32 v234, v234
    v_exp_f32 v180, v180
    v_exp_f32 v235, v235
    v_exp_f32 v181, v181
    v_exp_f32 v236, v236
    v_exp_f32 v182, v182
    v_exp_f32 v237, v237
    v_exp_f32 v183, v183
    v_exp_f32 v238, v238
    v_exp_f32 v184, v184
    v_exp_f32 v239, v239
    v_exp_f32 v185, v185
    v_exp_f32 v240, v240
    v_exp_f32 v186, v186
    v_exp_f32 v241, v241
    v_exp_f32 v187, v187
    v_exp_f32 v242, v242
    v_exp_f32 v188, v188
    v_exp_f32 v243, v243
    v_exp_f32 v189, v189
    v_exp_f32 v244, v244
    v_exp_f32 v190, v190
    v_exp_f32 v245, v245
    v_exp_f32 v191, v191
    v_exp_f32 v246, v246
    v_exp_f32 v192, v192
    v_exp_f32 v247, v247
    v_exp_f32 v193, v193
    v_exp_f32 v248, v248
    v_exp_f32 v194, v194
    v_exp_f32 v249, v249
    v_exp_f32 v195, v195
    v_pk_add_f32 v[250:251], v[232:233], v[234:235]
    v_pk_add_f32 v[252:253], v[178:179], v[180:181]
    v_pk_add_f32 v[250:251], v[250:251], v[236:237]
    v_pk_add_f32 v[252:253], v[252:253], v[182:183]
    v_pk_add_f32 v[250:251], v[250:251], v[238:239]
    v_pk_add_f32 v[252:253], v[252:253], v[184:185]
    v_pk_add_f32 v[250:251], v[250:251], v[240:241]
    v_pk_add_f32 v[252:253], v[252:253], v[186:187]
    v_pk_add_f32 v[250:251], v[250:251], v[242:243]
    v_pk_add_f32 v[252:253], v[252:253], v[188:189]
    v_pk_add_f32 v[250:251], v[250:251], v[244:245]
    v_pk_add_f32 v[252:253], v[252:253], v[190:191]
    v_pk_add_f32 v[250:251], v[250:251], v[246:247]
    v_pk_add_f32 v[252:253], v[252:253], v[192:193]
    v_pk_add_f32 v[250:251], v[250:251], v[248:249]
    v_pk_add_f32 v[252:253], v[252:253], v[194:195]
    v_add_f32 v250, v250, v251
    v_add_f32 v252, v252, v253
    v_rcp_f32 v250, v250
    v_rcp_f32 v252, v252
    s_nop 0
    v_pk_mul_f32 v[232:233], v[232:233], v[250:251] op_sel_hi:[1,0]
    v_pk_mul_f32 v[178:179], v[178:179], v[252:253] op_sel_hi:[1,0]
    v_pk_mul_f32 v[234:235], v[234:235], v[250:251] op_sel_hi:[1,0]
    v_pk_mul_f32 v[180:181], v[180:181], v[252:253] op_sel_hi:[1,0]
    v_pk_mul_f32 v[236:237], v[236:237], v[250:251] op_sel_hi:[1,0]
    v_pk_mul_f32 v[182:183], v[182:183], v[252:253] op_sel_hi:[1,0]
    v_pk_mul_f32 v[238:239], v[238:239], v[250:251] op_sel_hi:[1,0]
    v_pk_mul_f32 v[184:185], v[184:185], v[252:253] op_sel_hi:[1,0]
    v_pk_mul_f32 v[240:241], v[240:241], v[250:251] op_sel_hi:[1,0]
    v_pk_mul_f32 v[186:187], v[186:187], v[252:253] op_sel_hi:[1,0]
    v_pk_mul_f32 v[242:243], v[242:243], v[250:251] op_sel_hi:[1,0]
    v_pk_mul_f32 v[188:189], v[188:189], v[252:253] op_sel_hi:[1,0]
    v_pk_mul_f32 v[244:245], v[244:245], v[250:251] op_sel_hi:[1,0]
    v_pk_mul_f32 v[190:191], v[190:191], v[252:253] op_sel_hi:[1,0]
    v_pk_mul_f32 v[246:247], v[246:247], v[250:251] op_sel_hi:[1,0]
    v_pk_mul_f32 v[192:193], v[192:193], v[252:253] op_sel_hi:[1,0]
    v_pk_mul_f32 v[248:249], v[248:249], v[250:251] op_sel_hi:[1,0]
    v_pk_mul_f32 v[194:195], v[194:195], v[252:253] op_sel_hi:[1,0]
    v_cvt_pk_bf16_f32 v32, v178, v179
    v_cvt_pk_bf16_f32 v33, v180, v181
    v_cvt_pk_bf16_f32 v34, v182, v183
    v_cvt_pk_bf16_f32 v35, v184, v185
    v_cvt_pk_bf16_f32 v36, v186, v187
    v_cvt_pk_bf16_f32 v37, v188, v189
    v_cvt_pk_bf16_f32 v38, v190, v191
    v_cvt_pk_bf16_f32 v39, v192, v193
    v_cvt_pk_bf16_f32 v40, v194, v195
    v_cvt_pk_bf16_f32 v41, v232, v233
    v_cvt_pk_bf16_f32 v42, v234, v235
    v_cvt_pk_bf16_f32 v43, v236, v237
    v_cvt_pk_bf16_f32 v44, v238, v239
    v_cvt_pk_bf16_f32 v45, v240, v241
    v_cvt_pk_bf16_f32 v46, v242, v243
    v_cvt_pk_bf16_f32 v47, v244, v245
    v_cvt_pk_bf16_f32 v81, v246, v247
    v_cvt_pk_bf16_f32 v85, v248, v249
    v_permlane32_swap_b32 v32, v36
    v_permlane32_swap_b32 v33, v37
    v_permlane32_swap_b32 v34, v38
    v_permlane32_swap_b32 v35, v39
    v_permlane32_swap_b32 v40, v44
    v_permlane32_swap_b32 v41, v45
    v_permlane32_swap_b32 v42, v46
    v_permlane32_swap_b32 v43, v47
    v_permlane32_swap_b32 v81, v85
    buffer_load_dword v4, v2, s[20:23], s95 offen offset:64 sc1
    v_max3_f32 v250, v196, v197, v198
    v_min3_f32 v252, v196, v197, v198
    v_max3_f32 v250, v250, v199, v200
    v_min3_f32 v252, v252, v199, v200
    v_max3_f32 v250, v250, v201, v202
    v_min3_f32 v252, v252, v201, v202
    v_max3_f32 v250, v250, v203, v204
    v_min3_f32 v252, v252, v203, v204
    v_max3_f32 v250, v250, v205, v206
    v_min3_f32 v252, v252, v205, v206
    v_max3_f32 v250, v250, v207, v208
    v_min3_f32 v252, v252, v207, v208
    v_max3_f32 v250, v250, v209, v210
    v_min3_f32 v252, v252, v209, v210
    v_max3_f32 v250, v250, v211, v212
    v_min3_f32 v252, v252, v211, v212
    v_max_f32 v250, v250, v213
    v_min_f32 v252, v252, v213
    v_mul_f32 v250, v0, v250
    v_mul_f32 v252, v0, v252
    v_pk_fma_f32 v[232:233], v[196:197], v[0:1], v[250:251] op_sel_hi:[1,0,0] neg_lo:[0,0,1] neg_hi:[0,0,1]
    v_pk_fma_f32 v[196:197], v[196:197], v[0:1], v[252:253] op_sel_hi:[1,0,0] neg_lo:[1,0,0] neg_hi:[1,0,0]
    v_pk_fma_f32 v[234:235], v[198:199], v[0:1], v[250:251] op_sel_hi:[1,0,0] neg_lo:[0,0,1] neg_hi:[0,0,1]
    v_pk_fma_f32 v[198:199], v[198:199], v[0:1], v[252:253] op_sel_hi:[1,0,0] neg_lo:[1,0,0] neg_hi:[1,0,0]
    v_pk_fma_f32 v[236:237], v[200:201], v[0:1], v[250:251] op_sel_hi:[1,0,0] neg_lo:[0,0,1] neg_hi:[0,0,1]
    v_pk_fma_f32 v[200:201], v[200:201], v[0:1], v[252:253] op_sel_hi:[1,0,0] neg_lo:[1,0,0] neg_hi:[1,0,0]
    v_pk_fma_f32 v[238:239], v[202:203], v[0:1], v[250:251] op_sel_hi:[1,0,0] neg_lo:[0,0,1] neg_hi:[0,0,1]
    v_pk_fma_f32 v[202:203], v[202:203], v[0:1], v[252:253] op_sel_hi:[1,0,0] neg_lo:[1,0,0] neg_hi:[1,0,0]
    v_pk_fma_f32 v[240:241], v[204:205], v[0:1], v[250:251] op_sel_hi:[1,0,0] neg_lo:[0,0,1] neg_hi:[0,0,1]
    v_pk_fma_f32 v[204:205], v[204:205], v[0:1], v[252:253] op_sel_hi:[1,0,0] neg_lo:[1,0,0] neg_hi:[1,0,0]
    v_pk_fma_f32 v[242:243], v[206:207], v[0:1], v[250:251] op_sel_hi:[1,0,0] neg_lo:[0,0,1] neg_hi:[0,0,1]
    v_pk_fma_f32 v[206:207], v[206:207], v[0:1], v[252:253] op_sel_hi:[1,0,0] neg_lo:[1,0,0] neg_hi:[1,0,0]
    v_pk_fma_f32 v[244:245], v[208:209], v[0:1], v[250:251] op_sel_hi:[1,0,0] neg_lo:[0,0,1] neg_hi:[0,0,1]
    v_pk_fma_f32 v[208:209], v[208:209], v[0:1], v[252:253] op_sel_hi:[1,0,0] neg_lo:[1,0,0] neg_hi:[1,0,0]
    v_pk_fma_f32 v[246:247], v[210:211], v[0:1], v[250:251] op_sel_hi:[1,0,0] neg_lo:[0,0,1] neg_hi:[0,0,1]
    v_pk_fma_f32 v[210:211], v[210:211], v[0:1], v[252:253] op_sel_hi:[1,0,0] neg_lo:[1,0,0] neg_hi:[1,0,0]
    v_pk_fma_f32 v[248:249], v[212:213], v[0:1], v[250:251] op_sel_hi:[1,0,0] neg_lo:[0,0,1] neg_hi:[0,0,1]
    v_pk_fma_f32 v[212:213], v[212:213], v[0:1], v[252:253] op_sel_hi:[1,0,0] neg_lo:[1,0,0] neg_hi:[1,0,0]
    v_exp_f32 v232, v232
    v_exp_f32 v196, v196
    v_exp_f32 v233, v233
    v_exp_f32 v197, v197
    v_exp_f32 v234, v234
    v_exp_f32 v198, v198
    v_exp_f32 v235, v235
    v_exp_f32 v199, v199
    v_exp_f32 v236, v236
    v_exp_f32 v200, v200
    v_exp_f32 v237, v237
    v_exp_f32 v201, v201
    v_exp_f32 v238, v238
    v_exp_f32 v202, v202
    v_exp_f32 v239, v239
    v_exp_f32 v203, v203
    v_exp_f32 v240, v240
    v_exp_f32 v204, v204
    v_exp_f32 v241, v241
    v_exp_f32 v205, v205
    v_exp_f32 v242, v242
    v_exp_f32 v206, v206
    v_exp_f32 v243, v243
    v_exp_f32 v207, v207
    v_exp_f32 v244, v244
    v_exp_f32 v208, v208
    v_exp_f32 v245, v245
    v_exp_f32 v209, v209
    v_exp_f32 v246, v246
    v_exp_f32 v210, v210
    v_exp_f32 v247, v247
    v_exp_f32 v211, v211
    v_exp_f32 v248, v248
    v_exp_f32 v212, v212
    v_exp_f32 v249, v249
    v_exp_f32 v213, v213
    v_pk_add_f32 v[250:251], v[232:233], v[234:235]
    v_pk_add_f32 v[252:253], v[196:197], v[198:199]
    v_pk_add_f32 v[250:251], v[250:251], v[236:237]
    v_pk_add_f32 v[252:253], v[252:253], v[200:201]
    v_pk_add_f32 v[250:251], v[250:251], v[238:239]
    v_pk_add_f32 v[252:253], v[252:253], v[202:203]
    v_pk_add_f32 v[250:251], v[250:251], v[240:241]
    v_pk_add_f32 v[252:253], v[252:253], v[204:205]
    v_pk_add_f32 v[250:251], v[250:251], v[242:243]
    v_pk_add_f32 v[252:253], v[252:253], v[206:207]
    v_pk_add_f32 v[250:251], v[250:251], v[244:245]
    v_pk_add_f32 v[252:253], v[252:253], v[208:209]
    v_pk_add_f32 v[250:251], v[250:251], v[246:247]
    v_pk_add_f32 v[252:253], v[252:253], v[210:211]
    v_pk_add_f32 v[250:251], v[250:251], v[248:249]
    v_pk_add_f32 v[252:253], v[252:253], v[212:213]
    v_add_f32 v250, v250, v251
    v_add_f32 v252, v252, v253
    v_rcp_f32 v250, v250
    v_rcp_f32 v252, v252
    s_nop 0
    v_pk_mul_f32 v[232:233], v[232:233], v[250:251] op_sel_hi:[1,0]
    v_pk_mul_f32 v[196:197], v[196:197], v[252:253] op_sel_hi:[1,0]
    v_pk_mul_f32 v[234:235], v[234:235], v[250:251] op_sel_hi:[1,0]
    v_pk_mul_f32 v[198:199], v[198:199], v[252:253] op_sel_hi:[1,0]
    v_pk_mul_f32 v[236:237], v[236:237], v[250:251] op_sel_hi:[1,0]
    v_pk_mul_f32 v[200:201], v[200:201], v[252:253] op_sel_hi:[1,0]
    v_pk_mul_f32 v[238:239], v[238:239], v[250:251] op_sel_hi:[1,0]
    v_pk_mul_f32 v[202:203], v[202:203], v[252:253] op_sel_hi:[1,0]
    v_pk_mul_f32 v[240:241], v[240:241], v[250:251] op_sel_hi:[1,0]
    v_pk_mul_f32 v[204:205], v[204:205], v[252:253] op_sel_hi:[1,0]
    v_pk_mul_f32 v[242:243], v[242:243], v[250:251] op_sel_hi:[1,0]
    v_pk_mul_f32 v[206:207], v[206:207], v[252:253] op_sel_hi:[1,0]
    v_pk_mul_f32 v[244:245], v[244:245], v[250:251] op_sel_hi:[1,0]
    v_pk_mul_f32 v[208:209], v[208:209], v[252:253] op_sel_hi:[1,0]
    v_pk_mul_f32 v[246:247], v[246:247], v[250:251] op_sel_hi:[1,0]
    v_pk_mul_f32 v[210:211], v[210:211], v[252:253] op_sel_hi:[1,0]
    v_pk_mul_f32 v[248:249], v[248:249], v[250:251] op_sel_hi:[1,0]
    v_pk_mul_f32 v[212:213], v[212:213], v[252:253] op_sel_hi:[1,0]
    v_cvt_pk_bf16_f32 v48, v196, v197
    v_cvt_pk_bf16_f32 v49, v198, v199
    v_cvt_pk_bf16_f32 v50, v200, v201
    v_cvt_pk_bf16_f32 v51, v202, v203
    v_cvt_pk_bf16_f32 v52, v204, v205
    v_cvt_pk_bf16_f32 v53, v206, v207
    v_cvt_pk_bf16_f32 v54, v208, v209
    v_cvt_pk_bf16_f32 v55, v210, v211
    v_cvt_pk_bf16_f32 v56, v212, v213
    v_cvt_pk_bf16_f32 v57, v232, v233
    v_cvt_pk_bf16_f32 v58, v234, v235
    v_cvt_pk_bf16_f32 v59, v236, v237
    v_cvt_pk_bf16_f32 v60, v238, v239
    v_cvt_pk_bf16_f32 v61, v240, v241
    v_cvt_pk_bf16_f32 v62, v242, v243
    v_cvt_pk_bf16_f32 v63, v244, v245
    v_cvt_pk_bf16_f32 v82, v246, v247
    v_cvt_pk_bf16_f32 v86, v248, v249
    v_permlane32_swap_b32 v48, v52
    v_permlane32_swap_b32 v49, v53
    v_permlane32_swap_b32 v50, v54
    v_permlane32_swap_b32 v51, v55
    v_permlane32_swap_b32 v56, v60
    v_permlane32_swap_b32 v57, v61
    v_permlane32_swap_b32 v58, v62
    v_permlane32_swap_b32 v59, v63
    v_permlane32_swap_b32 v82, v86
    s_waitcnt vmcnt(0)
    v_cmp_ne_u32 vcc, 0, v4
    s_nop 1
    s_cmp_eq_u64 vcc, -1
    s_cbranch_scc0 L_sp7
L_ok7:
    s_add_u32 m0, s73, 143360
    s_nop 0
    buffer_load_dwordx4 v14, s[20:23], s49 offen offset:0 sc1 lds
    s_add_u32 m0, s73, 143360
    s_nop 0
    buffer_load_dwordx4 v14, s[20:23], s49 offen offset:1024 sc1 lds
    s_add_u32 m0, s73, 143360
    s_nop 0
    buffer_load_dwordx4 v14, s[20:23], s49 offen offset:2048 sc1 lds
    s_add_u32 m0, s73, 143360
    s_nop 0
    buffer_load_dwordx4 v14, s[20:23], s49 offen offset:3072 sc1 lds
    s_add_u32 m0, s73, 147456
    s_add_u32 s49, s49, 4096
    buffer_load_dwordx4 v14, s[20:23], s49 offen offset:0 sc1 lds
    v_max3_f32 v250, v214, v215, v216
    v_min3_f32 v252, v214, v215, v216
    v_max3_f32 v250, v250, v217, v218
    v_min3_f32 v252, v252, v217, v218
    v_max3_f32 v250, v250, v219, v220
    v_min3_f32 v252, v252, v219, v220
    v_max3_f32 v250, v250, v221, v222
    v_min3_f32 v252, v252, v221, v222
    v_max3_f32 v250, v250, v223, v224
    v_min3_f32 v252, v252, v223, v224
    v_max3_f32 v250, v250, v225, v226
    v_min3_f32 v252, v252, v225, v226
    v_max3_f32 v250, v250, v227, v228
    v_min3_f32 v252, v252, v227, v228
    v_max3_f32 v250, v250, v229, v230
    v_min3_f32 v252, v252, v229, v230
    v_max_f32 v250, v250, v231
    v_min_f32 v252, v252, v231
    v_mul_f32 v250, v0, v250
    v_mul_f32 v252, v0, v252
    v_pk_fma_f32 v[232:233], v[214:215], v[0:1], v[250:251] op_sel_hi:[1,0,0] neg_lo:[0,0,1] neg_hi:[0,0,1]
    v_pk_fma_f32 v[214:215], v[214:215], v[0:1], v[252:253] op_sel_hi:[1,0,0] neg_lo:[1,0,0] neg_hi:[1,0,0]
    v_pk_fma_f32 v[234:235], v[216:217], v[0:1], v[250:251] op_sel_hi:[1,0,0] neg_lo:[0,0,1] neg_hi:[0,0,1]
    v_pk_fma_f32 v[216:217], v[216:217], v[0:1], v[252:253] op_sel_hi:[1,0,0] neg_lo:[1,0,0] neg_hi:[1,0,0]
    v_pk_fma_f32 v[236:237], v[218:219], v[0:1], v[250:251] op_sel_hi:[1,0,0] neg_lo:[0,0,1] neg_hi:[0,0,1]
    v_pk_fma_f32 v[218:219], v[218:219], v[0:1], v[252:253] op_sel_hi:[1,0,0] neg_lo:[1,0,0] neg_hi:[1,0,0]
    v_pk_fma_f32 v[238:239], v[220:221], v[0:1], v[250:251] op_sel_hi:[1,0,0] neg_lo:[0,0,1] neg_hi:[0,0,1]
    v_pk_fma_f32 v[220:221], v[220:221], v[0:1], v[252:253] op_sel_hi:[1,0,0] neg_lo:[1,0,0] neg_hi:[1,0,0]
    v_pk_fma_f32 v[240:241], v[222:223], v[0:1], v[250:251] op_sel_hi:[1,0,0] neg_lo:[0,0,1] neg_hi:[0,0,1]
    v_pk_fma_f32 v[222:223], v[222:223], v[0:1], v[252:253] op_sel_hi:[1,0,0] neg_lo:[1,0,0] neg_hi:[1,0,0]
    v_pk_fma_f32 v[242:243], v[224:225], v[0:1], v[250:251] op_sel_hi:[1,0,0] neg_lo:[0,0,1] neg_hi:[0,0,1]
    v_pk_fma_f32 v[224:225], v[224:225], v[0:1], v[252:253] op_sel_hi:[1,0,0] neg_lo:[1,0,0] neg_hi:[1,0,0]
    v_pk_fma_f32 v[244:245], v[226:227], v[0:1], v[250:251] op_sel_hi:[1,0,0] neg_lo:[0,0,1] neg_hi:[0,0,1]
    v_pk_fma_f32 v[226:227], v[226:227], v[0:1], v[252:253] op_sel_hi:[1,0,0] neg_lo:[1,0,0] neg_hi:[1,0,0]
    v_pk_fma_f32 v[246:247], v[228:229], v[0:1], v[250:251] op_sel_hi:[1,0,0] neg_lo:[0,0,1] neg_hi:[0,0,1]
    v_pk_fma_f32 v[228:229], v[228:229], v[0:1], v[252:253] op_sel_hi:[1,0,0] neg_lo:[1,0,0] neg_hi:[1,0,0]
    v_pk_fma_f32 v[248:249], v[230:231], v[0:1], v[250:251] op_sel_hi:[1,0,0] neg_lo:[0,0,1] neg_hi:[0,0,1]
    v_pk_fma_f32 v[230:231], v[230:231], v[0:1], v[252:253] op_sel_hi:[1,0,0] neg_lo:[1,0,0] neg_hi:[1,0,0]
    v_exp_f32 v232, v232
    v_exp_f32 v214, v214
    v_exp_f32 v233, v233
    v_exp_f32 v215, v215
    v_exp_f32 v234, v234
    v_exp_f32 v216, v216
    v_exp_f32 v235, v235
    v_exp_f32 v217, v217
    v_exp_f32 v236, v236
    v_exp_f32 v218, v218
    v_exp_f32 v237, v237
    v_exp_f32 v219, v219
    v_exp_f32 v238, v238
    v_exp_f32 v220, v220
    v_exp_f32 v239, v239
    v_exp_f32 v221, v221
    v_exp_f32 v240, v240
    v_exp_f32 v222, v222
    v_exp_f32 v241, v241
    v_exp_f32 v223, v223
    v_exp_f32 v242, v242
    v_exp_f32 v224, v224
    v_exp_f32 v243, v243
    v_exp_f32 v225, v225
    v_exp_f32 v244, v244
    v_exp_f32 v226, v226
    v_exp_f32 v245, v245
    v_exp_f32 v227, v227
    v_exp_f32 v246, v246
    v_exp_f32 v228, v228
    v_exp_f32 v247, v247
    v_exp_f32 v229, v229
    v_exp_f32 v248, v248
    v_exp_f32 v230, v230
    v_exp_f32 v249, v249
    v_exp_f32 v231, v231
    v_pk_add_f32 v[250:251], v[232:233], v[234:235]
    v_pk_add_f32 v[252:253], v[214:215], v[216:217]
    v_pk_add_f32 v[250:251], v[250:251], v[236:237]
    v_pk_add_f32 v[252:253], v[252:253], v[218:219]
    v_pk_add_f32 v[250:251], v[250:251], v[238:239]
    v_pk_add_f32 v[252:253], v[252:253], v[220:221]
    v_pk_add_f32 v[250:251], v[250:251], v[240:241]
    v_pk_add_f32 v[252:253], v[252:253], v[222:223]
    v_pk_add_f32 v[250:251], v[250:251], v[242:243]
    v_pk_add_f32 v[252:253], v[252:253], v[224:225]
    v_pk_add_f32 v[250:251], v[250:251], v[244:245]
    v_pk_add_f32 v[252:253], v[252:253], v[226:227]
    v_pk_add_f32 v[250:251], v[250:251], v[246:247]
    v_pk_add_f32 v[252:253], v[252:253], v[228:229]
    v_pk_add_f32 v[250:251], v[250:251], v[248:249]
    v_pk_add_f32 v[252:253], v[252:253], v[230:231]
    v_add_f32 v250, v250, v251
    v_add_f32 v252, v252, v253
    v_rcp_f32 v250, v250
    v_rcp_f32 v252, v252
    s_nop 0
    v_pk_mul_f32 v[232:233], v[232:233], v[250:251] op_sel_hi:[1,0]
    v_pk_mul_f32 v[214:215], v[214:215], v[252:253] op_sel_hi:[1,0]
    v_pk_mul_f32 v[234:235], v[234:235], v[250:251] op_sel_hi:[1,0]
    v_pk_mul_f32 v[216:217], v[216:217], v[252:253] op_sel_hi:[1,0]
    v_pk_mul_f32 v[236:237], v[236:237], v[250:251] op_sel_hi:[1,0]
    v_pk_mul_f32 v[218:219], v[218:219], v[252:253] op_sel_hi:[1,0]
    v_pk_mul_f32 v[238:239], v[238:239], v[250:251] op_sel_hi:[1,0]
    v_pk_mul_f32 v[220:221], v[220:221], v[252:253] op_sel_hi:[1,0]
    v_pk_mul_f32 v[240:241], v[240:241], v[250:251] op_sel_hi:[1,0]
    v_pk_mul_f32 v[222:223], v[222:223], v[252:253] op_sel_hi:[1,0]
    v_pk_mul_f32 v[242:243], v[242:243], v[250:251] op_sel_hi:[1,0]
    v_pk_mul_f32 v[224:225], v[224:225], v[252:253] op_sel_hi:[1,0]
    v_pk_mul_f32 v[244:245], v[244:245], v[250:251] op_sel_hi:[1,0]
    v_pk_mul_f32 v[226:227], v[226:227], v[252:253] op_sel_hi:[1,0]
    v_pk_mul_f32 v[246:247], v[246:247], v[250:251] op_sel_hi:[1,0]
    v_pk_mul_f32 v[228:229], v[228:229], v[252:253] op_sel_hi:[1,0]
    v_pk_mul_f32 v[248:249], v[248:249], v[250:251] op_sel_hi:[1,0]
    v_pk_mul_f32 v[230:231], v[230:231], v[252:253] op_sel_hi:[1,0]
    v_cvt_pk_bf16_f32 v64, v214, v215
    v_cvt_pk_bf16_f32 v65, v216, v217
    v_cvt_pk_bf16_f32 v66, v218, v219
    v_cvt_pk_bf16_f32 v67, v220, v221
    v_cvt_pk_bf16_f32 v68, v222, v223
    v_cvt_pk_bf16_f32 v69, v224, v225
    v_cvt_pk_bf16_f32 v70, v226, v227
    v_cvt_pk_bf16_f32 v71, v228, v229
    v_cvt_pk_bf16_f32 v72, v230, v231
    v_cvt_pk_bf16_f32 v73, v232, v233
    v_cvt_pk_bf16_f32 v74, v234, v235
    v_cvt_pk_bf16_f32 v75, v236, v237
    v_cvt_pk_bf16_f32 v76, v238, v239
    v_cvt_pk_bf16_f32 v77, v240, v241
    v_cvt_pk_bf16_f32 v78, v242, v243
    v_cvt_pk_bf16_f32 v79, v244, v245
    v_cvt_pk_bf16_f32 v83, v246, v247
    v_cvt_pk_bf16_f32 v87, v248, v249
    v_permlane32_swap_b32 v64, v68
    v_permlane32_swap_b32 v65, v69
    v_permlane32_swap_b32 v66, v70
    v_permlane32_swap_b32 v67, v71
    v_permlane32_swap_b32 v72, v76
    v_permlane32_swap_b32 v73, v77
    v_permlane32_swap_b32 v74, v78
    v_permlane32_swap_b32 v75, v79
    v_permlane32_swap_b32 v83, v87
    s_waitcnt vmcnt(0)
    s_barrier
    ds_read_b128 a[168:171], v5 offset:0
    ds_read_b128 a[172:175], v5 offset:1024
    ds_read_b32 a176, v3 offset:0
    ds_read_b128 a[180:183], v5 offset:2048
    ds_read_b128 a[184:187], v5 offset:3072
    ds_read_b32 a189, v3 offset:512
    ds_read_b128 a[192:195], v5 offset:4096
    ds_read_b128 a[196:199], v5 offset:5120
    ds_read_b32 a202, v3 offset:1024
    ds_read_b128 a[204:207], v5 offset:6144
    ds_read_b128 a[208:211], v5 offset:7168
    ds_read_b32 a215, v3 offset:1536
    ds_read_b128 a[216:219], v5 offset:8192
    ds_read_b128 a[220:223], v5 offset:9216
    ds_read_b32 a224, v3 offset:2048
    ds_read_b128 a[0:3], v5 offset:10240
    ds_read_b128 a[4:7], v5 offset:11264
    ds_read_b32 a9, v3 offset:2560
    ds_read_b128 a[12:15], v5 offset:12288
    ds_read_b128 a[16:19], v5 offset:13312
    ds_read_b32 a22, v3 offset:3072
    ds_read_b128 a[24:27], v5 offset:14336
    ds_read_b128 a[28:31], v5 offset:15360
    ds_read_b32 a35, v3 offset:3584
    s_mul_i32 s50, s43, 9216
    s_add_u32 s50, s50, s44
    s_add_u32 s50, s50, 28311552
    s_waitcnt lgkmcnt(15)
    v_mfma_f32_32x32x16_bf16 v[160:175], a[168:171], v[16:19], 0
    v_mfma_f32_32x32x16_bf16 v[160:175], a[172:175], v[24:27], v[160:175]
    v_mfma_f32_32x32x16_bf16 v[160:175], a[176:179], v[80:83], v[160:175]
    v_mfma_f32_32x32x16_bf16 v[176:191], a[180:183], v[32:35], 0
    v_mfma_f32_32x32x16_bf16 v[176:191], a[184:187], v[40:43], v[176:191]
    v_mfma_f32_32x32x16_bf16 v[176:191], a[188:191], v[80:83], v[176:191]
    v_mfma_f32_32x32x16_bf16 v[192:207], a[192:195], v[48:51], 0
    s_nop 7
    v_add_f32 v170, 0x35c1a2a0, v169
    v_rcp_f32 v170, v170
    s_nop 0
    v_mul_f32 v170, 0x3f317218, v170
    v_mul_f32 v160, v160, v170
    v_mul_f32 v161, v161, v170
    v_mfma_f32_32x32x16_bf16 v[192:207], a[196:199], v[56:59], v[192:207]
    v_mul_f32 v162, v162, v170
    v_mul_f32 v163, v163, v170
    v_mul_f32 v164, v164, v170
    v_mul_f32 v165, v165, v170
    v_mul_f32 v166, v166, v170
    v_mul_f32 v167, v167, v170
    v_mfma_f32_32x32x16_bf16 v[192:207], a[200:203], v[80:83], v[192:207]
    v_mul_f32 v168, v168, v170
    v_cvt_pk_bf16_f32 v136, v160, v161
    v_cvt_pk_bf16_f32 v137, v162, v163
    v_cvt_pk_bf16_f32 v138, v164, v165
    v_cvt_pk_bf16_f32 v139, v166, v167
    buffer_store_dwordx4 v[136:139], v14, s[20:23], s50 offen offset:0 sc1
    s_waitcnt lgkmcnt(12)
    v_mfma_f32_32x32x16_bf16 v[208:223], a[204:207], v[64:67], 0
    v_add_f32 v186, 0x35c1a2a0, v185
    v_rcp_f32 v186, v186
    s_nop 0
    v_mul_f32 v186, 0x3f317218, v186
    v_mul_f32 v176, v176, v186
    v_mul_f32 v177, v177, v186
    v_mfma_f32_32x32x16_bf16 v[208:223], a[208:211], v[72:75], v[208:223]
    v_mul_f32 v178, v178, v186
    v_mul_f32 v179, v179, v186
    v_mul_f32 v180, v180, v186
    v_mul_f32 v181, v181, v186
    v_mul_f32 v182, v182, v186
    v_mul_f32 v183, v183, v186
    v_mfma_f32_32x32x16_bf16 v[208:223], a[212:215], v[80:83], v[208:223]
    v_mul_f32 v184, v184, v186
    v_cvt_pk_bf16_f32 v140, v168, v176
    v_cvt_pk_bf16_f32 v141, v177, v178
    v_cvt_pk_bf16_f32 v142, v179, v180
    v_cvt_pk_bf16_f32 v143, v181, v182
    buffer_store_dwordx4 v[140:143], v14, s[20:23], s50 offen offset:1024 sc1
    s_waitcnt lgkmcnt(9)
    v_mfma_f32_32x32x16_bf16 v[224:239], a[216:219], v[20:23], 0
    v_add_f32 v202, 0x35c1a2a0, v201
    v_rcp_f32 v202, v202
    s_nop 0
    v_mul_f32 v202, 0x3f317218, v202
    v_mul_f32 v192, v192, v202
    v_mul_f32 v193, v193, v202
    v_mfma_f32_32x32x16_bf16 v[224:239], a[220:223], v[28:31], v[224:239]
    v_mul_f32 v194, v194, v202
    v_mul_f32 v195, v195, v202
    v_mul_f32 v196, v196, v202
    v_mul_f32 v197, v197, v202
    v_mul_f32 v198, v198, v202
    v_mul_f32 v199, v199, v202
    v_mfma_f32_32x32x16_bf16 v[224:239], a[224:227], v[84:87], v[224:239]
    v_mul_f32 v200, v200, v202
    v_cvt_pk_bf16_f32 v144, v183, v184
    v_cvt_pk_bf16_f32 v145, v192, v193
    v_cvt_pk_bf16_f32 v146, v194, v195
    v_cvt_pk_bf16_f32 v147, v196, v197
    buffer_store_dwordx4 v[144:147], v14, s[20:23], s50 offen offset:2048 sc1
    s_waitcnt lgkmcnt(6)
    v_mfma_f32_32x32x16_bf16 v[88:103], a[0:3], v[36:39], 0
    v_add_f32 v218, 0x35c1a2a0, v217
    v_rcp_f32 v218, v218
    s_nop 0
    v_mul_f32 v218, 0x3f317218, v218
    v_mul_f32 v208, v208, v218
    v_mul_f32 v209, v209, v218
    v_mfma_f32_32x32x16_bf16 v[88:103], a[4:7], v[44:47], v[88:103]
    v_mul_f32 v210, v210, v218
    v_mul_f32 v211, v211, v218
    v_mul_f32 v212, v212, v218
    v_mul_f32 v213, v213, v218
    v_mul_f32 v214, v214, v218
    v_mul_f32 v215, v215, v218
    v_mfma_f32_32x32x16_bf16 v[88:103], a[8:11], v[84:87], v[88:103]
    v_mul_f32 v216, v216, v218
    v_cvt_pk_bf16_f32 v148, v198, v199
    v_cvt_pk_bf16_f32 v149, v200, v208
    v_cvt_pk_bf16_f32 v150, v209, v210
    v_cvt_pk_bf16_f32 v151, v211, v212
    buffer_store_dwordx4 v[148:151], v14, s[20:23], s50 offen offset:3072 sc1
    s_waitcnt lgkmcnt(3)
    v_mfma_f32_32x32x16_bf16 v[104:119], a[12:15], v[52:55], 0
    v_add_f32 v234, 0x35c1a2a0, v233
    v_rcp_f32 v234, v234
    s_nop 0
    v_mul_f32 v234, 0x3f317218, v234
    v_mul_f32 v224, v224, v234
    v_mul_f32 v225, v225, v234
    v_mfma_f32_32x32x16_bf16 v[104:119], a[16:19], v[60:63], v[104:119]
    v_mul_f32 v226, v226, v234
    v_mul_f32 v227, v227, v234
    v_mul_f32 v228, v228, v234
    v_mul_f32 v229, v229, v234
    v_mul_f32 v230, v230, v234
    v_mul_f32 v231, v231, v234
    v_mfma_f32_32x32x16_bf16 v[104:119], a[20:23], v[84:87], v[104:119]
    v_mul_f32 v232, v232, v234
    v_cvt_pk_bf16_f32 v152, v213, v214
    v_cvt_pk_bf16_f32 v153, v215, v216
    v_cvt_pk_bf16_f32 v154, v224, v225
    v_cvt_pk_bf16_f32 v155, v226, v227
    s_add_u32 s50, s50, 4096
    s_waitcnt lgkmcnt(0)
    v_mfma_f32_32x32x16_bf16 v[120:135], a[24:27], v[68:71], 0
    buffer_store_dwordx4 v[152:155], v14, s[20:23], s50 offen offset:0 sc1
    v_add_f32 v98, 0x35c1a2a0, v97
    v_rcp_f32 v98, v98
    s_nop 0
    v_mul_f32 v98, 0x3f317218, v98
    v_mul_f32 v88, v88, v98
    v_mfma_f32_32x32x16_bf16 v[120:135], a[28:31], v[76:79], v[120:135]
    v_mul_f32 v89, v89, v98
    v_mul_f32 v90, v90, v98
    v_mul_f32 v91, v91, v98
    v_mul_f32 v92, v92, v98
    v_mul_f32 v93, v93, v98
    v_mul_f32 v94, v94, v98
    v_mfma_f32_32x32x16_bf16 v[120:135], a[32:35], v[84:87], v[120:135]
    v_mul_f32 v95, v95, v98
    v_mul_f32 v96, v96, v98
    v_cvt_pk_bf16_f32 v156, v228, v229
    v_cvt_pk_bf16_f32 v157, v230, v231
    v_cvt_pk_bf16_f32 v158, v232, v88
    v_cvt_pk_bf16_f32 v159, v89, v90
    buffer_store_dwordx4 v[156:159], v14, s[20:23], s50 offen offset:1024 sc1
    v_add_f32 v114, 0x35c1a2a0, v113
    v_rcp_f32 v114, v114
    s_nop 0
    v_mul_f32 v114, 0x3f317218, v114
    v_mul_f32 v104, v104, v114
    v_mul_f32 v105, v105, v114
    v_mul_f32 v106, v106, v114
    v_mul_f32 v107, v107, v114
    v_mul_f32 v108, v108, v114
    v_mul_f32 v109, v109, v114
    v_mul_f32 v110, v110, v114
    v_mul_f32 v111, v111, v114
    v_mul_f32 v112, v112, v114
    v_cvt_pk_bf16_f32 v240, v91, v92
    v_cvt_pk_bf16_f32 v241, v93, v94
    v_cvt_pk_bf16_f32 v242, v95, v96
    v_cvt_pk_bf16_f32 v243, v104, v105
    buffer_store_dwordx4 v[240:243], v14, s[20:23], s50 offen offset:2048 sc1
    v_add_f32 v130, 0x35c1a2a0, v129
    v_rcp_f32 v130, v130
    s_nop 0
    v_mul_f32 v130, 0x3f317218, v130
    v_mul_f32 v120, v120, v130
    v_mul_f32 v121, v121, v130
    v_mul_f32 v122, v122, v130
    v_mul_f32 v123, v123, v130
    v_mul_f32 v124, v124, v130
    v_mul_f32 v125, v125, v130
    v_mul_f32 v126, v126, v130
    v_mul_f32 v127, v127, v130
    v_mul_f32 v128, v128, v130
    v_cvt_pk_bf16_f32 v244, v106, v107
    v_cvt_pk_bf16_f32 v245, v108, v109
    v_cvt_pk_bf16_f32 v246, v110, v111
    v_cvt_pk_bf16_f32 v247, v112, v120
    buffer_store_dwordx4 v[244:247], v14, s[20:23], s50 offen offset:3072 sc1
    v_cvt_pk_bf16_f32 v248, v121, v122
    v_cvt_pk_bf16_f32 v249, v123, v124
    v_cvt_pk_bf16_f32 v250, v125, v126
    v_cvt_pk_bf16_f32 v251, v127, v128
    s_add_u32 s50, s50, 4096
    buffer_store_dwordx4 v[248:251], v14, s[20:23], s50 offen offset:0 sc1
    s_waitcnt vmcnt(0) lgkmcnt(0)
    buffer_store_dword v6, v7, s[20:23], s62 offen sc1
    s_endpgm
L_sp0:
    s_sleep 1
    buffer_load_dword v239, v241, s[36:39], s99 offen sc1
    s_waitcnt vmcnt(0)
    v_readfirstlane_b32 s51, v239
    s_nop 1
    s_cmp_ge_u32 s51, 1
    s_cbranch_scc0 L_sp0
    s_branch L_ok0
L_sp1:
    s_sleep 1
    buffer_load_dword v238, v236, s[20:23], s97 offen sc1
    s_waitcnt vmcnt(0)
    v_cmp_ge_u32 vcc, v238, v237
    s_nop 1
    s_and_b32 s50, vcc_lo, s96
    s_cmp_eq_u32 s50, s96
    s_cbranch_scc0 L_sp1
    s_branch L_ok1
L_sp2:
    s_sleep 1
    buffer_load_dword v238, v236, s[20:23], s97 offen sc1
    s_waitcnt vmcnt(0)
    v_cmp_ge_u32 vcc, v238, v237
    s_nop 1
    s_and_b32 s50, vcc_lo, s78
    s_cmp_eq_u32 s50, s78
    s_cbranch_scc0 L_sp2
    s_branch L_ok2
L_sp3:
    s_sleep 1
    buffer_load_dword v238, v236, s[20:23], s97 offen sc1
    s_waitcnt vmcnt(0)
    v_cmp_ge_u32 vcc, v238, v237
    s_nop 1
    s_and_b32 s50, vcc_lo, 61440
    s_cmp_eq_u32 s50, 61440
    s_cbranch_scc0 L_sp3
    s_branch L_ok3
L_sp4:
    s_sleep 1
    buffer_load_dword v238, v236, s[20:23], s97 offen sc1
    s_waitcnt vmcnt(0)
    v_cmp_ge_u32 vcc, v238, v237
    s_nop 1
    s_and_b32 s50, vcc_lo, s79
    s_cmp_eq_u32 s50, s79
    s_cbranch_scc0 L_sp4
    s_branch L_ok4
L_sp5:
    s_sleep 2
    buffer_load_dword v249, v248, s[36:39], 0 offen sc1
    s_waitcnt vmcnt(0)
    v_cmp_ne_u32 vcc, 0, v249
    s_nop 1
    s_cmp_eq_u64 vcc, -1
    s_cbranch_scc0 L_sp5
    s_branch L_ok5
L_sp6:
    s_sleep 2
    buffer_load_dword v243, v241, s[20:23], s75 offen sc1
    s_waitcnt vmcnt(0)
    v_cmp_ne_u32 vcc, 0, v243
    s_nop 1
    s_cmp_eq_u64 vcc, -1
    s_cbranch_scc0 L_sp6
    s_branch L_ok6
L_sp7:
    s_sleep 2
    buffer_load_dword v4, v2, s[20:23], s95 offen offset:64 sc1
    s_waitcnt vmcnt(0)
    v_cmp_ne_u32 vcc, 0, v4
    s_nop 1
    s_cmp_eq_u64 vcc, -1
    s_cbranch_scc0 L_sp7
    s_branch L_ok7
L_end:
    s_endpgm
.p2align 7
L_tab0:
.long 0x0, 0x11c00, 0x23800, 0x0
.long 0x10, 0x11c10, 0x23810, 0x10
.long 0x20, 0x11c20, 0x23820, 0x20
.long 0x30, 0x11c30, 0x23830, 0x30
.long 0x40, 0x11c40, 0x23840, 0x40
.long 0x50, 0x11c50, 0x23850, 0x50
.long 0x60, 0x11c60, 0x23860, 0x60
.long 0x70, 0x11c70, 0x23870, 0x70
.long 0x2400, 0x14000, 0x25c00, 0x480
.long 0x2410, 0x14010, 0x25c10, 0x490
.long 0x2420, 0x14020, 0x25c20, 0x4a0
.long 0x2430, 0x14030, 0x25c30, 0x4b0
.long 0x2440, 0x14040, 0x25c40, 0x4c0
.long 0x2450, 0x14050, 0x25c50, 0x4d0
.long 0x2460, 0x14060, 0x25c60, 0x4e0
.long 0x2470, 0x14070, 0x25c70, 0x4f0
.long 0x4820, 0x16420, 0x28020, 0x920
.long 0x4830, 0x16430, 0x28030, 0x930
.long 0x4800, 0x16400, 0x28000, 0x900
.long 0x4810, 0x16410, 0x28010, 0x910
.long 0x4860, 0x16460, 0x28060, 0x960
.long 0x4870, 0x16470, 0x28070, 0x970
.long 0x4840, 0x16440, 0x28040, 0x940
.long 0x4850, 0x16450, 0x28050, 0x950
.long 0x6c20, 0x18820, 0x2a420, 0xda0
.long 0x6c30, 0x18830, 0x2a430, 0xdb0
.long 0x6c00, 0x18800, 0x2a400, 0xd80
.long 0x6c10, 0x18810, 0x2a410, 0xd90
.long 0x6c60, 0x18860, 0x2a460, 0xde0
.long 0x6c70, 0x18870, 0x2a470, 0xdf0
.long 0x6c40, 0x18840, 0x2a440, 0xdc0
.long 0x6c50, 0x18850, 0x2a450, 0xdd0
.long 0x9000, 0x1ac00, 0x2c800, 0x1200
.long 0x9010, 0x1ac10, 0x2c810, 0x1210
.long 0x9020, 0x1ac20, 0x2c820, 0x1220
.long 0x9030, 0x1ac30, 0x2c830, 0x1230
.long 0x9040, 0x1ac40, 0x2c840, 0x1240
.long 0x9050, 0x1ac50, 0x2c850, 0x1250
.long 0x9060, 0x1ac60, 0x2c860, 0x1260
.long 0x9070, 0x1ac70, 0x2c870, 0x1270
.long 0xb400, 0x1d000, 0x2ec00, 0x1680
.long 0xb410, 0x1d010, 0x2ec10, 0x1690
.long 0xb420, 0x1d020, 0x2ec20, 0x16a0
.long 0xb430, 0x1d030, 0x2ec30, 0x16b0
.long 0xb440, 0x1d040, 0x2ec40, 0x16c0
.long 0xb450, 0x1d050, 0x2ec50, 0x16d0
.long 0xb460, 0x1d060, 0x2ec60, 0x16e0
.long 0xb470, 0x1d070, 0x2ec70, 0x16f0
.long 0xd820, 0x1f420, 0x31020, 0x1b20
.long 0xd830, 0x1f430, 0x31030, 0x1b30
.long 0xd800, 0x1f400, 0x31000, 0x1b00
.long 0xd810, 0x1f410, 0x31010, 0x1b10
.long 0xd860, 0x1f460, 0x31060, 0x1b60
.long 0xd870, 0x1f470, 0x31070, 0x1b70
.long 0xd840, 0x1f440, 0x31040, 0x1b40
.long 0xd850, 0x1f450, 0x31050, 0x1b50
.long 0xfc20, 0x21820, 0x33420, 0x1fa0
.long 0xfc30, 0x21830, 0x33430, 0x1fb0
.long 0xfc00, 0x21800, 0x33400, 0x1f80
.long 0xfc10, 0x21810, 0x33410, 0x1f90
.long 0xfc60, 0x21860, 0x33460, 0x1fe0
.long 0xfc70, 0x21870, 0x33470, 0x1ff0
.long 0xfc40, 0x21840, 0x33440, 0x1fc0
.long 0xfc50, 0x21850, 0x33450, 0x1fd0
.long 0x2000, 0x4000, 0x0, 0x10000
.long 0x2010, 0x4010, 0x40, 0x10040
.long 0x2020, 0x4020, 0x8, 0x10008
.long 0x2030, 0x4030, 0x48, 0x10048
.long 0x2040, 0x4040, 0x80, 0x10080
.long 0x2050, 0x4050, 0xc0, 0x100c0
.long 0x2060, 0x4060, 0x88, 0x10088
.long 0x2070, 0x4070, 0xc8, 0x100c8
.long 0x2480, 0x4480, 0x120, 0x10120
.long 0x2490, 0x4490, 0x160, 0x10160
.long 0x24a0, 0x44a0, 0x128, 0x10128
.long 0x24b0, 0x44b0, 0x168, 0x10168
.long 0x24c0, 0x44c0, 0x1a0, 0x101a0
.long 0x24d0, 0x44d0, 0x1e0, 0x101e0
.long 0x24e0, 0x44e0, 0x1a8, 0x101a8
.long 0x24f0, 0x44f0, 0x1e8, 0x101e8
.long 0x2920, 0x4920, 0x10, 0x10010
.long 0x2930, 0x4930, 0x50, 0x10050
.long 0x2900, 0x4900, 0x18, 0x10018
.long 0x2910, 0x4910, 0x58, 0x10058
.long 0x2960, 0x4960, 0x90, 0x10090
.long 0x2970, 0x4970, 0xd0, 0x100d0
.long 0x2940, 0x4940, 0x98, 0x10098
.long 0x2950, 0x4950, 0xd8, 0x100d8
.long 0x2da0, 0x4da0, 0x130, 0x10130
.long 0x2db0, 0x4db0, 0x170, 0x10170
.long 0x2d80, 0x4d80, 0x138, 0x10138
.long 0x2d90, 0x4d90, 0x178, 0x10178
.long 0x2de0, 0x4de0, 0x1b0, 0x101b0
.long 0x2df0, 0x4df0, 0x1f0, 0x101f0
.long 0x2dc0, 0x4dc0, 0x1b8, 0x101b8
.long 0x2dd0, 0x4dd0, 0x1f8, 0x101f8
.long 0x3200, 0x5200, 0x1000, 0x11000
.long 0x3210, 0x5210, 0x1040, 0x11040
.long 0x3220, 0x5220, 0x1008, 0x11008
.long 0x3230, 0x5230, 0x1048, 0x11048
.long 0x3240, 0x5240, 0x1080, 0x11080
.long 0x3250, 0x5250, 0x10c0, 0x110c0
.long 0x3260, 0x5260, 0x1088, 0x11088
.long 0x3270, 0x5270, 0x10c8, 0x110c8
.long 0x3680, 0x5680, 0x1120, 0x11120
.long 0x3690, 0x5690, 0x1160, 0x11160
.long 0x36a0, 0x56a0, 0x1128, 0x11128
.long 0x36b0, 0x56b0, 0x1168, 0x11168
.long 0x36c0, 0x56c0, 0x11a0, 0x111a0
.long 0x36d0, 0x56d0, 0x11e0, 0x111e0
.long 0x36e0, 0x56e0, 0x11a8, 0x111a8
.long 0x36f0, 0x56f0, 0x11e8, 0x111e8
.long 0x3b20, 0x5b20, 0x1010, 0x11010
.long 0x3b30, 0x5b30, 0x1050, 0x11050
.long 0x3b00, 0x5b00, 0x1018, 0x11018
.long 0x3b10, 0x5b10, 0x1058, 0x11058
.long 0x3b60, 0x5b60, 0x1090, 0x11090
.long 0x3b70, 0x5b70, 0x10d0, 0x110d0
.long 0x3b40, 0x5b40, 0x1098, 0x11098
.long 0x3b50, 0x5b50, 0x10d8, 0x110d8
.long 0x3fa0, 0x5fa0, 0x1130, 0x11130
.long 0x3fb0, 0x5fb0, 0x1170, 0x11170
.long 0x3f80, 0x5f80, 0x1138, 0x11138
.long 0x3f90, 0x5f90, 0x1178, 0x11178
.long 0x3fe0, 0x5fe0, 0x11b0, 0x111b0
.long 0x3ff0, 0x5ff0, 0x11f0, 0x111f0
.long 0x3fc0, 0x5fc0, 0x11b8, 0x111b8
.long 0x3fd0, 0x5fd0, 0x11f8, 0x111f8
.long 0x20000, 0x20, 0x10020, 0x20020
.long 0x20040, 0x60, 0x10060, 0x20060
.long 0x20008, 0x28, 0x10028, 0x20028
.long 0x20048, 0x68, 0x10068, 0x20068
.long 0x20080, 0xa0, 0x100a0, 0x200a0
.long 0x200c0, 0xe0, 0x100e0, 0x200e0
.long 0x20088, 0xa8, 0x100a8, 0x200a8
.long 0x200c8, 0xe8, 0x100e8, 0x200e8
.long 0x20120, 0x100, 0x10100, 0x20100
.long 0x20160, 0x140, 0x10140, 0x20140
.long 0x20128, 0x108, 0x10108, 0x20108
.long 0x20168, 0x148, 0x10148, 0x20148
.long 0x201a0, 0x180, 0x10180, 0x20180
.long 0x201e0, 0x1c0, 0x101c0, 0x201c0
.long 0x201a8, 0x188, 0x10188, 0x20188
.long 0x201e8, 0x1c8, 0x101c8, 0x201c8
.long 0x20010, 0x30, 0x10030, 0x20030
.long 0x20050, 0x70, 0x10070, 0x20070
.long 0x20018, 0x38, 0x10038, 0x20038
.long 0x20058, 0x78, 0x10078, 0x20078
.long 0x20090, 0xb0, 0x100b0, 0x200b0
.long 0x200d0, 0xf0, 0x100f0, 0x200f0
.long 0x20098, 0xb8, 0x100b8, 0x200b8
.long 0x200d8, 0xf8, 0x100f8, 0x200f8
.long 0x20130, 0x110, 0x10110, 0x20110
.long 0x20170, 0x150, 0x10150, 0x20150
.long 0x20138, 0x118, 0x10118, 0x20118
.long 0x20178, 0x158, 0x10158, 0x20158
.long 0x201b0, 0x190, 0x10190, 0x20190
.long 0x201f0, 0x1d0, 0x101d0, 0x201d0
.long 0x201b8, 0x198, 0x10198, 0x20198
.long 0x201f8, 0x1d8, 0x101d8, 0x201d8
.long 0x21000, 0x1020, 0x11020, 0x21020
.long 0x21040, 0x1060, 0x11060, 0x21060
.long 0x21008, 0x1028, 0x11028, 0x21028
.long 0x21048, 0x1068, 0x11068, 0x21068
.long 0x21080, 0x10a0, 0x110a0, 0x210a0
.long 0x210c0, 0x10e0, 0x110e0, 0x210e0
.long 0x21088, 0x10a8, 0x110a8, 0x210a8
.long 0x210c8, 0x10e8, 0x110e8, 0x210e8
.long 0x21120, 0x1100, 0x11100, 0x21100
.long 0x21160, 0x1140, 0x11140, 0x21140
.long 0x21128, 0x1108, 0x11108, 0x21108
.long 0x21168, 0x1148, 0x11148, 0x21148
.long 0x211a0, 0x1180, 0x11180, 0x21180
.long 0x211e0, 0x11c0, 0x111c0, 0x211c0
.long 0x211a8, 0x1188, 0x11188, 0x21188
.long 0x211e8, 0x11c8, 0x111c8, 0x211c8
.long 0x21010, 0x1030, 0x11030, 0x21030
.long 0x21050, 0x1070, 0x11070, 0x21070
.long 0x21018, 0x1038, 0x11038, 0x21038
.long 0x21058, 0x1078, 0x11078, 0x21078
.long 0x21090, 0x10b0, 0x110b0, 0x210b0
.long 0x210d0, 0x10f0, 0x110f0, 0x210f0
.long 0x21098, 0x10b8, 0x110b8, 0x210b8
.long 0x210d8, 0x10f8, 0x110f8, 0x210f8
.long 0x21130, 0x1110, 0x11110, 0x21110
.long 0x21170, 0x1150, 0x11150, 0x21150
.long 0x21138, 0x1118, 0x11118, 0x21118
.long 0x21178, 0x1158, 0x11158, 0x21158
.long 0x211b0, 0x1190, 0x11190, 0x21190
.long 0x211f0, 0x11d0, 0x111d0, 0x211d0
.long 0x211b8, 0x1198, 0x11198, 0x21198
.long 0x211f8, 0x11d8, 0x111d8, 0x211d8
.long 0x0, 0x10000, 0x20000, 0x20
.long 0x40, 0x10040, 0x20040, 0x60
.long 0x8, 0x10008, 0x20008, 0x28
.long 0x48, 0x10048, 0x20048, 0x68
.long 0x80, 0x10080, 0x20080, 0xa0
.long 0xc0, 0x100c0, 0x200c0, 0xe0
.long 0x88, 0x10088, 0x20088, 0xa8
.long 0xc8, 0x100c8, 0x200c8, 0xe8
.long 0x120, 0x10120, 0x20120, 0x100
.long 0x160, 0x10160, 0x20160, 0x140
.long 0x128, 0x10128, 0x20128, 0x108
.long 0x168, 0x10168, 0x20168, 0x148
.long 0x1a0, 0x101a0, 0x201a0, 0x180
.long 0x1e0, 0x101e0, 0x201e0, 0x1c0
.long 0x1a8, 0x101a8, 0x201a8, 0x188
.long 0x1e8, 0x101e8, 0x201e8, 0x1c8
.long 0x10, 0x10010, 0x20010, 0x30
.long 0x50, 0x10050, 0x20050, 0x70
.long 0x18, 0x10018, 0x20018, 0x38
.long 0x58, 0x10058, 0x20058, 0x78
.long 0x90, 0x10090, 0x20090, 0xb0
.long 0xd0, 0x100d0, 0x200d0, 0xf0
.long 0x98, 0x10098, 0x20098, 0xb8
.long 0xd8, 0x100d8, 0x200d8, 0xf8
.long 0x130, 0x10130, 0x20130, 0x110
.long 0x170, 0x10170, 0x20170, 0x150
.long 0x138, 0x10138, 0x20138, 0x118
.long 0x178, 0x10178, 0x20178, 0x158
.long 0x1b0, 0x101b0, 0x201b0, 0x190
.long 0x1f0, 0x101f0, 0x201f0, 0x1d0
.long 0x1b8, 0x101b8, 0x201b8, 0x198
.long 0x1f8, 0x101f8, 0x201f8, 0x1d8
.long 0x2400, 0x12400, 0x22400, 0x2420
.long 0x2440, 0x12440, 0x22440, 0x2460
.long 0x2408, 0x12408, 0x22408, 0x2428
.long 0x2448, 0x12448, 0x22448, 0x2468
.long 0x2480, 0x12480, 0x22480, 0x24a0
.long 0x24c0, 0x124c0, 0x224c0, 0x24e0
.long 0x2488, 0x12488, 0x22488, 0x24a8
.long 0x24c8, 0x124c8, 0x224c8, 0x24e8
.long 0x2520, 0x12520, 0x22520, 0x2500
.long 0x2560, 0x12560, 0x22560, 0x2540
.long 0x2528, 0x12528, 0x22528, 0x2508
.long 0x2568, 0x12568, 0x22568, 0x2548
.long 0x25a0, 0x125a0, 0x225a0, 0x2580
.long 0x25e0, 0x125e0, 0x225e0, 0x25c0
.long 0x25a8, 0x125a8, 0x225a8, 0x2588
.long 0x25e8, 0x125e8, 0x225e8, 0x25c8
.long 0x2410, 0x12410, 0x22410, 0x2430
.long 0x2450, 0x12450, 0x22450, 0x2470
.long 0x2418, 0x12418, 0x22418, 0x2438
.long 0x2458, 0x12458, 0x22458, 0x2478
.long 0x2490, 0x12490, 0x22490, 0x24b0
.long 0x24d0, 0x124d0, 0x224d0, 0x24f0
.long 0x2498, 0x12498, 0x22498, 0x24b8
.long 0x24d8, 0x124d8, 0x224d8, 0x24f8
.long 0x2530, 0x12530, 0x22530, 0x2510
.long 0x2570, 0x12570, 0x22570, 0x2550
.long 0x2538, 0x12538, 0x22538, 0x2518
.long 0x2578, 0x12578, 0x22578, 0x2558
.long 0x25b0, 0x125b0, 0x225b0, 0x2590
.long 0x25f0, 0x125f0, 0x225f0, 0x25d0
.long 0x25b8, 0x125b8, 0x225b8, 0x2598
.long 0x25f8, 0x125f8, 0x225f8, 0x25d8
.long 0x10020, 0x20020, 0x0, 0x0
.long 0x10060, 0x20060, 0x480, 0x80
.long 0x10028, 0x20028, 0x900, 0x100
.long 0x10068, 0x20068, 0xd80, 0x180
.long 0x100a0, 0x200a0, 0x1200, 0x200
.long 0x100e0, 0x200e0, 0x1680, 0x280
.long 0x100a8, 0x200a8, 0x1b00, 0x300
.long 0x100e8, 0x200e8, 0x1f80, 0x380
.long 0x10100, 0x20100, 0x2400, 0x400
.long 0x10140, 0x20140, 0x2880, 0x480
.long 0x10108, 0x20108, 0x2d00, 0x500
.long 0x10148, 0x20148, 0x3180, 0x580
.long 0x10180, 0x20180, 0x3600, 0x600
.long 0x101c0, 0x201c0, 0x3a80, 0x680
.long 0x10188, 0x20188, 0x3f00, 0x700
.long 0x101c8, 0x201c8, 0x4380, 0x780
.long 0x10030, 0x20030, 0x4800, 0x780
.long 0x10070, 0x20070, 0x4c80, 0x780
.long 0x10038, 0x20038, 0x5100, 0x780
.long 0x10078, 0x20078, 0x5580, 0x780
.long 0x100b0, 0x200b0, 0x5a00, 0x780
.long 0x100f0, 0x200f0, 0x5e80, 0x780
.long 0x100b8, 0x200b8, 0x6300, 0x780
.long 0x100f8, 0x200f8, 0x6780, 0x780
.long 0x10110, 0x20110, 0x6c00, 0x780
.long 0x10150, 0x20150, 0x7080, 0x780
.long 0x10118, 0x20118, 0x7500, 0x780
.long 0x10158, 0x20158, 0x7980, 0x780
.long 0x10190, 0x20190, 0x7e00, 0x780
.long 0x101d0, 0x201d0, 0x8280, 0x780
.long 0x10198, 0x20198, 0x8700, 0x780
.long 0x101d8, 0x201d8, 0x8b80, 0x780
.long 0x12420, 0x22420, 0x40, 0x780
.long 0x12460, 0x22460, 0x4c0, 0x780
.long 0x12428, 0x22428, 0x940, 0x780
.long 0x12468, 0x22468, 0xdc0, 0x780
.long 0x124a0, 0x224a0, 0x1240, 0x780
.long 0x124e0, 0x224e0, 0x16c0, 0x780
.long 0x124a8, 0x224a8, 0x1b40, 0x780
.long 0x124e8, 0x224e8, 0x1fc0, 0x780
.long 0x12500, 0x22500, 0x2440, 0x780
.long 0x12540, 0x22540, 0x28c0, 0x780
.long 0x12508, 0x22508, 0x2d40, 0x780
.long 0x12548, 0x22548, 0x31c0, 0x780
.long 0x12580, 0x22580, 0x3640, 0x780
.long 0x125c0, 0x225c0, 0x3ac0, 0x780
.long 0x12588, 0x22588, 0x3f40, 0x780
.long 0x125c8, 0x225c8, 0x43c0, 0x780
.long 0x12430, 0x22430, 0x4840, 0x780
.long 0x12470, 0x22470, 0x4cc0, 0x780
.long 0x12438, 0x22438, 0x5140, 0x780
.long 0x12478, 0x22478, 0x55c0, 0x780
.long 0x124b0, 0x224b0, 0x5a40, 0x780
.long 0x124f0, 0x224f0, 0x5ec0, 0x780
.long 0x124b8, 0x224b8, 0x6340, 0x780
.long 0x124f8, 0x224f8, 0x67c0, 0x780
.long 0x12510, 0x22510, 0x6c40, 0x780
.long 0x12550, 0x22550, 0x70c0, 0x780
.long 0x12518, 0x22518, 0x7540, 0x780
.long 0x12558, 0x22558, 0x79c0, 0x780
.long 0x12590, 0x22590, 0x7e40, 0x780
.long 0x125d0, 0x225d0, 0x82c0, 0x780
.long 0x12598, 0x22598, 0x8740, 0x780
.long 0x125d8, 0x225d8, 0x8bc0, 0x780
.long 0x3f80, 0x0, 0x0, 0x0
.long 0x3f800000, 0x0, 0x0, 0x0
.long 0x0, 0x3f80, 0x0, 0x0
.long 0x0, 0x3f800000, 0x0, 0x0
.long 0x0, 0x0, 0x0, 0x0
.long 0x0, 0x0, 0x0, 0x0
.long 0x0, 0x0, 0x0, 0x0
.long 0x0, 0x0, 0x0, 0x0
.long 0x0, 0x0, 0x3f80, 0x0
.long 0x0, 0x0, 0x3f800000, 0x0
.long 0x0, 0x0, 0x0, 0x3f80
.long 0x0, 0x0, 0x0, 0x3f800000
.long 0x0, 0x0, 0x0, 0x0
.long 0x0, 0x0, 0x0, 0x0
.long 0x0, 0x0, 0x0, 0x0
.long 0x0, 0x0, 0x0, 0x0
.long 0x0, 0x0, 0x0, 0x0
.long 0x0, 0x0, 0x0, 0x0
.long 0x0, 0x0, 0x0, 0x0
.long 0x0, 0x0, 0x0, 0x0
.long 0x0, 0x0, 0x0, 0x0
.long 0x0, 0x0, 0x0, 0x0
.long 0x0, 0x0, 0x0, 0x0
.long 0x0, 0x0, 0x0, 0x0
.long 0x0, 0x0, 0x0, 0x0
.long 0x0, 0x0, 0x0, 0x0
.long 0x0, 0x0, 0x0, 0x0
.long 0x0, 0x0, 0x0, 0x0
.long 0x0, 0x0, 0x0, 0x0
.long 0x0, 0x0, 0x0, 0x0
.long 0x0, 0x0, 0x0, 0x0
.long 0x0, 0x0, 0x0, 0x0
.long 0x0, 0x0, 0x0, 0x0
.long 0x0, 0x0, 0x0, 0x0
.long 0x0, 0x0, 0x0, 0x0
.long 0x0, 0x0, 0x0, 0x0
.long 0x3f80, 0x0, 0x0, 0x0
.long 0x3f800000, 0x0, 0x0, 0x0
.long 0x0, 0x3f80, 0x0, 0x0
.long 0x0, 0x3f800000, 0x0, 0x0
.long 0x0, 0x0, 0x0, 0x0
.long 0x0, 0x0, 0x0, 0x0
.long 0x0, 0x0, 0x0, 0x0
.long 0x0, 0x0, 0x0, 0x0
.long 0x0, 0x0, 0x3f80, 0x0
.long 0x0, 0x0, 0x3f800000, 0x0
.long 0x0, 0x0, 0x0, 0x3f80
.long 0x0, 0x0, 0x0, 0x3f800000
.long 0x0, 0x0, 0x0, 0x0
.long 0x0, 0x0, 0x0, 0x0
.long 0x0, 0x0, 0x0, 0x0
.long 0x0, 0x0, 0x0, 0x0
.long 0x0, 0x0, 0x0, 0x0
.long 0x0, 0x0, 0x0, 0x0
.long 0x0, 0x0, 0x0, 0x0
.long 0x0, 0x0, 0x0, 0x0
.long 0x0, 0x0, 0x0, 0x0
.long 0x0, 0x0, 0x0, 0x0
.long 0x0, 0x0, 0x0, 0x0
.long 0x0, 0x0, 0x0, 0x0
.long 0x0, 0x0, 0x0, 0x0
.long 0x0, 0x0, 0x0, 0x0
.long 0x0, 0x0, 0x0, 0x0
.long 0x0, 0x0, 0x0, 0x0
.long 0x0, 0x0, 0x0, 0x0
.long 0x0, 0x0, 0x0, 0x0
.long 0x0, 0x0, 0x0, 0x0
.long 0x0, 0x0, 0x0, 0x0
.long 0x0, 0x0, 0x0, 0x0
.long 0x0, 0x0, 0x0, 0x0
.long 0x0, 0x0, 0x0, 0x0
.long 0x0, 0x0, 0x0, 0x0
.long 0x0, 0x0, 0x0, 0x0
.long 0x0, 0x0, 0x0, 0x0
.long 0x0, 0x0, 0x0, 0x0
.long 0x0, 0x0, 0x0, 0x0
.long 0x0, 0x0, 0x0, 0x0
.long 0x0, 0x0, 0x0, 0x0
.long 0x0, 0x0, 0x0, 0x0
.long 0x0, 0x0, 0x0, 0x0
.long 0x3f80, 0x0, 0x0, 0x0
.long 0x3f800000, 0x0, 0x0, 0x0
.long 0x0, 0x3f80, 0x0, 0x0
.long 0x0, 0x3f800000, 0x0, 0x0
.long 0x0, 0x0, 0x0, 0x0
.long 0x0, 0x0, 0x0, 0x0
.long 0x0, 0x0, 0x0, 0x0
.long 0x0, 0x0, 0x0, 0x0
.long 0x0, 0x0, 0x3f80, 0x0
.long 0x0, 0x0, 0x3f800000, 0x0
.long 0x0, 0x0, 0x0, 0x3f80
.long 0x0, 0x0, 0x0, 0x3f800000
.long 0x0, 0x0, 0x0, 0x0
.long 0x0, 0x0, 0x0, 0x0
.long 0x0, 0x0, 0x0, 0x0
.long 0x0, 0x0, 0x0, 0x0
.long 0x0, 0x0, 0x0, 0x0
.long 0x0, 0x0, 0x0, 0x0
.long 0x0, 0x0, 0x0, 0x0
.long 0x0, 0x0, 0x0, 0x0
.long 0x0, 0x0, 0x0, 0x0
.long 0x0, 0x0, 0x0, 0x0
.long 0x0, 0x0, 0x0, 0x0
.long 0x0, 0x0, 0x0, 0x0
.long 0x0, 0x0, 0x0, 0x0
.long 0x0, 0x0, 0x0, 0x0
.long 0x0, 0x0, 0x0, 0x0
.long 0x0, 0x0, 0x0, 0x0
.long 0x0, 0x0, 0x0, 0x0
.long 0x0, 0x0, 0x0, 0x0
.long 0x0, 0x0, 0x0, 0x0
.long 0x0, 0x0, 0x0, 0x0
.long 0x0, 0x0, 0x0, 0x0
.long 0x0, 0x0, 0x0, 0x0
.long 0x0, 0x0, 0x0, 0x0
.long 0x0, 0x0, 0x0, 0x0
.long 0x3f80, 0x0, 0x0, 0x0
.long 0x3f800000, 0x0, 0x0, 0x0
.long 0x0, 0x3f80, 0x0, 0x0
.long 0x0, 0x3f800000, 0x0, 0x0
.long 0x0, 0x0, 0x0, 0x0
.long 0x0, 0x0, 0x0, 0x0
.long 0x0, 0x0, 0x0, 0x0
.long 0x0, 0x0, 0x0, 0x0
.long 0x0, 0x0, 0x3f80, 0x0
.long 0x0, 0x0, 0x3f800000, 0x0
.long 0x0, 0x0, 0x0, 0x3f80
.long 0x0, 0x0, 0x0, 0x3f800000
.long 0x8, 0xf, 0x0, 0x0
.long 0x7, 0xf, 0x0, 0x0
.long 0x6, 0xf, 0x0, 0x0
.long 0x5, 0xf, 0x0, 0x0
.long 0x4, 0xf, 0x0, 0x0
.long 0x3, 0xf, 0x0, 0x0
.long 0x2, 0xf, 0x0, 0x0
.long 0x1, 0xf, 0x0, 0x0
.long 0x0, 0xf, 0x0, 0x0
.long 0x9, 0xf, 0x0, 0x0
.long 0x6, 0xf, 0x0, 0x0
.long 0x3, 0xf, 0x0, 0x0
.long 0x0, 0x0, 0x0, 0x0
.long 0x0, 0x0, 0x0, 0x0
.long 0x0, 0x0, 0x0, 0x0
.long 0x0, 0x0, 0x0, 0x0
.long 0x0, 0x0, 0x0, 0x0
.long 0x0, 0x0, 0x0, 0x0
.long 0x0, 0x0, 0x0, 0x0
.long 0x0, 0x0, 0x0, 0x0
.long 0x0, 0x0, 0x0, 0x0
.long 0x0, 0x0, 0x0, 0x0
.long 0x0, 0x0, 0x0, 0x0
.long 0x0, 0x0, 0x0, 0x0
.long 0x0, 0x0, 0x0, 0x0
.long 0x0, 0x0, 0x0, 0x0
.long 0x0, 0x0, 0x0, 0x0
.long 0x0, 0x0, 0x0, 0x0
.long 0x0, 0x0, 0x0, 0x0
.long 0x0, 0x0, 0x0, 0x0
.long 0x0, 0x0, 0x0, 0x0
.long 0x0, 0x0, 0x0, 0x0
.long 0x0, 0x0, 0x0, 0x0
.long 0x0, 0x0, 0x0, 0x0
.long 0x0, 0x0, 0x0, 0x0
.long 0x0, 0x0, 0x0, 0x0
.long 0x0, 0x0, 0x0, 0x0
.long 0x0, 0x0, 0x0, 0x0
.long 0x0, 0x0, 0x0, 0x0
.long 0x0, 0x0, 0x0, 0x0
.long 0x0, 0x0, 0x0, 0x0
.long 0x0, 0x0, 0x0, 0x0
.long 0x0, 0x0, 0x0, 0x0
.long 0x0, 0x0, 0x0, 0x0
.long 0x0, 0x0, 0x0, 0x0
.long 0x0, 0x0, 0x0, 0x0
.long 0x0, 0x0, 0x0, 0x0
.long 0x0, 0x0, 0x0, 0x0
.long 0x0, 0x0, 0x0, 0x0
.long 0x0, 0x0, 0x0, 0x0
.long 0x0, 0x0, 0x0, 0x0
.long 0x0, 0x0, 0x0, 0x0
.long 0x0, 0x0, 0x0, 0x0
.long 0x0, 0x0, 0x0, 0x0
.long 0x0, 0x0, 0x0, 0x0
.long 0x0, 0x0, 0x0, 0x0
.long 0x0, 0x0, 0x0, 0x0
.long 0x0, 0x0, 0x0, 0x0
.long 0x0, 0x0, 0x0, 0x0
.long 0x0, 0x0, 0x0, 0x0
.long 0x0, 0x0, 0x0, 0x0
.long 0x0, 0x0, 0x0, 0x0
.long 0x0, 0x0, 0x0, 0x0
.long 0x0, 0x0, 0x0, 0x0
.long 0x0, 0x0, 0x0, 0x0
.long 0x0, 0x0, 0x0, 0x0
.long 0x0, 0x0, 0x0, 0x0
.long 0x0, 0x0, 0x0, 0x0
.long 0x0, 0x0, 0x0, 0x0
.long 0x0, 0x0, 0x0, 0x0
.long 0x0, 0x0, 0x0, 0x0
.long 0x0, 0x0, 0x0, 0x0
.long 0x0, 0x0, 0x0, 0x0
.long 0x0, 0x0, 0x0, 0x0
.long 0x0, 0x0, 0x0, 0x0
.long 0x0, 0x0, 0x0, 0x0
.long 0x0, 0x0, 0x0, 0x0
.long 0x0, 0x0, 0x0, 0x0
.long 0x0, 0x0, 0x0, 0x0
.long 0x0, 0x0, 0x0, 0x0
.long 0x0, 0x0, 0x0, 0x0
.long 0x0, 0x0, 0x0, 0x0
.long 0x0, 0x0, 0x0, 0x0
.long 0x0, 0x0, 0x0, 0x0
.long 0x0, 0x0, 0x0, 0x0
.long 0x0, 0x0, 0x0, 0x0
.long 0x0, 0x0, 0x0, 0x0
.long 0x0, 0x0, 0x0, 0x0
.long 0x0, 0x0, 0x0, 0x0
.long 0x0, 0x0, 0x0, 0x0
.long 0x0, 0x0, 0x0, 0x0
.long 0x0, 0x0, 0x0, 0x0
.long 0x0, 0x0, 0x0, 0x0
.long 0x0, 0x0, 0x0, 0x0
.long 0x0, 0x0, 0x0, 0x0
.long 0x0, 0x0, 0x0, 0x0
.long 0x0, 0x0, 0x0, 0x0
.long 0x0, 0x0, 0x0, 0x0
.long 0x0, 0x0, 0x0, 0x0
.long 0x0, 0x0, 0x0, 0x0
.long 0x0, 0x0, 0x0, 0x0
.long 0x0, 0x0, 0x0, 0x0
.long 0x0, 0x0, 0x0, 0x0
.long 0x0, 0x0, 0x0, 0x0
.long 0x0, 0x0, 0x0, 0x0
.long 0x0, 0x0, 0x0, 0x0
.long 0x0, 0x0, 0x0, 0x0
.long 0x0, 0x0, 0x0, 0x0
.long 0x0, 0x0, 0x0, 0x0
.long 0x0, 0x0, 0x0, 0x0
.long 0x0, 0x0, 0x0, 0x0
.long 0x0, 0x0, 0x0, 0x0
.long 0x0, 0x0, 0x0, 0x0
.long 0x0, 0x0, 0x0, 0x0
.long 0x0, 0x0, 0x0, 0x0
.long 0x0, 0x0, 0x0, 0x0
.long 0x0, 0x0, 0x0, 0x0
.long 0x0, 0x0, 0x0, 0x0
.long 0x0, 0x0, 0x0, 0x0
.long 0x0, 0x0, 0x0, 0x0
.long 0x0, 0x0, 0x0, 0x0
.long 0x0, 0x0, 0x0, 0x0
.long 0x0, 0x0, 0x0, 0x0
.long 0x0, 0x0, 0x0, 0x0
.long 0x0, 0x0, 0x0, 0x0
.long 0x0, 0x0, 0x0, 0x0
.long 0x0, 0x0, 0x0, 0x0
.long 0x0, 0x0, 0x0, 0x0
.long 0x0, 0x0, 0x0, 0x0
.long 0x0, 0x0, 0x0, 0x0
.long 0x0, 0x0, 0x0, 0x0
.long 0x0, 0x0, 0x0, 0x0
.long 0x0, 0x0, 0x0, 0x0
.long 0x0, 0x0, 0x0, 0x0
.long 0x0, 0x0, 0x0, 0x0
.long 0x0, 0x0, 0x0, 0x0
.long 0x0, 0x0, 0x0, 0x0
.long 0x0, 0x0, 0x0, 0x0
.long 0x0, 0x0, 0x0, 0x0
.long 0x0, 0x0, 0x0, 0x0
.long 0x0, 0x0, 0x0, 0x0
.long 0x0, 0x0, 0x0, 0x0
.long 0x0, 0x0, 0x0, 0x0
.long 0x0, 0x0, 0x0, 0x0
.long 0x0, 0x0, 0x0, 0x0
.long 0x0, 0x0, 0x0, 0x0
.long 0x0, 0x0, 0x0, 0x0
.long 0x0, 0x0, 0x0, 0x0
.long 0x0, 0x0, 0x0, 0x0
.long 0x0, 0x0, 0x0, 0x0
.long 0x0, 0x0, 0x0, 0x0
.long 0x0, 0x0, 0x0, 0x0
.long 0x0, 0x0, 0x0, 0x0
.long 0x0, 0x0, 0x0, 0x0
.long 0x0, 0x0, 0x0, 0x0
.long 0x0, 0x0, 0x0, 0x0
.long 0x0, 0x0, 0x0, 0x0
.long 0x0, 0x0, 0x0, 0x0
.long 0x0, 0x0, 0x0, 0x0
.long 0x0, 0x0, 0x0, 0x0
.long 0x0, 0x0, 0x0, 0x0
.long 0x0, 0x0, 0x0, 0x0
.long 0x0, 0x0, 0x0, 0x0
.long 0x0, 0x0, 0x0, 0x0
.long 0x0, 0x0, 0x0, 0x0
.long 0x0, 0x0, 0x0, 0x0
.long 0x0, 0x0, 0x0, 0x0
.long 0x0, 0x0, 0x0, 0x0
.long 0x0, 0x0, 0x0, 0x0
.long 0x0, 0x0, 0x0, 0x0
.long 0x0, 0x0, 0x0, 0x0
.long 0x0, 0x0, 0x0, 0x0
.long 0x0, 0x0, 0x0, 0x0
.long 0x0, 0x0, 0x0, 0x0
.long 0x0, 0x0, 0x0, 0x0
.long 0x0, 0x0, 0x0, 0x0
.long 0x0, 0x0, 0x0, 0x0
.long 0x0, 0x0, 0x0, 0x0
.long 0x0, 0x0, 0x0, 0x0
.long 0x0, 0x0, 0x0, 0x0
.long 0x0, 0x0, 0x0, 0x0
.long 0x0, 0x0, 0x0, 0x0
.long 0x0, 0x0, 0x0, 0x0
.long 0x0, 0x0, 0x0, 0x0
.long 0x0, 0x0, 0x0, 0x0
.long 0x0, 0x0, 0x0, 0x0
.long 0x0, 0x0, 0x0, 0x0
.long 0x0, 0x0, 0x0, 0x0
.long 0x0, 0x0, 0x0, 0x0
.long 0x0, 0x0, 0x0, 0x0
.long 0x0, 0x0, 0x0, 0x0
.long 0x0, 0x0, 0x0, 0x0
.long 0x0, 0x2400, 0x7080, 0xbd00
.long 0x10, 0x2410, 0x7090, 0xbd10
.long 0x20, 0x2420, 0x70a0, 0xbd20
.long 0x30, 0x2430, 0x70b0, 0xbd30
.long 0x40, 0x2440, 0x70c0, 0xbd40
.long 0x50, 0x2450, 0x70d0, 0xbd50
.long 0x60, 0x2460, 0x70e0, 0xbd60
.long 0x70, 0x2470, 0x70f0, 0xbd70
.long 0x480, 0x5100, 0x7500, 0xc180
.long 0x490, 0x5110, 0x7510, 0xc190
.long 0x4a0, 0x5120, 0x7520, 0xc1a0
.long 0x4b0, 0x5130, 0x7530, 0xc1b0
.long 0x4c0, 0x5140, 0x7540, 0xc1c0
.long 0x4d0, 0x5150, 0x7550, 0xc1d0
.long 0x4e0, 0x5160, 0x7560, 0xc1e0
.long 0x4f0, 0x5170, 0x7570, 0xc1f0
.long 0x920, 0x55a0, 0xa220, 0xc620
.long 0x930, 0x55b0, 0xa230, 0xc630
.long 0x900, 0x5580, 0xa200, 0xc600
.long 0x910, 0x5590, 0xa210, 0xc610
.long 0x960, 0x55e0, 0xa260, 0xc660
.long 0x970, 0x55f0, 0xa270, 0xc670
.long 0x940, 0x55c0, 0xa240, 0xc640
.long 0x950, 0x55d0, 0xa250, 0xc650
.long 0xda0, 0x5a20, 0xa6a0, 0xf320
.long 0xdb0, 0x5a30, 0xa6b0, 0xf330
.long 0xd80, 0x5a00, 0xa680, 0xf300
.long 0xd90, 0x5a10, 0xa690, 0xf310
.long 0xde0, 0x5a60, 0xa6e0, 0xf360
.long 0xdf0, 0x5a70, 0xa6f0, 0xf370
.long 0xdc0, 0x5a40, 0xa6c0, 0xf340
.long 0xdd0, 0x5a50, 0xa6d0, 0xf350
.long 0x1200, 0x5e80, 0xab00, 0xf780
.long 0x1210, 0x5e90, 0xab10, 0xf790
.long 0x1220, 0x5ea0, 0xab20, 0xf7a0
.long 0x1230, 0x5eb0, 0xab30, 0xf7b0
.long 0x1240, 0x5ec0, 0xab40, 0xf7c0
.long 0x1250, 0x5ed0, 0xab50, 0xf7d0
.long 0x1260, 0x5ee0, 0xab60, 0xf7e0
.long 0x1270, 0x5ef0, 0xab70, 0xf7f0
.long 0x1680, 0x6300, 0xaf80, 0xfc00
.long 0x1690, 0x6310, 0xaf90, 0xfc10
.long 0x16a0, 0x6320, 0xafa0, 0xfc20
.long 0x16b0, 0x6330, 0xafb0, 0xfc30
.long 0x16c0, 0x6340, 0xafc0, 0xfc40
.long 0x16d0, 0x6350, 0xafd0, 0xfc50
.long 0x16e0, 0x6360, 0xafe0, 0xfc60
.long 0x16f0, 0x6370, 0xaff0, 0xfc70
.long 0x1b20, 0x67a0, 0xb420, 0x100a0
.long 0x1b30, 0x67b0, 0xb430, 0x100b0
.long 0x1b00, 0x6780, 0xb400, 0x10080
.long 0x1b10, 0x6790, 0xb410, 0x10090
.long 0x1b60, 0x67e0, 0xb460, 0x100e0
.long 0x1b70, 0x67f0, 0xb470, 0x100f0
.long 0x1b40, 0x67c0, 0xb440, 0x100c0
.long 0x1b50, 0x67d0, 0xb450, 0x100d0
.long 0x1fa0, 0x6c20, 0xb8a0, 0x10520
.long 0x1fb0, 0x6c30, 0xb8b0, 0x10530
.long 0x1f80, 0x6c00, 0xb880, 0x10500
.long 0x1f90, 0x6c10, 0xb890, 0x10510
.long 0x1fe0, 0x6c60, 0xb8e0, 0x10560
.long 0x1ff0, 0x6c70, 0xb8f0, 0x10570
.long 0x1fc0, 0x6c40, 0xb8c0, 0x10540
.long 0x1fd0, 0x6c50, 0xb8d0, 0x10550
.long 0x15600, 0x1a280, 0x1ef00, 0x23b80
.long 0x15610, 0x1a290, 0x1ef10, 0x23b90
.long 0x15620, 0x1a2a0, 0x1ef20, 0x23ba0
.long 0x15630, 0x1a2b0, 0x1ef30, 0x23bb0
.long 0x15640, 0x1a2c0, 0x1ef40, 0x23bc0
.long 0x15650, 0x1a2d0, 0x1ef50, 0x23bd0
.long 0x15660, 0x1a2e0, 0x1ef60, 0x23be0
.long 0x15670, 0x1a2f0, 0x1ef70, 0x23bf0
.long 0x15a80, 0x1a700, 0x1f380, 0x24000
.long 0x15a90, 0x1a710, 0x1f390, 0x24010
.long 0x15aa0, 0x1a720, 0x1f3a0, 0x24020
.long 0x15ab0, 0x1a730, 0x1f3b0, 0x24030
.long 0x15ac0, 0x1a740, 0x1f3c0, 0x24040
.long 0x15ad0, 0x1a750, 0x1f3d0, 0x24050
.long 0x15ae0, 0x1a760, 0x1f3e0, 0x24060
.long 0x15af0, 0x1a770, 0x1f3f0, 0x24070
.long 0x15f20, 0x1aba0, 0x1f820, 0x244a0
.long 0x15f30, 0x1abb0, 0x1f830, 0x244b0
.long 0x15f00, 0x1ab80, 0x1f800, 0x24480
.long 0x15f10, 0x1ab90, 0x1f810, 0x24490
.long 0x15f60, 0x1abe0, 0x1f860, 0x244e0
.long 0x15f70, 0x1abf0, 0x1f870, 0x244f0
.long 0x15f40, 0x1abc0, 0x1f840, 0x244c0
.long 0x15f50, 0x1abd0, 0x1f850, 0x244d0
.long 0x163a0, 0x1b020, 0x1fca0, 0x24920
.long 0x163b0, 0x1b030, 0x1fcb0, 0x24930
.long 0x16380, 0x1b000, 0x1fc80, 0x24900
.long 0x16390, 0x1b010, 0x1fc90, 0x24910
.long 0x163e0, 0x1b060, 0x1fce0, 0x24960
.long 0x163f0, 0x1b070, 0x1fcf0, 0x24970
.long 0x163c0, 0x1b040, 0x1fcc0, 0x24940
.long 0x163d0, 0x1b050, 0x1fcd0, 0x24950
.long 0x16800, 0x1b480, 0x20100, 0x24d80
.long 0x16810, 0x1b490, 0x20110, 0x24d90
.long 0x16820, 0x1b4a0, 0x20120, 0x24da0
.long 0x16830, 0x1b4b0, 0x20130, 0x24db0
.long 0x16840, 0x1b4c0, 0x20140, 0x24dc0
.long 0x16850, 0x1b4d0, 0x20150, 0x24dd0
.long 0x16860, 0x1b4e0, 0x20160, 0x24de0
.long 0x16870, 0x1b4f0, 0x20170, 0x24df0
.long 0x19500, 0x1b900, 0x20580, 0x25200
.long 0x19510, 0x1b910, 0x20590, 0x25210
.long 0x19520, 0x1b920, 0x205a0, 0x25220
.long 0x19530, 0x1b930, 0x205b0, 0x25230
.long 0x19540, 0x1b940, 0x205c0, 0x25240
.long 0x19550, 0x1b950, 0x205d0, 0x25250
.long 0x19560, 0x1b960, 0x205e0, 0x25260
.long 0x19570, 0x1b970, 0x205f0, 0x25270
.long 0x199a0, 0x1e620, 0x20a20, 0x256a0
.long 0x199b0, 0x1e630, 0x20a30, 0x256b0
.long 0x19980, 0x1e600, 0x20a00, 0x25680
.long 0x19990, 0x1e610, 0x20a10, 0x25690
.long 0x199e0, 0x1e660, 0x20a60, 0x256e0
.long 0x199f0, 0x1e670, 0x20a70, 0x256f0
.long 0x199c0, 0x1e640, 0x20a40, 0x256c0
.long 0x199d0, 0x1e650, 0x20a50, 0x256d0
.long 0x19e20, 0x1eaa0, 0x23720, 0x25b20
.long 0x19e30, 0x1eab0, 0x23730, 0x25b30
.long 0x19e00, 0x1ea80, 0x23700, 0x25b00
.long 0x19e10, 0x1ea90, 0x23710, 0x25b10
.long 0x19e60, 0x1eae0, 0x23760, 0x25b60
.long 0x19e70, 0x1eaf0, 0x23770, 0x25b70
.long 0x19e40, 0x1eac0, 0x23740, 0x25b40
.long 0x19e50, 0x1ead0, 0x23750, 0x25b50
.long 0x4c80, 0x9900, 0xe580, 0x13200
.long 0x4c90, 0x9910, 0xe590, 0x13210
.long 0x4ca0, 0x9920, 0xe5a0, 0x13220
.long 0x4cb0, 0x9930, 0xe5b0, 0x13230
.long 0x4cc0, 0x9940, 0xe5c0, 0x13240
.long 0x4cd0, 0x9950, 0xe5d0, 0x13250
.long 0x4ce0, 0x9960, 0xe5e0, 0x13260
.long 0x4cf0, 0x9970, 0xe5f0, 0x13270
.long 0x7980, 0x9d80, 0xea00, 0x13680
.long 0x7990, 0x9d90, 0xea10, 0x13690
.long 0x79a0, 0x9da0, 0xea20, 0x136a0
.long 0x79b0, 0x9db0, 0xea30, 0x136b0
.long 0x79c0, 0x9dc0, 0xea40, 0x136c0
.long 0x79d0, 0x9dd0, 0xea50, 0x136d0
.long 0x79e0, 0x9de0, 0xea60, 0x136e0
.long 0x79f0, 0x9df0, 0xea70, 0x136f0
.long 0x7e20, 0xcaa0, 0xeea0, 0x13b20
.long 0x7e30, 0xcab0, 0xeeb0, 0x13b30
.long 0x7e00, 0xca80, 0xee80, 0x13b00
.long 0x7e10, 0xca90, 0xee90, 0x13b10
.long 0x7e60, 0xcae0, 0xeee0, 0x13b60
.long 0x7e70, 0xcaf0, 0xeef0, 0x13b70
.long 0x7e40, 0xcac0, 0xeec0, 0x13b40
.long 0x7e50, 0xcad0, 0xeed0, 0x13b50
.long 0x82a0, 0xcf20, 0x11ba0, 0x13fa0
.long 0x82b0, 0xcf30, 0x11bb0, 0x13fb0
.long 0x8280, 0xcf00, 0x11b80, 0x13f80
.long 0x8290, 0xcf10, 0x11b90, 0x13f90
.long 0x82e0, 0xcf60, 0x11be0, 0x13fe0
.long 0x82f0, 0xcf70, 0x11bf0, 0x13ff0
.long 0x82c0, 0xcf40, 0x11bc0, 0x13fc0
.long 0x82d0, 0xcf50, 0x11bd0, 0x13fd0
.long 0x8700, 0xd380, 0x12000, 0x16c80
.long 0x8710, 0xd390, 0x12010, 0x16c90
.long 0x8720, 0xd3a0, 0x12020, 0x16ca0
.long 0x8730, 0xd3b0, 0x12030, 0x16cb0
.long 0x8740, 0xd3c0, 0x12040, 0x16cc0
.long 0x8750, 0xd3d0, 0x12050, 0x16cd0
.long 0x8760, 0xd3e0, 0x12060, 0x16ce0
.long 0x8770, 0xd3f0, 0x12070, 0x16cf0
.long 0x8b80, 0xd800, 0x12480, 0x17100
.long 0x8b90, 0xd810, 0x12490, 0x17110
.long 0x8ba0, 0xd820, 0x124a0, 0x17120
.long 0x8bb0, 0xd830, 0x124b0, 0x17130
.long 0x8bc0, 0xd840, 0x124c0, 0x17140
.long 0x8bd0, 0xd850, 0x124d0, 0x17150
.long 0x8be0, 0xd860, 0x124e0, 0x17160
.long 0x8bf0, 0xd870, 0x124f0, 0x17170
.long 0x9020, 0xdca0, 0x12920, 0x175a0
.long 0x9030, 0xdcb0, 0x12930, 0x175b0
.long 0x9000, 0xdc80, 0x12900, 0x17580
.long 0x9010, 0xdc90, 0x12910, 0x17590
.long 0x9060, 0xdce0, 0x12960, 0x175e0
.long 0x9070, 0xdcf0, 0x12970, 0x175f0
.long 0x9040, 0xdcc0, 0x12940, 0x175c0
.long 0x9050, 0xdcd0, 0x12950, 0x175d0
.long 0x94a0, 0xe120, 0x12da0, 0x17a20
.long 0x94b0, 0xe130, 0x12db0, 0x17a30
.long 0x9480, 0xe100, 0x12d80, 0x17a00
.long 0x9490, 0xe110, 0x12d90, 0x17a10
.long 0x94e0, 0xe160, 0x12de0, 0x17a60
.long 0x94f0, 0xe170, 0x12df0, 0x17a70
.long 0x94c0, 0xe140, 0x12dc0, 0x17a40
.long 0x94d0, 0xe150, 0x12dd0, 0x17a50
.long 0x1cb00, 0x21780, 0x26400, 0x28380
.long 0x1cb10, 0x21790, 0x26410, 0x28390
.long 0x1cb20, 0x217a0, 0x26420, 0x283a0
.long 0x1cb30, 0x217b0, 0x26430, 0x283b0
.long 0x1cb40, 0x217c0, 0x26440, 0x283c0
.long 0x1cb50, 0x217d0, 0x26450, 0x283d0
.long 0x1cb60, 0x217e0, 0x26460, 0x283e0
.long 0x1cb70, 0x217f0, 0x26470, 0x283f0
.long 0x1cf80, 0x21c00, 0x26880, 0x28380
.long 0x1cf90, 0x21c10, 0x26890, 0x28390
.long 0x1cfa0, 0x21c20, 0x268a0, 0x283a0
.long 0x1cfb0, 0x21c30, 0x268b0, 0x283b0
.long 0x1cfc0, 0x21c40, 0x268c0, 0x283c0
.long 0x1cfd0, 0x21c50, 0x268d0, 0x283d0
.long 0x1cfe0, 0x21c60, 0x268e0, 0x283e0
.long 0x1cff0, 0x21c70, 0x268f0, 0x283f0
.long 0x1d420, 0x220a0, 0x26d20, 0x283a0
.long 0x1d430, 0x220b0, 0x26d30, 0x283b0
.long 0x1d400, 0x22080, 0x26d00, 0x28380
.long 0x1d410, 0x22090, 0x26d10, 0x28390
.long 0x1d460, 0x220e0, 0x26d60, 0x283e0
.long 0x1d470, 0x220f0, 0x26d70, 0x283f0
.long 0x1d440, 0x220c0, 0x26d40, 0x283c0
.long 0x1d450, 0x220d0, 0x26d50, 0x283d0
.long 0x1d8a0, 0x22520, 0x271a0, 0x283a0
.long 0x1d8b0, 0x22530, 0x271b0, 0x283b0
.long 0x1d880, 0x22500, 0x27180, 0x28380
.long 0x1d890, 0x22510, 0x27190, 0x28390
.long 0x1d8e0, 0x22560, 0x271e0, 0x283e0
.long 0x1d8f0, 0x22570, 0x271f0, 0x283f0
.long 0x1d8c0, 0x22540, 0x271c0, 0x283c0
.long 0x1d8d0, 0x22550, 0x271d0, 0x283d0
.long 0x1dd00, 0x22980, 0x27600, 0x28380
.long 0x1dd10, 0x22990, 0x27610, 0x28390
.long 0x1dd20, 0x229a0, 0x27620, 0x283a0
.long 0x1dd30, 0x229b0, 0x27630, 0x283b0
.long 0x1dd40, 0x229c0, 0x27640, 0x283c0
.long 0x1dd50, 0x229d0, 0x27650, 0x283d0
.long 0x1dd60, 0x229e0, 0x27660, 0x283e0
.long 0x1dd70, 0x229f0, 0x27670, 0x283f0
.long 0x1e180, 0x22e00, 0x27a80, 0x28380
.long 0x1e190, 0x22e10, 0x27a90, 0x28390
.long 0x1e1a0, 0x22e20, 0x27aa0, 0x283a0
.long 0x1e1b0, 0x22e30, 0x27ab0, 0x283b0
.long 0x1e1c0, 0x22e40, 0x27ac0, 0x283c0
.long 0x1e1d0, 0x22e50, 0x27ad0, 0x283d0
.long 0x1e1e0, 0x22e60, 0x27ae0, 0x283e0
.long 0x1e1f0, 0x22e70, 0x27af0, 0x283f0
.long 0x20ea0, 0x232a0, 0x27f20, 0x283a0
.long 0x20eb0, 0x232b0, 0x27f30, 0x283b0
.long 0x20e80, 0x23280, 0x27f00, 0x28380
.long 0x20e90, 0x23290, 0x27f10, 0x28390
.long 0x20ee0, 0x232e0, 0x27f60, 0x283e0
.long 0x20ef0, 0x232f0, 0x27f70, 0x283f0
.long 0x20ec0, 0x232c0, 0x27f40, 0x283c0
.long 0x20ed0, 0x232d0, 0x27f50, 0x283d0
.long 0x21320, 0x25fa0, 0x283a0, 0x283a0
.long 0x21330, 0x25fb0, 0x283b0, 0x283b0
.long 0x21300, 0x25f80, 0x28380, 0x28380
.long 0x21310, 0x25f90, 0x28390, 0x28390
.long 0x21360, 0x25fe0, 0x283e0, 0x283e0
.long 0x21370, 0x25ff0, 0x283f0, 0x283f0
.long 0x21340, 0x25fc0, 0x283c0, 0x283c0
.long 0x21350, 0x25fd0, 0x283d0, 0x283d0
.long 0x10980, 0x0, 0x0, 0x0
.long 0x10990, 0x80, 0x2400, 0x80
.long 0x109a0, 0x100, 0x4800, 0x2400
.long 0x109b0, 0x180, 0x6c00, 0x2480
.long 0x109c0, 0x200, 0x9000, 0x4800
.long 0x109d0, 0x280, 0xb400, 0x4880
.long 0x109e0, 0x300, 0xd800, 0x6c00
.long 0x109f0, 0x380, 0xfc00, 0x6c80
.long 0x10e00, 0x400, 0x12000, 0x9000
.long 0x10e10, 0x480, 0x14400, 0x9080
.long 0x10e20, 0x500, 0x16800, 0xb400
.long 0x10e30, 0x580, 0x18c00, 0xb480
.long 0x10e40, 0x600, 0x1b000, 0xd800
.long 0x10e50, 0x680, 0x1d400, 0xd880
.long 0x10e60, 0x700, 0x1f800, 0xfc00
.long 0x10e70, 0x780, 0x21c00, 0xfc80
.long 0x112a0, 0x800, 0x24000, 0x12000
.long 0x112b0, 0x880, 0x26400, 0x12080
.long 0x11280, 0x900, 0x26400, 0x14400
.long 0x11290, 0x980, 0x26400, 0x14480
.long 0x112e0, 0xa00, 0x26400, 0x16800
.long 0x112f0, 0xa80, 0x26400, 0x16880
.long 0x112c0, 0xb00, 0x26400, 0x18c00
.long 0x112d0, 0xb80, 0x26400, 0x18c80
.long 0x11720, 0xc00, 0x26400, 0x1b000
.long 0x11730, 0xc80, 0x26400, 0x1b080
.long 0x11700, 0xd00, 0x26400, 0x1d400
.long 0x11710, 0xd00, 0x26400, 0x1d480
.long 0x11760, 0xd00, 0x26400, 0x1f800
.long 0x11770, 0xd00, 0x26400, 0x1f880
.long 0x11740, 0xd00, 0x26400, 0x21c00
.long 0x11750, 0xd00, 0x26400, 0x21c80
.long 0x14400, 0xd00, 0x26400, 0x24000
.long 0x14410, 0xd00, 0x26400, 0x24080
.long 0x14420, 0xd00, 0x26400, 0x26400
.long 0x14430, 0xd00, 0x26400, 0x26480
.long 0x14440, 0xd00, 0x26400, 0x26480
.long 0x14450, 0xd00, 0x26400, 0x26480
.long 0x14460, 0xd00, 0x26400, 0x26480
.long 0x14470, 0xd00, 0x26400, 0x26480
.long 0x14880, 0xd00, 0x26400, 0x26480
.long 0x14890, 0xd00, 0x26400, 0x26480
.long 0x148a0, 0xd00, 0x26400, 0x26480
.long 0x148b0, 0xd00, 0x26400, 0x26480
.long 0x148c0, 0xd00, 0x26400, 0x26480
.long 0x148d0, 0xd00, 0x26400, 0x26480
.long 0x148e0, 0xd00, 0x26400, 0x26480
.long 0x148f0, 0xd00, 0x26400, 0x26480
.long 0x14d20, 0xd00, 0x26400, 0x26480
.long 0x14d30, 0xd00, 0x26400, 0x26480
.long 0x14d00, 0xd00, 0x26400, 0x26480
.long 0x14d10, 0xd00, 0x26400, 0x26480
.long 0x14d60, 0xd00, 0x26400, 0x26480
.long 0x14d70, 0xd00, 0x26400, 0x26480
.long 0x14d40, 0xd00, 0x26400, 0x26480
.long 0x14d50, 0xd00, 0x26400, 0x26480
.long 0x151a0, 0xd00, 0x26400, 0x26480
.long 0x151b0, 0xd00, 0x26400, 0x26480
.long 0x15180, 0xd00, 0x26400, 0x26480
.long 0x15190, 0xd00, 0x26400, 0x26480
.long 0x151e0, 0xd00, 0x26400, 0x26480
.long 0x151f0, 0xd00, 0x26400, 0x26480
.long 0x151c0, 0xd00, 0x26400, 0x26480
.long 0x151d0, 0xd00, 0x26400, 0x26480
.long 0x2880, 0xd80, 0x28800, 0x28800
.long 0x2890, 0xe00, 0x2ac00, 0x28880
.long 0x28a0, 0xe80, 0x2d000, 0x2ac00
.long 0x28b0, 0xf00, 0x2f400, 0x2ac80
.long 0x28c0, 0xf80, 0x31800, 0x2d000
.long 0x28d0, 0x1000, 0x33c00, 0x2d080
.long 0x28e0, 0x1080, 0x36000, 0x2f400
.long 0x28f0, 0x1100, 0x38400, 0x2f480
.long 0x2d00, 0x1180, 0x3a800, 0x31800
.long 0x2d10, 0x1200, 0x3cc00, 0x31880
.long 0x2d20, 0x1280, 0x3f000, 0x33c00
.long 0x2d30, 0x1300, 0x41400, 0x33c80
.long 0x2d40, 0x1380, 0x43800, 0x36000
.long 0x2d50, 0x1400, 0x45c00, 0x36080
.long 0x2d60, 0x1480, 0x48000, 0x38400
.long 0x2d70, 0x1500, 0x4a400, 0x38480
.long 0x31a0, 0x1580, 0x4c800, 0x3a800
.long 0x31b0, 0x1600, 0x4ec00, 0x3a880
.long 0x3180, 0x1680, 0x4ec00, 0x3cc00
.long 0x3190, 0x1700, 0x4ec00, 0x3cc80
.long 0x31e0, 0x1780, 0x4ec00, 0x3f000
.long 0x31f0, 0x1800, 0x4ec00, 0x3f080
.long 0x31c0, 0x1880, 0x4ec00, 0x41400
.long 0x31d0, 0x1900, 0x4ec00, 0x41480
.long 0x3620, 0x1980, 0x4ec00, 0x43800
.long 0x3630, 0x1a00, 0x4ec00, 0x43880
.long 0x3600, 0x1a80, 0x4ec00, 0x45c00
.long 0x3610, 0x1a80, 0x4ec00, 0x45c80
.long 0x3660, 0x1a80, 0x4ec00, 0x48000
.long 0x3670, 0x1a80, 0x4ec00, 0x48080
.long 0x3640, 0x1a80, 0x4ec00, 0x4a400
.long 0x3650, 0x1a80, 0x4ec00, 0x4a480
.long 0x3a80, 0x1a80, 0x4ec00, 0x4c800
.long 0x3a90, 0x1a80, 0x4ec00, 0x4c880
.long 0x3aa0, 0x1a80, 0x4ec00, 0x4ec00
.long 0x3ab0, 0x1a80, 0x4ec00, 0x4ec80
.long 0x3ac0, 0x1a80, 0x4ec00, 0x4ec80
.long 0x3ad0, 0x1a80, 0x4ec00, 0x4ec80
.long 0x3ae0, 0x1a80, 0x4ec00, 0x4ec80
.long 0x3af0, 0x1a80, 0x4ec00, 0x4ec80
.long 0x3f00, 0x1a80, 0x4ec00, 0x4ec80
.long 0x3f10, 0x1a80, 0x4ec00, 0x4ec80
.long 0x3f20, 0x1a80, 0x4ec00, 0x4ec80
.long 0x3f30, 0x1a80, 0x4ec00, 0x4ec80
.long 0x3f40, 0x1a80, 0x4ec00, 0x4ec80
.long 0x3f50, 0x1a80, 0x4ec00, 0x4ec80
.long 0x3f60, 0x1a80, 0x4ec00, 0x4ec80
.long 0x3f70, 0x1a80, 0x4ec00, 0x4ec80
.long 0x43a0, 0x1a80, 0x4ec00, 0x4ec80
.long 0x43b0, 0x1a80, 0x4ec00, 0x4ec80
.long 0x4380, 0x1a80, 0x4ec00, 0x4ec80
.long 0x4390, 0x1a80, 0x4ec00, 0x4ec80
.long 0x43e0, 0x1a80, 0x4ec00, 0x4ec80
.long 0x43f0, 0x1a80, 0x4ec00, 0x4ec80
.long 0x43c0, 0x1a80, 0x4ec00, 0x4ec80
.long 0x43d0, 0x1a80, 0x4ec00, 0x4ec80
.long 0x4820, 0x1a80, 0x4ec00, 0x4ec80
.long 0x4830, 0x1a80, 0x4ec00, 0x4ec80
.long 0x4800, 0x1a80, 0x4ec00, 0x4ec80
.long 0x4810, 0x1a80, 0x4ec00, 0x4ec80
.long 0x4860, 0x1a80, 0x4ec00, 0x4ec80
.long 0x4870, 0x1a80, 0x4ec00, 0x4ec80
.long 0x4840, 0x1a80, 0x4ec00, 0x4ec80
.long 0x4850, 0x1a80, 0x4ec00, 0x4ec80
.long 0x17e80, 0x1b00, 0x51000, 0x51000
.long 0x17e90, 0x1b80, 0x53400, 0x51080
.long 0x17ea0, 0x1c00, 0x55800, 0x53400
.long 0x17eb0, 0x1c80, 0x57c00, 0x53480
.long 0x17ec0, 0x1d00, 0x5a000, 0x55800
.long 0x17ed0, 0x1d80, 0x5c400, 0x55880
.long 0x17ee0, 0x1e00, 0x5e800, 0x57c00
.long 0x17ef0, 0x1e80, 0x60c00, 0x57c80
.long 0x18300, 0x1f00, 0x63000, 0x5a000
.long 0x18310, 0x1f80, 0x65400, 0x5a080
.long 0x18320, 0x2000, 0x67800, 0x5c400
.long 0x18330, 0x2080, 0x69c00, 0x5c480
.long 0x18340, 0x2100, 0x6c000, 0x5e800
.long 0x18350, 0x2180, 0x6e400, 0x5e880
.long 0x18360, 0x2200, 0x70800, 0x60c00
.long 0x18370, 0x2280, 0x72c00, 0x60c80
.long 0x187a0, 0x2300, 0x75000, 0x63000
.long 0x187b0, 0x2380, 0x77400, 0x63080
.long 0x18780, 0x2400, 0x77400, 0x65400
.long 0x18790, 0x2480, 0x77400, 0x65480
.long 0x187e0, 0x2500, 0x77400, 0x67800
.long 0x187f0, 0x2580, 0x77400, 0x67880
.long 0x187c0, 0x2600, 0x77400, 0x69c00
.long 0x187d0, 0x2680, 0x77400, 0x69c80
.long 0x18c20, 0x2700, 0x77400, 0x6c000
.long 0x18c30, 0x2780, 0x77400, 0x6c080
.long 0x18c00, 0x2800, 0x77400, 0x6e400
.long 0x18c10, 0x2800, 0x77400, 0x6e480
.long 0x18c60, 0x2800, 0x77400, 0x70800
.long 0x18c70, 0x2800, 0x77400, 0x70880
.long 0x18c40, 0x2800, 0x77400, 0x72c00
.long 0x18c50, 0x2800, 0x77400, 0x72c80
.long 0x19080, 0x2800, 0x77400, 0x75000
.long 0x19090, 0x2800, 0x77400, 0x75080
.long 0x190a0, 0x2800, 0x77400, 0x77400
.long 0x190b0, 0x2800, 0x77400, 0x77480
.long 0x190c0, 0x2800, 0x77400, 0x77480
.long 0x190d0, 0x2800, 0x77400, 0x77480
.long 0x190e0, 0x2800, 0x77400, 0x77480
.long 0x190f0, 0x2800, 0x77400, 0x77480
.long 0x1bd80, 0x2800, 0x77400, 0x77480
.long 0x1bd90, 0x2800, 0x77400, 0x77480
.long 0x1bda0, 0x2800, 0x77400, 0x77480
.long 0x1bdb0, 0x2800, 0x77400, 0x77480
.long 0x1bdc0, 0x2800, 0x77400, 0x77480
.long 0x1bdd0, 0x2800, 0x77400, 0x77480
.long 0x1bde0, 0x2800, 0x77400, 0x77480
.long 0x1bdf0, 0x2800, 0x77400, 0x77480
.long 0x1c220, 0x2800, 0x77400, 0x77480
.long 0x1c230, 0x2800, 0x77400, 0x77480
.long 0x1c200, 0x2800, 0x77400, 0x77480
.long 0x1c210, 0x2800, 0x77400, 0x77480
.long 0x1c260, 0x2800, 0x77400, 0x77480
.long 0x1c270, 0x2800, 0x77400, 0x77480
.long 0x1c240, 0x2800, 0x77400, 0x77480
.long 0x1c250, 0x2800, 0x77400, 0x77480
.long 0x1c6a0, 0x2800, 0x77400, 0x77480
.long 0x1c6b0, 0x2800, 0x77400, 0x77480
.long 0x1c680, 0x2800, 0x77400, 0x77480
.long 0x1c690, 0x2800, 0x77400, 0x77480
.long 0x1c6e0, 0x2800, 0x77400, 0x77480
.long 0x1c6f0, 0x2800, 0x77400, 0x77480
.long 0x1c6c0, 0x2800, 0x77400, 0x77480
.long 0x1c6d0, 0x2800, 0x77400, 0x77480
.long 0x28380, 0x2880, 0x79800, 0x79800
.long 0x28390, 0x2900, 0x7bc00, 0x79880
.long 0x283a0, 0x2980, 0x7e000, 0x7bc00
.long 0x283b0, 0x2a00, 0x80400, 0x7bc80
.long 0x283c0, 0x2a80, 0x82800, 0x7e000
.long 0x283d0, 0x2b00, 0x84c00, 0x7e080
.long 0x283e0, 0x2b80, 0x87000, 0x80400
.long 0x283f0, 0x2c00, 0x89400, 0x80480
.long 0x28380, 0x2c80, 0x8b800, 0x82800
.long 0x28390, 0x2d00, 0x8dc00, 0x82880
.long 0x283a0, 0x2d80, 0x90000, 0x84c00
.long 0x283b0, 0x2e00, 0x92400, 0x84c80
.long 0x283c0, 0x2e80, 0x94800, 0x87000
.long 0x283d0, 0x2f00, 0x96c00, 0x87080
.long 0x283e0, 0x2f80, 0x99000, 0x89400
.long 0x283f0, 0x3000, 0x9b400, 0x89480
.long 0x283a0, 0x3080, 0x9d800, 0x8b800
.long 0x283b0, 0x3100, 0x9fc00, 0x8b880
.long 0x28380, 0x3180, 0x9fc00, 0x8dc00
.long 0x28390, 0x3200, 0x9fc00, 0x8dc80
.long 0x283e0, 0x3280, 0x9fc00, 0x90000
.long 0x283f0, 0x3300, 0x9fc00, 0x90080
.long 0x283c0, 0x3380, 0x9fc00, 0x92400
.long 0x283d0, 0x3400, 0x9fc00, 0x92480
.long 0x283a0, 0x3480, 0x9fc00, 0x94800
.long 0x283b0, 0x3500, 0x9fc00, 0x94880
.long 0x28380, 0x3580, 0x9fc00, 0x96c00
.long 0x28390, 0x3580, 0x9fc00, 0x96c80
.long 0x283e0, 0x3580, 0x9fc00, 0x99000
.long 0x283f0, 0x3580, 0x9fc00, 0x99080
.long 0x283c0, 0x3580, 0x9fc00, 0x9b400
.long 0x283d0, 0x3580, 0x9fc00, 0x9b480
.long 0x28380, 0x3580, 0x9fc00, 0x9d800
.long 0x28390, 0x3580, 0x9fc00, 0x9d880
.long 0x283a0, 0x3580, 0x9fc00, 0x9fc00
.long 0x283b0, 0x3580, 0x9fc00, 0x9fc80
.long 0x283c0, 0x3580, 0x9fc00, 0x9fc80
.long 0x283d0, 0x3580, 0x9fc00, 0x9fc80
.long 0x283e0, 0x3580, 0x9fc00, 0x9fc80
.long 0x283f0, 0x3580, 0x9fc00, 0x9fc80
.long 0x28380, 0x3580, 0x9fc00, 0x9fc80
.long 0x28390, 0x3580, 0x9fc00, 0x9fc80
.long 0x283a0, 0x3580, 0x9fc00, 0x9fc80
.long 0x283b0, 0x3580, 0x9fc00, 0x9fc80
.long 0x283c0, 0x3580, 0x9fc00, 0x9fc80
.long 0x283d0, 0x3580, 0x9fc00, 0x9fc80
.long 0x283e0, 0x3580, 0x9fc00, 0x9fc80
.long 0x283f0, 0x3580, 0x9fc00, 0x9fc80
.long 0x283a0, 0x3580, 0x9fc00, 0x9fc80
.long 0x283b0, 0x3580, 0x9fc00, 0x9fc80
.long 0x28380, 0x3580, 0x9fc00, 0x9fc80
.long 0x28390, 0x3580, 0x9fc00, 0x9fc80
.long 0x283e0, 0x3580, 0x9fc00, 0x9fc80
.long 0x283f0, 0x3580, 0x9fc00, 0x9fc80
.long 0x283c0, 0x3580, 0x9fc00, 0x9fc80
.long 0x283d0, 0x3580, 0x9fc00, 0x9fc80
.long 0x283a0, 0x3580, 0x9fc00, 0x9fc80
.long 0x283b0, 0x3580, 0x9fc00, 0x9fc80
.long 0x28380, 0x3580, 0x9fc00, 0x9fc80
.long 0x28390, 0x3580, 0x9fc00, 0x9fc80
.long 0x283e0, 0x3580, 0x9fc00, 0x9fc80
.long 0x283f0, 0x3580, 0x9fc00, 0x9fc80
.long 0x283c0, 0x3580, 0x9fc00, 0x9fc80
.long 0x283d0, 0x3580, 0x9fc00, 0x9fc80
.long 0x0, 0x0, 0x0, 0x0
.long 0x0, 0x0, 0x0, 0x0
.long 0x0, 0x0, 0x0, 0x0
.long 0x0, 0x0, 0x0, 0x0
.long 0x0, 0x0, 0x0, 0x0
.long 0x0, 0x0, 0x0, 0x0
.long 0x0, 0x0, 0x0, 0x0
.long 0x0, 0x0, 0x0, 0x0
.long 0x0, 0x0, 0x0, 0x0
.long 0x0, 0x0, 0x0, 0x0
.long 0x0, 0x0, 0x0, 0x0
.long 0x0, 0x0, 0x0, 0x0
.long 0x0, 0x0, 0x0, 0x0
.long 0x0, 0x0, 0x0, 0x0
.long 0x0, 0x0, 0x0, 0x0
.long 0x0, 0x0, 0x0, 0x0
.long 0x0, 0x0, 0x0, 0x0
.long 0x0, 0x0, 0x0, 0x0
.long 0x0, 0x0, 0x0, 0x0
.long 0x0, 0x0, 0x0, 0x0
.long 0x0, 0x0, 0x0, 0x0
.long 0x0, 0x0, 0x0, 0x0
.long 0x0, 0x0, 0x0, 0x0
.long 0x0, 0x0, 0x0, 0x0
.long 0x0, 0x0, 0x0, 0x0
.long 0x0, 0x0, 0x0, 0x0
.long 0x0, 0x0, 0x0, 0x0
.long 0x0, 0x0, 0x0, 0x0
.long 0x0, 0x0, 0x0, 0x0
.long 0x0, 0x0, 0x0, 0x0
.long 0x0, 0x0, 0x0, 0x0
.long 0x0, 0x0, 0x0, 0x0
.long 0x0, 0x0, 0x0, 0x0
.long 0x0, 0x0, 0x0, 0x0
.long 0x0, 0x0, 0x0, 0x0
.long 0x0, 0x0, 0x0, 0x0
.long 0x0, 0x0, 0x0, 0x0
.long 0x0, 0x0, 0x0, 0x0
.long 0x0, 0x0, 0x0, 0x0
.long 0x0, 0x0, 0x0, 0x0
.long 0x0, 0x0, 0x0, 0x0
.long 0x0, 0x0, 0x0, 0x0
.long 0x0, 0x0, 0x0, 0x0
.long 0x0, 0x0, 0x0, 0x0
.long 0x0, 0x0, 0x0, 0x0
.long 0x0, 0x0, 0x0, 0x0
.long 0x0, 0x0, 0x0, 0x0
.long 0x0, 0x0, 0x0, 0x0
.long 0x0, 0x0, 0x0, 0x0
.long 0x0, 0x0, 0x0, 0x0
.long 0x0, 0x0, 0x0, 0x0
.long 0x0, 0x0, 0x0, 0x0
.long 0x0, 0x0, 0x0, 0x0
.long 0x0, 0x0, 0x0, 0x0
.long 0x0, 0x0, 0x0, 0x0
.long 0x0, 0x0, 0x0, 0x0
.long 0x0, 0x0, 0x0, 0x0
.long 0x0, 0x0, 0x0, 0x0
.long 0x0, 0x0, 0x0, 0x0
.long 0x0, 0x0, 0x0, 0x0
.long 0x0, 0x0, 0x0, 0x0
.long 0x0, 0x0, 0x0, 0x0
.long 0x0, 0x0, 0x0, 0x0
.long 0x0, 0x0, 0x0, 0x0
.long 0x0, 0x0, 0x0, 0x0
.long 0x0, 0x0, 0x0, 0x0
.long 0x0, 0x0, 0x0, 0x0
.long 0x0, 0x0, 0x0, 0x0
.long 0x0, 0x0, 0x0, 0x0
.long 0x0, 0x0, 0x0, 0x0
.long 0x0, 0x0, 0x0, 0x0
.long 0x0, 0x0, 0x0, 0x0
.long 0x0, 0x0, 0x0, 0x0
.long 0x0, 0x0, 0x0, 0x0
.long 0x0, 0x0, 0x0, 0x0
.long 0x0, 0x0, 0x0, 0x0
.long 0x0, 0x0, 0x0, 0x0
.long 0x0, 0x0, 0x0, 0x0
.long 0x0, 0x0, 0x0, 0x0
.long 0x0, 0x0, 0x0, 0x0
.long 0x0, 0x0, 0x0, 0x0
.long 0x0, 0x0, 0x0, 0x0
.long 0x0, 0x0, 0x0, 0x0
.long 0x0, 0x0, 0x0, 0x0
.long 0x0, 0x0, 0x0, 0x0
.long 0x0, 0x0, 0x0, 0x0
.long 0x0, 0x0, 0x0, 0x0
.long 0x0, 0x0, 0x0, 0x0
.long 0x0, 0x0, 0x0, 0x0
.long 0x0, 0x0, 0x0, 0x0
.long 0x0, 0x0, 0x0, 0x0
.long 0x0, 0x0, 0x0, 0x0
.long 0x0, 0x0, 0x0, 0x0
.long 0x0, 0x0, 0x0, 0x0
.long 0x0, 0x0, 0x0, 0x0
.long 0x0, 0x0, 0x0, 0x0
.long 0x0, 0x0, 0x0, 0x0
.long 0x0, 0x0, 0x0, 0x0
.long 0x0, 0x0, 0x0, 0x0
.long 0x0, 0x0, 0x0, 0x0
.long 0x0, 0x0, 0x0, 0x0
.long 0x0, 0x0, 0x0, 0x0
.long 0x0, 0x0, 0x0, 0x0
.long 0x0, 0x0, 0x0, 0x0
.long 0x0, 0x0, 0x0, 0x0
.long 0x0, 0x0, 0x0, 0x0
.long 0x0, 0x0, 0x0, 0x0
.long 0x0, 0x0, 0x0, 0x0
.long 0x0, 0x0, 0x0, 0x0
.long 0x0, 0x0, 0x0, 0x0
.long 0x0, 0x0, 0x0, 0x0
.long 0x0, 0x0, 0x0, 0x0
.long 0x0, 0x0, 0x0, 0x0
.long 0x0, 0x0, 0x0, 0x0
.long 0x0, 0x0, 0x0, 0x0
.long 0x0, 0x0, 0x0, 0x0
.long 0x0, 0x0, 0x0, 0x0
.long 0x0, 0x0, 0x0, 0x0
.long 0x0, 0x0, 0x0, 0x0
.long 0x0, 0x0, 0x0, 0x0
.long 0x0, 0x0, 0x0, 0x0
.long 0x0, 0x0, 0x0, 0x0
.long 0x0, 0x0, 0x0, 0x0
.long 0x0, 0x0, 0x0, 0x0
.long 0x0, 0x0, 0x0, 0x0
.long 0x0, 0x0, 0x0, 0x0
.long 0x0, 0x0, 0x0, 0x0
.long 0x0, 0x0, 0x0, 0x0
.long 0x0, 0x0, 0x0, 0x0
.long 0x0, 0x0, 0x0, 0x0
.long 0x0, 0x0, 0x0, 0x0
.long 0x0, 0x0, 0x0, 0x0
.long 0x0, 0x0, 0x0, 0x0
.long 0x0, 0x0, 0x0, 0x0
.long 0x0, 0x0, 0x0, 0x0
.long 0x0, 0x0, 0x0, 0x0
.long 0x0, 0x0, 0x0, 0x0
.long 0x0, 0x0, 0x0, 0x0
.long 0x0, 0x0, 0x0, 0x0
.long 0x0, 0x0, 0x0, 0x0
.long 0x0, 0x0, 0x0, 0x0
.long 0x0, 0x0, 0x0, 0x0
.long 0x0, 0x0, 0x0, 0x0
.long 0x0, 0x0, 0x0, 0x0
.long 0x0, 0x0, 0x0, 0x0
.long 0x0, 0x0, 0x0, 0x0
.long 0x0, 0x0, 0x0, 0x0
.long 0x0, 0x0, 0x0, 0x0
.long 0x0, 0x0, 0x0, 0x0
.long 0x0, 0x0, 0x0, 0x0
.long 0x0, 0x0, 0x0, 0x0
.long 0x0, 0x0, 0x0, 0x0
.long 0x0, 0x0, 0x0, 0x0
.long 0x0, 0x0, 0x0, 0x0
.long 0x0, 0x0, 0x0, 0x0
.long 0x0, 0x0, 0x0, 0x0
.long 0x0, 0x0, 0x0, 0x0
.long 0x0, 0x0, 0x0, 0x0
.long 0x0, 0x0, 0x0, 0x0
.long 0x0, 0x0, 0x0, 0x0
.long 0x0, 0x0, 0x0, 0x0
.long 0x0, 0x0, 0x0, 0x0
.long 0x0, 0x0, 0x0, 0x0
.long 0x0, 0x0, 0x0, 0x0
.long 0x0, 0x0, 0x0, 0x0
.long 0x0, 0x0, 0x0, 0x0
.long 0x0, 0x0, 0x0, 0x0
.long 0x0, 0x0, 0x0, 0x0
.long 0x0, 0x0, 0x0, 0x0
.long 0x0, 0x0, 0x0, 0x0
.long 0x0, 0x0, 0x0, 0x0
.long 0x0, 0x0, 0x0, 0x0
.long 0x0, 0x0, 0x0, 0x0
.long 0x0, 0x0, 0x0, 0x0
.long 0x0, 0x0, 0x0, 0x0
.long 0x0, 0x0, 0x0, 0x0
.long 0x0, 0x0, 0x0, 0x0
.long 0x0, 0x0, 0x0, 0x0
.long 0x0, 0x0, 0x0, 0x0
.long 0x0, 0x0, 0x0, 0x0
.long 0x0, 0x0, 0x0, 0x0
.long 0x0, 0x0, 0x0, 0x0
.long 0x0, 0x0, 0x0, 0x0
.long 0x0, 0x0, 0x0, 0x0
.long 0x0, 0x0, 0x0, 0x0
.long 0x0, 0x0, 0x0, 0x0
.long 0x0, 0x0, 0x0, 0x0
.long 0x0, 0x0, 0x0, 0x0
.long 0x0, 0x0, 0x0, 0x0
.long 0x0, 0x0, 0x0, 0x0
.long 0x0, 0x0, 0x0, 0x0
.long 0x0, 0x0, 0x0, 0x0
.long 0x0, 0x0, 0x0, 0x0
.long 0x0, 0x0, 0x0, 0x0
.long 0x0, 0x0, 0x0, 0x0
.long 0x0, 0x0, 0x0, 0x0
.long 0x0, 0x0, 0x0, 0x0
.long 0x0, 0x0, 0x0, 0x0
.long 0x0, 0x0, 0x0, 0x0
.long 0x0, 0x0, 0x0, 0x0
.long 0x0, 0x0, 0x0, 0x0
.long 0x0, 0x0, 0x0, 0x0
.long 0x0, 0x0, 0x0, 0x0
.long 0x0, 0x0, 0x0, 0x0
.long 0x0, 0x0, 0x0, 0x0
.long 0x0, 0x0, 0x0, 0x0
.long 0x0, 0x0, 0x0, 0x0
.long 0x0, 0x0, 0x0, 0x0
.long 0x0, 0x0, 0x0, 0x0
.long 0x0, 0x0, 0x0, 0x0
.long 0x0, 0x0, 0x0, 0x0
.long 0x0, 0x0, 0x0, 0x0
.long 0x0, 0x0, 0x0, 0x0
.long 0x0, 0x0, 0x0, 0x0
.long 0x0, 0x0, 0x0, 0x0
.long 0x0, 0x0, 0x0, 0x0
.long 0x0, 0x0, 0x0, 0x0
.long 0x0, 0x0, 0x0, 0x0
.long 0x0, 0x0, 0x0, 0x0
.long 0x0, 0x0, 0x0, 0x0
.long 0x0, 0x0, 0x0, 0x0
.long 0x0, 0x0, 0x0, 0x0
.long 0x0, 0x0, 0x0, 0x0
.long 0x0, 0x0, 0x0, 0x0
.long 0x0, 0x0, 0x0, 0x0
.long 0x0, 0x0, 0x0, 0x0
.long 0x0, 0x0, 0x0, 0x0
.long 0x0, 0x0, 0x0, 0x0
.long 0x0, 0x0, 0x0, 0x0
.long 0x0, 0x0, 0x0, 0x0
.long 0x0, 0x0, 0x0, 0x0
.long 0x0, 0x0, 0x0, 0x0
.long 0x0, 0x0, 0x0, 0x0
.long 0x0, 0x0, 0x0, 0x0
.long 0x0, 0x0, 0x0, 0x0
.long 0x0, 0x0, 0x0, 0x0
.long 0x0, 0x0, 0x0, 0x0
.long 0x0, 0x0, 0x0, 0x0
.long 0x0, 0x0, 0x0, 0x0
.long 0x0, 0x0, 0x0, 0x0
.long 0x0, 0x0, 0x0, 0x0
.long 0x0, 0x0, 0x0, 0x0
.long 0x0, 0x0, 0x0, 0x0
.long 0x0, 0x0, 0x0, 0x0
.long 0x0, 0x0, 0x0, 0x0
.long 0x0, 0x0, 0x0, 0x0
.long 0x0, 0x0, 0x0, 0x0
.long 0x0, 0x0, 0x0, 0x0
.long 0x0, 0x0, 0x0, 0x0
.long 0x0, 0x0, 0x0, 0x0
.long 0x0, 0x0, 0x0, 0x0
.long 0x0, 0x0, 0x0, 0x0
.long 0x0, 0x0, 0x0, 0x0
.long 0x0, 0x0, 0x0, 0x0
.long 0x0, 0x0, 0x0, 0x0
.long 0x0, 0x0, 0x0, 0x0
.p2align 7
L_tab1:
.long 0x480, 0x12d0, 0x2990, 0x3c60
.long 0x490, 0x12e0, 0x29a0, 0x3c70
.long 0x510, 0x1360, 0x2a20, 0x3cf0
.long 0x520, 0x1370, 0x2a30, 0x3d00
.long 0x4a0, 0x12f0, 0x29b0, 0x3c80
.long 0x4b0, 0x1300, 0x29c0, 0x4080
.long 0x530, 0x1380, 0x2a40, 0x3d10
.long 0x540, 0x1390, 0x2a50, 0x4110
.long 0x4c0, 0x1b80, 0x29d0, 0x4090
.long 0x4d0, 0x1b90, 0x29e0, 0x40a0
.long 0x550, 0x1c10, 0x2a60, 0x4120
.long 0x560, 0x1c20, 0x2a70, 0x4130
.long 0x4e0, 0x1ba0, 0x29f0, 0x40b0
.long 0x4f0, 0x1bb0, 0x2a00, 0x40c0
.long 0x570, 0x1c30, 0x2a80, 0x4140
.long 0x580, 0x1c40, 0x2a90, 0x4150
.long 0x500, 0x1bc0, 0x3280, 0x40d0
.long 0x900, 0x1bd0, 0x3290, 0x40e0
.long 0x590, 0x1c50, 0x3310, 0x4160
.long 0x990, 0x1c60, 0x3320, 0x4170
.long 0x910, 0x1be0, 0x32a0, 0x40f0
.long 0x920, 0x1bf0, 0x32b0, 0x4100
.long 0x9a0, 0x1c70, 0x3330, 0x4180
.long 0x9b0, 0x1c80, 0x3340, 0x4190
.long 0x930, 0x1c00, 0x32c0, 0x4980
.long 0x940, 0x2000, 0x32d0, 0x4990
.long 0x9c0, 0x1c90, 0x3350, 0x4a10
.long 0x9d0, 0x2090, 0x3360, 0x4a20
.long 0x950, 0x2010, 0x32e0, 0x49a0
.long 0x960, 0x2020, 0x32f0, 0x49b0
.long 0x9e0, 0x20a0, 0x3370, 0x4a30
.long 0x9f0, 0x20b0, 0x3380, 0x4a40
.long 0x970, 0x2030, 0x3300, 0x49c0
.long 0x980, 0x2040, 0x3700, 0x49d0
.long 0xa00, 0x20c0, 0x3390, 0x4a50
.long 0xa10, 0x20d0, 0x3790, 0x4a60
.long 0x1200, 0x2050, 0x3710, 0x49e0
.long 0x1210, 0x2060, 0x3720, 0x49f0
.long 0x1290, 0x20e0, 0x37a0, 0x4a70
.long 0x12a0, 0x20f0, 0x37b0, 0x4a80
.long 0x1220, 0x2070, 0x3730, 0x4a00
.long 0x1230, 0x2080, 0x3740, 0x4e00
.long 0x12b0, 0x2100, 0x37c0, 0x4a90
.long 0x12c0, 0x2110, 0x37d0, 0x4e90
.long 0x1240, 0x2900, 0x3750, 0x4e10
.long 0x1250, 0x2910, 0x3760, 0x4e20
.long 0x12d0, 0x2990, 0x37e0, 0x4ea0
.long 0x12e0, 0x29a0, 0x37f0, 0x4eb0
.long 0x1260, 0x2920, 0x3770, 0x4e30
.long 0x1270, 0x2930, 0x3780, 0x4e40
.long 0x12f0, 0x29b0, 0x3800, 0x4ec0
.long 0x1300, 0x29c0, 0x3810, 0x4ed0
.long 0x1280, 0x2940, 0x4000, 0x4e50
.long 0x1680, 0x2950, 0x4010, 0x4e60
.long 0x1310, 0x29d0, 0x4090, 0x4ee0
.long 0x1710, 0x29e0, 0x40a0, 0x4ef0
.long 0x1690, 0x2960, 0x4020, 0x4e70
.long 0x16a0, 0x2970, 0x4030, 0x4e80
.long 0x1720, 0x29f0, 0x40b0, 0x4f00
.long 0x1730, 0x2a00, 0x40c0, 0x4f10
.long 0x16b0, 0x2980, 0x4040, 0x5700
.long 0x16c0, 0x2d80, 0x4050, 0x5710
.long 0x1740, 0x2a10, 0x40d0, 0x5790
.long 0x1750, 0x2e10, 0x40e0, 0x57a0
.long 0x6320, 0x7170, 0x8830, 0x9b00
.long 0x6330, 0x7180, 0x8840, 0x9f00
.long 0x63b0, 0x7200, 0x88c0, 0x9b90
.long 0x63c0, 0x7210, 0x88d0, 0x9f90
.long 0x6340, 0x7a00, 0x8850, 0x9f10
.long 0x6350, 0x7a10, 0x8860, 0x9f20
.long 0x63d0, 0x7a90, 0x88e0, 0x9fa0
.long 0x63e0, 0x7aa0, 0x88f0, 0x9fb0
.long 0x6360, 0x7a20, 0x8870, 0x9f30
.long 0x6370, 0x7a30, 0x8880, 0x9f40
.long 0x63f0, 0x7ab0, 0x8900, 0x9fc0
.long 0x6400, 0x7ac0, 0x8910, 0x9fd0
.long 0x6380, 0x7a40, 0x9100, 0x9f50
.long 0x6780, 0x7a50, 0x9110, 0x9f60
.long 0x6410, 0x7ad0, 0x9190, 0x9fe0
.long 0x6810, 0x7ae0, 0x91a0, 0x9ff0
.long 0x6790, 0x7a60, 0x9120, 0x9f70
.long 0x67a0, 0x7a70, 0x9130, 0x9f80
.long 0x6820, 0x7af0, 0x91b0, 0xa000
.long 0x6830, 0x7b00, 0x91c0, 0xa010
.long 0x67b0, 0x7a80, 0x9140, 0xa800
.long 0x67c0, 0x7e80, 0x9150, 0xa810
.long 0x6840, 0x7b10, 0x91d0, 0xa890
.long 0x6850, 0x7f10, 0x91e0, 0xa8a0
.long 0x67d0, 0x7e90, 0x9160, 0xa820
.long 0x67e0, 0x7ea0, 0x9170, 0xa830
.long 0x6860, 0x7f20, 0x91f0, 0xa8b0
.long 0x6870, 0x7f30, 0x9200, 0xa8c0
.long 0x67f0, 0x7eb0, 0x9180, 0xa840
.long 0x6800, 0x7ec0, 0x9580, 0xa850
.long 0x6880, 0x7f40, 0x9210, 0xa8d0
.long 0x6890, 0x7f50, 0x9610, 0xa8e0
.long 0x7080, 0x7ed0, 0x9590, 0xa860
.long 0x7090, 0x7ee0, 0x95a0, 0xa870
.long 0x7110, 0x7f60, 0x9620, 0xa8f0
.long 0x7120, 0x7f70, 0x9630, 0xa900
.long 0x70a0, 0x7ef0, 0x95b0, 0xa880
.long 0x70b0, 0x7f00, 0x95c0, 0xac80
.long 0x7130, 0x7f80, 0x9640, 0xa910
.long 0x7140, 0x7f90, 0x9650, 0xad10
.long 0x70c0, 0x8780, 0x95d0, 0xac90
.long 0x70d0, 0x8790, 0x95e0, 0xaca0
.long 0x7150, 0x8810, 0x9660, 0xad20
.long 0x7160, 0x8820, 0x9670, 0xad30
.long 0x70e0, 0x87a0, 0x95f0, 0xacb0
.long 0x70f0, 0x87b0, 0x9600, 0xacc0
.long 0x7170, 0x8830, 0x9680, 0xad40
.long 0x7180, 0x8840, 0x9690, 0xad50
.long 0x7100, 0x87c0, 0x9e80, 0xacd0
.long 0x7500, 0x87d0, 0x9e90, 0xace0
.long 0x7190, 0x8850, 0x9f10, 0xad60
.long 0x7590, 0x8860, 0x9f20, 0xad70
.long 0x7510, 0x87e0, 0x9ea0, 0xacf0
.long 0x7520, 0x87f0, 0x9eb0, 0xad00
.long 0x75a0, 0x8870, 0x9f30, 0xad80
.long 0x75b0, 0x8880, 0x9f40, 0xad90
.long 0x7530, 0x8800, 0x9ec0, 0xb580
.long 0x7540, 0x8c00, 0x9ed0, 0xb590
.long 0x75c0, 0x8890, 0x9f50, 0xb610
.long 0x75d0, 0x8c90, 0x9f60, 0xb620
.long 0x7550, 0x8c10, 0x9ee0, 0xb5a0
.long 0x7560, 0x8c20, 0x9ef0, 0xb5b0
.long 0x75e0, 0x8ca0, 0x9f70, 0xb630
.long 0x75f0, 0x8cb0, 0x9f80, 0xb640
.long 0xc1c0, 0x0, 0x10000, 0x20000
.long 0xc1d0, 0x20, 0x10020, 0x20020
.long 0xc250, 0x8, 0x10008, 0x20008
.long 0xc260, 0x28, 0x10028, 0x20028
.long 0xc1e0, 0x240, 0x10240, 0x20240
.long 0xc1f0, 0x260, 0x10260, 0x20260
.long 0xc270, 0x248, 0x10248, 0x20248
.long 0xc280, 0x268, 0x10268, 0x20268
.long 0xc200, 0x480, 0x10480, 0x20480
.long 0xc600, 0x4a0, 0x104a0, 0x204a0
.long 0xc290, 0x488, 0x10488, 0x20488
.long 0xc690, 0x4a8, 0x104a8, 0x204a8
.long 0xc610, 0x6c0, 0x106c0, 0x206c0
.long 0xc620, 0x6e0, 0x106e0, 0x206e0
.long 0xc6a0, 0x6c8, 0x106c8, 0x206c8
.long 0xc6b0, 0x6e8, 0x106e8, 0x206e8
.long 0xc630, 0x10, 0x10010, 0x20010
.long 0xc640, 0x30, 0x10030, 0x20030
.long 0xc6c0, 0x18, 0x10018, 0x20018
.long 0xc6d0, 0x38, 0x10038, 0x20038
.long 0xc650, 0x250, 0x10250, 0x20250
.long 0xc660, 0x270, 0x10270, 0x20270
.long 0xc6e0, 0x258, 0x10258, 0x20258
.long 0xc6f0, 0x278, 0x10278, 0x20278
.long 0xc670, 0x490, 0x10490, 0x20490
.long 0xc680, 0x4b0, 0x104b0, 0x204b0
.long 0xc700, 0x498, 0x10498, 0x20498
.long 0xc710, 0x4b8, 0x104b8, 0x204b8
.long 0xcf00, 0x6d0, 0x106d0, 0x206d0
.long 0xcf10, 0x6f0, 0x106f0, 0x206f0
.long 0xcf90, 0x6d8, 0x106d8, 0x206d8
.long 0xcfa0, 0x6f8, 0x106f8, 0x206f8
.long 0xcf20, 0x4800, 0x14800, 0x24800
.long 0xcf30, 0x4820, 0x14820, 0x24820
.long 0xcfb0, 0x4808, 0x14808, 0x24808
.long 0xcfc0, 0x4828, 0x14828, 0x24828
.long 0xcf40, 0x4a40, 0x14a40, 0x24a40
.long 0xcf50, 0x4a60, 0x14a60, 0x24a60
.long 0xcfd0, 0x4a48, 0x14a48, 0x24a48
.long 0xcfe0, 0x4a68, 0x14a68, 0x24a68
.long 0xcf60, 0x4c80, 0x14c80, 0x24c80
.long 0xcf70, 0x4ca0, 0x14ca0, 0x24ca0
.long 0xcff0, 0x4c88, 0x14c88, 0x24c88
.long 0xd000, 0x4ca8, 0x14ca8, 0x24ca8
.long 0xcf80, 0x4ec0, 0x14ec0, 0x24ec0
.long 0xd380, 0x4ee0, 0x14ee0, 0x24ee0
.long 0xd010, 0x4ec8, 0x14ec8, 0x24ec8
.long 0xd410, 0x4ee8, 0x14ee8, 0x24ee8
.long 0xd390, 0x4810, 0x14810, 0x24810
.long 0xd3a0, 0x4830, 0x14830, 0x24830
.long 0xd420, 0x4818, 0x14818, 0x24818
.long 0xd430, 0x4838, 0x14838, 0x24838
.long 0xd3b0, 0x4a50, 0x14a50, 0x24a50
.long 0xd3c0, 0x4a70, 0x14a70, 0x24a70
.long 0xd440, 0x4a58, 0x14a58, 0x24a58
.long 0xd450, 0x4a78, 0x14a78, 0x24a78
.long 0xd3d0, 0x4c90, 0x14c90, 0x24c90
.long 0xd3e0, 0x4cb0, 0x14cb0, 0x24cb0
.long 0xd460, 0x4c98, 0x14c98, 0x24c98
.long 0xd470, 0x4cb8, 0x14cb8, 0x24cb8
.long 0xd3f0, 0x4ed0, 0x14ed0, 0x24ed0
.long 0xd400, 0x4ef0, 0x14ef0, 0x24ef0
.long 0xd480, 0x4ed8, 0x14ed8, 0x24ed8
.long 0xd490, 0x4ef8, 0x14ef8, 0x24ef8
.long 0x0, 0x24a0, 0x4940, 0x6de0
.long 0x10, 0x24b0, 0x4950, 0x6df0
.long 0x90, 0x2530, 0x49d0, 0x6e70
.long 0xa0, 0x2540, 0x49e0, 0x6e80
.long 0x20, 0x24c0, 0x4960, 0x6e00
.long 0x30, 0x24d0, 0x4970, 0x6e00
.long 0xb0, 0x2550, 0x49f0, 0x6e90
.long 0xc0, 0x2560, 0x4a00, 0x6e90
.long 0x40, 0x24e0, 0x4980, 0x7b00
.long 0x50, 0x24f0, 0x4980, 0x7b10
.long 0xd0, 0x2570, 0x4a10, 0x7b90
.long 0xe0, 0x2580, 0x4a10, 0x7ba0
.long 0x60, 0x2500, 0x5680, 0x7b20
.long 0x70, 0x2500, 0x5690, 0x7b30
.long 0xf0, 0x2590, 0x5710, 0x7bb0
.long 0x100, 0x2590, 0x5720, 0x7bc0
.long 0x80, 0x3200, 0x56a0, 0x7b40
.long 0x80, 0x3210, 0x56b0, 0x7b50
.long 0x110, 0x3290, 0x5730, 0x7bd0
.long 0x110, 0x32a0, 0x5740, 0x7be0
.long 0xd80, 0x3220, 0x56c0, 0x7b60
.long 0xd90, 0x3230, 0x56d0, 0x7b70
.long 0xe10, 0x32b0, 0x5750, 0x7bf0
.long 0xe20, 0x32c0, 0x5760, 0x7c00
.long 0xda0, 0x3240, 0x56e0, 0x7b80
.long 0xdb0, 0x3250, 0x56f0, 0x7b80
.long 0xe30, 0x32d0, 0x5770, 0x7c10
.long 0xe40, 0x32e0, 0x5780, 0x7c10
.long 0xdc0, 0x3260, 0x5700, 0x8880
.long 0xdd0, 0x3270, 0x5700, 0x8890
.long 0xe50, 0x32f0, 0x5790, 0x8910
.long 0xe60, 0x3300, 0x5790, 0x8920
.long 0xde0, 0x3280, 0x6400, 0x88a0
.long 0xdf0, 0x3280, 0x6410, 0x88b0
.long 0xe70, 0x3310, 0x6490, 0x8930
.long 0xe80, 0x3310, 0x64a0, 0x8940
.long 0xe00, 0x3f80, 0x6420, 0x88c0
.long 0xe00, 0x3f90, 0x6430, 0x88d0
.long 0xe90, 0x4010, 0x64b0, 0x8950
.long 0xe90, 0x4020, 0x64c0, 0x8960
.long 0x1b00, 0x3fa0, 0x6440, 0x88e0
.long 0x1b10, 0x3fb0, 0x6450, 0x88f0
.long 0x1b90, 0x4030, 0x64d0, 0x8970
.long 0x1ba0, 0x4040, 0x64e0, 0x8980
.long 0x1b20, 0x3fc0, 0x6460, 0x8900
.long 0x1b30, 0x3fd0, 0x6470, 0x8900
.long 0x1bb0, 0x4050, 0x64f0, 0x8990
.long 0x1bc0, 0x4060, 0x6500, 0x8990
.long 0x1b40, 0x3fe0, 0x6480, 0x9600
.long 0x1b50, 0x3ff0, 0x6480, 0x9610
.long 0x1bd0, 0x4070, 0x6510, 0x9690
.long 0x1be0, 0x4080, 0x6510, 0x96a0
.long 0x1b60, 0x4000, 0x7180, 0x9620
.long 0x1b70, 0x4000, 0x7190, 0x9630
.long 0x1bf0, 0x4090, 0x7210, 0x96b0
.long 0x1c00, 0x4090, 0x7220, 0x96c0
.long 0x1b80, 0x4d00, 0x71a0, 0x9640
.long 0x1b80, 0x4d10, 0x71b0, 0x9650
.long 0x1c10, 0x4d90, 0x7230, 0x96d0
.long 0x1c10, 0x4da0, 0x7240, 0x96e0
.long 0x2880, 0x4d20, 0x71c0, 0x9660
.long 0x2890, 0x4d30, 0x71d0, 0x9670
.long 0x2910, 0x4db0, 0x7250, 0x96f0
.long 0x2920, 0x4dc0, 0x7260, 0x9700
.long 0xa280, 0x0, 0x24000, 0x15800
.long 0xa280, 0x20, 0x40000, 0x15a50
.long 0xa310, 0x8, 0x24008, 0x15ca0
.long 0xa310, 0x28, 0x40000, 0x15ef0
.long 0xaf80, 0x140, 0x24060, 0x16140
.long 0xaf90, 0x160, 0x40000, 0x16390
.long 0xb010, 0x148, 0x24068, 0x165e0
.long 0xb020, 0x168, 0x40000, 0x16830
.long 0xafa0, 0x280, 0x240c0, 0x16a80
.long 0xafb0, 0x2a0, 0x40000, 0x16cd0
.long 0xb030, 0x288, 0x240c8, 0x16f20
.long 0xb040, 0x2a8, 0x40000, 0x17170
.long 0xafc0, 0x3c0, 0x24120, 0x173c0
.long 0xafd0, 0x3e0, 0x40000, 0x17610
.long 0xb050, 0x3c8, 0x24128, 0x17860
.long 0xb060, 0x3e8, 0x40000, 0x17ab0
.long 0xafe0, 0x10, 0x24010, 0x17d00
.long 0xaff0, 0x30, 0x40000, 0x17f50
.long 0xb070, 0x18, 0x24018, 0x181a0
.long 0xb080, 0x38, 0x40000, 0x183f0
.long 0xb000, 0x150, 0x24070, 0x18640
.long 0xb000, 0x170, 0x40000, 0x18890
.long 0xb090, 0x158, 0x24078, 0x18ae0
.long 0xb090, 0x178, 0x40000, 0x18d30
.long 0xbd00, 0x290, 0x240d0, 0x18f80
.long 0xbd10, 0x2b0, 0x40000, 0x191d0
.long 0xbd90, 0x298, 0x240d8, 0x19420
.long 0xbda0, 0x2b8, 0x40000, 0x19670
.long 0xbd20, 0x3d0, 0x24130, 0x198c0
.long 0xbd30, 0x3f0, 0x40000, 0x19b10
.long 0xbdb0, 0x3d8, 0x24138, 0x19d60
.long 0xbdc0, 0x3f8, 0x40000, 0x19fb0
.long 0xbd40, 0x2800, 0x40000, 0x15920
.long 0xbd50, 0x2820, 0x25b00, 0x15b70
.long 0xbdd0, 0x2808, 0x40000, 0x15dc0
.long 0xbde0, 0x2828, 0x25b08, 0x16010
.long 0xbd60, 0x2940, 0x40000, 0x16260
.long 0xbd70, 0x2960, 0x25b60, 0x164b0
.long 0xbdf0, 0x2948, 0x40000, 0x16700
.long 0xbe00, 0x2968, 0x25b68, 0x16950
.long 0xbd80, 0x2a80, 0x40000, 0x16ba0
.long 0xbd80, 0x2aa0, 0x25bc0, 0x16df0
.long 0xbe10, 0x2a88, 0x40000, 0x17040
.long 0xbe10, 0x2aa8, 0x25bc8, 0x17290
.long 0xca80, 0x2bc0, 0x40000, 0x174e0
.long 0xca90, 0x2be0, 0x25c20, 0x17730
.long 0xcb10, 0x2bc8, 0x40000, 0x17980
.long 0xcb20, 0x2be8, 0x25c28, 0x17bd0
.long 0xcaa0, 0x2810, 0x40000, 0x17e20
.long 0xcab0, 0x2830, 0x25b10, 0x18070
.long 0xcb30, 0x2818, 0x40000, 0x182c0
.long 0xcb40, 0x2838, 0x25b18, 0x18510
.long 0xcac0, 0x2950, 0x40000, 0x18760
.long 0xcad0, 0x2970, 0x25b70, 0x189b0
.long 0xcb50, 0x2958, 0x40000, 0x18c00
.long 0xcb60, 0x2978, 0x25b78, 0x18e50
.long 0xcae0, 0x2a90, 0x40000, 0x190a0
.long 0xcaf0, 0x2ab0, 0x25bd0, 0x192f0
.long 0xcb70, 0x2a98, 0x40000, 0x19540
.long 0xcb80, 0x2ab8, 0x25bd8, 0x19790
.long 0xcb00, 0x2bd0, 0x40000, 0x199e0
.long 0xcb00, 0x2bf0, 0x25c30, 0x19c30
.long 0xcb90, 0x2bd8, 0x40000, 0x19e80
.long 0xcb90, 0x2bf8, 0x25c38, 0x1a0d0
.long 0x3f80, 0x0, 0x0, 0x0
.long 0x3f800000, 0x0, 0x0, 0x0
.long 0x0, 0x3f80, 0x0, 0x0
.long 0x0, 0x3f800000, 0x0, 0x0
.long 0x0, 0x0, 0x0, 0x0
.long 0x0, 0x0, 0x0, 0x0
.long 0x0, 0x0, 0x0, 0x0
.long 0x0, 0x0, 0x0, 0x0
.long 0x0, 0x0, 0x3f80, 0x0
.long 0x0, 0x0, 0x3f800000, 0x0
.long 0x0, 0x0, 0x0, 0x3f80
.long 0x0, 0x0, 0x0, 0x3f800000
.long 0x0, 0x0, 0x0, 0x0
.long 0x0, 0x0, 0x0, 0x0
.long 0x0, 0x0, 0x0, 0x0
.long 0x0, 0x0, 0x0, 0x0
.long 0x0, 0x0, 0x0, 0x0
.long 0x0, 0x0, 0x0, 0x0
.long 0x0, 0x0, 0x0, 0x0
.long 0x0, 0x0, 0x0, 0x0
.long 0x0, 0x0, 0x0, 0x0
.long 0x0, 0x0, 0x0, 0x0
.long 0x0, 0x0, 0x0, 0x0
.long 0x0, 0x0, 0x0, 0x0
.long 0x0, 0x0, 0x0, 0x0
.long 0x0, 0x0, 0x0, 0x0
.long 0x0, 0x0, 0x0, 0x0
.long 0x0, 0x0, 0x0, 0x0
.long 0x0, 0x0, 0x0, 0x0
.long 0x0, 0x0, 0x0, 0x0
.long 0x0, 0x0, 0x0, 0x0
.long 0x0, 0x0, 0x0, 0x0
.long 0x0, 0x0, 0x0, 0x0
.long 0x0, 0x0, 0x0, 0x0
.long 0x0, 0x0, 0x0, 0x0
.long 0x0, 0x0, 0x0, 0x0
.long 0x3f80, 0x0, 0x0, 0x0
.long 0x3f800000, 0x0, 0x0, 0x0
.long 0x0, 0x3f80, 0x0, 0x0
.long 0x0, 0x3f800000, 0x0, 0x0
.long 0x0, 0x0, 0x0, 0x0
.long 0x0, 0x0, 0x0, 0x0
.long 0x0, 0x0, 0x0, 0x0
.long 0x0, 0x0, 0x0, 0x0
.long 0x0, 0x0, 0x3f80, 0x0
.long 0x0, 0x0, 0x3f800000, 0x0
.long 0x0, 0x0, 0x0, 0x3f80
.long 0x0, 0x0, 0x0, 0x3f800000
.long 0x0, 0x0, 0x0, 0x0
.long 0x0, 0x0, 0x0, 0x0
.long 0x0, 0x0, 0x0, 0x0
.long 0x0, 0x0, 0x0, 0x0
.long 0x0, 0x0, 0x0, 0x0
.long 0x0, 0x0, 0x0, 0x0
.long 0x0, 0x0, 0x0, 0x0
.long 0x0, 0x0, 0x0, 0x0
.long 0x0, 0x0, 0x0, 0x0
.long 0x0, 0x0, 0x0, 0x0
.long 0x0, 0x0, 0x0, 0x0
.long 0x0, 0x0, 0x0, 0x0
.long 0x0, 0x0, 0x0, 0x0
.long 0x0, 0x0, 0x0, 0x0
.long 0x0, 0x0, 0x0, 0x0
.long 0x0, 0x0, 0x0, 0x0
.long 0x0, 0x0, 0x0, 0x0
.long 0x0, 0x0, 0x0, 0x0
.long 0x0, 0x0, 0x0, 0x0
.long 0x0, 0x0, 0x0, 0x0
.long 0x0, 0x0, 0x0, 0x0
.long 0x0, 0x0, 0x0, 0x0
.long 0x0, 0x0, 0x0, 0x0
.long 0x0, 0x0, 0x0, 0x0
.long 0x0, 0x0, 0x0, 0x0
.long 0x0, 0x0, 0x0, 0x0
.long 0x0, 0x0, 0x0, 0x0
.long 0x0, 0x0, 0x0, 0x0
.long 0x0, 0x0, 0x0, 0x0
.long 0x0, 0x0, 0x0, 0x0
.long 0x0, 0x0, 0x0, 0x0
.long 0x0, 0x0, 0x0, 0x0
.long 0x3f80, 0x0, 0x0, 0x0
.long 0x3f800000, 0x0, 0x0, 0x0
.long 0x0, 0x3f80, 0x0, 0x0
.long 0x0, 0x3f800000, 0x0, 0x0
.long 0x0, 0x0, 0x0, 0x0
.long 0x0, 0x0, 0x0, 0x0
.long 0x0, 0x0, 0x0, 0x0
.long 0x0, 0x0, 0x0, 0x0
.long 0x0, 0x0, 0x3f80, 0x0
.long 0x0, 0x0, 0x3f800000, 0x0
.long 0x0, 0x0, 0x0, 0x3f80
.long 0x0, 0x0, 0x0, 0x3f800000
.long 0x0, 0x0, 0x0, 0x0
.long 0x0, 0x0, 0x0, 0x0
.long 0x0, 0x0, 0x0, 0x0
.long 0x0, 0x0, 0x0, 0x0
.long 0x0, 0x0, 0x0, 0x0
.long 0x0, 0x0, 0x0, 0x0
.long 0x0, 0x0, 0x0, 0x0
.long 0x0, 0x0, 0x0, 0x0
.long 0x0, 0x0, 0x0, 0x0
.long 0x0, 0x0, 0x0, 0x0
.long 0x0, 0x0, 0x0, 0x0
.long 0x0, 0x0, 0x0, 0x0
.long 0x0, 0x0, 0x0, 0x0
.long 0x0, 0x0, 0x0, 0x0
.long 0x0, 0x0, 0x0, 0x0
.long 0x0, 0x0, 0x0, 0x0
.long 0x0, 0x0, 0x0, 0x0
.long 0x0, 0x0, 0x0, 0x0
.long 0x0, 0x0, 0x0, 0x0
.long 0x0, 0x0, 0x0, 0x0
.long 0x0, 0x0, 0x0, 0x0
.long 0x0, 0x0, 0x0, 0x0
.long 0x0, 0x0, 0x0, 0x0
.long 0x0, 0x0, 0x0, 0x0
.long 0x3f80, 0x0, 0x0, 0x0
.long 0x3f800000, 0x0, 0x0, 0x0
.long 0x0, 0x3f80, 0x0, 0x0
.long 0x0, 0x3f800000, 0x0, 0x0
.long 0x0, 0x0, 0x0, 0x0
.long 0x0, 0x0, 0x0, 0x0
.long 0x0, 0x0, 0x0, 0x0
.long 0x0, 0x0, 0x0, 0x0
.long 0x0, 0x0, 0x3f80, 0x0
.long 0x0, 0x0, 0x3f800000, 0x0
.long 0x0, 0x0, 0x0, 0x3f80
.long 0x0, 0x0, 0x0, 0x3f800000
.long 0x0, 0x0, 0x0, 0x0
.long 0x150, 0x8c, 0x10, 0x10
.long 0x2a0, 0x11c, 0x20, 0x20
.long 0x3f0, 0xd80, 0x30, 0x30
.long 0x540, 0xe0c, 0x40, 0x40
.long 0x690, 0xe9c, 0x50, 0x50
.long 0x7e0, 0x1b00, 0x60, 0x60
.long 0x930, 0x1b8c, 0x70, 0x70
.long 0xa80, 0x1c1c, 0x80, 0x80
.long 0xbd0, 0x2880, 0x90, 0x90
.long 0xd20, 0x290c, 0xa0, 0xa0
.long 0xe70, 0x299c, 0xb0, 0xb0
.long 0xfc0, 0x3600, 0xc0, 0xc0
.long 0x1110, 0x368c, 0xd0, 0xd0
.long 0x1260, 0x371c, 0xe0, 0xe0
.long 0x13b0, 0x4380, 0xf0, 0xf0
.long 0x1500, 0x440c, 0x100, 0x100
.long 0x1650, 0x449c, 0x110, 0x110
.long 0x17a0, 0x5100, 0x40000000, 0x120
.long 0x18f0, 0x518c, 0x40000000, 0x130
.long 0x1a40, 0x521c, 0x120, 0x40000000
.long 0x1b90, 0x5e80, 0x130, 0x40000000
.long 0x1ce0, 0x5f0c, 0x40000000, 0x40000000
.long 0x1e30, 0x5f9c, 0x40000000, 0x40000000
.long 0x1f80, 0x6c00, 0x40000000, 0x40000000
.long 0x20d0, 0x6c8c, 0x40000000, 0x40000000
.long 0x2220, 0x6d1c, 0x40000000, 0x40000000
.long 0x2370, 0x7980, 0x40000000, 0x40000000
.long 0x24c0, 0x7a0c, 0x40000000, 0x40000000
.long 0x2610, 0x7a9c, 0x40000000, 0x40000000
.long 0x2760, 0x8700, 0x40000000, 0x40000000
.long 0x28b0, 0x878c, 0x40000000, 0x40000000
.long 0xa0, 0x881c, 0x140, 0x140
.long 0x1f0, 0x9480, 0x150, 0x150
.long 0x340, 0x950c, 0x160, 0x160
.long 0x490, 0x959c, 0x170, 0x170
.long 0x5e0, 0xa200, 0x180, 0x180
.long 0x730, 0xa28c, 0x190, 0x190
.long 0x880, 0xa31c, 0x1a0, 0x1a0
.long 0x9d0, 0xaf80, 0x1b0, 0x1b0
.long 0xb20, 0xb00c, 0x1c0, 0x1c0
.long 0xc70, 0xb09c, 0x1d0, 0x1d0
.long 0xdc0, 0xbd00, 0x1e0, 0x1e0
.long 0xf10, 0xbd8c, 0x1f0, 0x1f0
.long 0x1060, 0xbe1c, 0x200, 0x200
.long 0x11b0, 0xca80, 0x210, 0x210
.long 0x1300, 0xcb0c, 0x220, 0x220
.long 0x1450, 0xcb9c, 0x230, 0x230
.long 0x15a0, 0xd800, 0x240, 0x240
.long 0x16f0, 0xd88c, 0x250, 0x250
.long 0x1840, 0xd91c, 0x40000000, 0x260
.long 0x1990, 0xe580, 0x40000000, 0x270
.long 0x1ae0, 0xe60c, 0x260, 0x40000000
.long 0x1c30, 0xe69c, 0x270, 0x40000000
.long 0x1d80, 0xe69c, 0x40000000, 0x40000000
.long 0x1ed0, 0xe69c, 0x40000000, 0x40000000
.long 0x2020, 0xe69c, 0x40000000, 0x40000000
.long 0x2170, 0xe69c, 0x40000000, 0x40000000
.long 0x22c0, 0xe69c, 0x40000000, 0x40000000
.long 0x2410, 0xe69c, 0x40000000, 0x40000000
.long 0x2560, 0xe69c, 0x40000000, 0x40000000
.long 0x26b0, 0xe69c, 0x40000000, 0x40000000
.long 0x2800, 0xe69c, 0x40000000, 0x40000000
.long 0x2950, 0xe69c, 0x40000000, 0x40000000
.long 0x15800, 0x15840, 0x0, 0x27000
.long 0x15810, 0x15840, 0x8, 0x27008
.long 0x15808, 0x15888, 0x10, 0x27010
.long 0x15818, 0x15888, 0x18, 0x27018
.long 0x16140, 0x16180, 0x540, 0x27020
.long 0x16150, 0x16180, 0x548, 0x27028
.long 0x16148, 0x161c8, 0x550, 0x27030
.long 0x16158, 0x161c8, 0x558, 0x27038
.long 0x16a80, 0x16ac0, 0xa80, 0x27040
.long 0x16a90, 0x16ac0, 0xa88, 0x27048
.long 0x16a88, 0x16b08, 0xa90, 0x27050
.long 0x16a98, 0x16b08, 0xa98, 0x27058
.long 0x173c0, 0x17400, 0xfc0, 0x27060
.long 0x173d0, 0x17400, 0xfc8, 0x27068
.long 0x173c8, 0x17448, 0xfd0, 0x27070
.long 0x173d8, 0x17448, 0xfd8, 0x27078
.long 0x15820, 0x15840, 0x20, 0x27080
.long 0x15830, 0x15840, 0x20, 0x27088
.long 0x15828, 0x15888, 0x20, 0x27090
.long 0x15838, 0x15888, 0x20, 0x27098
.long 0x16160, 0x16180, 0x560, 0x270a0
.long 0x16170, 0x16180, 0x560, 0x270a8
.long 0x16168, 0x161c8, 0x560, 0x270b0
.long 0x16178, 0x161c8, 0x560, 0x270b8
.long 0x16aa0, 0x16ac0, 0xaa0, 0x270c0
.long 0x16ab0, 0x16ac0, 0xaa0, 0x270c8
.long 0x16aa8, 0x16b08, 0xaa0, 0x270d0
.long 0x16ab8, 0x16b08, 0xaa0, 0x270d8
.long 0x173e0, 0x17400, 0xfe0, 0x270e0
.long 0x173f0, 0x17400, 0xfe0, 0x270e8
.long 0x173e8, 0x17448, 0xfe0, 0x270f0
.long 0x173f8, 0x17448, 0xfe0, 0x270f8
.long 0x15ca0, 0x15ce0, 0x2a0, 0x27104
.long 0x15cb0, 0x15ce0, 0x2a8, 0x2710c
.long 0x15ca8, 0x15d28, 0x2b0, 0x27114
.long 0x15cb8, 0x15d28, 0x2b8, 0x2711c
.long 0x165e0, 0x16620, 0x7e0, 0x27124
.long 0x165f0, 0x16620, 0x7e8, 0x2712c
.long 0x165e8, 0x16668, 0x7f0, 0x27134
.long 0x165f8, 0x16668, 0x7f8, 0x2713c
.long 0x16f20, 0x16f60, 0xd20, 0x27144
.long 0x16f30, 0x16f60, 0xd28, 0x2714c
.long 0x16f28, 0x16fa8, 0xd30, 0x27154
.long 0x16f38, 0x16fa8, 0xd38, 0x2715c
.long 0x17860, 0x178a0, 0x1260, 0x27164
.long 0x17870, 0x178a0, 0x1268, 0x2716c
.long 0x17868, 0x178e8, 0x1270, 0x27174
.long 0x17878, 0x178e8, 0x1278, 0x2717c
.long 0x15cc0, 0x15ce0, 0x2c0, 0x27184
.long 0x15cd0, 0x15ce0, 0x2c0, 0x2718c
.long 0x15cc8, 0x15d28, 0x2c0, 0x27194
.long 0x15cd8, 0x15d28, 0x2c0, 0x2719c
.long 0x16600, 0x16620, 0x800, 0x271a4
.long 0x16610, 0x16620, 0x800, 0x271ac
.long 0x16608, 0x16668, 0x800, 0x271b4
.long 0x16618, 0x16668, 0x800, 0x271bc
.long 0x16f40, 0x16f60, 0xd40, 0x271c4
.long 0x16f50, 0x16f60, 0xd40, 0x271cc
.long 0x16f48, 0x16fa8, 0xd40, 0x271d4
.long 0x16f58, 0x16fa8, 0xd40, 0x271dc
.long 0x17880, 0x178a0, 0x1280, 0x271e4
.long 0x17890, 0x178a0, 0x1280, 0x271ec
.long 0x17888, 0x178e8, 0x1280, 0x271f4
.long 0x17898, 0x178e8, 0x1280, 0x271fc
.long 0x23000, 0x0, 0x0, 0x0
.long 0x23010, 0x2800, 0x10, 0x0
.long 0x23020, 0x5000, 0x20, 0x0
.long 0x23030, 0x7800, 0x30, 0x0
.long 0x23040, 0xa000, 0x40, 0x0
.long 0x23050, 0xc800, 0x50, 0x0
.long 0x23060, 0xf000, 0x60, 0x0
.long 0x23070, 0x11800, 0x70, 0x0
.long 0x23080, 0x14000, 0x80, 0x0
.long 0x23090, 0x16800, 0x90, 0x0
.long 0x230a0, 0x19000, 0xa0, 0x0
.long 0x230b0, 0x1b800, 0xb0, 0x0
.long 0x230c0, 0x1e000, 0xc0, 0x0
.long 0x230d0, 0x20800, 0xd0, 0x0
.long 0x230e0, 0x23000, 0xe0, 0x0
.long 0x230f0, 0x25800, 0xf0, 0x0
.long 0x23100, 0x0, 0x0, 0x0
.long 0x23110, 0x2800, 0x10, 0x0
.long 0x23120, 0x5000, 0x20, 0x0
.long 0x23130, 0x7800, 0x30, 0x0
.long 0x23140, 0xa000, 0x40, 0x0
.long 0x23150, 0xc800, 0x50, 0x0
.long 0x23160, 0xf000, 0x60, 0x0
.long 0x23170, 0x11800, 0x70, 0x0
.long 0x23180, 0x14000, 0x80, 0x0
.long 0x23190, 0x16800, 0x90, 0x0
.long 0x231a0, 0x19000, 0xa0, 0x0
.long 0x231b0, 0x1b800, 0xb0, 0x0
.long 0x231c0, 0x1e000, 0xc0, 0x0
.long 0x231d0, 0x20800, 0xd0, 0x0
.long 0x231e0, 0x23000, 0xe0, 0x0
.long 0x231f0, 0x25800, 0xf0, 0x0
.long 0x23200, 0x0, 0x0, 0x0
.long 0x23210, 0x2800, 0x10, 0x0
.long 0x23220, 0x5000, 0x20, 0x0
.long 0x23230, 0x7800, 0x30, 0x0
.long 0x23240, 0xa000, 0x40, 0x0
.long 0x23250, 0xc800, 0x50, 0x0
.long 0x23260, 0xf000, 0x60, 0x0
.long 0x23270, 0x11800, 0x70, 0x0
.long 0x23280, 0x14000, 0x80, 0x0
.long 0x23290, 0x16800, 0x90, 0x0
.long 0x232a0, 0x19000, 0xa0, 0x0
.long 0x232b0, 0x1b800, 0xb0, 0x0
.long 0x232c0, 0x1e000, 0xc0, 0x0
.long 0x232d0, 0x20800, 0xd0, 0x0
.long 0x232e0, 0x23000, 0xe0, 0x0
.long 0x232f0, 0x25800, 0xf0, 0x0
.long 0x23300, 0x0, 0x0, 0x0
.long 0x23310, 0x2800, 0x10, 0x0
.long 0x23320, 0x5000, 0x20, 0x0
.long 0x23330, 0x7800, 0x30, 0x0
.long 0x23340, 0xa000, 0x40, 0x0
.long 0x23350, 0xc800, 0x50, 0x0
.long 0x23360, 0xf000, 0x60, 0x0
.long 0x23370, 0x11800, 0x70, 0x0
.long 0x23380, 0x14000, 0x80, 0x0
.long 0x23390, 0x16800, 0x90, 0x0
.long 0x233a0, 0x19000, 0xa0, 0x0
.long 0x233b0, 0x1b800, 0xb0, 0x0
.long 0x233c0, 0x1e000, 0xc0, 0x0
.long 0x233d0, 0x20800, 0xd0, 0x0
.long 0x233e0, 0x23000, 0xe0, 0x0
.long 0x233f0, 0x25800, 0xf0, 0x0
.long 0x24000, 0x24a94, 0x2552c, 0x25fec
.long 0x24004, 0x24a98, 0x2556c, 0x25ff0
.long 0x24008, 0x24a9c, 0x25570, 0x25ff4
.long 0x2400c, 0x24aa0, 0x25574, 0x25ff8
.long 0x24010, 0x24aa4, 0x25578, 0x25ffc
.long 0x24014, 0x24ae4, 0x2557c, 0x26000
.long 0x24018, 0x24ae8, 0x25580, 0x26040
.long 0x2401c, 0x24aec, 0x25584, 0x26044
.long 0x24020, 0x24af0, 0x25588, 0x26048
.long 0x24060, 0x24af4, 0x2558c, 0x2604c
.long 0x24064, 0x24af8, 0x255cc, 0x26050
.long 0x24068, 0x24afc, 0x255d0, 0x26054
.long 0x2406c, 0x24b00, 0x255d4, 0x26058
.long 0x24070, 0x24b04, 0x255d8, 0x2605c
.long 0x24074, 0x24b44, 0x255dc, 0x26060
.long 0x24078, 0x24b48, 0x255e0, 0x260a0
.long 0x2407c, 0x24b4c, 0x255e4, 0x260a4
.long 0x24080, 0x24b50, 0x255e8, 0x260a8
.long 0x240c0, 0x24b54, 0x255ec, 0x260ac
.long 0x240c4, 0x24b58, 0x2562c, 0x260b0
.long 0x240c8, 0x24b5c, 0x25630, 0x260b4
.long 0x240cc, 0x24b60, 0x25634, 0x260b8
.long 0x240d0, 0x24b64, 0x25638, 0x260bc
.long 0x240d4, 0x24ba4, 0x2563c, 0x260c0
.long 0x240d8, 0x24ba8, 0x25640, 0x26100
.long 0x240dc, 0x24bac, 0x25644, 0x26104
.long 0x240e0, 0x24bb0, 0x25648, 0x26108
.long 0x24120, 0x24bb4, 0x2564c, 0x2610c
.long 0x24124, 0x24bb8, 0x2568c, 0x26110
.long 0x24128, 0x24bbc, 0x25690, 0x26114
.long 0x2412c, 0x24bc0, 0x25694, 0x26118
.long 0x24130, 0x24bc4, 0x25698, 0x2611c
.long 0x24134, 0x24c04, 0x2569c, 0x26120
.long 0x24138, 0x24c08, 0x256a0, 0x26160
.long 0x2413c, 0x24c0c, 0x256a4, 0x26164
.long 0x24140, 0x24c10, 0x256a8, 0x26168
.long 0x24180, 0x24c14, 0x256ac, 0x2616c
.long 0x24184, 0x24c18, 0x256ec, 0x26170
.long 0x24188, 0x24c1c, 0x256f0, 0x26174
.long 0x2418c, 0x24c20, 0x256f4, 0x26178
.long 0x24190, 0x24c24, 0x256f8, 0x2617c
.long 0x24194, 0x24c64, 0x256fc, 0x26180
.long 0x24198, 0x24c68, 0x25700, 0x261e4
.long 0x2419c, 0x24c6c, 0x25704, 0x261e8
.long 0x241a0, 0x24c70, 0x25708, 0x261ec
.long 0x241e0, 0x24c74, 0x2570c, 0x261f0
.long 0x241e4, 0x24c78, 0x2574c, 0x261f4
.long 0x241e8, 0x24c7c, 0x25750, 0x261f8
.long 0x241ec, 0x24c80, 0x25754, 0x261fc
.long 0x241f0, 0x24c84, 0x25758, 0x26200
.long 0x241f4, 0x24cc4, 0x2575c, 0x26204
.long 0x241f8, 0x24cc8, 0x25760, 0x26244
.long 0x241fc, 0x24ccc, 0x25764, 0x26248
.long 0x24200, 0x24cd0, 0x25768, 0x2624c
.long 0x24240, 0x24cd4, 0x2576c, 0x26250
.long 0x24244, 0x24cd8, 0x257ac, 0x26254
.long 0x24248, 0x24cdc, 0x257b0, 0x26258
.long 0x2424c, 0x24ce0, 0x257b4, 0x2625c
.long 0x24250, 0x24ce4, 0x257b8, 0x26260
.long 0x24254, 0x24d24, 0x257bc, 0x26264
.long 0x24258, 0x24d28, 0x257c0, 0x262a4
.long 0x2425c, 0x24d2c, 0x257c4, 0x262a8
.long 0x24260, 0x24d30, 0x257c8, 0x262ac
.long 0x242a0, 0x24d34, 0x257cc, 0x262b0
.long 0x242a4, 0x24d38, 0x2580c, 0x262b4
.long 0x242a8, 0x24d3c, 0x25810, 0x262b8
.long 0x242ac, 0x24d40, 0x25814, 0x262bc
.long 0x242b0, 0x24d44, 0x25818, 0x262c0
.long 0x242b4, 0x24da8, 0x2581c, 0x262c4
.long 0x242b8, 0x24dac, 0x25820, 0x26304
.long 0x242bc, 0x24db0, 0x25824, 0x26308
.long 0x242c0, 0x24db4, 0x25828, 0x2630c
.long 0x24300, 0x24db8, 0x2582c, 0x26310
.long 0x24304, 0x24dbc, 0x2586c, 0x26314
.long 0x24308, 0x24dc0, 0x25870, 0x26318
.long 0x2430c, 0x24dc4, 0x25874, 0x2631c
.long 0x24310, 0x24dc8, 0x25878, 0x26320
.long 0x24314, 0x24e08, 0x2587c, 0x26324
.long 0x24318, 0x24e0c, 0x25880, 0x26364
.long 0x2431c, 0x24e10, 0x25884, 0x26368
.long 0x24320, 0x24e14, 0x25888, 0x2636c
.long 0x24360, 0x24e18, 0x2588c, 0x26370
.long 0x24364, 0x24e1c, 0x258cc, 0x26374
.long 0x24368, 0x24e20, 0x258d0, 0x26378
.long 0x2436c, 0x24e24, 0x258d4, 0x2637c
.long 0x24370, 0x24e28, 0x258d8, 0x26380
.long 0x24374, 0x24e68, 0x258dc, 0x26384
.long 0x24378, 0x24e6c, 0x258e0, 0x263c4
.long 0x2437c, 0x24e70, 0x258e4, 0x263c8
.long 0x24380, 0x24e74, 0x258e8, 0x263cc
.long 0x243c0, 0x24e78, 0x258ec, 0x263d0
.long 0x243c4, 0x24e7c, 0x2592c, 0x263d4
.long 0x243c8, 0x24e80, 0x25930, 0x263d8
.long 0x243cc, 0x24e84, 0x25934, 0x263dc
.long 0x243d0, 0x24e88, 0x25938, 0x263e0
.long 0x243d4, 0x24ec8, 0x2593c, 0x263e4
.long 0x243d8, 0x24ecc, 0x25940, 0x26404
.long 0x243dc, 0x24ed0, 0x25944, 0x26408
.long 0x243e0, 0x24ed4, 0x25948, 0x2640c
.long 0x24420, 0x24ed8, 0x2594c, 0x26410
.long 0x24424, 0x24edc, 0x2598c, 0x26414
.long 0x24428, 0x24ee0, 0x25990, 0x26418
.long 0x2442c, 0x24ee4, 0x25994, 0x2641c
.long 0x24430, 0x24ee8, 0x25998, 0x26420
.long 0x24434, 0x24f08, 0x2599c, 0x26424
.long 0x24438, 0x24f0c, 0x259a0, 0x26464
.long 0x2443c, 0x24f10, 0x259a4, 0x26468
.long 0x24440, 0x24f14, 0x259a8, 0x2646c
.long 0x24480, 0x24f18, 0x259ac, 0x26470
.long 0x24484, 0x24f1c, 0x259ec, 0x26474
.long 0x24488, 0x24f20, 0x259f0, 0x26478
.long 0x2448c, 0x24f24, 0x259f4, 0x2647c
.long 0x24490, 0x24f28, 0x259f8, 0x26480
.long 0x24494, 0x24f68, 0x259fc, 0x26484
.long 0x24498, 0x24f6c, 0x25a00, 0x264c4
.long 0x2449c, 0x24f70, 0x25a04, 0x264c8
.long 0x244a0, 0x24f74, 0x25a08, 0x264cc
.long 0x244e0, 0x24f78, 0x25a0c, 0x264d0
.long 0x244e4, 0x24f7c, 0x25a4c, 0x264d4
.long 0x244e8, 0x24f80, 0x25a50, 0x264d8
.long 0x244ec, 0x24f84, 0x25a54, 0x264dc
.long 0x244f0, 0x24f88, 0x25a58, 0x264e0
.long 0x244f4, 0x24fc8, 0x25a5c, 0x264e4
.long 0x244f8, 0x24fcc, 0x25a60, 0x26524
.long 0x244fc, 0x24fd0, 0x25a64, 0x26528
.long 0x24500, 0x24fd4, 0x25a68, 0x2652c
.long 0x24540, 0x24fd8, 0x25a6c, 0x26530
.long 0x24544, 0x24fdc, 0x25aac, 0x26534
.long 0x24548, 0x24fe0, 0x25ab0, 0x26538
.long 0x2454c, 0x24fe4, 0x25ab4, 0x2653c
.long 0x24550, 0x24fe8, 0x25ab8, 0x26540
.long 0x24554, 0x25028, 0x25abc, 0x26544
.long 0x24558, 0x2502c, 0x25ac0, 0x26584
.long 0x2455c, 0x25030, 0x25ac4, 0x26588
.long 0x24560, 0x25034, 0x25ac8, 0x2658c
.long 0x245a0, 0x25038, 0x25acc, 0x26590
.long 0x245a4, 0x2503c, 0x25b00, 0x26594
.long 0x245a8, 0x25040, 0x25b04, 0x26598
.long 0x245ac, 0x25044, 0x25b08, 0x2659c
.long 0x245b0, 0x25048, 0x25b0c, 0x265a0
.long 0x245b4, 0x25088, 0x25b10, 0x265a4
.long 0x245b8, 0x2508c, 0x25b14, 0x265e4
.long 0x245bc, 0x25090, 0x25b18, 0x265e8
.long 0x245c0, 0x25094, 0x25b1c, 0x265ec
.long 0x24600, 0x25098, 0x25b20, 0x265f0
.long 0x24604, 0x2509c, 0x25b60, 0x265f4
.long 0x24608, 0x250a0, 0x25b64, 0x265f8
.long 0x2460c, 0x250a4, 0x25b68, 0x265fc
.long 0x24610, 0x250a8, 0x25b6c, 0x26600
.long 0x24614, 0x250e8, 0x25b70, 0x26604
.long 0x24618, 0x250ec, 0x25b74, 0x26644
.long 0x2461c, 0x250f0, 0x25b78, 0x26648
.long 0x24620, 0x250f4, 0x25b7c, 0x2664c
.long 0x24660, 0x250f8, 0x25b80, 0x26650
.long 0x24664, 0x250fc, 0x25bc0, 0x26654
.long 0x24668, 0x25100, 0x25bc4, 0x26658
.long 0x2466c, 0x25104, 0x25bc8, 0x2665c
.long 0x24670, 0x25108, 0x25bcc, 0x26660
.long 0x24674, 0x25148, 0x25bd0, 0x26664
.long 0x24678, 0x2514c, 0x25bd4, 0x266a4
.long 0x2467c, 0x25150, 0x25bd8, 0x266a8
.long 0x24680, 0x25154, 0x25bdc, 0x266ac
.long 0x246e4, 0x25158, 0x25be0, 0x266b0
.long 0x246e8, 0x2515c, 0x25c20, 0x266b4
.long 0x246ec, 0x25160, 0x25c24, 0x266b8
.long 0x246f0, 0x25164, 0x25c28, 0x266bc
.long 0x246f4, 0x25168, 0x25c2c, 0x266c0
.long 0x246f8, 0x251a8, 0x25c30, 0x266c4
.long 0x246fc, 0x251ac, 0x25c34, 0x26704
.long 0x24700, 0x251b0, 0x25c38, 0x26708
.long 0x24704, 0x251b4, 0x25c3c, 0x2670c
.long 0x24744, 0x251b8, 0x25c40, 0x26710
.long 0x24748, 0x251bc, 0x25c80, 0x26714
.long 0x2474c, 0x251c0, 0x25c84, 0x26718
.long 0x24750, 0x251c4, 0x25c88, 0x2671c
.long 0x24754, 0x251c8, 0x25c8c, 0x26720
.long 0x24758, 0x25208, 0x25c90, 0x26724
.long 0x2475c, 0x2520c, 0x25c94, 0x26764
.long 0x24760, 0x25210, 0x25c98, 0x26768
.long 0x24764, 0x25214, 0x25c9c, 0x2676c
.long 0x247a4, 0x25218, 0x25ca0, 0x26770
.long 0x247a8, 0x2521c, 0x25ce0, 0x26774
.long 0x247ac, 0x25220, 0x25ce4, 0x26778
.long 0x247b0, 0x25224, 0x25ce8, 0x2677c
.long 0x247b4, 0x25228, 0x25cec, 0x26780
.long 0x247b8, 0x25268, 0x25cf0, 0x26784
.long 0x247bc, 0x2526c, 0x25cf4, 0x267c4
.long 0x247c0, 0x25270, 0x25cf8, 0x267c8
.long 0x247c4, 0x25274, 0x25cfc, 0x267cc
.long 0x24804, 0x25278, 0x25d00, 0x267d0
.long 0x24808, 0x2527c, 0x25d40, 0x267d4
.long 0x2480c, 0x25280, 0x25d44, 0x267d8
.long 0x24810, 0x25284, 0x25d48, 0x267dc
.long 0x24814, 0x25288, 0x25d4c, 0x267e0
.long 0x24818, 0x252c8, 0x25d50, 0x267e4
.long 0x2481c, 0x252cc, 0x25d54, 0x26824
.long 0x24820, 0x252d0, 0x25d58, 0x26828
.long 0x24824, 0x252d4, 0x25d5c, 0x2682c
.long 0x24864, 0x252d8, 0x25d60, 0x26830
.long 0x24868, 0x252dc, 0x25da0, 0x26834
.long 0x2486c, 0x252e0, 0x25da4, 0x26838
.long 0x24870, 0x252e4, 0x25da8, 0x2683c
.long 0x24874, 0x252e8, 0x25dac, 0x26840
.long 0x24878, 0x25328, 0x25db0, 0x26844
.long 0x2487c, 0x2532c, 0x25db4, 0x268a8
.long 0x24880, 0x25330, 0x25db8, 0x268ac
.long 0x24884, 0x25334, 0x25dbc, 0x268b0
.long 0x248c4, 0x25338, 0x25dc0, 0x268b4
.long 0x248c8, 0x2533c, 0x25e00, 0x268b8
.long 0x248cc, 0x25340, 0x25e04, 0x268bc
.long 0x248d0, 0x25344, 0x25e08, 0x268c0
.long 0x248d4, 0x25348, 0x25e0c, 0x268c4
.long 0x248d8, 0x25388, 0x25e10, 0x268c8
.long 0x248dc, 0x2538c, 0x25e14, 0x26908
.long 0x248e0, 0x25390, 0x25e18, 0x2690c
.long 0x248e4, 0x25394, 0x25e1c, 0x26910
.long 0x24904, 0x25398, 0x25e20, 0x26914
.long 0x24908, 0x2539c, 0x25e60, 0x26918
.long 0x2490c, 0x253a0, 0x25e64, 0x2691c
.long 0x24910, 0x253a4, 0x25e68, 0x26920
.long 0x24914, 0x253a8, 0x25e6c, 0x26924
.long 0x24918, 0x253e8, 0x25e70, 0x26928
.long 0x2491c, 0x253ec, 0x25e74, 0x26968
.long 0x24920, 0x253f0, 0x25e78, 0x2696c
.long 0x24924, 0x253f4, 0x25e7c, 0x26970
.long 0x24964, 0x253f8, 0x25e80, 0x26974
.long 0x24968, 0x253fc, 0x25ec0, 0x26978
.long 0x2496c, 0x25400, 0x25ec4, 0x2697c
.long 0x24970, 0x25404, 0x25ec8, 0x26980
.long 0x24974, 0x25408, 0x25ecc, 0x26984
.long 0x24978, 0x2546c, 0x25ed0, 0x26988
.long 0x2497c, 0x25470, 0x25ed4, 0x269c8
.long 0x24980, 0x25474, 0x25ed8, 0x269cc
.long 0x24984, 0x25478, 0x25edc, 0x269d0
.long 0x249c4, 0x2547c, 0x25ee0, 0x269d4
.long 0x249c8, 0x25480, 0x25f20, 0x269d8
.long 0x249cc, 0x25484, 0x25f24, 0x269dc
.long 0x249d0, 0x25488, 0x25f28, 0x269e0
.long 0x249d4, 0x2548c, 0x25f2c, 0x269e4
.long 0x249d8, 0x254cc, 0x25f30, 0x269e8
.long 0x249dc, 0x254d0, 0x25f34, 0x26a08
.long 0x249e0, 0x254d4, 0x25f38, 0x26a0c
.long 0x249e4, 0x254d8, 0x25f3c, 0x26a10
.long 0x24a24, 0x254dc, 0x25f40, 0x26a14
.long 0x24a28, 0x254e0, 0x25f80, 0x26a18
.long 0x24a2c, 0x254e4, 0x25f84, 0x26a1c
.long 0x24a30, 0x254e8, 0x25f88, 0x26a20
.long 0x24a34, 0x254ec, 0x25f8c, 0x26a24
.long 0x24a38, 0x2550c, 0x25f90, 0x26a28
.long 0x24a3c, 0x25510, 0x25f94, 0x26a68
.long 0x24a40, 0x25514, 0x25f98, 0x26a6c
.long 0x24a44, 0x25518, 0x25f9c, 0x26a70
.long 0x24a84, 0x2551c, 0x25fa0, 0x26a74
.long 0x24a88, 0x25520, 0x25fe0, 0x26a78
.long 0x24a8c, 0x25524, 0x25fe4, 0x26a7c
.long 0x24a90, 0x25528, 0x25fe8, 0x26a80
.long 0x26a84, 0x27554, 0x24000, 0x0
.long 0x26a88, 0x27558, 0x24010, 0x0
.long 0x26ac8, 0x2755c, 0x24020, 0x0
.long 0x26acc, 0x27560, 0x24030, 0x0
.long 0x26ad0, 0x27564, 0x24040, 0x0
.long 0x26ad4, 0x27568, 0x24050, 0x0
.long 0x26ad8, 0x2756c, 0x24060, 0x0
.long 0x26adc, 0x275ac, 0x24070, 0x0
.long 0x26ae0, 0x275b0, 0x24080, 0x0
.long 0x26ae4, 0x275b4, 0x24090, 0x0
.long 0x26ae8, 0x275b8, 0x240a0, 0x0
.long 0x26b28, 0x275bc, 0x240b0, 0x0
.long 0x26b2c, 0x275c0, 0x240c0, 0x0
.long 0x26b30, 0x275c4, 0x240d0, 0x0
.long 0x26b34, 0x275c8, 0x240e0, 0x0
.long 0x26b38, 0x275cc, 0x240f0, 0x0
.long 0x26b3c, 0x27640, 0x24100, 0x0
.long 0x26b40, 0x27644, 0x24110, 0x0
.long 0x26b44, 0x27648, 0x24120, 0x0
.long 0x26b48, 0x2764c, 0x24130, 0x0
.long 0x26b88, 0x27650, 0x24140, 0x0
.long 0x26b8c, 0x27654, 0x24150, 0x0
.long 0x26b90, 0x27658, 0x24160, 0x0
.long 0x26b94, 0x2765c, 0x24170, 0x0
.long 0x26b98, 0x27660, 0x24180, 0x0
.long 0x26b9c, 0x27664, 0x24190, 0x0
.long 0x26ba0, 0x27668, 0x241a0, 0x0
.long 0x26ba4, 0x2766c, 0x241b0, 0x0
.long 0x26ba8, 0x27670, 0x241c0, 0x0
.long 0x26be8, 0x27674, 0x241d0, 0x0
.long 0x26bec, 0x27678, 0x241e0, 0x0
.long 0x26bf0, 0x2767c, 0x241f0, 0x0
.long 0x26bf4, 0x27680, 0x24200, 0x0
.long 0x26bf8, 0x27684, 0x24210, 0x0
.long 0x26bfc, 0x27688, 0x24220, 0x0
.long 0x26c00, 0x2768c, 0x24230, 0x0
.long 0x26c04, 0x27690, 0x24240, 0x0
.long 0x26c08, 0x27694, 0x24250, 0x0
.long 0x26c48, 0x27698, 0x24260, 0x0
.long 0x26c4c, 0x2769c, 0x24270, 0x0
.long 0x26c50, 0x276a0, 0x24280, 0x0
.long 0x26c54, 0x276a4, 0x24290, 0x0
.long 0x26c58, 0x276a8, 0x242a0, 0x0
.long 0x26c5c, 0x276ac, 0x242b0, 0x0
.long 0x26c60, 0x276b0, 0x242c0, 0x0
.long 0x26c64, 0x276b4, 0x242d0, 0x0
.long 0x26c68, 0x276b8, 0x242e0, 0x0
.long 0x26ca8, 0x276bc, 0x242f0, 0x0
.long 0x26cac, 0x276c0, 0x24300, 0x0
.long 0x26cb0, 0x276c4, 0x24310, 0x0
.long 0x26cb4, 0x276c8, 0x24320, 0x0
.long 0x26cb8, 0x276cc, 0x24330, 0x0
.long 0x26cbc, 0x276d0, 0x24340, 0x0
.long 0x26cc0, 0x276d4, 0x24350, 0x0
.long 0x26cc4, 0x276d8, 0x24360, 0x0
.long 0x26cc8, 0x276dc, 0x24370, 0x0
.long 0x26d08, 0x276e0, 0x24380, 0x0
.long 0x26d0c, 0x276e4, 0x24390, 0x0
.long 0x26d10, 0x276e8, 0x243a0, 0x0
.long 0x26d14, 0x276ec, 0x243b0, 0x0
.long 0x26d18, 0x276f0, 0x243c0, 0x0
.long 0x26d1c, 0x276f4, 0x243d0, 0x0
.long 0x26d20, 0x276f8, 0x243e0, 0x0
.long 0x26d24, 0x276fc, 0x243f0, 0x0
.long 0x26d28, 0x27600, 0x24400, 0x0
.long 0x26d68, 0x27604, 0x24410, 0x0
.long 0x26d6c, 0x27608, 0x24420, 0x0
.long 0x26d70, 0x2760c, 0x24430, 0x0
.long 0x26d74, 0x27610, 0x24440, 0x0
.long 0x26d78, 0x27614, 0x24450, 0x0
.long 0x26d7c, 0x27618, 0x24460, 0x0
.long 0x26d80, 0x2761c, 0x24470, 0x0
.long 0x26d84, 0x27620, 0x24480, 0x0
.long 0x26d88, 0x27624, 0x24490, 0x0
.long 0x26dc8, 0x27628, 0x244a0, 0x0
.long 0x26dcc, 0x2762c, 0x244b0, 0x0
.long 0x26dd0, 0x27630, 0x244c0, 0x0
.long 0x26dd4, 0x27634, 0x244d0, 0x0
.long 0x26dd8, 0x27638, 0x244e0, 0x0
.long 0x26ddc, 0x2763c, 0x244f0, 0x0
.long 0x26de0, 0x27640, 0x24500, 0x0
.long 0x26de4, 0x27644, 0x24510, 0x0
.long 0x26de8, 0x27648, 0x24520, 0x0
.long 0x26e28, 0x2764c, 0x24530, 0x0
.long 0x26e2c, 0x27650, 0x24540, 0x0
.long 0x26e30, 0x27654, 0x24550, 0x0
.long 0x26e34, 0x27658, 0x24560, 0x0
.long 0x26e38, 0x2765c, 0x24570, 0x0
.long 0x26e3c, 0x27660, 0x24580, 0x0
.long 0x26e40, 0x27664, 0x24590, 0x0
.long 0x26e44, 0x27668, 0x245a0, 0x0
.long 0x26e48, 0x2766c, 0x245b0, 0x0
.long 0x26e88, 0x27670, 0x245c0, 0x0
.long 0x26e8c, 0x27674, 0x245d0, 0x0
.long 0x26e90, 0x27678, 0x245e0, 0x0
.long 0x26e94, 0x2767c, 0x245f0, 0x0
.long 0x26e98, 0x27680, 0x24600, 0x0
.long 0x26e9c, 0x27684, 0x24610, 0x0
.long 0x26ea0, 0x27688, 0x24620, 0x0
.long 0x26ea4, 0x2768c, 0x24630, 0x0
.long 0x26ea8, 0x27690, 0x24640, 0x0
.long 0x26ee8, 0x27694, 0x24650, 0x0
.long 0x26eec, 0x27698, 0x24660, 0x0
.long 0x26ef0, 0x2769c, 0x24670, 0x0
.long 0x26ef4, 0x276a0, 0x24680, 0x0
.long 0x26ef8, 0x276a4, 0x24690, 0x0
.long 0x26efc, 0x276a8, 0x246a0, 0x0
.long 0x26f00, 0x276ac, 0x246b0, 0x0
.long 0x26f04, 0x276b0, 0x246c0, 0x0
.long 0x26f08, 0x276b4, 0x246d0, 0x0
.long 0x26f6c, 0x276b8, 0x246e0, 0x0
.long 0x26f70, 0x276bc, 0x246f0, 0x0
.long 0x26f74, 0x276c0, 0x24700, 0x0
.long 0x26f78, 0x276c4, 0x24710, 0x0
.long 0x26f7c, 0x276c8, 0x24720, 0x0
.long 0x26f80, 0x276cc, 0x24730, 0x0
.long 0x26f84, 0x276d0, 0x24740, 0x0
.long 0x26f88, 0x276d4, 0x24750, 0x0
.long 0x26f8c, 0x276d8, 0x24760, 0x0
.long 0x26fcc, 0x276dc, 0x24770, 0x0
.long 0x26fd0, 0x276e0, 0x24780, 0x0
.long 0x26fd4, 0x276e4, 0x24790, 0x0
.long 0x26fd8, 0x276e8, 0x247a0, 0x0
.long 0x26fdc, 0x276ec, 0x247b0, 0x0
.long 0x26fe0, 0x276f0, 0x247c0, 0x0
.long 0x26fe4, 0x276f4, 0x247d0, 0x0
.long 0x26fe8, 0x276f8, 0x247e0, 0x0
.long 0x26fec, 0x276fc, 0x247f0, 0x0
.long 0x2700c, 0x27600, 0x24800, 0x0
.long 0x27010, 0x27604, 0x24810, 0x0
.long 0x27014, 0x27608, 0x24820, 0x0
.long 0x27018, 0x2760c, 0x24830, 0x0
.long 0x2701c, 0x27610, 0x24840, 0x0
.long 0x27020, 0x27614, 0x24850, 0x0
.long 0x27024, 0x27618, 0x24860, 0x0
.long 0x27028, 0x2761c, 0x24870, 0x0
.long 0x2702c, 0x27620, 0x24880, 0x0
.long 0x2706c, 0x27624, 0x24890, 0x0
.long 0x27070, 0x27628, 0x248a0, 0x0
.long 0x27074, 0x2762c, 0x248b0, 0x0
.long 0x27078, 0x27630, 0x248c0, 0x0
.long 0x2707c, 0x27634, 0x248d0, 0x0
.long 0x27080, 0x27638, 0x248e0, 0x0
.long 0x27084, 0x2763c, 0x248f0, 0x0
.long 0x27088, 0x27640, 0x24900, 0x0
.long 0x2708c, 0x27644, 0x24910, 0x0
.long 0x270cc, 0x27648, 0x24920, 0x0
.long 0x270d0, 0x2764c, 0x24930, 0x0
.long 0x270d4, 0x27650, 0x24940, 0x0
.long 0x270d8, 0x27654, 0x24950, 0x0
.long 0x270dc, 0x27658, 0x24960, 0x0
.long 0x270e0, 0x2765c, 0x24970, 0x0
.long 0x270e4, 0x27660, 0x24980, 0x0
.long 0x270e8, 0x27664, 0x24990, 0x0
.long 0x270ec, 0x27668, 0x249a0, 0x0
.long 0x2712c, 0x2766c, 0x249b0, 0x0
.long 0x27130, 0x27670, 0x249c0, 0x0
.long 0x27134, 0x27674, 0x249d0, 0x0
.long 0x27138, 0x27678, 0x249e0, 0x0
.long 0x2713c, 0x2767c, 0x249f0, 0x0
.long 0x27140, 0x27680, 0x24a00, 0x0
.long 0x27144, 0x27684, 0x24a10, 0x0
.long 0x27148, 0x27688, 0x24a20, 0x0
.long 0x2714c, 0x2768c, 0x24a30, 0x0
.long 0x2718c, 0x27690, 0x24a40, 0x0
.long 0x27190, 0x27694, 0x24a50, 0x0
.long 0x27194, 0x27698, 0x24a60, 0x0
.long 0x27198, 0x2769c, 0x24a70, 0x0
.long 0x2719c, 0x276a0, 0x24a80, 0x0
.long 0x271a0, 0x276a4, 0x24a90, 0x0
.long 0x271a4, 0x276a8, 0x24aa0, 0x0
.long 0x271a8, 0x276ac, 0x24ab0, 0x0
.long 0x271ac, 0x276b0, 0x24ac0, 0x0
.long 0x271ec, 0x276b4, 0x24ad0, 0x0
.long 0x271f0, 0x276b8, 0x24ae0, 0x0
.long 0x271f4, 0x276bc, 0x24af0, 0x0
.long 0x271f8, 0x276c0, 0x24b00, 0x0
.long 0x271fc, 0x276c4, 0x24b10, 0x0
.long 0x27200, 0x276c8, 0x24b20, 0x0
.long 0x27204, 0x276cc, 0x24b30, 0x0
.long 0x27208, 0x276d0, 0x24b40, 0x0
.long 0x2720c, 0x276d4, 0x24b50, 0x0
.long 0x2724c, 0x276d8, 0x24b60, 0x0
.long 0x27250, 0x276dc, 0x24b70, 0x0
.long 0x27254, 0x276e0, 0x24b80, 0x0
.long 0x27258, 0x276e4, 0x24b90, 0x0
.long 0x2725c, 0x276e8, 0x24ba0, 0x0
.long 0x27260, 0x276ec, 0x24bb0, 0x0
.long 0x27264, 0x276f0, 0x24bc0, 0x0
.long 0x27268, 0x276f4, 0x24bd0, 0x0
.long 0x2726c, 0x276f8, 0x24be0, 0x0
.long 0x272ac, 0x276fc, 0x24bf0, 0x0
.long 0x272b0, 0x27600, 0x24c00, 0x0
.long 0x272b4, 0x27604, 0x24c10, 0x0
.long 0x272b8, 0x27608, 0x24c20, 0x0
.long 0x272bc, 0x2760c, 0x24c30, 0x0
.long 0x272c0, 0x27610, 0x24c40, 0x0
.long 0x272c4, 0x27614, 0x24c50, 0x0
.long 0x272c8, 0x27618, 0x24c60, 0x0
.long 0x272cc, 0x2761c, 0x24c70, 0x0
.long 0x2730c, 0x27620, 0x24c80, 0x0
.long 0x27310, 0x27624, 0x24c90, 0x0
.long 0x27314, 0x27628, 0x24ca0, 0x0
.long 0x27318, 0x2762c, 0x24cb0, 0x0
.long 0x2731c, 0x27630, 0x24cc0, 0x0
.long 0x27320, 0x27634, 0x24cd0, 0x0
.long 0x27324, 0x27638, 0x24ce0, 0x0
.long 0x27328, 0x2763c, 0x24cf0, 0x0
.long 0x2732c, 0x27640, 0x24d00, 0x0
.long 0x2736c, 0x27644, 0x24d10, 0x0
.long 0x27370, 0x27648, 0x24d20, 0x0
.long 0x27374, 0x2764c, 0x24d30, 0x0
.long 0x27378, 0x27650, 0x24d40, 0x0
.long 0x2737c, 0x27654, 0x24d50, 0x0
.long 0x27380, 0x27658, 0x24d60, 0x0
.long 0x27384, 0x2765c, 0x24d70, 0x0
.long 0x27388, 0x27660, 0x24d80, 0x0
.long 0x2738c, 0x27664, 0x24d90, 0x0
.long 0x273cc, 0x27668, 0x24da0, 0x0
.long 0x273d0, 0x2766c, 0x24db0, 0x0
.long 0x273d4, 0x27670, 0x24dc0, 0x0
.long 0x273d8, 0x27674, 0x24dd0, 0x0
.long 0x273dc, 0x27678, 0x24de0, 0x0
.long 0x273e0, 0x2767c, 0x24df0, 0x0
.long 0x273e4, 0x27680, 0x24e00, 0x0
.long 0x273e8, 0x27684, 0x24e10, 0x0
.long 0x273ec, 0x27688, 0x24e20, 0x0
.long 0x2742c, 0x2768c, 0x24e30, 0x0
.long 0x27430, 0x27690, 0x24e40, 0x0
.long 0x27434, 0x27694, 0x24e50, 0x0
.long 0x27438, 0x27698, 0x24e60, 0x0
.long 0x2743c, 0x2769c, 0x24e70, 0x0
.long 0x27440, 0x276a0, 0x24e80, 0x0
.long 0x27444, 0x276a4, 0x24e90, 0x0
.long 0x27448, 0x276a8, 0x24ea0, 0x0
.long 0x2744c, 0x276ac, 0x24eb0, 0x0
.long 0x2748c, 0x276b0, 0x24ec0, 0x0
.long 0x27490, 0x276b4, 0x24ed0, 0x0
.long 0x27494, 0x276b8, 0x24ee0, 0x0
.long 0x27498, 0x276bc, 0x24ef0, 0x0
.long 0x2749c, 0x276c0, 0x24f00, 0x0
.long 0x274a0, 0x276c4, 0x24f10, 0x0
.long 0x274a4, 0x276c8, 0x24f20, 0x0
.long 0x274a8, 0x276cc, 0x24f30, 0x0
.long 0x274ac, 0x276d0, 0x24f40, 0x0
.long 0x274ec, 0x276d4, 0x24f50, 0x0
.long 0x274f0, 0x276d8, 0x24f60, 0x0
.long 0x274f4, 0x276dc, 0x24f70, 0x0
.long 0x274f8, 0x276e0, 0x24f80, 0x0
.long 0x274fc, 0x276e4, 0x24f90, 0x0
.long 0x27500, 0x276e8, 0x24fa0, 0x0
.long 0x27504, 0x276ec, 0x24fb0, 0x0
.long 0x27508, 0x276f0, 0x24fc0, 0x0
.long 0x2750c, 0x276f4, 0x24fd0, 0x0
.long 0x2754c, 0x276f8, 0x24fe0, 0x0
.long 0x27550, 0x276fc, 0x24ff0, 0x0
.long 0x0, 0x0, 0x0, 0x0
.long 0x2800, 0x0, 0x0, 0x0
.long 0x5000, 0x0, 0x0, 0x0
.long 0x7800, 0x0, 0x0, 0x0
.long 0xc800, 0x0, 0x0, 0x0
.long 0xf000, 0x0, 0x0, 0x0
.long 0x11800, 0x0, 0x0, 0x0
.long 0x14000, 0x0, 0x0, 0x0
.long 0x19000, 0x0, 0x0, 0x0
.long 0x1b800, 0x0, 0x0, 0x0
.long 0x1b800, 0x0, 0x0, 0x0
.long 0x1b800, 0x0, 0x0, 0x0
.long 0x1b800, 0x0, 0x0, 0x0
.long 0x1b800, 0x0, 0x0, 0x0
.long 0x1b800, 0x0, 0x0, 0x0
.long 0x1b800, 0x0, 0x0, 0x0
.long 0x1b800, 0x0, 0x0, 0x0
.long 0x1b800, 0x0, 0x0, 0x0
.long 0x1b800, 0x0, 0x0, 0x0
.long 0x1b800, 0x0, 0x0, 0x0
.long 0x1b800, 0x0, 0x0, 0x0
.long 0x1b800, 0x0, 0x0, 0x0
.long 0x1b800, 0x0, 0x0, 0x0
.long 0x1b800, 0x0, 0x0, 0x0
.long 0x1b800, 0x0, 0x0, 0x0
.long 0x1b800, 0x0, 0x0, 0x0
.long 0x1b800, 0x0, 0x0, 0x0
.long 0x1b800, 0x0, 0x0, 0x0
.long 0x1b800, 0x0, 0x0, 0x0
.long 0x1b800, 0x0, 0x0, 0x0
.long 0x1b800, 0x0, 0x0, 0x0
.long 0x1b800, 0x0, 0x0, 0x0
.long 0x1b800, 0x0, 0x0, 0x0
.long 0x1b800, 0x0, 0x0, 0x0
.long 0x1b800, 0x0, 0x0, 0x0
.long 0x1b800, 0x0, 0x0, 0x0
.long 0x1b800, 0x0, 0x0, 0x0
.long 0x1b800, 0x0, 0x0, 0x0
.long 0x1b800, 0x0, 0x0, 0x0
.long 0x1b800, 0x0, 0x0, 0x0
.long 0x1b800, 0x0, 0x0, 0x0
.long 0x1b800, 0x0, 0x0, 0x0
.long 0x1b800, 0x0, 0x0, 0x0
.long 0x1b800, 0x0, 0x0, 0x0
.long 0x1b800, 0x0, 0x0, 0x0
.long 0x1b800, 0x0, 0x0, 0x0
.long 0x1b800, 0x0, 0x0, 0x0
.long 0x1b800, 0x0, 0x0, 0x0
.long 0x1b800, 0x0, 0x0, 0x0
.long 0x1b800, 0x0, 0x0, 0x0
.long 0x1b800, 0x0, 0x0, 0x0
.long 0x1b800, 0x0, 0x0, 0x0
.long 0x1b800, 0x0, 0x0, 0x0
.long 0x1b800, 0x0, 0x0, 0x0
.long 0x1b800, 0x0, 0x0, 0x0
.long 0x1b800, 0x0, 0x0, 0x0
.long 0x1b800, 0x0, 0x0, 0x0
.long 0x1b800, 0x0, 0x0, 0x0
.long 0x1b800, 0x0, 0x0, 0x0
.long 0x1b800, 0x0, 0x0, 0x0
.long 0x1b800, 0x0, 0x0, 0x0
.long 0x1b800, 0x0, 0x0, 0x0
.long 0x1b800, 0x0, 0x0, 0x0
.long 0x1b800, 0x0, 0x0, 0x0
.long 0x1e000, 0x0, 0x0, 0x0
.long 0x20800, 0x0, 0x0, 0x0
.long 0x25800, 0x0, 0x0, 0x0
.long 0x80, 0x0, 0x0, 0x0
.long 0x2880, 0x0, 0x0, 0x0
.long 0x5080, 0x0, 0x0, 0x0
.long 0xa080, 0x0, 0x0, 0x0
.long 0xc880, 0x0, 0x0, 0x0
.long 0xf080, 0x0, 0x0, 0x0
.long 0x11880, 0x0, 0x0, 0x0
.long 0x11880, 0x0, 0x0, 0x0
.long 0x11880, 0x0, 0x0, 0x0
.long 0x11880, 0x0, 0x0, 0x0
.long 0x11880, 0x0, 0x0, 0x0
.long 0x11880, 0x0, 0x0, 0x0
.long 0x11880, 0x0, 0x0, 0x0
.long 0x11880, 0x0, 0x0, 0x0
.long 0x11880, 0x0, 0x0, 0x0
.long 0x11880, 0x0, 0x0, 0x0
.long 0x11880, 0x0, 0x0, 0x0
.long 0x11880, 0x0, 0x0, 0x0
.long 0x11880, 0x0, 0x0, 0x0
.long 0x11880, 0x0, 0x0, 0x0
.long 0x11880, 0x0, 0x0, 0x0
.long 0x11880, 0x0, 0x0, 0x0
.long 0x11880, 0x0, 0x0, 0x0
.long 0x11880, 0x0, 0x0, 0x0
.long 0x11880, 0x0, 0x0, 0x0
.long 0x11880, 0x0, 0x0, 0x0
.long 0x11880, 0x0, 0x0, 0x0
.long 0x11880, 0x0, 0x0, 0x0
.long 0x11880, 0x0, 0x0, 0x0
.long 0x11880, 0x0, 0x0, 0x0
.long 0x11880, 0x0, 0x0, 0x0
.long 0x11880, 0x0, 0x0, 0x0
.long 0x11880, 0x0, 0x0, 0x0
.long 0x11880, 0x0, 0x0, 0x0
.long 0x11880, 0x0, 0x0, 0x0
.long 0x11880, 0x0, 0x0, 0x0
.long 0x11880, 0x0, 0x0, 0x0
.long 0x11880, 0x0, 0x0, 0x0
.long 0x11880, 0x0, 0x0, 0x0
.long 0x11880, 0x0, 0x0, 0x0
.long 0x11880, 0x0, 0x0, 0x0
.long 0x11880, 0x0, 0x0, 0x0
.long 0x11880, 0x0, 0x0, 0x0
.long 0x11880, 0x0, 0x0, 0x0
.long 0x11880, 0x0, 0x0, 0x0
.long 0x11880, 0x0, 0x0, 0x0
.long 0x11880, 0x0, 0x0, 0x0
.long 0x11880, 0x0, 0x0, 0x0
.long 0x11880, 0x0, 0x0, 0x0
.long 0x11880, 0x0, 0x0, 0x0
.long 0x11880, 0x0, 0x0, 0x0
.long 0x11880, 0x0, 0x0, 0x0
.long 0x11880, 0x0, 0x0, 0x0
.long 0x11880, 0x0, 0x0, 0x0
.long 0x11880, 0x0, 0x0, 0x0
.long 0x11880, 0x0, 0x0, 0x0
.long 0x11880, 0x0, 0x0, 0x0
.long 0x11880, 0x0, 0x0, 0x0
.long 0x11880, 0x0, 0x0, 0x0
.long 0x11880, 0x0, 0x0, 0x0
.long 0x11880, 0x0, 0x0, 0x0
.long 0x16880, 0x0, 0x0, 0x0
.long 0x19080, 0x0, 0x0, 0x0
.long 0x1b880, 0x0, 0x0, 0x0
.long 0x1e080, 0x0, 0x0, 0x0
.long 0x23080, 0x0, 0x0, 0x0
.long 0x25880, 0x0, 0x0, 0x0
.long 0x100, 0x0, 0x0, 0x0
.long 0x2900, 0x0, 0x0, 0x0
.long 0x7900, 0x0, 0x0, 0x0
.long 0xa100, 0x0, 0x0, 0x0
.long 0xa100, 0x0, 0x0, 0x0
.long 0xa100, 0x0, 0x0, 0x0
.long 0xa100, 0x0, 0x0, 0x0
.long 0xa100, 0x0, 0x0, 0x0
.long 0xa100, 0x0, 0x0, 0x0
.long 0xa100, 0x0, 0x0, 0x0
.long 0xa100, 0x0, 0x0, 0x0
.long 0xa100, 0x0, 0x0, 0x0
.long 0xa100, 0x0, 0x0, 0x0
.long 0xa100, 0x0, 0x0, 0x0
.long 0xa100, 0x0, 0x0, 0x0
.long 0xa100, 0x0, 0x0, 0x0
.long 0xa100, 0x0, 0x0, 0x0
.long 0xa100, 0x0, 0x0, 0x0
.long 0xa100, 0x0, 0x0, 0x0
.long 0xa100, 0x0, 0x0, 0x0
.long 0xa100, 0x0, 0x0, 0x0
.long 0xa100, 0x0, 0x0, 0x0
.long 0xa100, 0x0, 0x0, 0x0
.long 0xa100, 0x0, 0x0, 0x0
.long 0xa100, 0x0, 0x0, 0x0
.long 0xa100, 0x0, 0x0, 0x0
.long 0xa100, 0x0, 0x0, 0x0
.long 0xa100, 0x0, 0x0, 0x0
.long 0xa100, 0x0, 0x0, 0x0
.long 0xa100, 0x0, 0x0, 0x0
.long 0xa100, 0x0, 0x0, 0x0
.long 0xa100, 0x0, 0x0, 0x0
.long 0xa100, 0x0, 0x0, 0x0
.long 0xa100, 0x0, 0x0, 0x0
.long 0xa100, 0x0, 0x0, 0x0
.long 0xa100, 0x0, 0x0, 0x0
.long 0xa100, 0x0, 0x0, 0x0
.long 0xa100, 0x0, 0x0, 0x0
.long 0xa100, 0x0, 0x0, 0x0
.long 0xa100, 0x0, 0x0, 0x0
.long 0xa100, 0x0, 0x0, 0x0
.long 0xa100, 0x0, 0x0, 0x0
.long 0xa100, 0x0, 0x0, 0x0
.long 0xa100, 0x0, 0x0, 0x0
.long 0xa100, 0x0, 0x0, 0x0
.long 0xa100, 0x0, 0x0, 0x0
.long 0xa100, 0x0, 0x0, 0x0
.long 0xa100, 0x0, 0x0, 0x0
.long 0xa100, 0x0, 0x0, 0x0
.long 0xa100, 0x0, 0x0, 0x0
.long 0xa100, 0x0, 0x0, 0x0
.long 0xa100, 0x0, 0x0, 0x0
.long 0xa100, 0x0, 0x0, 0x0
.long 0xa100, 0x0, 0x0, 0x0
.long 0xa100, 0x0, 0x0, 0x0
.long 0xa100, 0x0, 0x0, 0x0
.long 0xa100, 0x0, 0x0, 0x0
.long 0xa100, 0x0, 0x0, 0x0
.long 0xc900, 0x0, 0x0, 0x0
.long 0xf100, 0x0, 0x0, 0x0
.long 0xa000, 0x0, 0x0, 0x0
.long 0x16800, 0x0, 0x0, 0x0
.long 0x23000, 0x0, 0x0, 0x0
.long 0x7880, 0x0, 0x0, 0x0
.long 0x14080, 0x0, 0x0, 0x0
.long 0x20880, 0x0, 0x0, 0x0
.long 0x5100, 0x0, 0x0, 0x0
.long 0x11900, 0x0, 0x0, 0x0
.long 0x11900, 0x0, 0x0, 0x0
.long 0x11900, 0x0, 0x0, 0x0
.long 0x11900, 0x0, 0x0, 0x0
.long 0x11900, 0x0, 0x0, 0x0
.long 0x11900, 0x0, 0x0, 0x0
.long 0x11900, 0x0, 0x0, 0x0
.long 0x11900, 0x0, 0x0, 0x0
.long 0x11900, 0x0, 0x0, 0x0
.long 0x11900, 0x0, 0x0, 0x0
.long 0x11900, 0x0, 0x0, 0x0
.long 0x11900, 0x0, 0x0, 0x0
.long 0x11900, 0x0, 0x0, 0x0
.long 0x11900, 0x0, 0x0, 0x0
.long 0x11900, 0x0, 0x0, 0x0
.long 0x11900, 0x0, 0x0, 0x0
.long 0x11900, 0x0, 0x0, 0x0
.long 0x11900, 0x0, 0x0, 0x0
.long 0x11900, 0x0, 0x0, 0x0
.long 0x11900, 0x0, 0x0, 0x0
.long 0x11900, 0x0, 0x0, 0x0
.long 0x11900, 0x0, 0x0, 0x0
.long 0x11900, 0x0, 0x0, 0x0
.long 0x11900, 0x0, 0x0, 0x0
.long 0x11900, 0x0, 0x0, 0x0
.long 0x11900, 0x0, 0x0, 0x0
.long 0x11900, 0x0, 0x0, 0x0
.long 0x11900, 0x0, 0x0, 0x0
.long 0x11900, 0x0, 0x0, 0x0
.long 0x11900, 0x0, 0x0, 0x0
.long 0x11900, 0x0, 0x0, 0x0
.long 0x11900, 0x0, 0x0, 0x0
.long 0x11900, 0x0, 0x0, 0x0
.long 0x11900, 0x0, 0x0, 0x0
.long 0x11900, 0x0, 0x0, 0x0
.long 0x11900, 0x0, 0x0, 0x0
.long 0x11900, 0x0, 0x0, 0x0
.long 0x11900, 0x0, 0x0, 0x0
.long 0x11900, 0x0, 0x0, 0x0
.long 0x11900, 0x0, 0x0, 0x0
.long 0x11900, 0x0, 0x0, 0x0
.long 0x11900, 0x0, 0x0, 0x0
.long 0x11900, 0x0, 0x0, 0x0
.long 0x11900, 0x0, 0x0, 0x0
.long 0x11900, 0x0, 0x0, 0x0
.long 0x11900, 0x0, 0x0, 0x0
.long 0x11900, 0x0, 0x0, 0x0
.long 0x11900, 0x0, 0x0, 0x0
.long 0x11900, 0x0, 0x0, 0x0
.long 0x11900, 0x0, 0x0, 0x0
.long 0x11900, 0x0, 0x0, 0x0
.long 0x11900, 0x0, 0x0, 0x0
.long 0x11900, 0x0, 0x0, 0x0
.long 0x11900, 0x0, 0x0, 0x0
.long 0x11900, 0x0, 0x0, 0x0
L_tabend:
.section .rodata,"a"
.p2align 6
.amdhsa_kernel recurrent_scan__linear_kernel_hedgehog__dense_activation_silu__prompt_kernel
  .amdhsa_next_free_vgpr 512
  .amdhsa_next_free_sgpr 102
  .amdhsa_accum_offset 256
  .amdhsa_group_segment_fixed_size 0
  .amdhsa_kernarg_size 80
  .amdhsa_user_sgpr_count 2
  .amdhsa_user_sgpr_kernarg_segment_ptr 1
  .amdhsa_system_sgpr_workgroup_id_x 1
.end_amdhsa_kernel
```
